```python
import torch

def _softmax(x, axis=-1):
    return torch.softmax(x, dim=axis)
def _gelu(x):
    return torch.nn.functional.gelu(x, approximate="tanh")
def _silu(x):
    return torch.nn.functional.silu(x)
def _sigmoid(x):
    return torch.sigmoid(x)
def _layernorm(x, axis=-1, eps=1e-5):
    m = x.mean(dim=axis, keepdim=True)
    v = x.var(dim=axis, keepdim=True, unbiased=False)
    return (x - m) / torch.sqrt(v + eps)
def _scatter_add(tgt, idx, src, axis=0):
    return tgt.clone().index_add_(axis, idx, src)
def _segment_sum(src, seg, n):
    out = torch.zeros((n,) + src.shape[1:], dtype=src.dtype)
    return out.index_add_(0, seg, src)
def _pad(x, pw):
    flat = tuple(v for pair in reversed(pw) for v in pair)
    return torch.nn.functional.pad(x, flat)

kernel_name = 'sequential_preLN__sliding_block_cached__glu_gated_swiglu__decode'

def setup_inputs():

    _w = (lambda a: (lambda t: t.to(torch.bfloat16) if t.is_floating_point() else t)(torch.as_tensor(a)))
    def _A_setup():
        B, Sq, D = 1, 1, 640
        Hq, Hkv, Sk, Dh = 32, 32, 32768, 192
        assert Hq % Hkv == 0, (Hq, Hkv)
        return {
            "x": _w((lambda *s: torch.randn(*s, dtype=torch.bfloat16) * 0.05)(B, Sq, D)),
            "k_cache": _w((lambda *s: torch.randn(*s, dtype=torch.bfloat16) * 1.6)(B, Hkv, Sk, Dh)),
            "v_cache": _w((lambda *s: torch.randn(*s, dtype=torch.bfloat16) * 0.8)(B, Hkv, Sk, Dh)),
            "wq": _w((lambda *s: torch.randn(*s, dtype=torch.bfloat16) * 1.6)(D, Hq * Dh) * (D ** -0.5)),
            "wo": _w((lambda *s: torch.randn(*s, dtype=torch.bfloat16) * 0.8)(Hq * Dh, D) * ((Hq * Dh) ** -0.5)),
        }
    _A_in = _A_setup()

    def _B_setup():
        B, S, D, F = 1, 1, 640, 1536
        return {
            "x": _w((lambda *s: torch.randn(*s, dtype=torch.bfloat16) * 0.05)(B, S, D)),
            "w1": _w((lambda *s: torch.randn(*s, dtype=torch.bfloat16) * 0.4)(D, F) * (2.0 / D) ** 0.5),
            "w3": _w((lambda *s: torch.randn(*s, dtype=torch.bfloat16) * 0.4)(D, F) * (2.0 / D) ** 0.5),
            "w2": _w((lambda *s: torch.randn(*s, dtype=torch.bfloat16) * 0.4)(F, D) * (2.0 / F) ** 0.5),
        }
    _B_in = _B_setup()

    return {
        "A_x": _A_in["x"],
        "A_k_cache": _A_in["k_cache"],
        "A_v_cache": _A_in["v_cache"],
        "A_wq": _A_in["wq"],
        "A_wo": _A_in["wo"],
        "B_x": _B_in["x"],
        "B_w1": _B_in["w1"],
        "B_w3": _B_in["w3"],
        "B_w2": _B_in["w2"],
    }

def reference(A_x, A_k_cache, A_v_cache, A_wq, A_wo, B_x, B_w1, B_w3, B_w2):
    def _A_ref(x, k_cache, v_cache, wq, wo):
        B, Sq, D = x.shape
        Hq, Dh = 32, 192
        Hkv, Sk = k_cache.shape[1], k_cache.shape[2]
        W = min(4096, max(256, Sk // 4))
        rep = Hq // Hkv
        q = (lambda x, *d: x.permute(*d))((x @ wq).reshape(B, Sq, Hq, Dh), 0, 2, 1, 3)
        k = (lambda x, n, axis: torch.repeat_interleave(x, n, dim=axis))(k_cache[:, :, Sk - W:, :], rep, axis=1)
        v = (lambda x, n, axis: torch.repeat_interleave(x, n, dim=axis))(v_cache[:, :, Sk - W:, :], rep, axis=1)
        scores = torch.einsum("bhqd,bhkd->bhqk", q, k) * (Dh ** -0.5)
        p = _softmax(scores, axis=-1)
        o = torch.einsum("bhqk,bhkd->bhqd", p, v)
        return (lambda x, *d: x.permute(*d))(o, 0, 2, 1, 3).reshape(B, Sq, Hq * Dh) @ wo

    def _B_ref(x, w1, w3, w2):
        gate = torch.einsum("bsd,df->bsf", x, w1)
        up = torch.einsum("bsd,df->bsf", x, w3)
        h = _silu(gate) * up
        out = torch.einsum("bsf,fd->bsd", h, w2)
        return out

    x = A_x
    h = x + _A_ref(_layernorm(x, axis=-1), A_k_cache, A_v_cache, A_wq, A_wo)
    h2 = h + _B_ref(_layernorm(h, axis=-1), B_w1, B_w3, B_w2)
    return h2
```

```asm
; @launch grid=(256,1,1) block=(768,1,1) lds=57856
.amdgcn_target "amdgcn-amd-amdhsa--gfx950"
.text
.globl sequential_preLN__sliding_block_cached__glu_gated_swiglu__decode_kernel
.p2align 8
.type sequential_preLN__sliding_block_cached__glu_gated_swiglu__decode_kernel,@function
sequential_preLN__sliding_block_cached__glu_gated_swiglu__decode_kernel:
  s_cmp_ge_u32 s2, 256
  s_cbranch_scc1 L_end
  s_load_dwordx2 s[8:9], s[0:1], 8
  s_load_dwordx16 s[36:51], s[0:1], 0
  s_load_dwordx8 s[52:59], s[0:1], 64
  v_lshrrev_b32 v1, 6, v0
  v_and_b32 v0, 63, v0
  v_readfirstlane_b32 s3, v1
  s_and_b32 s4, s2, 7
  s_lshr_b32 s79, s2, 6
  s_lshl2_add_u32 s6, s4, s79
  s_bfe_u32 s7, s2, 0x30003
  s_cmp_lg_u32 s3, 0
  s_cbranch_scc1 L_nocpf
  s_getpc_b64 s[20:21]
L_pc0:
  s_mul_i32 s68, s7, 2048
  v_min_u32 v8, 15, v0
  v_lshl_add_u32 v8, v8, 7, s68
  v_min_u32 v8, L_codeend-L_pc0-4, v8
  global_load_dword v10, v8, s[20:21]
L_nocpf:
  v_lshrrev_b32 v2, 3, v0
  v_and_b32 v3, 7, v0
  v_lshlrev_b32 v3, 4, v3
  s_mov_b32 s11, 0x20000
  s_cmp_gt_u32 s3, 7
  s_cbranch_scc1 L_helper
  s_lshl3_add_u32 s68, s7, s3
  s_mul_i32 s60, s6, 4096
  s_add_u32 s60, s60, s68
  s_addk_i32 s60, 3584
  s_mul_i32 s60, s60, 3072
  v_mul_u32_u24 v2, 384, v2
  v_add_u32 v1, v2, v3
  s_mov_b32 s10, 402653184
  s_waitcnt lgkmcnt(0)
  buffer_load_dwordx4 v[16:19], v1, s[8:11], s60 offen offset:0 nt
  buffer_load_dwordx4 v[20:23], v1, s[8:11], s60 offen offset:128 nt
  buffer_load_dwordx4 v[24:27], v1, s[8:11], s60 offen offset:256 nt
  s_barrier
  s_branch L_stream
L_helper:
  v_lshlrev_b32 v1, 3, v0
  v_mov_b32 v4, 0
  v_mov_b32 v5, 0
  ds_write_b64 v1, v[4:5] offset:384
  s_sub_u32 s73, s3, 8
  s_cmp_eq_u32 s3, 11
  s_cbranch_scc1 L_misc
  s_mul_i32 s68, s7, 80
  v_add_u32 v7, s68, v2
  v_lshlrev_b32 v7, 1, v7
  v_mul_u32_u24 v2, 12288, v2
  v_add_u32 v2, v2, v3
  s_mul_i32 s68, s68, 12288
  s_mul_i32 s69, s6, 384
  s_add_u32 s68, s68, s69
  s_lshl_b32 s69, s73, 7
  s_add_u32 s68, s68, s69
  v_lshlrev_b32 v1, 2, v0
  s_setprio 3
  s_waitcnt lgkmcnt(0)
  s_barrier
  s_mov_b32 s8, s42
  s_mov_b32 s9, s43
  s_mov_b32 s10, 7864320
  global_load_dword v64, v1, s[36:37] offset:0
  global_load_dword v65, v1, s[36:37] offset:256
  global_load_dword v66, v1, s[36:37] offset:512
  global_load_dword v67, v1, s[36:37] offset:768
  global_load_dword v68, v1, s[36:37] offset:1024
  global_load_ushort v8, v7, s[36:37] offset:0
  global_load_ushort v9, v7, s[36:37] offset:16
  global_load_ushort v10, v7, s[36:37] offset:32
  global_load_ushort v11, v7, s[36:37] offset:48
  global_load_ushort v12, v7, s[36:37] offset:64
  global_load_ushort v13, v7, s[36:37] offset:80
  global_load_ushort v14, v7, s[36:37] offset:96
  global_load_ushort v15, v7, s[36:37] offset:112
  global_load_ushort v16, v7, s[36:37] offset:128
  global_load_ushort v17, v7, s[36:37] offset:144
  buffer_load_dwordx4 v[24:27], v2, s[8:11], s68 offen nt
  s_add_u32 s68, s68, 98304
  buffer_load_dwordx4 v[28:31], v2, s[8:11], s68 offen nt
  s_add_u32 s68, s68, 98304
  buffer_load_dwordx4 v[32:35], v2, s[8:11], s68 offen nt
  s_add_u32 s68, s68, 98304
  buffer_load_dwordx4 v[36:39], v2, s[8:11], s68 offen nt
  s_add_u32 s68, s68, 98304
  buffer_load_dwordx4 v[40:43], v2, s[8:11], s68 offen nt
  s_add_u32 s68, s68, 98304
  buffer_load_dwordx4 v[44:47], v2, s[8:11], s68 offen nt
  s_add_u32 s68, s68, 98304
  buffer_load_dwordx4 v[48:51], v2, s[8:11], s68 offen nt
  s_add_u32 s68, s68, 98304
  buffer_load_dwordx4 v[52:55], v2, s[8:11], s68 offen nt
  s_add_u32 s68, s68, 98304
  buffer_load_dwordx4 v[56:59], v2, s[8:11], s68 offen nt
  s_add_u32 s68, s68, 98304
  buffer_load_dwordx4 v[60:63], v2, s[8:11], s68 offen nt
  s_load_dwordx2 s[28:29], s[58:59], 1044480
  s_branch L_q2
L_misc:
  s_setprio 3
  s_waitcnt lgkmcnt(0)
  s_barrier
  s_load_dwordx2 s[28:29], s[58:59], 1044480
  s_branch L_misc2
L_stream:
  s_add_u32 s61, s60, 196608
  s_waitcnt vmcnt(2)
  buffer_load_dwordx4 v[28:31], v1, s[8:11], s61 offen offset:0 nt
  s_load_dwordx2 s[28:29], s[58:59], 1044480
  s_mov_b32 s24, s58
  s_mov_b32 s25, s59
  s_mov_b32 s26, 4194304
  s_mov_b32 s27, 0x20000
  s_add_u32 s32, s58, 4194304
  s_addc_u32 s33, s59, 0
  s_mov_b32 s34, 4194304
  s_mov_b32 s35, 0x20000
  s_lshl3_add_u32 s71, s6, s7
  s_lshr_b32 s79, s2, 3
  s_mov_b32 s12, s40
  s_mov_b32 s13, s41
  s_mov_b32 s14, 402653184
  s_mov_b32 s15, 0x20000
  s_waitcnt vmcnt(2)
  buffer_load_dwordx4 v[32:35], v1, s[8:11], s61 offen offset:128 nt
  s_waitcnt vmcnt(2)
  buffer_load_dwordx4 v[36:39], v1, s[8:11], s61 offen offset:256 nt
  s_add_u32 s62, s61, 196608
  s_waitcnt vmcnt(2)
  buffer_load_dwordx4 v[40:43], v1, s[8:11], s62 offen offset:0 nt
  s_waitcnt vmcnt(2)
  buffer_load_dwordx4 v[44:47], v1, s[8:11], s62 offen offset:128 nt
  s_waitcnt vmcnt(2)
  buffer_load_dwordx4 v[48:51], v1, s[8:11], s62 offen offset:256 nt
  s_add_u32 s63, s62, 196608
  s_waitcnt vmcnt(2)
  buffer_load_dwordx4 v[52:55], v1, s[8:11], s63 offen offset:0 nt
  s_waitcnt vmcnt(2)
  buffer_load_dwordx4 v[56:59], v1, s[8:11], s63 offen offset:128 nt
  s_waitcnt vmcnt(2)
  buffer_load_dwordx4 v[60:63], v1, s[8:11], s63 offen offset:256 nt
  s_add_u32 s64, s63, 196608
  s_waitcnt vmcnt(2)
  buffer_load_dwordx4 v[64:67], v1, s[8:11], s64 offen offset:0 nt
  s_waitcnt vmcnt(2)
  buffer_load_dwordx4 v[68:71], v1, s[8:11], s64 offen offset:128 nt
  s_waitcnt vmcnt(2)
  buffer_load_dwordx4 v[72:75], v1, s[8:11], s64 offen offset:256 nt
  s_add_u32 s65, s64, 196608
  s_waitcnt vmcnt(2)
  buffer_load_dwordx4 v[76:79], v1, s[8:11], s65 offen offset:0 nt
  s_waitcnt vmcnt(2)
  buffer_load_dwordx4 v[80:83], v1, s[8:11], s65 offen offset:128 nt
  s_waitcnt vmcnt(2)
  buffer_load_dwordx4 v[84:87], v1, s[8:11], s65 offen offset:256 nt
  s_add_u32 s66, s65, 196608
  s_waitcnt vmcnt(2)
  buffer_load_dwordx4 v[88:91], v1, s[8:11], s66 offen offset:0 nt
  s_waitcnt vmcnt(2)
  buffer_load_dwordx4 v[92:95], v1, s[8:11], s66 offen offset:128 nt
  s_waitcnt vmcnt(2)
  buffer_load_dwordx4 v[96:99], v1, s[8:11], s66 offen offset:256 nt
  s_add_u32 s67, s66, 196608
  s_waitcnt vmcnt(2)
  buffer_load_dwordx4 v[100:103], v1, s[8:11], s67 offen offset:0 nt
  s_waitcnt vmcnt(2)
  buffer_load_dwordx4 v[104:107], v1, s[8:11], s67 offen offset:128 nt
  s_waitcnt vmcnt(2)
  buffer_load_dwordx4 v[108:111], v1, s[8:11], s67 offen offset:256 nt
  s_waitcnt vmcnt(2)
  buffer_load_dwordx4 v[112:115], v1, s[12:15], s60 offen offset:0 nt
  s_waitcnt vmcnt(2)
  buffer_load_dwordx4 v[116:119], v1, s[12:15], s60 offen offset:128 nt
  s_waitcnt vmcnt(2)
  buffer_load_dwordx4 v[120:123], v1, s[12:15], s60 offen offset:256 nt
  s_waitcnt lgkmcnt(0)
  s_mul_i32 s30, s28, 0x2c9277b5
  s_add_u32 s30, s30, 0xac564b05
  s_mul_i32 s31, s29, 0x0019660d
  s_add_u32 s31, s31, 0x3c6ef35f
  v_and_b32 v2, 3, v0
  v_min_u32 v2, 2, v2
  v_lshlrev_b32 v2, 3, v2
  s_mov_b32 s70, 200007
L_spin_1:
  ds_read_b32 v4, v2 offset:384
  s_waitcnt lgkmcnt(0)
  v_cmp_eq_u32 vcc, 0, v4
  s_nop 0
  s_cbranch_vccz L_sdone_2
  s_sleep 1
  s_sub_u32 s70, s70, 1
  s_cbranch_scc0 L_spin_1
L_sdone_2:
  ds_read_b128 v[4:7], v3 offset:0
  ds_read_b128 v[8:11], v3 offset:128
  ds_read_b128 v[12:15], v3 offset:256
  v_mov_b32 v160, 0
  v_mov_b32 v161, 0
  v_mov_b32 v162, 0
  v_mov_b32 v163, 0
  v_mov_b32 v164, 0
  v_mov_b32 v165, 0
  v_mov_b32 v166, 0
  v_mov_b32 v167, 0
  s_waitcnt vmcnt(3) lgkmcnt(0)
  v_dot2c_f32_bf16 v160, v16, v4
  v_dot2c_f32_bf16 v161, v28, v4
  v_dot2c_f32_bf16 v162, v40, v4
  v_dot2c_f32_bf16 v163, v52, v4
  v_dot2c_f32_bf16 v160, v17, v5
  v_dot2c_f32_bf16 v161, v29, v5
  v_dot2c_f32_bf16 v162, v41, v5
  v_dot2c_f32_bf16 v163, v53, v5
  v_dot2c_f32_bf16 v160, v18, v6
  v_dot2c_f32_bf16 v161, v30, v6
  v_dot2c_f32_bf16 v162, v42, v6
  v_dot2c_f32_bf16 v163, v54, v6
  v_dot2c_f32_bf16 v160, v19, v7
  v_dot2c_f32_bf16 v161, v31, v7
  v_dot2c_f32_bf16 v162, v43, v7
  v_dot2c_f32_bf16 v163, v55, v7
  v_dot2c_f32_bf16 v160, v20, v8
  v_dot2c_f32_bf16 v161, v32, v8
  v_dot2c_f32_bf16 v162, v44, v8
  v_dot2c_f32_bf16 v163, v56, v8
  v_dot2c_f32_bf16 v160, v21, v9
  v_dot2c_f32_bf16 v161, v33, v9
  v_dot2c_f32_bf16 v162, v45, v9
  v_dot2c_f32_bf16 v163, v57, v9
  v_dot2c_f32_bf16 v160, v22, v10
  v_dot2c_f32_bf16 v161, v34, v10
  v_dot2c_f32_bf16 v162, v46, v10
  v_dot2c_f32_bf16 v163, v58, v10
  v_dot2c_f32_bf16 v160, v23, v11
  v_dot2c_f32_bf16 v161, v35, v11
  v_dot2c_f32_bf16 v162, v47, v11
  v_dot2c_f32_bf16 v163, v59, v11
  v_dot2c_f32_bf16 v160, v24, v12
  v_dot2c_f32_bf16 v161, v36, v12
  v_dot2c_f32_bf16 v162, v48, v12
  v_dot2c_f32_bf16 v163, v60, v12
  v_dot2c_f32_bf16 v160, v25, v13
  v_dot2c_f32_bf16 v161, v37, v13
  v_dot2c_f32_bf16 v162, v49, v13
  v_dot2c_f32_bf16 v163, v61, v13
  v_dot2c_f32_bf16 v160, v26, v14
  v_dot2c_f32_bf16 v161, v38, v14
  v_dot2c_f32_bf16 v162, v50, v14
  v_dot2c_f32_bf16 v163, v62, v14
  v_dot2c_f32_bf16 v160, v27, v15
  v_dot2c_f32_bf16 v161, v39, v15
  v_dot2c_f32_bf16 v162, v51, v15
  v_dot2c_f32_bf16 v163, v63, v15
  v_dot2c_f32_bf16 v164, v64, v4
  v_dot2c_f32_bf16 v165, v76, v4
  v_dot2c_f32_bf16 v166, v88, v4
  v_dot2c_f32_bf16 v167, v100, v4
  v_dot2c_f32_bf16 v164, v65, v5
  v_dot2c_f32_bf16 v165, v77, v5
  v_dot2c_f32_bf16 v166, v89, v5
  v_dot2c_f32_bf16 v167, v101, v5
  v_dot2c_f32_bf16 v164, v66, v6
  v_dot2c_f32_bf16 v165, v78, v6
  v_dot2c_f32_bf16 v166, v90, v6
  v_dot2c_f32_bf16 v167, v102, v6
  v_dot2c_f32_bf16 v164, v67, v7
  v_dot2c_f32_bf16 v165, v79, v7
  v_dot2c_f32_bf16 v166, v91, v7
  v_dot2c_f32_bf16 v167, v103, v7
  v_dot2c_f32_bf16 v164, v68, v8
  v_dot2c_f32_bf16 v165, v80, v8
  v_dot2c_f32_bf16 v166, v92, v8
  v_dot2c_f32_bf16 v167, v104, v8
  v_dot2c_f32_bf16 v164, v69, v9
  v_dot2c_f32_bf16 v165, v81, v9
  v_dot2c_f32_bf16 v166, v93, v9
  v_dot2c_f32_bf16 v167, v105, v9
  v_dot2c_f32_bf16 v164, v70, v10
  v_dot2c_f32_bf16 v165, v82, v10
  v_dot2c_f32_bf16 v166, v94, v10
  v_dot2c_f32_bf16 v167, v106, v10
  v_dot2c_f32_bf16 v164, v71, v11
  v_dot2c_f32_bf16 v165, v83, v11
  v_dot2c_f32_bf16 v166, v95, v11
  v_dot2c_f32_bf16 v167, v107, v11
  v_dot2c_f32_bf16 v164, v72, v12
  v_dot2c_f32_bf16 v165, v84, v12
  v_dot2c_f32_bf16 v166, v96, v12
  v_dot2c_f32_bf16 v167, v108, v12
  v_dot2c_f32_bf16 v164, v73, v13
  v_dot2c_f32_bf16 v165, v85, v13
  v_dot2c_f32_bf16 v166, v97, v13
  v_dot2c_f32_bf16 v167, v109, v13
  v_dot2c_f32_bf16 v164, v74, v14
  v_dot2c_f32_bf16 v165, v86, v14
  v_dot2c_f32_bf16 v166, v98, v14
  v_dot2c_f32_bf16 v167, v110, v14
  v_dot2c_f32_bf16 v164, v75, v15
  v_dot2c_f32_bf16 v165, v87, v15
  v_dot2c_f32_bf16 v166, v99, v15
  v_dot2c_f32_bf16 v167, v111, v15
  v_add_f32_dpp v160, v160, v160 quad_perm:[1,0,3,2] row_mask:0xf bank_mask:0xf
  v_add_f32_dpp v161, v161, v161 quad_perm:[1,0,3,2] row_mask:0xf bank_mask:0xf
  v_add_f32_dpp v162, v162, v162 quad_perm:[1,0,3,2] row_mask:0xf bank_mask:0xf
  v_add_f32_dpp v163, v163, v163 quad_perm:[1,0,3,2] row_mask:0xf bank_mask:0xf
  v_add_f32_dpp v164, v164, v164 quad_perm:[1,0,3,2] row_mask:0xf bank_mask:0xf
  v_add_f32_dpp v165, v165, v165 quad_perm:[1,0,3,2] row_mask:0xf bank_mask:0xf
  v_add_f32_dpp v166, v166, v166 quad_perm:[1,0,3,2] row_mask:0xf bank_mask:0xf
  v_add_f32_dpp v167, v167, v167 quad_perm:[1,0,3,2] row_mask:0xf bank_mask:0xf
  v_add_f32_dpp v160, v160, v160 quad_perm:[2,3,0,1] row_mask:0xf bank_mask:0xf
  v_add_f32_dpp v161, v161, v161 quad_perm:[2,3,0,1] row_mask:0xf bank_mask:0xf
  v_add_f32_dpp v162, v162, v162 quad_perm:[2,3,0,1] row_mask:0xf bank_mask:0xf
  v_add_f32_dpp v163, v163, v163 quad_perm:[2,3,0,1] row_mask:0xf bank_mask:0xf
  v_add_f32_dpp v164, v164, v164 quad_perm:[2,3,0,1] row_mask:0xf bank_mask:0xf
  v_add_f32_dpp v165, v165, v165 quad_perm:[2,3,0,1] row_mask:0xf bank_mask:0xf
  v_add_f32_dpp v166, v166, v166 quad_perm:[2,3,0,1] row_mask:0xf bank_mask:0xf
  v_add_f32_dpp v167, v167, v167 quad_perm:[2,3,0,1] row_mask:0xf bank_mask:0xf
  v_add_f32_dpp v160, v160, v160 row_half_mirror row_mask:0xf bank_mask:0xf
  v_add_f32_dpp v161, v161, v161 row_half_mirror row_mask:0xf bank_mask:0xf
  v_add_f32_dpp v162, v162, v162 row_half_mirror row_mask:0xf bank_mask:0xf
  v_add_f32_dpp v163, v163, v163 row_half_mirror row_mask:0xf bank_mask:0xf
  v_add_f32_dpp v164, v164, v164 row_half_mirror row_mask:0xf bank_mask:0xf
  v_add_f32_dpp v165, v165, v165 row_half_mirror row_mask:0xf bank_mask:0xf
  v_add_f32_dpp v166, v166, v166 row_half_mirror row_mask:0xf bank_mask:0xf
  v_add_f32_dpp v167, v167, v167 row_half_mirror row_mask:0xf bank_mask:0xf
  s_mov_b32 s68, 0x3d93cd3a
  v_mov_b32 v2, 0
  v_cvt_pk_bf16_f32 v160, v2, v160
  v_cvt_pk_bf16_f32 v161, v2, v161
  v_cvt_pk_bf16_f32 v162, v2, v162
  v_cvt_pk_bf16_f32 v163, v2, v163
  v_cvt_pk_bf16_f32 v164, v2, v164
  v_cvt_pk_bf16_f32 v165, v2, v165
  v_cvt_pk_bf16_f32 v166, v2, v166
  v_cvt_pk_bf16_f32 v167, v2, v167
  v_mul_f32 v160, s68, v160
  v_mul_f32 v161, s68, v161
  v_mul_f32 v162, s68, v162
  v_mul_f32 v163, s68, v163
  v_mul_f32 v164, s68, v164
  v_mul_f32 v165, s68, v165
  v_mul_f32 v166, s68, v166
  v_mul_f32 v167, s68, v167
  v_cvt_pk_bf16_f32 v160, v2, v160
  v_cvt_pk_bf16_f32 v161, v2, v161
  v_cvt_pk_bf16_f32 v162, v2, v162
  v_cvt_pk_bf16_f32 v163, v2, v163
  v_cvt_pk_bf16_f32 v164, v2, v164
  v_cvt_pk_bf16_f32 v165, v2, v165
  v_cvt_pk_bf16_f32 v166, v2, v166
  v_cvt_pk_bf16_f32 v167, v2, v167
  v_max_f32 v4, v160, v161
  v_max3_f32 v4, v4, v162, v163
  v_max3_f32 v4, v4, v164, v165
  v_max3_f32 v4, v4, v166, v167
  s_nop 1
  v_max_f32_dpp v4, v4, v4 row_ror:8 row_mask:0xf bank_mask:0xf
  v_mov_b32 v88, v4
  s_nop 1
  v_permlane16_swap_b32 v4, v88
  v_max_f32 v4, v4, v88
  v_mov_b32 v88, v4
  s_nop 1
  v_permlane32_swap_b32 v4, v88
  v_max_f32 v4, v4, v88
  s_mov_b32 s68, 0x3fb8aa3b
  v_sub_f32 v160, v160, v4
  v_sub_f32 v161, v161, v4
  v_sub_f32 v162, v162, v4
  v_sub_f32 v163, v163, v4
  v_sub_f32 v164, v164, v4
  v_sub_f32 v165, v165, v4
  v_sub_f32 v166, v166, v4
  v_sub_f32 v167, v167, v4
  v_mul_f32 v160, s68, v160
  v_mul_f32 v161, s68, v161
  v_mul_f32 v162, s68, v162
  v_mul_f32 v163, s68, v163
  v_mul_f32 v164, s68, v164
  v_mul_f32 v165, s68, v165
  v_mul_f32 v166, s68, v166
  v_mul_f32 v167, s68, v167
  v_exp_f32 v160, v160
  v_exp_f32 v161, v161
  v_exp_f32 v162, v162
  v_exp_f32 v163, v163
  v_exp_f32 v164, v164
  v_exp_f32 v165, v165
  v_exp_f32 v166, v166
  v_exp_f32 v167, v167
  v_add_f32 v5, v160, v161
  v_add_f32 v5, v5, v162
  v_add_f32 v5, v5, v163
  v_add_f32 v5, v5, v164
  v_add_f32 v5, v5, v165
  v_add_f32 v5, v5, v166
  v_add_f32 v5, v5, v167
  s_nop 1
  v_add_f32_dpp v5, v5, v5 row_ror:8 row_mask:0xf bank_mask:0xf
  v_mov_b32 v88, v5
  s_nop 1
  v_permlane16_swap_b32 v5, v88
  v_add_f32 v5, v5, v88
  v_mov_b32 v88, v5
  s_nop 1
  v_permlane32_swap_b32 v5, v88
  v_add_f32 v5, v5, v88
  s_lshl_b32 s69, s3, 4
  v_mov_b32 v88, s69
  v_mov_b32 v6, 1
  v_mov_b32 v7, 1
  ds_write_b128 v88, v[4:7] offset:512
  v_cvt_pk_bf16_f32 v160, v160, v2
  v_cvt_pk_bf16_f32 v161, v161, v2
  v_cvt_pk_bf16_f32 v162, v162, v2
  v_cvt_pk_bf16_f32 v163, v163, v2
  v_cvt_pk_bf16_f32 v164, v164, v2
  v_cvt_pk_bf16_f32 v165, v165, v2
  v_cvt_pk_bf16_f32 v166, v166, v2
  v_cvt_pk_bf16_f32 v167, v167, v2
  v_mov_b32 v88, 0
  v_mov_b32 v89, 0
  v_mov_b32 v90, 0
  v_mov_b32 v91, 0
  v_mov_b32 v92, 0
  v_mov_b32 v93, 0
  v_mov_b32 v94, 0
  v_mov_b32 v95, 0
  v_mov_b32 v96, 0
  v_mov_b32 v97, 0
  v_mov_b32 v98, 0
  v_mov_b32 v99, 0
  v_mov_b32 v100, 0
  v_mov_b32 v101, 0
  v_mov_b32 v102, 0
  v_mov_b32 v103, 0
  v_mov_b32 v104, 0
  v_mov_b32 v105, 0
  v_mov_b32 v106, 0
  v_mov_b32 v107, 0
  v_mov_b32 v108, 0
  v_mov_b32 v109, 0
  v_mov_b32 v110, 0
  v_mov_b32 v111, 0
  v_and_b32 v8, 7, v0
  v_lshlrev_b32 v8, 5, v8
  v_lshrrev_b32 v9, 4, v0
  v_lshl_add_u32 v8, v9, 3, v8
  s_mul_i32 s69, s3, 768
  v_add_u32 v8, s69, v8
  v_mov_b32 v11, 1
  s_waitcnt vmcnt(2)
  buffer_load_dwordx4 v[124:127], v1, s[12:15], s61 offen offset:0 nt
  v_lshlrev_b32 v10, 16, v160
  v_dot2c_f32_bf16 v88, v112, v160
  v_dot2c_f32_bf16 v89, v112, v10
  v_dot2c_f32_bf16 v90, v113, v160
  v_dot2c_f32_bf16 v91, v113, v10
  v_dot2c_f32_bf16 v92, v114, v160
  v_dot2c_f32_bf16 v93, v114, v10
  v_dot2c_f32_bf16 v94, v115, v160
  v_dot2c_f32_bf16 v95, v115, v10
  s_waitcnt vmcnt(2)
  buffer_load_dwordx4 v[128:131], v1, s[12:15], s61 offen offset:128 nt
  v_dot2c_f32_bf16 v96, v116, v160
  v_dot2c_f32_bf16 v97, v116, v10
  v_dot2c_f32_bf16 v98, v117, v160
  v_dot2c_f32_bf16 v99, v117, v10
  v_dot2c_f32_bf16 v100, v118, v160
  v_dot2c_f32_bf16 v101, v118, v10
  v_dot2c_f32_bf16 v102, v119, v160
  v_dot2c_f32_bf16 v103, v119, v10
  s_waitcnt vmcnt(2)
  buffer_load_dwordx4 v[132:135], v1, s[12:15], s61 offen offset:256 nt
  v_dot2c_f32_bf16 v104, v120, v160
  v_dot2c_f32_bf16 v105, v120, v10
  v_dot2c_f32_bf16 v106, v121, v160
  v_dot2c_f32_bf16 v107, v121, v10
  v_dot2c_f32_bf16 v108, v122, v160
  v_dot2c_f32_bf16 v109, v122, v10
  v_dot2c_f32_bf16 v110, v123, v160
  v_dot2c_f32_bf16 v111, v123, v10
  s_waitcnt vmcnt(2)
  buffer_load_dwordx4 v[136:139], v1, s[12:15], s62 offen offset:0 nt
  v_lshlrev_b32 v10, 16, v161
  v_dot2c_f32_bf16 v88, v124, v161
  v_dot2c_f32_bf16 v89, v124, v10
  v_dot2c_f32_bf16 v90, v125, v161
  v_dot2c_f32_bf16 v91, v125, v10
  v_dot2c_f32_bf16 v92, v126, v161
  v_dot2c_f32_bf16 v93, v126, v10
  v_dot2c_f32_bf16 v94, v127, v161
  v_dot2c_f32_bf16 v95, v127, v10
  s_waitcnt vmcnt(2)
  buffer_load_dwordx4 v[140:143], v1, s[12:15], s62 offen offset:128 nt
  v_dot2c_f32_bf16 v96, v128, v161
  v_dot2c_f32_bf16 v97, v128, v10
  v_dot2c_f32_bf16 v98, v129, v161
  v_dot2c_f32_bf16 v99, v129, v10
  v_dot2c_f32_bf16 v100, v130, v161
  v_dot2c_f32_bf16 v101, v130, v10
  v_dot2c_f32_bf16 v102, v131, v161
  v_dot2c_f32_bf16 v103, v131, v10
  s_waitcnt vmcnt(2)
  buffer_load_dwordx4 v[144:147], v1, s[12:15], s62 offen offset:256 nt
  v_dot2c_f32_bf16 v104, v132, v161
  v_dot2c_f32_bf16 v105, v132, v10
  v_dot2c_f32_bf16 v106, v133, v161
  v_dot2c_f32_bf16 v107, v133, v10
  v_dot2c_f32_bf16 v108, v134, v161
  v_dot2c_f32_bf16 v109, v134, v10
  v_dot2c_f32_bf16 v110, v135, v161
  v_dot2c_f32_bf16 v111, v135, v10
  s_waitcnt vmcnt(2)
  buffer_load_dwordx4 v[148:151], v1, s[12:15], s63 offen offset:0 nt
  v_lshlrev_b32 v10, 16, v162
  v_dot2c_f32_bf16 v88, v136, v162
  v_dot2c_f32_bf16 v89, v136, v10
  v_dot2c_f32_bf16 v90, v137, v162
  v_dot2c_f32_bf16 v91, v137, v10
  v_dot2c_f32_bf16 v92, v138, v162
  v_dot2c_f32_bf16 v93, v138, v10
  v_dot2c_f32_bf16 v94, v139, v162
  v_dot2c_f32_bf16 v95, v139, v10
  s_waitcnt vmcnt(2)
  buffer_load_dwordx4 v[152:155], v1, s[12:15], s63 offen offset:128 nt
  v_dot2c_f32_bf16 v96, v140, v162
  v_dot2c_f32_bf16 v97, v140, v10
  v_dot2c_f32_bf16 v98, v141, v162
  v_dot2c_f32_bf16 v99, v141, v10
  v_dot2c_f32_bf16 v100, v142, v162
  v_dot2c_f32_bf16 v101, v142, v10
  v_dot2c_f32_bf16 v102, v143, v162
  v_dot2c_f32_bf16 v103, v143, v10
  s_waitcnt vmcnt(2)
  buffer_load_dwordx4 v[156:159], v1, s[12:15], s63 offen offset:256 nt
  v_dot2c_f32_bf16 v104, v144, v162
  v_dot2c_f32_bf16 v105, v144, v10
  v_dot2c_f32_bf16 v106, v145, v162
  v_dot2c_f32_bf16 v107, v145, v10
  v_dot2c_f32_bf16 v108, v146, v162
  v_dot2c_f32_bf16 v109, v146, v10
  v_dot2c_f32_bf16 v110, v147, v162
  v_dot2c_f32_bf16 v111, v147, v10
  s_waitcnt vmcnt(2)
  buffer_load_dwordx4 v[16:19], v1, s[12:15], s64 offen offset:0 nt
  v_lshlrev_b32 v10, 16, v163
  v_dot2c_f32_bf16 v88, v148, v163
  v_dot2c_f32_bf16 v89, v148, v10
  v_dot2c_f32_bf16 v90, v149, v163
  v_dot2c_f32_bf16 v91, v149, v10
  v_dot2c_f32_bf16 v92, v150, v163
  v_dot2c_f32_bf16 v93, v150, v10
  v_dot2c_f32_bf16 v94, v151, v163
  v_dot2c_f32_bf16 v95, v151, v10
  s_waitcnt vmcnt(2)
  buffer_load_dwordx4 v[20:23], v1, s[12:15], s64 offen offset:128 nt
  v_dot2c_f32_bf16 v96, v152, v163
  v_dot2c_f32_bf16 v97, v152, v10
  v_dot2c_f32_bf16 v98, v153, v163
  v_dot2c_f32_bf16 v99, v153, v10
  v_dot2c_f32_bf16 v100, v154, v163
  v_dot2c_f32_bf16 v101, v154, v10
  v_dot2c_f32_bf16 v102, v155, v163
  v_dot2c_f32_bf16 v103, v155, v10
  s_waitcnt vmcnt(2)
  buffer_load_dwordx4 v[24:27], v1, s[12:15], s64 offen offset:256 nt
  v_dot2c_f32_bf16 v104, v156, v163
  v_dot2c_f32_bf16 v105, v156, v10
  v_dot2c_f32_bf16 v106, v157, v163
  v_dot2c_f32_bf16 v107, v157, v10
  v_dot2c_f32_bf16 v108, v158, v163
  v_dot2c_f32_bf16 v109, v158, v10
  v_dot2c_f32_bf16 v110, v159, v163
  v_dot2c_f32_bf16 v111, v159, v10
  s_waitcnt vmcnt(2)
  buffer_load_dwordx4 v[28:31], v1, s[12:15], s65 offen offset:0 nt
  v_lshlrev_b32 v10, 16, v164
  v_dot2c_f32_bf16 v88, v16, v164
  v_dot2c_f32_bf16 v89, v16, v10
  v_dot2c_f32_bf16 v90, v17, v164
  v_dot2c_f32_bf16 v91, v17, v10
  v_dot2c_f32_bf16 v92, v18, v164
  v_dot2c_f32_bf16 v93, v18, v10
  v_dot2c_f32_bf16 v94, v19, v164
  v_dot2c_f32_bf16 v95, v19, v10
  s_waitcnt vmcnt(2)
  buffer_load_dwordx4 v[32:35], v1, s[12:15], s65 offen offset:128 nt
  v_dot2c_f32_bf16 v96, v20, v164
  v_dot2c_f32_bf16 v97, v20, v10
  v_dot2c_f32_bf16 v98, v21, v164
  v_dot2c_f32_bf16 v99, v21, v10
  v_dot2c_f32_bf16 v100, v22, v164
  v_dot2c_f32_bf16 v101, v22, v10
  v_dot2c_f32_bf16 v102, v23, v164
  v_dot2c_f32_bf16 v103, v23, v10
  s_waitcnt vmcnt(2)
  buffer_load_dwordx4 v[36:39], v1, s[12:15], s65 offen offset:256 nt
  s_mov_b64 exec, 1
  ds_add_u32 v2, v11 offset:648
  s_mov_b64 exec, -1
  v_dot2c_f32_bf16 v104, v24, v164
  v_dot2c_f32_bf16 v105, v24, v10
  v_dot2c_f32_bf16 v106, v25, v164
  v_dot2c_f32_bf16 v107, v25, v10
  v_dot2c_f32_bf16 v108, v26, v164
  v_dot2c_f32_bf16 v109, v26, v10
  v_dot2c_f32_bf16 v110, v27, v164
  v_dot2c_f32_bf16 v111, v27, v10
  s_waitcnt vmcnt(2)
  buffer_load_dwordx4 v[40:43], v1, s[12:15], s66 offen offset:0 nt
  v_lshlrev_b32 v10, 16, v165
  v_dot2c_f32_bf16 v88, v28, v165
  v_dot2c_f32_bf16 v89, v28, v10
  v_dot2c_f32_bf16 v90, v29, v165
  v_dot2c_f32_bf16 v91, v29, v10
  v_dot2c_f32_bf16 v92, v30, v165
  v_dot2c_f32_bf16 v93, v30, v10
  v_dot2c_f32_bf16 v94, v31, v165
  v_dot2c_f32_bf16 v95, v31, v10
  s_waitcnt vmcnt(2)
  buffer_load_dwordx4 v[44:47], v1, s[12:15], s66 offen offset:128 nt
  v_dot2c_f32_bf16 v96, v32, v165
  v_dot2c_f32_bf16 v97, v32, v10
  v_dot2c_f32_bf16 v98, v33, v165
  v_dot2c_f32_bf16 v99, v33, v10
  v_dot2c_f32_bf16 v100, v34, v165
  v_dot2c_f32_bf16 v101, v34, v10
  v_dot2c_f32_bf16 v102, v35, v165
  v_dot2c_f32_bf16 v103, v35, v10
  s_waitcnt vmcnt(2)
  buffer_load_dwordx4 v[48:51], v1, s[12:15], s66 offen offset:256 nt
  v_dot2c_f32_bf16 v104, v36, v165
  v_dot2c_f32_bf16 v105, v36, v10
  v_dot2c_f32_bf16 v106, v37, v165
  v_dot2c_f32_bf16 v107, v37, v10
  v_dot2c_f32_bf16 v108, v38, v165
  v_dot2c_f32_bf16 v109, v38, v10
  v_dot2c_f32_bf16 v110, v39, v165
  v_dot2c_f32_bf16 v111, v39, v10
  s_waitcnt vmcnt(2)
  buffer_load_dwordx4 v[52:55], v1, s[12:15], s67 offen offset:0 nt
  v_lshlrev_b32 v10, 16, v166
  v_dot2c_f32_bf16 v88, v40, v166
  v_dot2c_f32_bf16 v89, v40, v10
  v_dot2c_f32_bf16 v90, v41, v166
  v_dot2c_f32_bf16 v91, v41, v10
  v_dot2c_f32_bf16 v92, v42, v166
  v_dot2c_f32_bf16 v93, v42, v10
  v_dot2c_f32_bf16 v94, v43, v166
  v_dot2c_f32_bf16 v95, v43, v10
  s_waitcnt vmcnt(2)
  buffer_load_dwordx4 v[56:59], v1, s[12:15], s67 offen offset:128 nt
  s_mov_b64 exec, 1
  ds_add_u32 v2, v11 offset:644
  s_mov_b64 exec, -1
  v_dot2c_f32_bf16 v96, v44, v166
  v_dot2c_f32_bf16 v97, v44, v10
  v_dot2c_f32_bf16 v98, v45, v166
  v_dot2c_f32_bf16 v99, v45, v10
  v_dot2c_f32_bf16 v100, v46, v166
  v_dot2c_f32_bf16 v101, v46, v10
  v_dot2c_f32_bf16 v102, v47, v166
  v_dot2c_f32_bf16 v103, v47, v10
  s_waitcnt vmcnt(2)
  buffer_load_dwordx4 v[60:63], v1, s[12:15], s67 offen offset:256 nt
  v_dot2c_f32_bf16 v104, v48, v166
  v_dot2c_f32_bf16 v105, v48, v10
  v_dot2c_f32_bf16 v106, v49, v166
  v_dot2c_f32_bf16 v107, v49, v10
  v_dot2c_f32_bf16 v108, v50, v166
  v_dot2c_f32_bf16 v109, v50, v10
  v_dot2c_f32_bf16 v110, v51, v166
  v_dot2c_f32_bf16 v111, v51, v10
  s_mov_b32 s70, 200007
L_spin_3:
  ds_read_b128 v[12:15], v2 offset:672
  ds_read_b32 v7, v2 offset:656
  s_waitcnt lgkmcnt(0)
  v_cmp_eq_u32 vcc, 0, v15
  s_nop 0
  s_cbranch_vccz L_sdone_4
  s_sleep 1
  s_sub_u32 s70, s70, 1
  s_cbranch_scc0 L_spin_3
L_sdone_4:
  v_sub_f32 v9, v4, v12
  v_mul_f32 v9, s68, v9
  v_exp_f32 v9, v9
  v_readfirstlane_b32 s46, v7
  v_mul_f32 v9, v9, v13
  v_min_u32 v12, 47, v0
  v_lshlrev_b32 v12, 4, v12
  s_mul_i32 s74, s71, 768
  s_add_u32 s74, s74, 1114112
  s_lshl_b32 s75, s4, 9
  s_lshl4_add_u32 s75, s79, s75
  s_add_u32 s75, s75, 1064960
  s_mov_b32 s22, 0xaaaaaaaa
  s_mov_b32 s23, 0xaaaaaaaa
  v_mov_b32 v14, s30
  v_mov_b32 v15, s31
  s_waitcnt vmcnt(2)
  v_lshlrev_b32 v10, 16, v167
  v_dot2c_f32_bf16 v88, v52, v167
  v_dot2c_f32_bf16 v89, v52, v10
  v_dot2c_f32_bf16 v90, v53, v167
  v_dot2c_f32_bf16 v91, v53, v10
  v_dot2c_f32_bf16 v92, v54, v167
  v_dot2c_f32_bf16 v93, v54, v10
  v_dot2c_f32_bf16 v94, v55, v167
  v_dot2c_f32_bf16 v95, v55, v10
  v_permlane32_swap_b32 v88, v92
  v_permlane32_swap_b32 v89, v93
  v_permlane32_swap_b32 v90, v94
  v_permlane32_swap_b32 v91, v95
  v_add_f32 v88, v88, v92
  v_add_f32 v89, v89, v93
  v_add_f32 v90, v90, v94
  v_add_f32 v91, v91, v95
  s_nop 0
  v_permlane16_swap_b32 v88, v90
  v_permlane16_swap_b32 v89, v91
  v_add_f32 v88, v88, v90
  v_add_f32 v89, v89, v91
  s_nop 0
  v_add_f32_dpp v88, v88, v88 row_ror:8 row_mask:0xf bank_mask:0xf
  v_add_f32_dpp v89, v89, v89 row_ror:8 row_mask:0xf bank_mask:0xf
  v_mul_f32 v88, v9, v88
  v_mul_f32 v89, v9, v89
  ds_write_b64 v8, v[88:89] offset:1024
  s_waitcnt vmcnt(1)
  v_dot2c_f32_bf16 v96, v56, v167
  v_dot2c_f32_bf16 v97, v56, v10
  v_dot2c_f32_bf16 v98, v57, v167
  v_dot2c_f32_bf16 v99, v57, v10
  v_dot2c_f32_bf16 v100, v58, v167
  v_dot2c_f32_bf16 v101, v58, v10
  v_dot2c_f32_bf16 v102, v59, v167
  v_dot2c_f32_bf16 v103, v59, v10
  v_permlane32_swap_b32 v96, v100
  v_permlane32_swap_b32 v97, v101
  v_permlane32_swap_b32 v98, v102
  v_permlane32_swap_b32 v99, v103
  v_add_f32 v96, v96, v100
  v_add_f32 v97, v97, v101
  v_add_f32 v98, v98, v102
  v_add_f32 v99, v99, v103
  s_nop 0
  v_permlane16_swap_b32 v96, v98
  v_permlane16_swap_b32 v97, v99
  v_add_f32 v96, v96, v98
  v_add_f32 v97, v97, v99
  s_nop 0
  v_add_f32_dpp v96, v96, v96 row_ror:8 row_mask:0xf bank_mask:0xf
  v_add_f32_dpp v97, v97, v97 row_ror:8 row_mask:0xf bank_mask:0xf
  v_mul_f32 v96, v9, v96
  v_mul_f32 v97, v9, v97
  ds_write_b64 v8, v[96:97] offset:1280
  s_waitcnt vmcnt(0)
  v_dot2c_f32_bf16 v104, v60, v167
  v_dot2c_f32_bf16 v105, v60, v10
  v_dot2c_f32_bf16 v106, v61, v167
  v_dot2c_f32_bf16 v107, v61, v10
  v_dot2c_f32_bf16 v108, v62, v167
  v_dot2c_f32_bf16 v109, v62, v10
  v_dot2c_f32_bf16 v110, v63, v167
  v_dot2c_f32_bf16 v111, v63, v10
  v_permlane32_swap_b32 v104, v108
  v_permlane32_swap_b32 v105, v109
  v_permlane32_swap_b32 v106, v110
  v_permlane32_swap_b32 v107, v111
  v_add_f32 v104, v104, v108
  v_add_f32 v105, v105, v109
  v_add_f32 v106, v106, v110
  v_add_f32 v107, v107, v111
  s_nop 0
  v_permlane16_swap_b32 v104, v106
  v_permlane16_swap_b32 v105, v107
  v_add_f32 v104, v104, v106
  v_add_f32 v105, v105, v107
  s_nop 0
  v_add_f32_dpp v104, v104, v104 row_ror:8 row_mask:0xf bank_mask:0xf
  v_add_f32_dpp v105, v105, v105 row_ror:8 row_mask:0xf bank_mask:0xf
  v_mul_f32 v104, v9, v104
  v_mul_f32 v105, v9, v105
  ds_write_b64 v8, v[104:105] offset:1536
  s_mov_b64 exec, 1
  ds_add_rtn_u32 v10, v2, v11 offset:640
  s_waitcnt lgkmcnt(0)
  v_readfirstlane_b32 s68, v10
  s_mov_b64 exec, -1
  s_cmp_lg_u32 s68, 7
  s_cbranch_scc1 L_nopub
  ds_read_b128 v[16:19], v12 offset:1024
  ds_read_b128 v[20:23], v12 offset:1792
  ds_read_b128 v[24:27], v12 offset:2560
  ds_read_b128 v[28:31], v12 offset:3328
  ds_read_b128 v[32:35], v12 offset:4096
  ds_read_b128 v[36:39], v12 offset:4864
  ds_read_b128 v[40:43], v12 offset:5632
  ds_read_b128 v[44:47], v12 offset:6400
  s_waitcnt lgkmcnt(6)
  v_add_f32 v16, v16, v20
  v_add_f32 v17, v17, v21
  v_add_f32 v18, v18, v22
  v_add_f32 v19, v19, v23
  s_waitcnt lgkmcnt(4)
  v_add_f32 v24, v24, v28
  v_add_f32 v25, v25, v29
  v_add_f32 v26, v26, v30
  v_add_f32 v27, v27, v31
  v_add_f32 v16, v16, v24
  v_add_f32 v17, v17, v25
  v_add_f32 v18, v18, v26
  v_add_f32 v19, v19, v27
  s_waitcnt lgkmcnt(2)
  v_add_f32 v32, v32, v36
  v_add_f32 v33, v33, v37
  v_add_f32 v34, v34, v38
  v_add_f32 v35, v35, v39
  s_waitcnt lgkmcnt(0)
  v_add_f32 v40, v40, v44
  v_add_f32 v41, v41, v45
  v_add_f32 v42, v42, v46
  v_add_f32 v43, v43, v47
  v_add_f32 v32, v32, v40
  v_add_f32 v33, v33, v41
  v_add_f32 v34, v34, v42
  v_add_f32 v35, v35, v43
  v_add_f32 v4, v16, v32
  v_add_f32 v5, v17, v33
  v_add_f32 v6, v18, v34
  v_add_f32 v7, v19, v35
  v_cvt_pk_bf16_f32 v8, v4, v5
  v_cvt_pk_bf16_f32 v9, v6, v7
  v_cndmask_b32 v4, v8, v14, s[22:23]
  v_cndmask_b32 v5, v9, v15, s[22:23]
  v_cndmask_b32 v6, v14, v8, s[22:23]
  v_cndmask_b32 v7, v15, v9, s[22:23]
  s_mov_b32 exec_lo, 0xffffffff
  s_mov_b32 exec_hi, 0xffff
  buffer_store_dwordx4 v[4:7], v12, s[32:35], s74 offen
  s_mov_b64 exec, -1
  s_cmp_lg_u32 s46, 1
  s_cbranch_scc1 L_slow_5
L_back_6:
  s_mov_b64 exec, 1
  buffer_store_dwordx4 v[4:7], v12, s[32:35], s75 offen
  ds_write_b32 v2, v11 offset:660
  s_mov_b64 exec, -1
L_nopub:
  s_cmp_eq_u32 s3, 7
  s_cbranch_scc1 L_end
  v_mov_b32 v1, 0
  s_mov_b32 s70, 200007
L_spin_7:
  ds_read_b64 v[4:5], v1 offset:664
  s_waitcnt lgkmcnt(0)
  v_cmp_eq_u32 vcc, 0, v5
  s_nop 0
  s_cbranch_vccz L_sdone_8
  s_sleep 1
  s_sub_u32 s70, s70, 1
  s_cbranch_scc0 L_spin_7
L_sdone_8:
  v_readfirstlane_b32 s5, v5
  v_readfirstlane_b32 s47, v4
  s_sub_u32 s5, s5, 1
  s_cmp_lt_u32 s5, 12
  s_cbranch_scc1 L_ffn
  s_cmp_lt_u32 s5, 20
  s_cbranch_scc1 L_end
  s_cmp_lt_u32 s3, 5
  s_cbranch_scc1 L_f1
  s_endpgm
L_q2:
  s_mov_b32 s69, 0xffff0000
  s_mov_b32 s24, s58
  s_mov_b32 s25, s59
  s_mov_b32 s26, 4194304
  s_mov_b32 s27, 0x20000
  s_add_u32 s32, s58, 4194304
  s_addc_u32 s33, s59, 0
  s_mov_b32 s34, 4194304
  s_mov_b32 s35, 0x20000
  s_lshl3_add_u32 s71, s6, s7
  s_lshr_b32 s79, s2, 3
  s_waitcnt lgkmcnt(0)
  s_mul_i32 s30, s28, 0x2c9277b5
  s_add_u32 s30, s30, 0xac564b05
  s_mul_i32 s31, s29, 0x0019660d
  s_add_u32 s31, s31, 0x3c6ef35f
  s_not_b32 s20, s30
  v_mov_b32 v92, s20
  v_mov_b32 v93, s20
  v_mov_b32 v94, s20
  v_mov_b32 v95, s20
  v_lshlrev_b32 v91, 4, v0
  s_lshl_b32 s64, s71, 11
  s_lshl_b32 s65, s73, 9
  s_add_u32 s64, s64, s65
  s_add_u32 s64, s64, 1310720
  s_mov_b32 exec_hi, 0
  buffer_store_dwordx4 v[92:95], v91, s[32:35], s64 offen
  s_mov_b32 exec_hi, -1
  s_waitcnt vmcnt(21)
  v_lshlrev_b32 v70, 16, v64
  v_and_b32 v71, s69, v64
  v_lshlrev_b32 v72, 16, v65
  v_and_b32 v73, s69, v65
  v_lshlrev_b32 v74, 16, v66
  v_and_b32 v75, s69, v66
  v_lshlrev_b32 v76, 16, v67
  v_and_b32 v77, s69, v67
  v_lshlrev_b32 v78, 16, v68
  v_and_b32 v79, s69, v68
  v_add_f32 v4, v70, v71
  v_add_f32 v5, v72, v73
  v_add_f32 v6, v74, v75
  v_add_f32 v7, v76, v77
  v_add_f32 v4, v4, v5
  v_add_f32 v6, v6, v7
  v_add_f32 v5, v78, v79
  v_add_f32 v4, v4, v6
  v_add_f32 v4, v4, v5
  s_nop 1
  v_add_f32_dpp v4, v4, v4 quad_perm:[1,0,3,2] row_mask:0xf bank_mask:0xf
  s_nop 1
  v_add_f32_dpp v4, v4, v4 quad_perm:[2,3,0,1] row_mask:0xf bank_mask:0xf
  s_nop 1
  v_add_f32_dpp v4, v4, v4 row_half_mirror row_mask:0xf bank_mask:0xf
  s_nop 1
  v_add_f32_dpp v4, v4, v4 row_mirror row_mask:0xf bank_mask:0xf
  v_mov_b32 v5, v4
  s_nop 1
  v_permlane16_swap_b32 v4, v5
  v_add_f32 v4, v4, v5
  v_mov_b32 v5, v4
  s_nop 1
  v_permlane32_swap_b32 v4, v5
  v_add_f32 v4, v4, v5
  v_mul_f32 v4, 0x3acccccd, v4
  v_sub_f32 v70, v70, v4
  v_sub_f32 v71, v71, v4
  v_sub_f32 v72, v72, v4
  v_sub_f32 v73, v73, v4
  v_sub_f32 v74, v74, v4
  v_sub_f32 v75, v75, v4
  v_sub_f32 v76, v76, v4
  v_sub_f32 v77, v77, v4
  v_sub_f32 v78, v78, v4
  v_sub_f32 v79, v79, v4
  v_mul_f32 v5, v70, v70
  v_fmac_f32 v5, v71, v71
  v_fmac_f32 v5, v72, v72
  v_fmac_f32 v5, v73, v73
  v_fmac_f32 v5, v74, v74
  v_fmac_f32 v5, v75, v75
  v_fmac_f32 v5, v76, v76
  v_fmac_f32 v5, v77, v77
  v_fmac_f32 v5, v78, v78
  v_fmac_f32 v5, v79, v79
  s_nop 1
  v_add_f32_dpp v5, v5, v5 quad_perm:[1,0,3,2] row_mask:0xf bank_mask:0xf
  s_nop 1
  v_add_f32_dpp v5, v5, v5 quad_perm:[2,3,0,1] row_mask:0xf bank_mask:0xf
  s_nop 1
  v_add_f32_dpp v5, v5, v5 row_half_mirror row_mask:0xf bank_mask:0xf
  s_nop 1
  v_add_f32_dpp v5, v5, v5 row_mirror row_mask:0xf bank_mask:0xf
  v_mov_b32 v6, v5
  s_nop 1
  v_permlane16_swap_b32 v5, v6
  v_add_f32 v5, v5, v6
  v_mov_b32 v6, v5
  s_nop 1
  v_permlane32_swap_b32 v5, v6
  v_add_f32 v5, v5, v6
  v_mul_f32 v5, 0x3acccccd, v5
  v_cvt_pk_bf16_f32 v4, v4, v4
  v_lshlrev_b32 v4, 16, v4
  v_cvt_pk_bf16_f32 v5, v5, v5
  v_lshlrev_b32 v5, 16, v5
  v_add_f32 v5, 0x3727c5ac, v5
  v_cvt_pk_bf16_f32 v5, v5, v5
  v_lshlrev_b32 v5, 16, v5
  v_sqrt_f32 v5, v5
  s_nop 0
  v_cvt_pk_bf16_f32 v5, v5, v5
  v_lshlrev_b32 v5, 16, v5
  v_rcp_f32 v5, v5
  v_mov_b32 v6, 0
  s_waitcnt vmcnt(11)
  v_lshlrev_b32 v8, 16, v8
  v_lshlrev_b32 v9, 16, v9
  v_lshlrev_b32 v10, 16, v10
  v_lshlrev_b32 v11, 16, v11
  v_lshlrev_b32 v12, 16, v12
  v_lshlrev_b32 v13, 16, v13
  v_lshlrev_b32 v14, 16, v14
  v_lshlrev_b32 v15, 16, v15
  v_lshlrev_b32 v16, 16, v16
  v_lshlrev_b32 v17, 16, v17
  v_sub_f32 v8, v8, v4
  v_sub_f32 v9, v9, v4
  v_sub_f32 v10, v10, v4
  v_sub_f32 v11, v11, v4
  v_sub_f32 v12, v12, v4
  v_sub_f32 v13, v13, v4
  v_sub_f32 v14, v14, v4
  v_sub_f32 v15, v15, v4
  v_sub_f32 v16, v16, v4
  v_sub_f32 v17, v17, v4
  v_cvt_pk_bf16_f32 v8, v6, v8
  v_cvt_pk_bf16_f32 v9, v6, v9
  v_cvt_pk_bf16_f32 v10, v6, v10
  v_cvt_pk_bf16_f32 v11, v6, v11
  v_cvt_pk_bf16_f32 v12, v6, v12
  v_cvt_pk_bf16_f32 v13, v6, v13
  v_cvt_pk_bf16_f32 v14, v6, v14
  v_cvt_pk_bf16_f32 v15, v6, v15
  v_cvt_pk_bf16_f32 v16, v6, v16
  v_cvt_pk_bf16_f32 v17, v6, v17
  v_mul_f32 v8, v8, v5
  v_mul_f32 v9, v9, v5
  v_mul_f32 v10, v10, v5
  v_mul_f32 v11, v11, v5
  v_mul_f32 v12, v12, v5
  v_mul_f32 v13, v13, v5
  v_mul_f32 v14, v14, v5
  v_mul_f32 v15, v15, v5
  v_mul_f32 v16, v16, v5
  v_mul_f32 v17, v17, v5
  v_cvt_pk_bf16_f32 v70, v6, v8
  v_cvt_pk_bf16_f32 v8, v8, v6
  v_cvt_pk_bf16_f32 v71, v6, v9
  v_cvt_pk_bf16_f32 v9, v9, v6
  v_cvt_pk_bf16_f32 v72, v6, v10
  v_cvt_pk_bf16_f32 v10, v10, v6
  v_cvt_pk_bf16_f32 v73, v6, v11
  v_cvt_pk_bf16_f32 v11, v11, v6
  v_cvt_pk_bf16_f32 v74, v6, v12
  v_cvt_pk_bf16_f32 v12, v12, v6
  v_cvt_pk_bf16_f32 v75, v6, v13
  v_cvt_pk_bf16_f32 v13, v13, v6
  v_cvt_pk_bf16_f32 v76, v6, v14
  v_cvt_pk_bf16_f32 v14, v14, v6
  v_cvt_pk_bf16_f32 v77, v6, v15
  v_cvt_pk_bf16_f32 v15, v15, v6
  v_cvt_pk_bf16_f32 v78, v6, v16
  v_cvt_pk_bf16_f32 v16, v16, v6
  v_cvt_pk_bf16_f32 v79, v6, v17
  v_cvt_pk_bf16_f32 v17, v17, v6
  v_mov_b32 v80, 0
  v_mov_b32 v81, 0
  v_mov_b32 v82, 0
  v_mov_b32 v83, 0
  v_mov_b32 v84, 0
  v_mov_b32 v85, 0
  v_mov_b32 v86, 0
  v_mov_b32 v87, 0
  v_and_b32 v90, 7, v0
  v_lshrrev_b32 v6, 4, v0
  v_lshl_add_u32 v90, v90, 2, v6
  v_lshlrev_b32 v90, 4, v90
  s_lshl_b32 s64, s71, 11
  s_lshl_b32 s69, s73, 9
  s_add_u32 s69, s69, 1310720
  s_add_u32 s64, s64, s69
  s_waitcnt vmcnt(10)
  v_dot2c_f32_bf16 v80, v24, v8
  v_dot2c_f32_bf16 v81, v24, v70
  v_dot2c_f32_bf16 v82, v25, v8
  v_dot2c_f32_bf16 v83, v25, v70
  v_dot2c_f32_bf16 v84, v26, v8
  v_dot2c_f32_bf16 v85, v26, v70
  v_dot2c_f32_bf16 v86, v27, v8
  v_dot2c_f32_bf16 v87, v27, v70
  s_waitcnt vmcnt(9)
  v_dot2c_f32_bf16 v80, v28, v9
  v_dot2c_f32_bf16 v81, v28, v71
  v_dot2c_f32_bf16 v82, v29, v9
  v_dot2c_f32_bf16 v83, v29, v71
  v_dot2c_f32_bf16 v84, v30, v9
  v_dot2c_f32_bf16 v85, v30, v71
  v_dot2c_f32_bf16 v86, v31, v9
  v_dot2c_f32_bf16 v87, v31, v71
  s_waitcnt vmcnt(8)
  v_dot2c_f32_bf16 v80, v32, v10
  v_dot2c_f32_bf16 v81, v32, v72
  v_dot2c_f32_bf16 v82, v33, v10
  v_dot2c_f32_bf16 v83, v33, v72
  v_dot2c_f32_bf16 v84, v34, v10
  v_dot2c_f32_bf16 v85, v34, v72
  v_dot2c_f32_bf16 v86, v35, v10
  v_dot2c_f32_bf16 v87, v35, v72
  s_waitcnt vmcnt(7)
  v_dot2c_f32_bf16 v80, v36, v11
  v_dot2c_f32_bf16 v81, v36, v73
  v_dot2c_f32_bf16 v82, v37, v11
  v_dot2c_f32_bf16 v83, v37, v73
  v_dot2c_f32_bf16 v84, v38, v11
  v_dot2c_f32_bf16 v85, v38, v73
  v_dot2c_f32_bf16 v86, v39, v11
  v_dot2c_f32_bf16 v87, v39, v73
  s_waitcnt vmcnt(6)
  v_dot2c_f32_bf16 v80, v40, v12
  v_dot2c_f32_bf16 v81, v40, v74
  v_dot2c_f32_bf16 v82, v41, v12
  v_dot2c_f32_bf16 v83, v41, v74
  v_dot2c_f32_bf16 v84, v42, v12
  v_dot2c_f32_bf16 v85, v42, v74
  v_dot2c_f32_bf16 v86, v43, v12
  v_dot2c_f32_bf16 v87, v43, v74
  s_waitcnt vmcnt(5)
  v_dot2c_f32_bf16 v80, v44, v13
  v_dot2c_f32_bf16 v81, v44, v75
  v_dot2c_f32_bf16 v82, v45, v13
  v_dot2c_f32_bf16 v83, v45, v75
  v_dot2c_f32_bf16 v84, v46, v13
  v_dot2c_f32_bf16 v85, v46, v75
  v_dot2c_f32_bf16 v86, v47, v13
  v_dot2c_f32_bf16 v87, v47, v75
  s_waitcnt vmcnt(4)
  v_dot2c_f32_bf16 v80, v48, v14
  v_dot2c_f32_bf16 v81, v48, v76
  v_dot2c_f32_bf16 v82, v49, v14
  v_dot2c_f32_bf16 v83, v49, v76
  v_dot2c_f32_bf16 v84, v50, v14
  v_dot2c_f32_bf16 v85, v50, v76
  v_dot2c_f32_bf16 v86, v51, v14
  v_dot2c_f32_bf16 v87, v51, v76
  s_waitcnt vmcnt(3)
  v_dot2c_f32_bf16 v80, v52, v15
  v_dot2c_f32_bf16 v81, v52, v77
  v_dot2c_f32_bf16 v82, v53, v15
  v_dot2c_f32_bf16 v83, v53, v77
  v_dot2c_f32_bf16 v84, v54, v15
  v_dot2c_f32_bf16 v85, v54, v77
  v_dot2c_f32_bf16 v86, v55, v15
  v_dot2c_f32_bf16 v87, v55, v77
  s_waitcnt vmcnt(2)
  v_dot2c_f32_bf16 v80, v56, v16
  v_dot2c_f32_bf16 v81, v56, v78
  v_dot2c_f32_bf16 v82, v57, v16
  v_dot2c_f32_bf16 v83, v57, v78
  v_dot2c_f32_bf16 v84, v58, v16
  v_dot2c_f32_bf16 v85, v58, v78
  v_dot2c_f32_bf16 v86, v59, v16
  v_dot2c_f32_bf16 v87, v59, v78
  s_waitcnt vmcnt(0)
  v_dot2c_f32_bf16 v80, v60, v17
  v_dot2c_f32_bf16 v81, v60, v79
  v_dot2c_f32_bf16 v82, v61, v17
  v_dot2c_f32_bf16 v83, v61, v79
  v_dot2c_f32_bf16 v84, v62, v17
  v_dot2c_f32_bf16 v85, v62, v79
  v_dot2c_f32_bf16 v86, v63, v17
  v_dot2c_f32_bf16 v87, v63, v79
  v_permlane32_swap_b32 v80, v84
  v_permlane32_swap_b32 v81, v85
  v_permlane32_swap_b32 v82, v86
  v_permlane32_swap_b32 v83, v87
  v_add_f32 v80, v80, v84
  v_add_f32 v81, v81, v85
  v_add_f32 v82, v82, v86
  v_add_f32 v83, v83, v87
  s_nop 0
  v_permlane16_swap_b32 v80, v82
  v_permlane16_swap_b32 v81, v83
  v_add_f32 v80, v80, v82
  v_add_f32 v81, v81, v83
  s_nop 0
  v_add_f32_dpp v80, v80, v80 row_ror:8 row_mask:0xf bank_mask:0xf
  v_add_f32_dpp v81, v81, v81 row_ror:8 row_mask:0xf bank_mask:0xf
  v_mov_b32 v82, s30
  v_mov_b32 v83, s31
  s_mov_b32 exec_lo, 0xff00ff
  s_mov_b32 exec_hi, 0xff00ff
  buffer_store_dwordx4 v[80:83], v90, s[32:35], s64 offen
  s_mov_b64 exec, -1
  v_and_b32 v3, 31, v0
  v_lshrrev_b32 v2, 5, v0
  v_lshlrev_b32 v2, 11, v2
  v_lshl_add_u32 v2, v3, 4, v2
  s_lshl_b32 s68, s6, 14
  s_add_u32 s60, s68, s69
  s_add_u32 s61, s60, 4096
  s_add_u32 s62, s60, 8192
  s_add_u32 s63, s60, 12288
  v_lshlrev_b32 v3, 2, v3
  s_lshl_b32 s69, s73, 7
  v_add_u32 v3, s69, v3
  v_mov_b32 v1, 0
  s_mov_b32 s65, 0
  s_sleep 40
  s_mov_b32 s16, s32
  s_mov_b32 s17, s33
  s_mov_b32 s18, 4194304
  s_mov_b32 s19, 0x20000
  s_mov_b32 s70, 200007
L_spin_9:
  buffer_load_dwordx4 v[8:11], v2, s[16:19], s60 offen sc1
  buffer_load_dwordx4 v[12:15], v2, s[16:19], s61 offen sc1
  buffer_load_dwordx4 v[16:19], v2, s[16:19], s62 offen sc1
  buffer_load_dwordx4 v[20:23], v2, s[16:19], s63 offen sc1
  s_waitcnt vmcnt(0)
  v_cmp_ne_u64 vcc, s[30:31], v[10:11]
  v_cmp_ne_u64 s[20:21], s[30:31], v[14:15]
  v_cmp_ne_u64 s[22:23], s[30:31], v[18:19]
  s_or_b64 vcc, vcc, s[20:21]
  v_cmp_ne_u64 s[20:21], s[30:31], v[22:23]
  s_or_b64 vcc, vcc, s[22:23]
  s_or_b64 vcc, vcc, s[20:21]
  s_nop 0
  s_cbranch_vccz L_sdone_10
  s_sleep 20
  ds_read_b32 v4, v1 offset:656
  s_waitcnt lgkmcnt(0)
  v_readfirstlane_b32 s46, v4
  s_nop 0
  s_sub_u32 s68, s46, s65
  s_cmp_lg_u32 s68, 2
  s_cbranch_scc1 L_qlazy_11
  s_mov_b32 exec_lo, 0xff00ff
  s_mov_b32 exec_hi, 0xff00ff
  buffer_store_dwordx4 v[80:83], v90, s[24:27], s64 offen sc1
  s_mov_b64 exec, -1
  s_mov_b32 s65, 1
L_qlazy_11:
  s_and_b32 s99, s70, 7
  s_cselect_b32 s16, s32, s24
  s_cselect_b32 s17, s33, s25
  s_sub_u32 s70, s70, 1
  s_cbranch_scc0 L_spin_9
L_sdone_10:
  v_add_f32 v8, v8, v12
  v_add_f32 v9, v9, v13
  v_add_f32 v16, v16, v20
  v_add_f32 v17, v17, v21
  v_add_f32 v8, v8, v16
  v_add_f32 v9, v9, v17
  v_mov_b32 v10, v8
  v_mov_b32 v11, v9
  s_nop 0
  v_permlane32_swap_b32 v8, v10
  v_permlane32_swap_b32 v9, v11
  v_add_f32 v8, v8, v10
  v_add_f32 v9, v9, v11
  v_cvt_pk_bf16_f32 v8, v8, v9
  ds_write_b32 v3, v8 offset:0
  s_lshl_b32 s69, s73, 3
  v_mov_b32 v4, s69
  v_mov_b32 v6, 1
  s_waitcnt lgkmcnt(0)
  ds_write_b32 v4, v6 offset:384
  v_mov_b32 v1, 0
  s_mov_b32 s70, 200007
L_spin_12:
  ds_read_b32 v4, v1 offset:656
  s_waitcnt lgkmcnt(0)
  v_cmp_gt_u32 vcc, 1, v4
  s_nop 0
  s_cbranch_vccz L_sdone_13
  s_sleep 2
  s_sub_u32 s70, s70, 1
  s_cbranch_scc0 L_spin_12
L_sdone_13:
  v_readfirstlane_b32 s46, v4
  ds_read_b32 v4, v1 offset:656
  s_waitcnt lgkmcnt(0)
  v_readfirstlane_b32 s46, v4
  s_nop 0
  s_sub_u32 s68, s46, s65
  s_cmp_lg_u32 s68, 2
  s_cbranch_scc1 L_qlazy_14
  s_mov_b32 exec_lo, 0xff00ff
  s_mov_b32 exec_hi, 0xff00ff
  buffer_store_dwordx4 v[80:83], v90, s[24:27], s64 offen sc1
  s_mov_b64 exec, -1
  s_mov_b32 s65, 1
L_qlazy_14:
  s_cmp_lg_u32 s3, 8
  s_cbranch_scc1 L_role
  v_mov_b32 v1, 0
  s_mov_b32 s70, 200007
L_spin_15:
  ds_read_b32 v4, v1 offset:648
  s_waitcnt lgkmcnt(0)
  v_cmp_gt_u32 vcc, 8, v4
  s_nop 0
  s_cbranch_vccz L_sdone_16
  s_sleep 2
  s_sub_u32 s70, s70, 1
  s_cbranch_scc0 L_spin_15
L_sdone_16:
  s_lshl_b32 s68, s4, 5
  v_mov_b32 v6, s68
  v_mov_b32 v5, 1
  s_mov_b64 exec, 1
  global_atomic_add v5, v6, v5, s[56:57] sc0 sc1
  s_waitcnt vmcnt(0)
  v_and_b32 v5, 31, v5
  v_add_u32 v5, 1, v5
  ds_write_b32 v1, v5 offset:668
  s_mov_b64 exec, -1
  s_branch L_role
L_misc2:
  s_getreg_b32 s64, hwreg(HW_REG_XCC_ID)
  s_mov_b32 s24, s58
  s_mov_b32 s25, s59
  s_mov_b32 s26, 4194304
  s_mov_b32 s27, 0x20000
  s_add_u32 s32, s58, 4194304
  s_addc_u32 s33, s59, 0
  s_mov_b32 s34, 4194304
  s_mov_b32 s35, 0x20000
  s_lshl3_add_u32 s71, s6, s7
  s_lshr_b32 s79, s2, 3
  v_and_b32 v1, 31, v0
  v_lshlrev_b32 v1, 4, v1
  v_lshrrev_b32 v2, 5, v0
  v_lshl_add_u32 v1, v2, 13, v1
  s_lshl_b32 s66, s2, 9
  s_and_b32 s68, s66, 0xffffe000
  s_add_u32 s66, s66, s68
  s_add_u32 s66, s66, 131072
  v_mov_b32 v6, 0
  v_mov_b32 v7, 0
  s_cmp_ge_u32 s79, 4
  s_cbranch_scc1 L_nopr0
  s_mov_b32 exec_lo, 0xffff
  s_mov_b32 exec_hi, 0xffff
  buffer_store_dwordx4 v[4:7], v1, s[24:27], s66 offen sc1
  s_mov_b64 exec, -1
L_nopr0:
  s_waitcnt lgkmcnt(0)
  s_mul_i32 s30, s28, 0x2c9277b5
  s_add_u32 s30, s30, 0xac564b05
  s_mul_i32 s31, s29, 0x0019660d
  s_add_u32 s31, s31, 0x3c6ef35f
  s_and_b32 s64, s64, 15
  v_mov_b32 v4, s30
  v_mov_b32 v5, s31
  v_mov_b32 v6, s64
  v_mov_b32 v7, s64
  s_lshl_b32 s68, s4, 9
  s_add_u32 s68, s68, 1056768
  s_lshl_b32 s69, s79, 4
  v_mov_b32 v1, s69
  s_mov_b64 exec, 1
  buffer_store_dwordx4 v[4:7], v1, s[32:35], s68 offen
  s_mov_b64 exec, -1
  v_and_b32 v1, 31, v0
  v_lshlrev_b32 v1, 4, v1
  s_mov_b32 s70, 12
  s_mov_b32 s46, 2
L_idpoll:
  s_sleep 16
  buffer_load_dwordx4 v[8:11], v1, s[32:35], s68 offen sc1
  s_waitcnt vmcnt(0)
  v_cmp_ne_u64 vcc, s[30:31], v[8:9]
  s_nop 0
  s_cbranch_vccz L_iddone
  s_sub_u32 s70, s70, 1
  s_cbranch_scc0 L_idpoll
  s_branch L_idset
L_iddone:
  v_cmp_ne_u32 vcc, s64, v10
  s_nop 0
  s_cbranch_vccnz L_idset
  s_mov_b32 s46, 1
L_idset:
  v_mov_b32 v1, 0
  v_mov_b32 v4, s46
  ds_write_b32 v1, v4 offset:656
  s_mov_b32 s60, -1
  s_mov_b32 s61, -1
  s_lshl_b32 s67, s4, 9
  s_add_u32 s67, s67, 1069056
  s_cmp_ge_u32 s79, 4
  s_cbranch_scc1 L_nopr1
  s_waitcnt lgkmcnt(0)
  s_add_u32 s69, s66, 0
  s_memtime s[62:63]
  s_waitcnt lgkmcnt(0)
  s_load_dword s65, s[58:59], s69
  s_waitcnt lgkmcnt(0)
  s_memtime s[20:21]
  s_waitcnt lgkmcnt(0)
  s_sub_u32 s62, s20, s62
  s_min_u32 s60, s60, s62
  s_add_u32 s69, s66, 8192
  s_memtime s[62:63]
  s_waitcnt lgkmcnt(0)
  s_load_dword s65, s[58:59], s69
  s_waitcnt lgkmcnt(0)
  s_memtime s[20:21]
  s_waitcnt lgkmcnt(0)
  s_sub_u32 s62, s20, s62
  s_min_u32 s61, s61, s62
  s_add_u32 s69, s66, 128
  s_memtime s[62:63]
  s_waitcnt lgkmcnt(0)
  s_load_dword s65, s[58:59], s69
  s_waitcnt lgkmcnt(0)
  s_memtime s[20:21]
  s_waitcnt lgkmcnt(0)
  s_sub_u32 s62, s20, s62
  s_min_u32 s60, s60, s62
  s_add_u32 s69, s66, 8320
  s_memtime s[62:63]
  s_waitcnt lgkmcnt(0)
  s_load_dword s65, s[58:59], s69
  s_waitcnt lgkmcnt(0)
  s_memtime s[20:21]
  s_waitcnt lgkmcnt(0)
  s_sub_u32 s62, s20, s62
  s_min_u32 s61, s61, s62
  s_lshl_b32 s69, s79, 4
  v_mov_b32 v1, s69
  v_mov_b32 v4, s60
  v_mov_b32 v5, s61
  v_mov_b32 v6, s30
  v_mov_b32 v7, s31
  s_mov_b64 exec, 1
  buffer_store_dwordx4 v[4:7], v1, s[32:35], s67 offen
  s_mov_b64 exec, -1
L_nopr1:
  v_and_b32 v1, 7, v0
  v_lshlrev_b32 v1, 4, v1
  s_mov_b32 s70, 200007
L_spin_17:
  ds_read_b128 v[4:7], v1 offset:512
  s_waitcnt lgkmcnt(0)
  v_cmp_eq_u32 vcc, 0, v7
  s_nop 0
  s_cbranch_vccz L_sdone_18
  s_sleep 4
  s_sub_u32 s70, s70, 1
  s_cbranch_scc0 L_spin_17
L_sdone_18:
  s_mov_b32 s68, 0x3fb8aa3b
  v_mov_b32 v2, v4
  s_nop 1
  v_max_f32_dpp v2, v2, v2 quad_perm:[1,0,3,2] row_mask:0xf bank_mask:0xf
  s_nop 1
  v_max_f32_dpp v2, v2, v2 quad_perm:[2,3,0,1] row_mask:0xf bank_mask:0xf
  s_nop 1
  v_max_f32_dpp v2, v2, v2 row_half_mirror row_mask:0xf bank_mask:0xf
  v_sub_f32 v4, v4, v2
  v_mul_f32 v4, s68, v4
  v_exp_f32 v4, v4
  s_nop 0
  v_mul_f32 v3, v4, v5
  s_nop 1
  v_add_f32_dpp v3, v3, v3 quad_perm:[1,0,3,2] row_mask:0xf bank_mask:0xf
  s_nop 1
  v_add_f32_dpp v3, v3, v3 quad_perm:[2,3,0,1] row_mask:0xf bank_mask:0xf
  s_nop 1
  v_add_f32_dpp v3, v3, v3 row_half_mirror row_mask:0xf bank_mask:0xf
  s_lshl_b32 s68, s71, 4
  s_add_u32 s68, s68, 1052672
  v_mov_b32 v4, s30
  v_mov_b32 v5, s31
  s_mov_b32 exec_lo, 0x1
  s_mov_b32 exec_hi, 0x0
  buffer_store_dwordx4 v[2:5], v1, s[32:35], s68 offen
  s_mov_b64 exec, -1
  s_cmp_lg_u32 s46, 1
  s_cbranch_scc1 L_slow_19
L_back_20:
  s_cmp_lg_u32 s46, 1
  s_cbranch_scc1 L_noshare
  v_and_b32 v8, 7, v0
  v_lshlrev_b32 v8, 4, v8
  buffer_load_dwordx4 v[4:7], v8, s[32:35], s67 offen sc1
  s_waitcnt vmcnt(0)
  v_cmp_eq_u64 vcc, s[30:31], v[6:7]
  s_nop 1
  v_cndmask_b32 v4, -1, v4, vcc
  v_cndmask_b32 v5, -1, v5, vcc
  s_nop 0
  v_min_u32_dpp v4, v4, v4 quad_perm:[1,0,3,2] row_mask:0xf bank_mask:0xf
  v_min_u32_dpp v5, v5, v5 quad_perm:[1,0,3,2] row_mask:0xf bank_mask:0xf
  s_nop 0
  v_min_u32_dpp v4, v4, v4 quad_perm:[2,3,0,1] row_mask:0xf bank_mask:0xf
  v_min_u32_dpp v5, v5, v5 quad_perm:[2,3,0,1] row_mask:0xf bank_mask:0xf
  s_nop 0
  v_min_u32_dpp v4, v4, v4 row_half_mirror row_mask:0xf bank_mask:0xf
  v_min_u32_dpp v5, v5, v5 row_half_mirror row_mask:0xf bank_mask:0xf
  s_nop 0
  v_min_u32_dpp v4, v4, v4 row_mirror row_mask:0xf bank_mask:0xf
  v_min_u32_dpp v5, v5, v5 row_mirror row_mask:0xf bank_mask:0xf
  v_mov_b32 v6, v4
  v_mov_b32 v7, v5
  s_nop 0
  v_permlane16_swap_b32 v4, v6
  v_permlane16_swap_b32 v5, v7
  v_min_u32 v4, v4, v6
  v_min_u32 v5, v5, v7
  v_readfirstlane_b32 s62, v4
  v_readfirstlane_b32 s63, v5
  s_min_u32 s60, s60, s62
  s_min_u32 s61, s61, s63
L_noshare:
  s_cmp_lt_u32 s61, s60
  s_cselect_b32 s47, 8192, 0
  v_mov_b32 v8, 0
  v_mov_b32 v4, s47
  ds_write_b32 v8, v4 offset:664
  s_not_b32 s20, s30
  v_mov_b32 v12, s20
  v_mov_b32 v13, s20
  v_mov_b32 v14, s20
  v_mov_b32 v15, s20
  v_lshlrev_b32 v9, 4, v0
  s_mul_i32 s74, s71, 768
  s_add_u32 s74, s74, 1114112
  s_mov_b32 exec_hi, 0xffff
  buffer_store_dwordx4 v[12:15], v9, s[32:35], s74 offen
  s_mov_b32 exec_hi, -1
  s_lshl_b32 s74, s6, 7
  s_add_u32 s74, s74, 1052672
  s_mov_b32 s16, s32
  s_mov_b32 s17, s33
  s_mov_b32 s18, 4194304
  s_mov_b32 s19, 0x20000
  s_mov_b32 s70, 200007
L_spin_21:
  s_sleep 16
  buffer_load_dwordx4 v[4:7], v1, s[16:19], s74 offen sc1
  s_waitcnt vmcnt(0)
  v_cmp_ne_u64 vcc, s[30:31], v[6:7]
  s_nop 0
  s_cbranch_vccz L_sdone_22
  s_and_b32 s99, s70, 7
  s_cmp_eq_u32 s46, 1
  s_cselect_b32 s99, 1, s99
  s_cmp_lg_u32 s99, 0
  s_cselect_b32 s16, s32, s24
  s_cselect_b32 s17, s33, s25
  s_sub_u32 s70, s70, 1
  s_cbranch_scc0 L_spin_21
L_sdone_22:
  s_mov_b32 s68, 0x3fb8aa3b
  v_mov_b32 v2, v4
  s_nop 1
  v_max_f32_dpp v2, v2, v2 quad_perm:[1,0,3,2] row_mask:0xf bank_mask:0xf
  s_nop 1
  v_max_f32_dpp v2, v2, v2 quad_perm:[2,3,0,1] row_mask:0xf bank_mask:0xf
  s_nop 1
  v_max_f32_dpp v2, v2, v2 row_half_mirror row_mask:0xf bank_mask:0xf
  v_sub_f32 v4, v4, v2
  v_mul_f32 v4, s68, v4
  v_exp_f32 v4, v4
  s_nop 0
  v_mul_f32 v3, v4, v5
  s_nop 1
  v_add_f32_dpp v3, v3, v3 quad_perm:[1,0,3,2] row_mask:0xf bank_mask:0xf
  s_nop 1
  v_add_f32_dpp v3, v3, v3 quad_perm:[2,3,0,1] row_mask:0xf bank_mask:0xf
  s_nop 1
  v_add_f32_dpp v3, v3, v3 row_half_mirror row_mask:0xf bank_mask:0xf
  v_rcp_f32 v3, v3
  v_mov_b32 v4, 1
  v_mov_b32 v5, 1
  v_mov_b32 v1, 0
  ds_write_b128 v1, v[2:5] offset:672
  v_mov_b32 v1, 0
  s_mov_b32 s70, 200007
L_spin_23:
  ds_read_b32 v4, v1 offset:644
  s_waitcnt lgkmcnt(0)
  v_cmp_gt_u32 vcc, 8, v4
  s_nop 0
  s_cbranch_vccz L_sdone_24
  s_sleep 1
  s_sub_u32 s70, s70, 1
  s_cbranch_scc0 L_spin_23
L_sdone_24:
  s_lshl_b32 s68, s4, 9
  s_lshl4_add_u32 s68, s79, s68
  s_add_u32 s68, s68, 1060864
  v_mov_b32 v6, s30
  v_mov_b32 v7, s31
  s_mov_b64 exec, 1
  buffer_store_dwordx4 v[4:7], v1, s[32:35], s68 offen
  s_mov_b64 exec, -1
L_role:
  v_mov_b32 v1, 0
  s_mov_b32 s70, 200007
L_spin_25:
  ds_read_b64 v[4:5], v1 offset:664
  s_waitcnt lgkmcnt(0)
  v_cmp_eq_u32 vcc, 0, v5
  s_nop 0
  s_cbranch_vccz L_sdone_26
  s_sleep 4
  s_sub_u32 s70, s70, 1
  s_cbranch_scc0 L_spin_25
L_sdone_26:
  v_readfirstlane_b32 s5, v5
  v_readfirstlane_b32 s47, v4
  s_sub_u32 s5, s5, 1
  s_cmp_lt_u32 s5, 20
  s_cbranch_scc0 L_end
  s_mov_b32 s12, s44
  s_mov_b32 s13, s45
  s_mov_b32 s14, 7864320
  s_mov_b32 s15, 0x20000
  v_lshrrev_b32 v24, 4, v0
  v_lshlrev_b32 v24, 10, v24
  v_bfe_u32 v25, v0, 2, 2
  v_lshl_add_u32 v24, v25, 7, v24
  v_and_b32 v25, 3, v0
  v_lshl_add_u32 v24, v25, 3, v24
  s_cmp_ge_u32 s5, 10
  s_cselect_b32 s76, 1, 0
  s_mul_i32 s77, s76, 10
  s_sub_u32 s77, s5, s77
  s_lshl1_add_u32 s78, s4, s76
  s_lshl2_add_u32 s78, s78, s73
  v_lshrrev_b32 v2, 3, v0
  v_mul_u32_u24 v26, 1280, v2
  v_and_b32 v3, 7, v0
  v_lshl_add_u32 v26, v3, 4, v26
  s_mul_i32 s60, s78, 122880
  s_lshl_b32 s69, s77, 7
  s_add_u32 s60, s60, s69
  s_mul_i32 s61, s73, 12288
  v_add_u32 v24, s61, v24
  s_add_u32 s61, s61, 8704
  v_mul_u32_u24 v60, 768, v3
  v_lshl_add_u32 v60, v2, 4, v60
  s_lshr_b32 s68, s78, 1
  s_mul_i32 s74, s68, 6144
  s_and_b32 s68, s78, 1
  s_mul_i32 s68, s68, 384
  s_add_u32 s74, s74, s68
  s_add_u32 s74, s74, 1114112
  v_lshlrev_b32 v62, 2, v0
  s_lshl_b32 s68, s73, 8
  v_add_u32 v61, s68, v62
  s_mul_i32 s75, s4, 5120
  s_lshl_b32 s69, s5, 8
  s_add_u32 s75, s75, s69
  s_and_b32 s69, s75, 0xffffe000
  s_add_u32 s75, s75, s69
  s_add_u32 s75, s75, 0
  s_xor_b32 s62, s47, 8192
  s_add_u32 s62, s62, s75
  s_add_u32 s63, s47, s75
  s_mov_b32 s66, 0xff00ff00
  s_mov_b32 s67, 0xff00ff00
  v_mov_b32 v50, s30
  v_mov_b32 v51, s31
  v_cndmask_b32 v52, 0, v50, s[66:67]
  v_cndmask_b32 v53, 0, v51, s[66:67]
  v_cndmask_b32 v54, v50, 0, s[66:67]
  v_cndmask_b32 v55, v51, 0, s[66:67]
  v_mov_b32 v1, 0
  s_mov_b32 s70, 200007
L_spin_27:
  ds_read_b32 v4, v1 offset:644
  s_waitcnt lgkmcnt(0)
  v_cmp_gt_u32 vcc, 8, v4
  s_nop 0
  s_cbranch_vccz L_sdone_28
  s_sleep 1
  s_sub_u32 s70, s70, 1
  s_cbranch_scc0 L_spin_27
L_sdone_28:
  s_mov_b32 m0, s61
  s_nop 0
  buffer_load_dwordx4 v26, s[12:15], s60 offen nt lds
  s_add_u32 s60, s60, 10240
  s_add_u32 s61, s61, 1024
  s_mov_b32 m0, s61
  s_nop 0
  buffer_load_dwordx4 v26, s[12:15], s60 offen nt lds
  s_add_u32 s60, s60, 10240
  s_add_u32 s61, s61, 1024
  s_mov_b32 m0, s61
  s_nop 0
  buffer_load_dwordx4 v26, s[12:15], s60 offen nt lds
  s_add_u32 s60, s60, 10240
  s_add_u32 s61, s61, 1024
  s_mov_b32 m0, s61
  s_nop 0
  buffer_load_dwordx4 v26, s[12:15], s60 offen nt lds
  s_add_u32 s60, s60, 10240
  s_add_u32 s61, s61, 1024
  s_mov_b32 m0, s61
  s_nop 0
  buffer_load_dwordx4 v26, s[12:15], s60 offen nt lds
  s_add_u32 s60, s60, 10240
  s_add_u32 s61, s61, 1024
  s_mov_b32 m0, s61
  s_nop 0
  buffer_load_dwordx4 v26, s[12:15], s60 offen nt lds
  s_add_u32 s60, s60, 10240
  s_add_u32 s61, s61, 1024
  s_mov_b32 m0, s61
  s_nop 0
  buffer_load_dwordx4 v26, s[12:15], s60 offen nt lds
  s_add_u32 s60, s60, 10240
  s_add_u32 s61, s61, 1024
  s_mov_b32 m0, s61
  s_nop 0
  buffer_load_dwordx4 v26, s[12:15], s60 offen nt lds
  s_add_u32 s60, s60, 10240
  s_add_u32 s61, s61, 1024
  s_waitcnt vmcnt(7)
  s_mov_b32 m0, s61
  s_nop 0
  buffer_load_dwordx4 v26, s[12:15], s60 offen nt lds
  s_add_u32 s60, s60, 10240
  s_add_u32 s61, s61, 1024
  s_waitcnt vmcnt(7)
  s_mov_b32 m0, s61
  s_nop 0
  buffer_load_dwordx4 v26, s[12:15], s60 offen nt lds
  s_add_u32 s60, s60, 10240
  s_add_u32 s61, s61, 1024
  s_waitcnt vmcnt(7)
  s_mov_b32 m0, s61
  s_nop 0
  buffer_load_dwordx4 v26, s[12:15], s60 offen nt lds
  s_add_u32 s60, s60, 10240
  s_add_u32 s61, s61, 1024
  s_waitcnt vmcnt(7)
  s_mov_b32 m0, s61
  s_nop 0
  buffer_load_dwordx4 v26, s[12:15], s60 offen nt lds
  s_waitcnt vmcnt(8)
  ds_read_b64_tr_b16 v[64:65], v24 offset:8704
  ds_read_b64_tr_b16 v[66:67], v24 offset:9216
  ds_read_b64_tr_b16 v[68:69], v24 offset:8736
  ds_read_b64_tr_b16 v[70:71], v24 offset:9248
  ds_read_b64_tr_b16 v[72:73], v24 offset:8768
  ds_read_b64_tr_b16 v[74:75], v24 offset:9280
  ds_read_b64_tr_b16 v[76:77], v24 offset:8800
  ds_read_b64_tr_b16 v[78:79], v24 offset:9312
  s_waitcnt vmcnt(4)
  ds_read_b64_tr_b16 v[80:81], v24 offset:12800
  ds_read_b64_tr_b16 v[82:83], v24 offset:13312
  ds_read_b64_tr_b16 v[84:85], v24 offset:12832
  ds_read_b64_tr_b16 v[86:87], v24 offset:13344
  ds_read_b64_tr_b16 v[88:89], v24 offset:12864
  ds_read_b64_tr_b16 v[90:91], v24 offset:13376
  ds_read_b64_tr_b16 v[92:93], v24 offset:12896
  ds_read_b64_tr_b16 v[94:95], v24 offset:13408
  s_waitcnt vmcnt(0)
  ds_read_b64_tr_b16 v[96:97], v24 offset:16896
  ds_read_b64_tr_b16 v[98:99], v24 offset:17408
  ds_read_b64_tr_b16 v[100:101], v24 offset:16928
  ds_read_b64_tr_b16 v[102:103], v24 offset:17440
  ds_read_b64_tr_b16 v[104:105], v24 offset:16960
  ds_read_b64_tr_b16 v[106:107], v24 offset:17472
  ds_read_b64_tr_b16 v[108:109], v24 offset:16992
  ds_read_b64_tr_b16 v[110:111], v24 offset:17504
  v_mov_b32 v1, 0
  s_mov_b32 s70, 200007
L_spin_29:
  ds_read_b32 v4, v1 offset:640
  s_waitcnt lgkmcnt(0)
  v_cmp_gt_u32 vcc, 8, v4
  s_nop 0
  s_cbranch_vccz L_sdone_30
  s_sleep 1
  s_sub_u32 s70, s70, 1
  s_cbranch_scc0 L_spin_29
L_sdone_30:
  s_mov_b32 s16, s32
  s_mov_b32 s17, s33
  s_mov_b32 s18, 4194304
  s_mov_b32 s19, 0x20000
  s_mov_b32 s70, 200007
L_spin_31:
  buffer_load_dwordx4 v[8:11], v60, s[16:19], s74 offen offset:0 sc1
  buffer_load_dwordx4 v[12:15], v60, s[16:19], s74 offen offset:128 sc1
  buffer_load_dwordx4 v[16:19], v60, s[16:19], s74 offen offset:256 sc1
L_opw0:
  s_waitcnt vmcnt(2)
  v_xor_b32 v8, v8, v52
  v_xor_b32 v9, v9, v53
  v_xor_b32 v10, v10, v54
  v_xor_b32 v11, v11, v55
  s_nop 1
  v_mfma_f32_16x16x32_bf16 v[32:35], v[8:11], v[64:67], 0
  v_mfma_f32_16x16x32_bf16 v[36:39], v[8:11], v[68:71], 0
  v_mfma_f32_16x16x32_bf16 v[40:43], v[8:11], v[72:75], 0
  v_mfma_f32_16x16x32_bf16 v[44:47], v[8:11], v[76:79], 0
  v_or_b32 v2, v8, v9
  v_or_b32 v3, v10, v11
  s_waitcnt vmcnt(1)
  v_xor_b32 v12, v12, v52
  v_xor_b32 v13, v13, v53
  v_xor_b32 v14, v14, v54
  v_xor_b32 v15, v15, v55
  s_nop 1
  v_mfma_f32_16x16x32_bf16 v[32:35], v[12:15], v[80:83], v[32:35]
  v_mfma_f32_16x16x32_bf16 v[36:39], v[12:15], v[84:87], v[36:39]
  v_mfma_f32_16x16x32_bf16 v[40:43], v[12:15], v[88:91], v[40:43]
  v_mfma_f32_16x16x32_bf16 v[44:47], v[12:15], v[92:95], v[44:47]
  v_or3_b32 v2, v2, v12, v13
  v_or3_b32 v3, v3, v14, v15
  s_waitcnt vmcnt(0)
  v_xor_b32 v16, v16, v52
  v_xor_b32 v17, v17, v53
  v_xor_b32 v18, v18, v54
  v_xor_b32 v19, v19, v55
  s_nop 1
  v_mfma_f32_16x16x32_bf16 v[32:35], v[16:19], v[96:99], v[32:35]
  v_mfma_f32_16x16x32_bf16 v[36:39], v[16:19], v[100:103], v[36:39]
  v_mfma_f32_16x16x32_bf16 v[40:43], v[16:19], v[104:107], v[40:43]
  v_mfma_f32_16x16x32_bf16 v[44:47], v[16:19], v[108:111], v[44:47]
  v_or3_b32 v2, v2, v16, v17
  v_or3_b32 v3, v3, v18, v19
  v_cndmask_b32 v2, v3, v2, s[66:67]
  v_cmp_ne_u32 vcc, 0, v2
  s_nop 0
  s_cbranch_vccz L_sdone_32
  s_and_b32 s99, s70, 7
  s_cmp_eq_u32 s46, 1
  s_cselect_b32 s99, 1, s99
  s_cmp_lg_u32 s99, 0
  s_cselect_b32 s16, s32, s24
  s_cselect_b32 s17, s33, s25
  s_sub_u32 s70, s70, 1
  s_cbranch_scc0 L_spin_31
L_sdone_32:
  v_add_f32 v4, v32, v33
  v_add_f32 v8, v34, v35
  v_add_f32 v5, v36, v37
  v_add_f32 v9, v38, v39
  v_add_f32 v6, v40, v41
  v_add_f32 v10, v42, v43
  v_add_f32 v7, v44, v45
  v_add_f32 v11, v46, v47
  v_add_f32 v4, v4, v8
  v_add_f32 v5, v5, v9
  v_add_f32 v6, v6, v10
  v_add_f32 v7, v7, v11
  s_nop 0
  v_permlane32_swap_b32 v4, v6
  v_permlane32_swap_b32 v5, v7
  v_add_f32 v4, v4, v6
  v_add_f32 v5, v5, v7
  s_nop 1
  v_permlane16_swap_b32 v4, v5
  v_add_f32 v4, v4, v5
  ds_write_b32 v61, v4 offset:7168
  s_cmp_lg_u32 s3, 8
  s_waitcnt lgkmcnt(0)
  s_barrier
  s_cbranch_scc1 L_end
  ds_read_b32 v5, v62 offset:7424
  ds_read_b32 v6, v62 offset:7680
  ds_read_b32 v7, v62 offset:7936
  s_waitcnt lgkmcnt(0)
  v_add_f32 v4, v4, v5
  v_add_f32 v6, v6, v7
  v_add_f32 v48, v4, v6
  s_nop 1
  v_mov_b32_dpp v49, v48 quad_perm:[1,0,3,2] row_mask:0xf bank_mask:0xf
  v_cvt_pk_bf16_f32 v48, v48, v49
  s_nop 1
  v_mov_b32_dpp v49, v48 quad_perm:[2,3,0,1] row_mask:0xf bank_mask:0xf
  s_mov_b32 exec_lo, 0x11111111
  s_mov_b32 exec_hi, 0x11111111
  buffer_store_dwordx4 v[48:51], v62, s[24:27], s62 offen sc1
  buffer_store_dwordx4 v[48:51], v62, s[24:27], s63 offen sc1
  s_barrier
  s_endpgm
L_f1:
  v_lshrrev_b32 v58, 4, v0
  v_lshlrev_b32 v58, 10, v58
  v_bfe_u32 v5, v0, 2, 2
  v_lshl_add_u32 v58, v5, 7, v58
  v_and_b32 v5, 3, v0
  v_lshl_add_u32 v58, v5, 3, v58
  s_mov_b32 s12, s48
  s_mov_b32 s13, s49
  s_mov_b32 s14, 1966080
  s_mov_b32 s15, 0x20000
  s_mov_b32 s16, s50
  s_mov_b32 s17, s51
  s_mov_b32 s18, 1966080
  s_mov_b32 s19, 0x20000
  s_sub_u32 s75, s5, 20
  s_lshr_b32 s78, s75, 2
  s_mul_i32 s75, s75, 5
  s_add_u32 s75, s75, s3
  s_mul_i32 s68, s78, 20
  s_sub_u32 s74, s75, s68
  s_mul_i32 s68, s4, 3
  s_add_u32 s78, s78, s68
  s_mul_i32 s68, s4, 60
  s_add_u32 s75, s75, s68
  s_lshl_b32 s68, s3, 13
  v_add_u32 v58, s68, v58
  s_add_u32 s73, s68, 8704
  v_lshrrev_b32 v3, 4, v0
  v_and_b32 v2, 7, v0
  v_lshl_add_u32 v50, v2, 2, v3
  v_lshlrev_b32 v50, 1, v50
  s_lshl_b32 s68, s74, 6
  v_add_u32 v61, s68, v50
  s_lshl_b32 s68, s3, 6
  v_add_u32 v51, s68, v50
  v_lshlrev_b32 v52, 4, v3
  v_add_u32 v52, s68, v52
  v_lshlrev_b32 v54, 3, v2
  v_add_u32 v54, s68, v54
  v_lshrrev_b32 v53, 3, v0
  v_mul_u32_u24 v62, 3072, v53
  v_lshl_add_u32 v62, v2, 4, v62
  v_mul_u32_u24 v53, 2560, v53
  v_lshl_add_u32 v53, v2, 4, v53
  s_lshl_b32 s68, s74, 7
  v_add_u32 v53, s68, v53
  v_add_u32 v59, 20480, v53
  s_add_u32 s60, s47, 0
  v_lshlrev_b32 v55, 4, v0
  v_mov_b32 v57, 0
  v_cmp_eq_u32 s[62:63], 1, v3
  v_cmp_eq_u32 s[64:65], 2, v3
  v_cmp_eq_u32 s[66:67], 3, v3
  s_mul_i32 s76, s75, 1280
  s_add_u32 s76, s76, 2228224
  s_mov_b32 s77, 0xffff0000
  v_mov_b32 v14, s30
  v_mov_b32 v15, s31
  s_mul_i32 s72, s74, 98304
  s_lshl_b32 s68, s78, 7
  s_add_u32 s72, s72, s68
  v_and_b32 v4, 0xffffe000, v53
  v_add_u32 v53, v53, v4
  v_and_b32 v4, 0xffffe000, v59
  v_add_u32 v59, v59, v4
  s_not_b32 s20, s30
  v_mov_b32 v8, s20
  v_mov_b32 v9, s20
  v_mov_b32 v10, s20
  v_mov_b32 v11, s20
  buffer_store_dwordx4 v[8:11], v55, s[32:35], s76 offen
  s_mov_b64 exec, 0xffff
  buffer_store_dwordx4 v[8:11], v55, s[32:35], s76 offen offset:1024
  s_mov_b64 exec, -1
  v_mov_b32 v1, 0
  s_mov_b32 s70, 200007
L_spin_33:
  ds_read_b32 v4, v1 offset:660
  s_waitcnt lgkmcnt(0)
  v_cmp_gt_u32 vcc, 1, v4
  s_nop 0
  s_cbranch_vccz L_sdone_34
  s_sleep 1
  s_sub_u32 s70, s70, 1
  s_cbranch_scc0 L_spin_33
L_sdone_34:
  s_add_u32 m0, s73, 0
  s_nop 0
  buffer_load_dwordx4 v62, s[12:15], s72 offen nt lds
  s_add_u32 m0, s73, 4096
  s_nop 0
  buffer_load_dwordx4 v62, s[16:19], s72 offen nt lds
  s_add_u32 s72, s72, 24576
  s_add_u32 m0, s73, 1024
  s_nop 0
  buffer_load_dwordx4 v62, s[12:15], s72 offen nt lds
  s_add_u32 m0, s73, 5120
  s_nop 0
  buffer_load_dwordx4 v62, s[16:19], s72 offen nt lds
  s_add_u32 s72, s72, 24576
  s_add_u32 m0, s73, 2048
  s_nop 0
  buffer_load_dwordx4 v62, s[12:15], s72 offen nt lds
  s_add_u32 m0, s73, 6144
  s_nop 0
  buffer_load_dwordx4 v62, s[16:19], s72 offen nt lds
  s_add_u32 s72, s72, 24576
  s_add_u32 m0, s73, 3072
  s_nop 0
  buffer_load_dwordx4 v62, s[12:15], s72 offen nt lds
  s_add_u32 m0, s73, 7168
  s_nop 0
  buffer_load_dwordx4 v62, s[16:19], s72 offen nt lds
  global_load_ushort v56, v61, s[36:37]
  s_setprio 3
  s_waitcnt vmcnt(0)
  buffer_load_dwordx4 v[96:99], v53, s[24:27], s60 offen sc1
  buffer_load_dwordx4 v[100:103], v59, s[24:27], s60 offen sc1
  ds_read_b64_tr_b16 v[64:65], v58 offset:8704
  ds_read_b64_tr_b16 v[66:67], v58 offset:9216
  ds_read_b64_tr_b16 v[68:69], v58 offset:8736
  ds_read_b64_tr_b16 v[70:71], v58 offset:9248
  ds_read_b64_tr_b16 v[72:73], v58 offset:8768
  ds_read_b64_tr_b16 v[74:75], v58 offset:9280
  ds_read_b64_tr_b16 v[76:77], v58 offset:8800
  ds_read_b64_tr_b16 v[78:79], v58 offset:9312
  ds_read_b64_tr_b16 v[80:81], v58 offset:12800
  ds_read_b64_tr_b16 v[82:83], v58 offset:13312
  ds_read_b64_tr_b16 v[84:85], v58 offset:12832
  ds_read_b64_tr_b16 v[86:87], v58 offset:13344
  ds_read_b64_tr_b16 v[88:89], v58 offset:12864
  ds_read_b64_tr_b16 v[90:91], v58 offset:13376
  ds_read_b64_tr_b16 v[92:93], v58 offset:12896
  ds_read_b64_tr_b16 v[94:95], v58 offset:13408
  v_mov_b32 v8, 0x3f803f80
  v_mov_b32 v9, 0x3f803f80
  v_mov_b32 v10, 0x3f803f80
  v_mov_b32 v11, 0x3f803f80
  s_waitcnt lgkmcnt(0)
  s_nop 0
  v_mfma_f32_16x16x32_bf16 v[16:19], v[8:11], v[64:67], 0
  v_mfma_f32_16x16x32_bf16 v[20:23], v[8:11], v[68:71], 0
  v_mfma_f32_16x16x32_bf16 v[24:27], v[8:11], v[72:75], 0
  v_mfma_f32_16x16x32_bf16 v[28:31], v[8:11], v[76:79], 0
  v_mfma_f32_16x16x32_bf16 v[32:35], v[8:11], v[80:83], 0
  v_mfma_f32_16x16x32_bf16 v[36:39], v[8:11], v[84:87], 0
  v_mfma_f32_16x16x32_bf16 v[40:43], v[8:11], v[88:91], 0
  v_mfma_f32_16x16x32_bf16 v[44:47], v[8:11], v[92:95], 0
  s_nop 1
  v_cndmask_b32 v12, v16, v20, s[62:63]
  v_cndmask_b32 v12, v12, v24, s[64:65]
  v_cndmask_b32 v12, v12, v28, s[66:67]
  s_nop 0
  v_cndmask_b32 v13, v32, v36, s[62:63]
  v_cndmask_b32 v13, v13, v40, s[64:65]
  v_cndmask_b32 v13, v13, v44, s[66:67]
  v_cvt_pk_bf16_f32 v60, v12, v13
  s_waitcnt vmcnt(2)
  v_lshlrev_b32 v56, 16, v56
  s_mov_b32 s70, 200007
  s_branch L_ypw0
L_yppoll:
  buffer_load_dwordx4 v[96:99], v53, s[24:27], s60 offen sc1
  buffer_load_dwordx4 v[100:103], v59, s[24:27], s60 offen sc1
L_ypw0:
  s_waitcnt vmcnt(0)
  v_cmp_ne_u64 vcc, s[30:31], v[98:99]
  v_cmp_ne_u64 s[20:21], s[30:31], v[102:103]
  s_nop 0
  s_or_b64 vcc, vcc, s[20:21]
  s_nop 0
  s_cbranch_vccz L_ypok
  s_sub_u32 s70, s70, 1
  s_cbranch_scc0 L_yppoll
L_ypok:
  v_lshlrev_b32 v8, 16, v96
  v_lshlrev_b32 v24, 16, v100
  v_lshlrev_b32 v10, 16, v97
  v_lshlrev_b32 v26, 16, v101
  v_and_b32 v9, s77, v96
  v_and_b32 v25, s77, v100
  v_and_b32 v11, s77, v97
  v_and_b32 v27, s77, v101
  v_add_f32 v8, v8, v24
  v_add_f32 v10, v10, v26
  v_add_f32 v9, v9, v25
  v_add_f32 v11, v11, v27
  v_permlane32_swap_b32 v8, v10
  s_nop 0
  v_permlane32_swap_b32 v9, v11
  v_add_f32 v8, v8, v10
  v_add_f32 v9, v9, v11
  s_nop 1
  v_permlane16_swap_b32 v8, v9
  v_add_f32 v8, v8, v9
  s_nop 1
  v_add_f32_dpp v8, v8, v8 row_ror:8 row_mask:0xf bank_mask:0xf
  v_cvt_pk_bf16_f32 v8, v57, v8
  v_add_f32 v8, v8, v56
  v_cvt_pk_bf16_f32 v8, v8, v8
  ds_write_b16 v51, v8 offset:8192
  v_and_b32 v48, s77, v8
  v_mul_f32 v49, v48, v48
  s_waitcnt lgkmcnt(0)
  ds_read_b128 v[8:11], v52 offset:8192
  ds_read_b64 v[4:5], v54 offset:8192
  v_add_f32_dpp v48, v48, v48 quad_perm:[1,0,3,2] row_mask:0xf bank_mask:0xf
  v_add_f32_dpp v49, v49, v49 quad_perm:[1,0,3,2] row_mask:0xf bank_mask:0xf
  s_nop 0
  v_add_f32_dpp v48, v48, v48 quad_perm:[2,3,0,1] row_mask:0xf bank_mask:0xf
  v_add_f32_dpp v49, v49, v49 quad_perm:[2,3,0,1] row_mask:0xf bank_mask:0xf
  s_nop 0
  v_add_f32_dpp v48, v48, v48 row_half_mirror row_mask:0xf bank_mask:0xf
  v_add_f32_dpp v49, v49, v49 row_half_mirror row_mask:0xf bank_mask:0xf
  s_waitcnt lgkmcnt(0)
  v_mfma_f32_16x16x32_bf16 v[16:19], v[8:11], v[64:67], 0
  v_mfma_f32_16x16x32_bf16 v[20:23], v[8:11], v[68:71], 0
  v_mfma_f32_16x16x32_bf16 v[24:27], v[8:11], v[72:75], 0
  v_mfma_f32_16x16x32_bf16 v[28:31], v[8:11], v[76:79], 0
  v_mfma_f32_16x16x32_bf16 v[32:35], v[8:11], v[80:83], 0
  v_mfma_f32_16x16x32_bf16 v[36:39], v[8:11], v[84:87], 0
  v_mfma_f32_16x16x32_bf16 v[40:43], v[8:11], v[88:91], 0
  v_mfma_f32_16x16x32_bf16 v[44:47], v[8:11], v[92:95], 0
  v_mov_b32 v6, v48
  v_mov_b32 v7, v49
  s_nop 0
  v_permlane16_swap_b32 v48, v6
  v_permlane16_swap_b32 v49, v7
  v_add_f32 v48, v48, v6
  v_add_f32 v49, v49, v7
  v_mov_b32 v6, v48
  v_mov_b32 v7, v49
  s_nop 0
  v_permlane32_swap_b32 v48, v6
  v_permlane32_swap_b32 v49, v7
  v_add_f32 v48, v48, v6
  v_add_f32 v49, v49, v7
  s_mov_b32 s20, 0xff00
  s_mov_b32 s21, 0
  v_mov_b32 v6, s30
  v_mov_b32 v7, s31
  v_cndmask_b32 v4, v4, v48, s[20:21]
  v_cndmask_b32 v5, v5, v49, s[20:21]
  v_cndmask_b32 v12, v16, v20, s[62:63]
  v_cndmask_b32 v12, v12, v24, s[64:65]
  v_cndmask_b32 v12, v12, v28, s[66:67]
  v_cndmask_b32 v13, v32, v36, s[62:63]
  v_cndmask_b32 v13, v13, v40, s[64:65]
  v_cndmask_b32 v13, v13, v44, s[66:67]
  v_cvt_pk_bf16_f32 v12, v12, v13
  v_mov_b32 v13, v60
  buffer_store_dwordx4 v[12:15], v55, s[32:35], s76 offen
  s_mov_b32 exec_lo, 0xffff
  s_mov_b32 exec_hi, 0x0
  buffer_store_dwordx4 v[4:7], v55, s[32:35], s76 offen offset:1024
  s_mov_b64 exec, -1
  s_cmp_lg_u32 s46, 1
  s_cbranch_scc1 L_slow_35
L_back_36:
  s_endpgm
L_ffn:
  v_mov_b32 v57, 0
  s_mul_i32 s72, s4, 12
  s_add_u32 s72, s72, s5
  s_cmp_lt_u32 s3, 5
  s_cbranch_scc1 L_f2
  s_cmp_eq_u32 s3, 5
  s_cbranch_scc1 L_hid
  s_cmp_ge_u32 s5, 10
  s_cbranch_scc1 L_end
  s_mul_i32 s72, s4, 10
  s_add_u32 s72, s72, s5
  v_lshrrev_b32 v2, 1, v0
  v_mul_u32_u24 v2, 2560, v2
  v_and_b32 v3, 1, v0
  v_lshl_add_u32 v96, v3, 4, v2
  s_lshl_b32 s68, s72, 5
  v_add_u32 v96, s68, v96
  v_add_u32 v100, 81920, v96
  v_add_u32 v101, 163840, v96
  s_add_u32 s10, s47, 524288
  v_lshrrev_b32 v4, 4, v0
  v_lshl_add_u32 v97, v3, 2, v4
  v_lshlrev_b32 v97, 1, v97
  v_lshlrev_b32 v99, 4, v3
  v_and_b32 v98, 16, v0
  s_lshr_b32 s68, s72, 2
  s_mul_i32 s13, s4, 60
  s_add_u32 s13, s13, s68
  s_mul_i32 s13, s13, 1280
  s_and_b32 s68, s72, 3
  s_lshl_b32 s68, s68, 5
  s_add_u32 s13, s13, s68
  s_add_u32 s13, s13, 2229248
  s_lshl_b32 s14, s72, 4
  s_mov_b32 s69, 0xffff0000
  v_and_b32 v4, 0xffffe000, v96
  v_add_u32 v96, v96, v4
  v_and_b32 v4, 0xffffe000, v100
  v_add_u32 v100, v100, v4
  v_and_b32 v4, 0xffffe000, v101
  v_add_u32 v101, v101, v4
  s_mov_b32 s64, s54
  s_mov_b32 s65, s55
  s_mov_b32 s66, 1280
  s_mov_b32 s67, 0x20000
  v_cmp_lt_u32 s[62:63], 31, v0
  s_setprio 3
  s_barrier
  s_barrier
  v_mov_b32 v1, 0
  s_mov_b32 s70, 200007
L_spin_37:
  ds_read_b32 v4, v1 offset:652
  s_waitcnt lgkmcnt(0)
  v_cmp_gt_u32 vcc, 1, v4
  s_nop 0
  s_cbranch_vccz L_sdone_38
  s_sleep 2
  s_sub_u32 s70, s70, 1
  s_cbranch_scc0 L_spin_37
L_sdone_38:
  s_sleep 14
  s_mov_b32 s16, s32
  s_mov_b32 s17, s33
  s_mov_b32 s18, 4194304
  s_mov_b32 s19, 0x20000
  s_mov_b32 s70, 200007
L_spin_39:
  buffer_load_dwordx4 v[4:7], v99, s[16:19], s13 offen sc1
  buffer_load_dwordx4 v[16:19], v96, s[24:27], s10 offen sc1
  buffer_load_dwordx4 v[20:23], v100, s[24:27], s10 offen sc1
  buffer_load_dwordx4 v[24:27], v101, s[24:27], s10 offen sc1
  s_waitcnt vmcnt(0)
  v_cmp_ne_u64 vcc, s[30:31], v[6:7]
  v_cmp_ne_u64 s[20:21], s[30:31], v[18:19]
  v_cmp_ne_u64 s[22:23], s[30:31], v[22:23]
  s_or_b64 vcc, vcc, s[20:21]
  v_cmp_ne_u64 s[20:21], s[30:31], v[26:27]
  s_or_b64 vcc, vcc, s[22:23]
  s_or_b64 vcc, vcc, s[20:21]
  s_nop 0
  s_cbranch_vccz L_sdone_40
  s_and_b32 s99, s70, 7
  s_cmp_eq_u32 s46, 1
  s_cselect_b32 s99, 1, s99
  s_cmp_lg_u32 s99, 0
  s_cselect_b32 s16, s32, s24
  s_cselect_b32 s17, s33, s25
  s_sub_u32 s70, s70, 1
  s_cbranch_scc0 L_spin_39
L_sdone_40:
  v_lshlrev_b32 v40, 16, v16
  v_and_b32 v41, s69, v16
  v_lshlrev_b32 v42, 16, v17
  v_and_b32 v43, s69, v17
  v_lshlrev_b32 v44, 16, v20
  v_and_b32 v45, s69, v20
  v_lshlrev_b32 v46, 16, v21
  v_and_b32 v47, s69, v21
  v_lshlrev_b32 v48, 16, v24
  v_and_b32 v49, s69, v24
  v_lshlrev_b32 v50, 16, v25
  v_and_b32 v51, s69, v25
  v_add_f32 v8, v40, v44
  v_add_f32 v9, v41, v45
  v_add_f32 v10, v42, v46
  v_add_f32 v11, v43, v47
  v_add_f32 v8, v8, v48
  v_add_f32 v9, v9, v49
  v_add_f32 v10, v10, v50
  v_add_f32 v11, v11, v51
  v_cndmask_b32 v58, v4, v5, s[62:63]
  v_permlane32_swap_b32 v8, v10
  v_permlane32_swap_b32 v9, v11
  v_add_f32 v8, v8, v10
  v_add_f32 v9, v9, v11
  v_lshrrev_b32 v58, v98, v58
  v_lshlrev_b32 v58, 16, v58
  v_permlane16_swap_b32 v8, v9
  v_add_f32 v8, v8, v9
  s_nop 1
  v_add_f32_dpp v8, v8, v8 row_ror:8 row_mask:0xf bank_mask:0xf
  s_nop 1
  v_add_f32_dpp v8, v8, v8 row_ror:4 row_mask:0xf bank_mask:0xf
  s_nop 1
  v_add_f32_dpp v8, v8, v8 quad_perm:[2,3,0,1] row_mask:0xf bank_mask:0xf
  v_cvt_pk_bf16_f32 v8, v57, v8
  v_add_f32 v8, v8, v58
  v_cvt_pk_bf16_f32 v8, v8, v8
  s_mov_b32 exec_lo, 0x30003
  s_mov_b32 exec_hi, 0x30003
  buffer_store_short v8, v97, s[64:67], s14 offen
  s_cmp_lg_u32 s72, 0
  s_cbranch_scc1 L_fin_exit
  s_mov_b64 exec, 1
  v_mov_b32 v4, s30
  v_mov_b32 v5, s31
  s_mov_b32 s68, 1044480
  buffer_store_dwordx2 v[4:5], v57, s[24:27], s68 offen
L_fin_exit:
  s_endpgm
L_hid:
  v_lshrrev_b32 v4, 5, v0
  v_and_b32 v2, 7, v0
  v_lshl_add_u32 v62, v2, 1, v4
  v_lshlrev_b32 v2, 4, v62
  v_lshlrev_b32 v62, 1, v62
  v_bfe_u32 v3, v0, 3, 2
  v_mul_u32_u24 v60, 1280, v3
  v_add_u32 v60, v60, v2
  v_and_b32 v3, 31, v0
  v_mul_u32_u24 v61, 1280, v3
  s_lshr_b32 s68, s72, 2
  s_mul_i32 s65, s68, 25600
  s_add_u32 s65, s65, 2228224
  s_and_b32 s73, s72, 3
  s_lshl_b32 s73, s73, 8
  s_add_u32 s60, s65, s73
  s_add_u32 s61, s60, 5120
  s_add_u32 s62, s60, 10240
  s_add_u32 s63, s60, 15360
  s_add_u32 s64, s60, 20480
  v_mov_b32 v36, 0
  v_mov_b32 v37, 0
  v_mov_b32 v38, s30
  v_mov_b32 v39, s31
  v_mov_b32 v59, 1
  s_mov_b32 s69, 0xffff0000
  s_setprio 3
  s_barrier
  s_barrier
  s_mov_b32 s16, s32
  s_mov_b32 s17, s33
  s_mov_b32 s18, 4194304
  s_mov_b32 s19, 0x20000
  s_mov_b32 s70, 200007
L_spin_41:
  s_mov_b32 exec_lo, 0xfffff
  s_mov_b32 exec_hi, 0xfffff
  buffer_load_dwordx4 v[36:39], v61, s[16:19], s65 offen offset:1152 sc1
  s_mov_b64 exec, -1
  buffer_load_dwordx4 v[16:19], v60, s[16:19], s60 offen sc1
  buffer_load_dwordx4 v[20:23], v60, s[16:19], s61 offen sc1
  buffer_load_dwordx4 v[24:27], v60, s[16:19], s62 offen sc1
  buffer_load_dwordx4 v[28:31], v60, s[16:19], s63 offen sc1
  buffer_load_dwordx4 v[32:35], v60, s[16:19], s64 offen sc1
  s_waitcnt vmcnt(0)
  v_cmp_ne_u64 vcc, s[30:31], v[38:39]
  v_cmp_ne_u64 s[20:21], s[30:31], v[18:19]
  v_cmp_ne_u64 s[22:23], s[30:31], v[22:23]
  s_or_b64 vcc, vcc, s[20:21]
  v_cmp_ne_u64 s[20:21], s[30:31], v[26:27]
  s_or_b64 vcc, vcc, s[22:23]
  v_cmp_ne_u64 s[22:23], s[30:31], v[30:31]
  s_or_b64 vcc, vcc, s[20:21]
  v_cmp_ne_u64 s[20:21], s[30:31], v[34:35]
  s_or_b64 vcc, vcc, s[22:23]
  s_or_b64 vcc, vcc, s[20:21]
  s_nop 0
  s_cbranch_vccz L_sdone_42
  s_and_b32 s99, s70, 7
  s_cmp_eq_u32 s46, 1
  s_cselect_b32 s99, 1, s99
  s_cmp_lg_u32 s99, 0
  s_cselect_b32 s16, s32, s24
  s_cselect_b32 s17, s33, s25
  s_sub_u32 s70, s70, 1
  s_cbranch_scc0 L_spin_41
L_sdone_42:
  v_add_f32_dpp v36, v36, v36 quad_perm:[1,0,3,2] row_mask:0xf bank_mask:0xf
  v_add_f32_dpp v37, v37, v37 quad_perm:[1,0,3,2] row_mask:0xf bank_mask:0xf
  v_lshlrev_b32 v8, 16, v16
  v_and_b32 v9, s69, v16
  v_lshlrev_b32 v10, 16, v17
  v_and_b32 v11, s69, v17
  v_add_f32_dpp v36, v36, v36 quad_perm:[2,3,0,1] row_mask:0xf bank_mask:0xf
  v_add_f32_dpp v37, v37, v37 quad_perm:[2,3,0,1] row_mask:0xf bank_mask:0xf
  v_lshlrev_b32 v40, 16, v20
  v_and_b32 v41, s69, v20
  v_lshlrev_b32 v42, 16, v21
  v_and_b32 v43, s69, v21
  v_add_f32_dpp v36, v36, v36 row_half_mirror row_mask:0xf bank_mask:0xf
  v_add_f32_dpp v37, v37, v37 row_half_mirror row_mask:0xf bank_mask:0xf
  v_lshlrev_b32 v44, 16, v24
  v_and_b32 v45, s69, v24
  v_lshlrev_b32 v46, 16, v25
  v_and_b32 v47, s69, v25
  v_add_f32_dpp v36, v36, v36 row_mirror row_mask:0xf bank_mask:0xf
  v_add_f32_dpp v37, v37, v37 row_mirror row_mask:0xf bank_mask:0xf
  v_lshlrev_b32 v48, 16, v28
  v_and_b32 v49, s69, v28
  v_lshlrev_b32 v50, 16, v29
  v_and_b32 v51, s69, v29
  v_mov_b32 v22, v36
  v_mov_b32 v23, v37
  v_lshlrev_b32 v52, 16, v32
  v_and_b32 v53, s69, v32
  v_lshlrev_b32 v54, 16, v33
  v_and_b32 v55, s69, v33
  v_permlane16_swap_b32 v36, v22
  v_permlane16_swap_b32 v37, v23
  v_add_f32 v8, v8, v40
  v_add_f32 v9, v9, v41
  v_add_f32 v10, v10, v42
  v_add_f32 v11, v11, v43
  v_add_f32 v36, v36, v22
  v_add_f32 v37, v37, v23
  v_add_f32 v44, v44, v48
  v_add_f32 v45, v45, v49
  v_add_f32 v46, v46, v50
  v_add_f32 v47, v47, v51
  v_mul_f32 v20, 0x3acccccd, v36
  v_mul_f32 v21, 0x3acccccd, v37
  v_add_f32 v8, v8, v52
  v_add_f32 v9, v9, v53
  v_add_f32 v10, v10, v54
  v_add_f32 v11, v11, v55
  v_fma_f32 v21, -v20, v20, v21
  v_max_f32 v21, 0, v21
  v_add_f32 v8, v8, v44
  v_add_f32 v9, v9, v45
  v_add_f32 v10, v10, v46
  v_add_f32 v11, v11, v47
  v_cvt_pk_bf16_f32 v20, v57, v20
  v_cvt_pk_bf16_f32 v21, v57, v21
  v_fma_f32 v8, -v20, v10, v8
  v_fma_f32 v9, -v20, v11, v9
  v_add_f32 v21, 0x3727c5ac, v21
  v_cvt_pk_bf16_f32 v21, v57, v21
  v_add_f32_dpp v8, v8, v8 row_ror:8 row_mask:0xf bank_mask:0xf
  v_add_f32_dpp v9, v9, v9 row_ror:8 row_mask:0xf bank_mask:0xf
  v_sqrt_f32 v21, v21
  v_mov_b32 v10, v8
  v_mov_b32 v11, v9
  v_cvt_pk_bf16_f32 v21, v57, v21
  v_permlane16_swap_b32 v8, v10
  v_rcp_f32 v21, v21
  v_permlane16_swap_b32 v9, v11
  v_add_f32 v8, v8, v10
  v_add_f32 v9, v9, v11
  v_mul_f32 v8, v8, v21
  v_mul_f32 v9, v9, v21
  v_cvt_pk_bf16_f32 v8, v57, v8
  v_cvt_pk_bf16_f32 v9, v57, v9
  v_mul_f32 v12, 0xbfb8aa3b, v8
  v_exp_f32 v12, v12
  s_nop 0
  v_add_f32 v12, 1.0, v12
  v_rcp_f32 v12, v12
  s_nop 0
  v_mul_f32 v8, v8, v12
  v_cvt_pk_bf16_f32 v8, v57, v8
  v_mul_f32 v8, v8, v9
  v_cvt_pk_bf16_f32 v8, v8, v8
  ds_write_b16 v62, v8 offset:896
  ds_write_b32 v57, v59 offset:652
  s_endpgm
L_f2:
  s_mov_b32 s8, s52
  s_mov_b32 s9, s53
  s_mov_b32 s10, 1966080
  s_mov_b32 s11, 0x20000
  s_lshl_b32 s68, s3, 8
  v_lshlrev_b32 v58, 2, v0
  v_add_u32 v58, s68, v58
  v_lshlrev_b32 v116, 1, v58
  s_mul_i32 s68, s72, 2560
  v_add_u32 v116, s68, v116
  s_xor_b32 s78, s47, 8192
  s_add_u32 s78, s78, 524288
  s_add_u32 s77, s47, 524288
  s_mov_b32 s60, 0x05040100
  s_mov_b32 s61, 0x07060302
  s_mul_i32 s62, s72, 20480
  v_and_b32 v4, 0xffffe000, v116
  v_add_u32 v116, v116, v4
  s_setprio 3
  s_barrier
  s_barrier
  buffer_load_dword v64, v58, s[8:11], s62 offen offset:0 nt
  buffer_load_dword v65, v58, s[8:11], s62 offen offset:1280 nt
  buffer_load_dword v66, v58, s[8:11], s62 offen offset:2560 nt
  s_add_u32 s62, s62, 3840
  buffer_load_dword v67, v58, s[8:11], s62 offen offset:0 nt
  buffer_load_dword v68, v58, s[8:11], s62 offen offset:1280 nt
  buffer_load_dword v69, v58, s[8:11], s62 offen offset:2560 nt
  s_add_u32 s62, s62, 3840
  buffer_load_dword v70, v58, s[8:11], s62 offen offset:0 nt
  buffer_load_dword v71, v58, s[8:11], s62 offen offset:1280 nt
  buffer_load_dword v72, v58, s[8:11], s62 offen offset:2560 nt
  s_add_u32 s62, s62, 3840
  buffer_load_dword v73, v58, s[8:11], s62 offen offset:0 nt
  buffer_load_dword v74, v58, s[8:11], s62 offen offset:1280 nt
  buffer_load_dword v75, v58, s[8:11], s62 offen offset:2560 nt
  s_add_u32 s62, s62, 3840
  buffer_load_dword v76, v58, s[8:11], s62 offen offset:0 nt
  buffer_load_dword v77, v58, s[8:11], s62 offen offset:1280 nt
  buffer_load_dword v78, v58, s[8:11], s62 offen offset:2560 nt
  s_add_u32 s62, s62, 3840
  buffer_load_dword v79, v58, s[8:11], s62 offen offset:0 nt
  s_waitcnt vmcnt(0)
  v_perm_b32 v80, v65, v64, s60
  v_perm_b32 v88, v65, v64, s61
  v_perm_b32 v81, v67, v66, s60
  v_perm_b32 v89, v67, v66, s61
  v_perm_b32 v82, v69, v68, s60
  v_perm_b32 v90, v69, v68, s61
  v_perm_b32 v83, v71, v70, s60
  v_perm_b32 v91, v71, v70, s61
  v_perm_b32 v84, v73, v72, s60
  v_perm_b32 v92, v73, v72, s61
  v_perm_b32 v85, v75, v74, s60
  v_perm_b32 v93, v75, v74, s61
  v_perm_b32 v86, v77, v76, s60
  v_perm_b32 v94, v77, v76, s61
  v_perm_b32 v87, v79, v78, s60
  v_perm_b32 v95, v79, v78, s61
  v_mov_b32 v16, 0
  v_mov_b32 v17, 0
  v_mov_b32 v6, s30
  v_mov_b32 v7, s31
  s_mov_b32 s70, 200007
L_spin_43:
  ds_read_b32 v4, v57 offset:652
  ds_read_b128 v[8:11], v57 offset:896
  ds_read_b128 v[12:15], v57 offset:912
  s_waitcnt lgkmcnt(0)
  v_cmp_eq_u32 vcc, 0, v4
  s_nop 0
  s_cbranch_vccz L_sdone_44
  s_sub_u32 s70, s70, 1
  s_cbranch_scc0 L_spin_43
L_sdone_44:
  v_dot2c_f32_bf16 v16, v8, v80
  v_dot2c_f32_bf16 v17, v8, v88
  v_dot2c_f32_bf16 v16, v9, v81
  v_dot2c_f32_bf16 v17, v9, v89
  v_dot2c_f32_bf16 v16, v10, v82
  v_dot2c_f32_bf16 v17, v10, v90
  v_dot2c_f32_bf16 v16, v11, v83
  v_dot2c_f32_bf16 v17, v11, v91
  v_dot2c_f32_bf16 v16, v12, v84
  v_dot2c_f32_bf16 v17, v12, v92
  v_dot2c_f32_bf16 v16, v13, v85
  v_dot2c_f32_bf16 v17, v13, v93
  v_dot2c_f32_bf16 v16, v14, v86
  v_dot2c_f32_bf16 v17, v14, v94
  v_dot2c_f32_bf16 v16, v15, v87
  v_dot2c_f32_bf16 v17, v15, v95
  s_nop 2
  v_cvt_pk_bf16_f32 v4, v16, v17
  s_nop 1
  v_mov_b32_dpp v5, v4 quad_perm:[1,0,3,2] row_mask:0xf bank_mask:0xf
  s_mov_b32 exec_lo, 0x55555555
  s_mov_b32 exec_hi, 0x55555555
  buffer_store_dwordx4 v[4:7], v116, s[24:27], s78 offen sc1
  buffer_store_dwordx4 v[4:7], v116, s[24:27], s77 offen sc1
L_end:
  s_endpgm
L_slow_5:
  s_mov_b32 exec_lo, 0xffffffff
  s_mov_b32 exec_hi, 0xffff
  buffer_store_dwordx4 v[4:7], v12, s[24:27], s74 offen sc1
  s_mov_b64 exec, -1
  s_nop 1
  s_branch L_back_6
L_slow_19:
  s_mov_b32 exec_lo, 0x1
  s_mov_b32 exec_hi, 0x0
  buffer_store_dwordx4 v[2:5], v1, s[24:27], s68 offen sc1
  s_mov_b64 exec, -1
  s_nop 1
  s_branch L_back_20
L_slow_35:
  buffer_store_dwordx4 v[12:15], v55, s[24:27], s76 offen sc1
  s_mov_b32 exec_lo, 0xffff
  s_mov_b32 exec_hi, 0x0
  buffer_store_dwordx4 v[4:7], v55, s[24:27], s76 offen offset:1024 sc1
  s_mov_b64 exec, -1
  s_nop 1
  s_branch L_back_36
L_codeend:
.section .rodata,"a"
.p2align 6
.amdhsa_kernel sequential_preLN__sliding_block_cached__glu_gated_swiglu__decode_kernel
  .amdhsa_next_free_vgpr 168
  .amdhsa_next_free_sgpr 100
  .amdhsa_accum_offset 168
  .amdhsa_group_segment_fixed_size 0
  .amdhsa_kernarg_size 96
  .amdhsa_user_sgpr_count 2
  .amdhsa_user_sgpr_kernarg_segment_ptr 1
  .amdhsa_system_sgpr_workgroup_id_x 1
.end_amdhsa_kernel
```

```asm
; @launch grid=(256,1,1) block=(768,1,1) lds=57856
.amdgcn_target "amdgcn-amd-amdhsa--gfx950"
.text
.globl sequential_preLN__sliding_block_cached__glu_gated_swiglu__decode_kernel
.p2align 8
.type sequential_preLN__sliding_block_cached__glu_gated_swiglu__decode_kernel,@function
sequential_preLN__sliding_block_cached__glu_gated_swiglu__decode_kernel:
  s_cmp_ge_u32 s2, 256
  s_cbranch_scc1 L_end
  s_load_dwordx2 s[8:9], s[0:1], 8
  s_load_dwordx16 s[36:51], s[0:1], 0
  s_load_dwordx8 s[52:59], s[0:1], 64
  v_lshrrev_b32 v1, 6, v0
  v_and_b32 v0, 63, v0
  v_readfirstlane_b32 s3, v1
  s_and_b32 s4, s2, 7
  s_lshr_b32 s79, s2, 6
  s_lshl2_add_u32 s6, s4, s79
  s_bfe_u32 s7, s2, 0x30003
  s_cmp_lg_u32 s3, 0
  s_cbranch_scc1 L_nocpf
  s_getpc_b64 s[20:21]
L_pc0:
  s_mul_i32 s68, s7, 2048
  v_min_u32 v8, 15, v0
  v_lshl_add_u32 v8, v8, 7, s68
  v_min_u32 v8, L_codeend-L_pc0-4, v8
  global_load_dword v10, v8, s[20:21]
L_nocpf:
  v_lshrrev_b32 v2, 3, v0
  v_and_b32 v3, 7, v0
  v_lshlrev_b32 v3, 4, v3
  s_mov_b32 s11, 0x20000
  s_cmp_gt_u32 s3, 7
  s_cbranch_scc1 L_helper
  s_lshl3_add_u32 s68, s7, s3
  s_mul_i32 s60, s6, 4096
  s_add_u32 s60, s60, s68
  s_addk_i32 s60, 3584
  s_mul_i32 s60, s60, 3072
  v_mul_u32_u24 v2, 384, v2
  v_add_u32 v1, v2, v3
  s_mov_b32 s10, 402653184
  s_waitcnt lgkmcnt(0)
  buffer_load_dwordx4 v[16:19], v1, s[8:11], s60 offen offset:0 nt
  buffer_load_dwordx4 v[20:23], v1, s[8:11], s60 offen offset:128 nt
  buffer_load_dwordx4 v[24:27], v1, s[8:11], s60 offen offset:256 nt
  s_barrier
  s_branch L_stream
L_helper:
  v_lshlrev_b32 v1, 3, v0
  v_mov_b32 v4, 0
  v_mov_b32 v5, 0
  ds_write_b64 v1, v[4:5] offset:384
  s_sub_u32 s73, s3, 8
  s_cmp_eq_u32 s3, 11
  s_cbranch_scc1 L_misc
  s_mul_i32 s68, s7, 80
  v_add_u32 v7, s68, v2
  v_lshlrev_b32 v7, 1, v7
  v_mul_u32_u24 v2, 12288, v2
  v_add_u32 v2, v2, v3
  s_mul_i32 s68, s68, 12288
  s_mul_i32 s69, s6, 384
  s_add_u32 s68, s68, s69
  s_lshl_b32 s69, s73, 7
  s_add_u32 s68, s68, s69
  v_lshlrev_b32 v1, 2, v0
  s_setprio 3
  s_waitcnt lgkmcnt(0)
  s_barrier
  s_mov_b32 s8, s42
  s_mov_b32 s9, s43
  s_mov_b32 s10, 7864320
  global_load_dword v64, v1, s[36:37] offset:0
  global_load_dword v65, v1, s[36:37] offset:256
  global_load_dword v66, v1, s[36:37] offset:512
  global_load_dword v67, v1, s[36:37] offset:768
  global_load_dword v68, v1, s[36:37] offset:1024
  global_load_ushort v8, v7, s[36:37] offset:0
  global_load_ushort v9, v7, s[36:37] offset:16
  global_load_ushort v10, v7, s[36:37] offset:32
  global_load_ushort v11, v7, s[36:37] offset:48
  global_load_ushort v12, v7, s[36:37] offset:64
  global_load_ushort v13, v7, s[36:37] offset:80
  global_load_ushort v14, v7, s[36:37] offset:96
  global_load_ushort v15, v7, s[36:37] offset:112
  global_load_ushort v16, v7, s[36:37] offset:128
  global_load_ushort v17, v7, s[36:37] offset:144
  buffer_load_dwordx4 v[24:27], v2, s[8:11], s68 offen nt
  s_add_u32 s68, s68, 98304
  buffer_load_dwordx4 v[28:31], v2, s[8:11], s68 offen nt
  s_add_u32 s68, s68, 98304
  buffer_load_dwordx4 v[32:35], v2, s[8:11], s68 offen nt
  s_add_u32 s68, s68, 98304
  buffer_load_dwordx4 v[36:39], v2, s[8:11], s68 offen nt
  s_add_u32 s68, s68, 98304
  buffer_load_dwordx4 v[40:43], v2, s[8:11], s68 offen nt
  s_add_u32 s68, s68, 98304
  buffer_load_dwordx4 v[44:47], v2, s[8:11], s68 offen nt
  s_add_u32 s68, s68, 98304
  buffer_load_dwordx4 v[48:51], v2, s[8:11], s68 offen nt
  s_add_u32 s68, s68, 98304
  buffer_load_dwordx4 v[52:55], v2, s[8:11], s68 offen nt
  s_add_u32 s68, s68, 98304
  buffer_load_dwordx4 v[56:59], v2, s[8:11], s68 offen nt
  s_add_u32 s68, s68, 98304
  buffer_load_dwordx4 v[60:63], v2, s[8:11], s68 offen nt
  s_load_dwordx2 s[28:29], s[58:59], 1044480
  s_branch L_q2
L_misc:
  s_setprio 3
  s_waitcnt lgkmcnt(0)
  s_barrier
  s_load_dwordx2 s[28:29], s[58:59], 1044480
  s_branch L_misc2
L_stream:
  s_add_u32 s61, s60, 196608
  s_waitcnt vmcnt(2)
  buffer_load_dwordx4 v[28:31], v1, s[8:11], s61 offen offset:0 nt
  s_load_dwordx2 s[28:29], s[58:59], 1044480
  s_mov_b32 s24, s58
  s_mov_b32 s25, s59
  s_mov_b32 s26, 4194304
  s_mov_b32 s27, 0x20000
  s_add_u32 s32, s58, 4194304
  s_addc_u32 s33, s59, 0
  s_mov_b32 s34, 4194304
  s_mov_b32 s35, 0x20000
  s_lshl3_add_u32 s71, s6, s7
  s_lshr_b32 s79, s2, 3
  s_mov_b32 s12, s40
  s_mov_b32 s13, s41
  s_mov_b32 s14, 402653184
  s_mov_b32 s15, 0x20000
  s_waitcnt vmcnt(2)
  buffer_load_dwordx4 v[32:35], v1, s[8:11], s61 offen offset:128 nt
  s_waitcnt vmcnt(2)
  buffer_load_dwordx4 v[36:39], v1, s[8:11], s61 offen offset:256 nt
  s_add_u32 s62, s61, 196608
  s_waitcnt vmcnt(2)
  buffer_load_dwordx4 v[40:43], v1, s[8:11], s62 offen offset:0 nt
  s_waitcnt vmcnt(2)
  buffer_load_dwordx4 v[44:47], v1, s[8:11], s62 offen offset:128 nt
  s_waitcnt vmcnt(2)
  buffer_load_dwordx4 v[48:51], v1, s[8:11], s62 offen offset:256 nt
  s_add_u32 s63, s62, 196608
  s_waitcnt vmcnt(2)
  buffer_load_dwordx4 v[52:55], v1, s[8:11], s63 offen offset:0 nt
  s_waitcnt vmcnt(2)
  buffer_load_dwordx4 v[56:59], v1, s[8:11], s63 offen offset:128 nt
  s_waitcnt vmcnt(2)
  buffer_load_dwordx4 v[60:63], v1, s[8:11], s63 offen offset:256 nt
  s_add_u32 s64, s63, 196608
  s_waitcnt vmcnt(2)
  buffer_load_dwordx4 v[64:67], v1, s[8:11], s64 offen offset:0 nt
  s_waitcnt vmcnt(2)
  buffer_load_dwordx4 v[68:71], v1, s[8:11], s64 offen offset:128 nt
  s_waitcnt vmcnt(2)
  buffer_load_dwordx4 v[72:75], v1, s[8:11], s64 offen offset:256 nt
  s_add_u32 s65, s64, 196608
  s_waitcnt vmcnt(2)
  buffer_load_dwordx4 v[76:79], v1, s[8:11], s65 offen offset:0 nt
  s_waitcnt vmcnt(2)
  buffer_load_dwordx4 v[80:83], v1, s[8:11], s65 offen offset:128 nt
  s_waitcnt vmcnt(2)
  buffer_load_dwordx4 v[84:87], v1, s[8:11], s65 offen offset:256 nt
  s_add_u32 s66, s65, 196608
  s_waitcnt vmcnt(2)
  buffer_load_dwordx4 v[88:91], v1, s[8:11], s66 offen offset:0 nt
  s_waitcnt vmcnt(2)
  buffer_load_dwordx4 v[92:95], v1, s[8:11], s66 offen offset:128 nt
  s_waitcnt vmcnt(2)
  buffer_load_dwordx4 v[96:99], v1, s[8:11], s66 offen offset:256 nt
  s_add_u32 s67, s66, 196608
  s_waitcnt vmcnt(2)
  buffer_load_dwordx4 v[100:103], v1, s[8:11], s67 offen offset:0 nt
  s_waitcnt vmcnt(2)
  buffer_load_dwordx4 v[104:107], v1, s[8:11], s67 offen offset:128 nt
  s_waitcnt vmcnt(2)
  buffer_load_dwordx4 v[108:111], v1, s[8:11], s67 offen offset:256 nt
  s_waitcnt vmcnt(2)
  buffer_load_dwordx4 v[112:115], v1, s[12:15], s60 offen offset:0 nt
  s_waitcnt vmcnt(2)
  buffer_load_dwordx4 v[116:119], v1, s[12:15], s60 offen offset:128 nt
  s_waitcnt vmcnt(2)
  buffer_load_dwordx4 v[120:123], v1, s[12:15], s60 offen offset:256 nt
  s_waitcnt lgkmcnt(0)
  s_mul_i32 s30, s28, 0x2c9277b5
  s_add_u32 s30, s30, 0xac564b05
  s_mul_i32 s31, s29, 0x0019660d
  s_add_u32 s31, s31, 0x3c6ef35f
  v_and_b32 v2, 3, v0
  v_min_u32 v2, 2, v2
  v_lshlrev_b32 v2, 3, v2
  s_mov_b32 s70, 200007
L_spin_1:
  ds_read_b32 v4, v2 offset:384
  s_waitcnt lgkmcnt(0)
  v_cmp_eq_u32 vcc, 0, v4
  s_nop 0
  s_cbranch_vccz L_sdone_2
  s_sleep 1
  s_sub_u32 s70, s70, 1
  s_cbranch_scc0 L_spin_1
L_sdone_2:
  ds_read_b128 v[4:7], v3 offset:0
  ds_read_b128 v[8:11], v3 offset:128
  ds_read_b128 v[12:15], v3 offset:256
  v_mov_b32 v160, 0
  v_mov_b32 v161, 0
  v_mov_b32 v162, 0
  v_mov_b32 v163, 0
  v_mov_b32 v164, 0
  v_mov_b32 v165, 0
  v_mov_b32 v166, 0
  v_mov_b32 v167, 0
  s_waitcnt vmcnt(3) lgkmcnt(0)
  v_dot2c_f32_bf16 v160, v16, v4
  v_dot2c_f32_bf16 v161, v28, v4
  v_dot2c_f32_bf16 v162, v40, v4
  v_dot2c_f32_bf16 v163, v52, v4
  v_dot2c_f32_bf16 v160, v17, v5
  v_dot2c_f32_bf16 v161, v29, v5
  v_dot2c_f32_bf16 v162, v41, v5
  v_dot2c_f32_bf16 v163, v53, v5
  v_dot2c_f32_bf16 v160, v18, v6
  v_dot2c_f32_bf16 v161, v30, v6
  v_dot2c_f32_bf16 v162, v42, v6
  v_dot2c_f32_bf16 v163, v54, v6
  v_dot2c_f32_bf16 v160, v19, v7
  v_dot2c_f32_bf16 v161, v31, v7
  v_dot2c_f32_bf16 v162, v43, v7
  v_dot2c_f32_bf16 v163, v55, v7
  v_dot2c_f32_bf16 v160, v20, v8
  v_dot2c_f32_bf16 v161, v32, v8
  v_dot2c_f32_bf16 v162, v44, v8
  v_dot2c_f32_bf16 v163, v56, v8
  v_dot2c_f32_bf16 v160, v21, v9
  v_dot2c_f32_bf16 v161, v33, v9
  v_dot2c_f32_bf16 v162, v45, v9
  v_dot2c_f32_bf16 v163, v57, v9
  v_dot2c_f32_bf16 v160, v22, v10
  v_dot2c_f32_bf16 v161, v34, v10
  v_dot2c_f32_bf16 v162, v46, v10
  v_dot2c_f32_bf16 v163, v58, v10
  v_dot2c_f32_bf16 v160, v23, v11
  v_dot2c_f32_bf16 v161, v35, v11
  v_dot2c_f32_bf16 v162, v47, v11
  v_dot2c_f32_bf16 v163, v59, v11
  v_dot2c_f32_bf16 v160, v24, v12
  v_dot2c_f32_bf16 v161, v36, v12
  v_dot2c_f32_bf16 v162, v48, v12
  v_dot2c_f32_bf16 v163, v60, v12
  v_dot2c_f32_bf16 v160, v25, v13
  v_dot2c_f32_bf16 v161, v37, v13
  v_dot2c_f32_bf16 v162, v49, v13
  v_dot2c_f32_bf16 v163, v61, v13
  v_dot2c_f32_bf16 v160, v26, v14
  v_dot2c_f32_bf16 v161, v38, v14
  v_dot2c_f32_bf16 v162, v50, v14
  v_dot2c_f32_bf16 v163, v62, v14
  v_dot2c_f32_bf16 v160, v27, v15
  v_dot2c_f32_bf16 v161, v39, v15
  v_dot2c_f32_bf16 v162, v51, v15
  v_dot2c_f32_bf16 v163, v63, v15
  v_dot2c_f32_bf16 v164, v64, v4
  v_dot2c_f32_bf16 v165, v76, v4
  v_dot2c_f32_bf16 v166, v88, v4
  v_dot2c_f32_bf16 v167, v100, v4
  v_dot2c_f32_bf16 v164, v65, v5
  v_dot2c_f32_bf16 v165, v77, v5
  v_dot2c_f32_bf16 v166, v89, v5
  v_dot2c_f32_bf16 v167, v101, v5
  v_dot2c_f32_bf16 v164, v66, v6
  v_dot2c_f32_bf16 v165, v78, v6
  v_dot2c_f32_bf16 v166, v90, v6
  v_dot2c_f32_bf16 v167, v102, v6
  v_dot2c_f32_bf16 v164, v67, v7
  v_dot2c_f32_bf16 v165, v79, v7
  v_dot2c_f32_bf16 v166, v91, v7
  v_dot2c_f32_bf16 v167, v103, v7
  v_dot2c_f32_bf16 v164, v68, v8
  v_dot2c_f32_bf16 v165, v80, v8
  v_dot2c_f32_bf16 v166, v92, v8
  v_dot2c_f32_bf16 v167, v104, v8
  v_dot2c_f32_bf16 v164, v69, v9
  v_dot2c_f32_bf16 v165, v81, v9
  v_dot2c_f32_bf16 v166, v93, v9
  v_dot2c_f32_bf16 v167, v105, v9
  v_dot2c_f32_bf16 v164, v70, v10
  v_dot2c_f32_bf16 v165, v82, v10
  v_dot2c_f32_bf16 v166, v94, v10
  v_dot2c_f32_bf16 v167, v106, v10
  v_dot2c_f32_bf16 v164, v71, v11
  v_dot2c_f32_bf16 v165, v83, v11
  v_dot2c_f32_bf16 v166, v95, v11
  v_dot2c_f32_bf16 v167, v107, v11
  v_dot2c_f32_bf16 v164, v72, v12
  v_dot2c_f32_bf16 v165, v84, v12
  v_dot2c_f32_bf16 v166, v96, v12
  v_dot2c_f32_bf16 v167, v108, v12
  v_dot2c_f32_bf16 v164, v73, v13
  v_dot2c_f32_bf16 v165, v85, v13
  v_dot2c_f32_bf16 v166, v97, v13
  v_dot2c_f32_bf16 v167, v109, v13
  v_dot2c_f32_bf16 v164, v74, v14
  v_dot2c_f32_bf16 v165, v86, v14
  v_dot2c_f32_bf16 v166, v98, v14
  v_dot2c_f32_bf16 v167, v110, v14
  v_dot2c_f32_bf16 v164, v75, v15
  v_dot2c_f32_bf16 v165, v87, v15
  v_dot2c_f32_bf16 v166, v99, v15
  v_dot2c_f32_bf16 v167, v111, v15
  v_add_f32_dpp v160, v160, v160 quad_perm:[1,0,3,2] row_mask:0xf bank_mask:0xf
  v_add_f32_dpp v161, v161, v161 quad_perm:[1,0,3,2] row_mask:0xf bank_mask:0xf
  v_add_f32_dpp v162, v162, v162 quad_perm:[1,0,3,2] row_mask:0xf bank_mask:0xf
  v_add_f32_dpp v163, v163, v163 quad_perm:[1,0,3,2] row_mask:0xf bank_mask:0xf
  v_add_f32_dpp v164, v164, v164 quad_perm:[1,0,3,2] row_mask:0xf bank_mask:0xf
  v_add_f32_dpp v165, v165, v165 quad_perm:[1,0,3,2] row_mask:0xf bank_mask:0xf
  v_add_f32_dpp v166, v166, v166 quad_perm:[1,0,3,2] row_mask:0xf bank_mask:0xf
  v_add_f32_dpp v167, v167, v167 quad_perm:[1,0,3,2] row_mask:0xf bank_mask:0xf
  v_add_f32_dpp v160, v160, v160 quad_perm:[2,3,0,1] row_mask:0xf bank_mask:0xf
  v_add_f32_dpp v161, v161, v161 quad_perm:[2,3,0,1] row_mask:0xf bank_mask:0xf
  v_add_f32_dpp v162, v162, v162 quad_perm:[2,3,0,1] row_mask:0xf bank_mask:0xf
  v_add_f32_dpp v163, v163, v163 quad_perm:[2,3,0,1] row_mask:0xf bank_mask:0xf
  v_add_f32_dpp v164, v164, v164 quad_perm:[2,3,0,1] row_mask:0xf bank_mask:0xf
  v_add_f32_dpp v165, v165, v165 quad_perm:[2,3,0,1] row_mask:0xf bank_mask:0xf
  v_add_f32_dpp v166, v166, v166 quad_perm:[2,3,0,1] row_mask:0xf bank_mask:0xf
  v_add_f32_dpp v167, v167, v167 quad_perm:[2,3,0,1] row_mask:0xf bank_mask:0xf
  v_add_f32_dpp v160, v160, v160 row_half_mirror row_mask:0xf bank_mask:0xf
  v_add_f32_dpp v161, v161, v161 row_half_mirror row_mask:0xf bank_mask:0xf
  v_add_f32_dpp v162, v162, v162 row_half_mirror row_mask:0xf bank_mask:0xf
  v_add_f32_dpp v163, v163, v163 row_half_mirror row_mask:0xf bank_mask:0xf
  v_add_f32_dpp v164, v164, v164 row_half_mirror row_mask:0xf bank_mask:0xf
  v_add_f32_dpp v165, v165, v165 row_half_mirror row_mask:0xf bank_mask:0xf
  v_add_f32_dpp v166, v166, v166 row_half_mirror row_mask:0xf bank_mask:0xf
  v_add_f32_dpp v167, v167, v167 row_half_mirror row_mask:0xf bank_mask:0xf
  s_mov_b32 s68, 0x3d93cd3a
  v_mov_b32 v2, 0
  v_cvt_pk_bf16_f32 v160, v2, v160
  v_cvt_pk_bf16_f32 v161, v2, v161
  v_cvt_pk_bf16_f32 v162, v2, v162
  v_cvt_pk_bf16_f32 v163, v2, v163
  v_cvt_pk_bf16_f32 v164, v2, v164
  v_cvt_pk_bf16_f32 v165, v2, v165
  v_cvt_pk_bf16_f32 v166, v2, v166
  v_cvt_pk_bf16_f32 v167, v2, v167
  v_mul_f32 v160, s68, v160
  v_mul_f32 v161, s68, v161
  v_mul_f32 v162, s68, v162
  v_mul_f32 v163, s68, v163
  v_mul_f32 v164, s68, v164
  v_mul_f32 v165, s68, v165
  v_mul_f32 v166, s68, v166
  v_mul_f32 v167, s68, v167
  v_cvt_pk_bf16_f32 v160, v2, v160
  v_cvt_pk_bf16_f32 v161, v2, v161
  v_cvt_pk_bf16_f32 v162, v2, v162
  v_cvt_pk_bf16_f32 v163, v2, v163
  v_cvt_pk_bf16_f32 v164, v2, v164
  v_cvt_pk_bf16_f32 v165, v2, v165
  v_cvt_pk_bf16_f32 v166, v2, v166
  v_cvt_pk_bf16_f32 v167, v2, v167
  v_max_f32 v4, v160, v161
  v_max3_f32 v4, v4, v162, v163
  v_max3_f32 v4, v4, v164, v165
  v_max3_f32 v4, v4, v166, v167
  s_nop 1
  v_max_f32_dpp v4, v4, v4 row_ror:8 row_mask:0xf bank_mask:0xf
  v_mov_b32 v88, v4
  s_nop 1
  v_permlane16_swap_b32 v4, v88
  v_max_f32 v4, v4, v88
  v_mov_b32 v88, v4
  s_nop 1
  v_permlane32_swap_b32 v4, v88
  v_max_f32 v4, v4, v88
  s_mov_b32 s68, 0x3fb8aa3b
  v_sub_f32 v160, v160, v4
  v_sub_f32 v161, v161, v4
  v_sub_f32 v162, v162, v4
  v_sub_f32 v163, v163, v4
  v_sub_f32 v164, v164, v4
  v_sub_f32 v165, v165, v4
  v_sub_f32 v166, v166, v4
  v_sub_f32 v167, v167, v4
  v_mul_f32 v160, s68, v160
  v_mul_f32 v161, s68, v161
  v_mul_f32 v162, s68, v162
  v_mul_f32 v163, s68, v163
  v_mul_f32 v164, s68, v164
  v_mul_f32 v165, s68, v165
  v_mul_f32 v166, s68, v166
  v_mul_f32 v167, s68, v167
  v_exp_f32 v160, v160
  v_exp_f32 v161, v161
  v_exp_f32 v162, v162
  v_exp_f32 v163, v163
  v_exp_f32 v164, v164
  v_exp_f32 v165, v165
  v_exp_f32 v166, v166
  v_exp_f32 v167, v167
  v_add_f32 v5, v160, v161
  v_add_f32 v5, v5, v162
  v_add_f32 v5, v5, v163
  v_add_f32 v5, v5, v164
  v_add_f32 v5, v5, v165
  v_add_f32 v5, v5, v166
  v_add_f32 v5, v5, v167
  s_nop 1
  v_add_f32_dpp v5, v5, v5 row_ror:8 row_mask:0xf bank_mask:0xf
  v_mov_b32 v88, v5
  s_nop 1
  v_permlane16_swap_b32 v5, v88
  v_add_f32 v5, v5, v88
  v_mov_b32 v88, v5
  s_nop 1
  v_permlane32_swap_b32 v5, v88
  v_add_f32 v5, v5, v88
  s_lshl_b32 s69, s3, 4
  v_mov_b32 v88, s69
  v_mov_b32 v6, 1
  v_mov_b32 v7, 1
  ds_write_b128 v88, v[4:7] offset:512
  v_cvt_pk_bf16_f32 v160, v160, v2
  v_cvt_pk_bf16_f32 v161, v161, v2
  v_cvt_pk_bf16_f32 v162, v162, v2
  v_cvt_pk_bf16_f32 v163, v163, v2
  v_cvt_pk_bf16_f32 v164, v164, v2
  v_cvt_pk_bf16_f32 v165, v165, v2
  v_cvt_pk_bf16_f32 v166, v166, v2
  v_cvt_pk_bf16_f32 v167, v167, v2
  v_mov_b32 v88, 0
  v_mov_b32 v89, 0
  v_mov_b32 v90, 0
  v_mov_b32 v91, 0
  v_mov_b32 v92, 0
  v_mov_b32 v93, 0
  v_mov_b32 v94, 0
  v_mov_b32 v95, 0
  v_mov_b32 v96, 0
  v_mov_b32 v97, 0
  v_mov_b32 v98, 0
  v_mov_b32 v99, 0
  v_mov_b32 v100, 0
  v_mov_b32 v101, 0
  v_mov_b32 v102, 0
  v_mov_b32 v103, 0
  v_mov_b32 v104, 0
  v_mov_b32 v105, 0
  v_mov_b32 v106, 0
  v_mov_b32 v107, 0
  v_mov_b32 v108, 0
  v_mov_b32 v109, 0
  v_mov_b32 v110, 0
  v_mov_b32 v111, 0
  v_and_b32 v8, 7, v0
  v_lshlrev_b32 v8, 5, v8
  v_lshrrev_b32 v9, 4, v0
  v_lshl_add_u32 v8, v9, 3, v8
  s_mul_i32 s69, s3, 768
  v_add_u32 v8, s69, v8
  v_mov_b32 v11, 1
  s_waitcnt vmcnt(2)
  buffer_load_dwordx4 v[124:127], v1, s[12:15], s61 offen offset:0 nt
  v_lshlrev_b32 v10, 16, v160
  v_dot2c_f32_bf16 v88, v112, v160
  v_dot2c_f32_bf16 v89, v112, v10
  v_dot2c_f32_bf16 v90, v113, v160
  v_dot2c_f32_bf16 v91, v113, v10
  v_dot2c_f32_bf16 v92, v114, v160
  v_dot2c_f32_bf16 v93, v114, v10
  v_dot2c_f32_bf16 v94, v115, v160
  v_dot2c_f32_bf16 v95, v115, v10
  s_waitcnt vmcnt(2)
  buffer_load_dwordx4 v[128:131], v1, s[12:15], s61 offen offset:128 nt
  v_dot2c_f32_bf16 v96, v116, v160
  v_dot2c_f32_bf16 v97, v116, v10
  v_dot2c_f32_bf16 v98, v117, v160
  v_dot2c_f32_bf16 v99, v117, v10
  v_dot2c_f32_bf16 v100, v118, v160
  v_dot2c_f32_bf16 v101, v118, v10
  v_dot2c_f32_bf16 v102, v119, v160
  v_dot2c_f32_bf16 v103, v119, v10
  s_waitcnt vmcnt(2)
  buffer_load_dwordx4 v[132:135], v1, s[12:15], s61 offen offset:256 nt
  v_dot2c_f32_bf16 v104, v120, v160
  v_dot2c_f32_bf16 v105, v120, v10
  v_dot2c_f32_bf16 v106, v121, v160
  v_dot2c_f32_bf16 v107, v121, v10
  v_dot2c_f32_bf16 v108, v122, v160
  v_dot2c_f32_bf16 v109, v122, v10
  v_dot2c_f32_bf16 v110, v123, v160
  v_dot2c_f32_bf16 v111, v123, v10
  s_waitcnt vmcnt(2)
  buffer_load_dwordx4 v[136:139], v1, s[12:15], s62 offen offset:0 nt
  v_lshlrev_b32 v10, 16, v161
  v_dot2c_f32_bf16 v88, v124, v161
  v_dot2c_f32_bf16 v89, v124, v10
  v_dot2c_f32_bf16 v90, v125, v161
  v_dot2c_f32_bf16 v91, v125, v10
  v_dot2c_f32_bf16 v92, v126, v161
  v_dot2c_f32_bf16 v93, v126, v10
  v_dot2c_f32_bf16 v94, v127, v161
  v_dot2c_f32_bf16 v95, v127, v10
  s_waitcnt vmcnt(2)
  buffer_load_dwordx4 v[140:143], v1, s[12:15], s62 offen offset:128 nt
  v_dot2c_f32_bf16 v96, v128, v161
  v_dot2c_f32_bf16 v97, v128, v10
  v_dot2c_f32_bf16 v98, v129, v161
  v_dot2c_f32_bf16 v99, v129, v10
  v_dot2c_f32_bf16 v100, v130, v161
  v_dot2c_f32_bf16 v101, v130, v10
  v_dot2c_f32_bf16 v102, v131, v161
  v_dot2c_f32_bf16 v103, v131, v10
  s_waitcnt vmcnt(2)
  buffer_load_dwordx4 v[144:147], v1, s[12:15], s62 offen offset:256 nt
  v_dot2c_f32_bf16 v104, v132, v161
  v_dot2c_f32_bf16 v105, v132, v10
  v_dot2c_f32_bf16 v106, v133, v161
  v_dot2c_f32_bf16 v107, v133, v10
  v_dot2c_f32_bf16 v108, v134, v161
  v_dot2c_f32_bf16 v109, v134, v10
  v_dot2c_f32_bf16 v110, v135, v161
  v_dot2c_f32_bf16 v111, v135, v10
  s_waitcnt vmcnt(2)
  buffer_load_dwordx4 v[148:151], v1, s[12:15], s63 offen offset:0 nt
  v_lshlrev_b32 v10, 16, v162
  v_dot2c_f32_bf16 v88, v136, v162
  v_dot2c_f32_bf16 v89, v136, v10
  v_dot2c_f32_bf16 v90, v137, v162
  v_dot2c_f32_bf16 v91, v137, v10
  v_dot2c_f32_bf16 v92, v138, v162
  v_dot2c_f32_bf16 v93, v138, v10
  v_dot2c_f32_bf16 v94, v139, v162
  v_dot2c_f32_bf16 v95, v139, v10
  s_waitcnt vmcnt(2)
  buffer_load_dwordx4 v[152:155], v1, s[12:15], s63 offen offset:128 nt
  v_dot2c_f32_bf16 v96, v140, v162
  v_dot2c_f32_bf16 v97, v140, v10
  v_dot2c_f32_bf16 v98, v141, v162
  v_dot2c_f32_bf16 v99, v141, v10
  v_dot2c_f32_bf16 v100, v142, v162
  v_dot2c_f32_bf16 v101, v142, v10
  v_dot2c_f32_bf16 v102, v143, v162
  v_dot2c_f32_bf16 v103, v143, v10
  s_waitcnt vmcnt(2)
  buffer_load_dwordx4 v[156:159], v1, s[12:15], s63 offen offset:256 nt
  v_dot2c_f32_bf16 v104, v144, v162
  v_dot2c_f32_bf16 v105, v144, v10
  v_dot2c_f32_bf16 v106, v145, v162
  v_dot2c_f32_bf16 v107, v145, v10
  v_dot2c_f32_bf16 v108, v146, v162
  v_dot2c_f32_bf16 v109, v146, v10
  v_dot2c_f32_bf16 v110, v147, v162
  v_dot2c_f32_bf16 v111, v147, v10
  s_waitcnt vmcnt(2)
  buffer_load_dwordx4 v[16:19], v1, s[12:15], s64 offen offset:0 nt
  v_lshlrev_b32 v10, 16, v163
  v_dot2c_f32_bf16 v88, v148, v163
  v_dot2c_f32_bf16 v89, v148, v10
  v_dot2c_f32_bf16 v90, v149, v163
  v_dot2c_f32_bf16 v91, v149, v10
  v_dot2c_f32_bf16 v92, v150, v163
  v_dot2c_f32_bf16 v93, v150, v10
  v_dot2c_f32_bf16 v94, v151, v163
  v_dot2c_f32_bf16 v95, v151, v10
  s_waitcnt vmcnt(2)
  buffer_load_dwordx4 v[20:23], v1, s[12:15], s64 offen offset:128 nt
  v_dot2c_f32_bf16 v96, v152, v163
  v_dot2c_f32_bf16 v97, v152, v10
  v_dot2c_f32_bf16 v98, v153, v163
  v_dot2c_f32_bf16 v99, v153, v10
  v_dot2c_f32_bf16 v100, v154, v163
  v_dot2c_f32_bf16 v101, v154, v10
  v_dot2c_f32_bf16 v102, v155, v163
  v_dot2c_f32_bf16 v103, v155, v10
  s_waitcnt vmcnt(2)
  buffer_load_dwordx4 v[24:27], v1, s[12:15], s64 offen offset:256 nt
  v_dot2c_f32_bf16 v104, v156, v163
  v_dot2c_f32_bf16 v105, v156, v10
  v_dot2c_f32_bf16 v106, v157, v163
  v_dot2c_f32_bf16 v107, v157, v10
  v_dot2c_f32_bf16 v108, v158, v163
  v_dot2c_f32_bf16 v109, v158, v10
  v_dot2c_f32_bf16 v110, v159, v163
  v_dot2c_f32_bf16 v111, v159, v10
  s_waitcnt vmcnt(2)
  buffer_load_dwordx4 v[28:31], v1, s[12:15], s65 offen offset:0 nt
  v_lshlrev_b32 v10, 16, v164
  v_dot2c_f32_bf16 v88, v16, v164
  v_dot2c_f32_bf16 v89, v16, v10
  v_dot2c_f32_bf16 v90, v17, v164
  v_dot2c_f32_bf16 v91, v17, v10
  v_dot2c_f32_bf16 v92, v18, v164
  v_dot2c_f32_bf16 v93, v18, v10
  v_dot2c_f32_bf16 v94, v19, v164
  v_dot2c_f32_bf16 v95, v19, v10
  s_waitcnt vmcnt(2)
  buffer_load_dwordx4 v[32:35], v1, s[12:15], s65 offen offset:128 nt
  v_dot2c_f32_bf16 v96, v20, v164
  v_dot2c_f32_bf16 v97, v20, v10
  v_dot2c_f32_bf16 v98, v21, v164
  v_dot2c_f32_bf16 v99, v21, v10
  v_dot2c_f32_bf16 v100, v22, v164
  v_dot2c_f32_bf16 v101, v22, v10
  v_dot2c_f32_bf16 v102, v23, v164
  v_dot2c_f32_bf16 v103, v23, v10
  s_waitcnt vmcnt(2)
  buffer_load_dwordx4 v[36:39], v1, s[12:15], s65 offen offset:256 nt
  s_mov_b64 exec, 1
  ds_add_u32 v2, v11 offset:648
  s_mov_b64 exec, -1
  v_dot2c_f32_bf16 v104, v24, v164
  v_dot2c_f32_bf16 v105, v24, v10
  v_dot2c_f32_bf16 v106, v25, v164
  v_dot2c_f32_bf16 v107, v25, v10
  v_dot2c_f32_bf16 v108, v26, v164
  v_dot2c_f32_bf16 v109, v26, v10
  v_dot2c_f32_bf16 v110, v27, v164
  v_dot2c_f32_bf16 v111, v27, v10
  s_waitcnt vmcnt(2)
  buffer_load_dwordx4 v[40:43], v1, s[12:15], s66 offen offset:0 nt
  v_lshlrev_b32 v10, 16, v165
  v_dot2c_f32_bf16 v88, v28, v165
  v_dot2c_f32_bf16 v89, v28, v10
  v_dot2c_f32_bf16 v90, v29, v165
  v_dot2c_f32_bf16 v91, v29, v10
  v_dot2c_f32_bf16 v92, v30, v165
  v_dot2c_f32_bf16 v93, v30, v10
  v_dot2c_f32_bf16 v94, v31, v165
  v_dot2c_f32_bf16 v95, v31, v10
  s_waitcnt vmcnt(2)
  buffer_load_dwordx4 v[44:47], v1, s[12:15], s66 offen offset:128 nt
  v_dot2c_f32_bf16 v96, v32, v165
  v_dot2c_f32_bf16 v97, v32, v10
  v_dot2c_f32_bf16 v98, v33, v165
  v_dot2c_f32_bf16 v99, v33, v10
  v_dot2c_f32_bf16 v100, v34, v165
  v_dot2c_f32_bf16 v101, v34, v10
  v_dot2c_f32_bf16 v102, v35, v165
  v_dot2c_f32_bf16 v103, v35, v10
  s_waitcnt vmcnt(2)
  buffer_load_dwordx4 v[48:51], v1, s[12:15], s66 offen offset:256 nt
  v_dot2c_f32_bf16 v104, v36, v165
  v_dot2c_f32_bf16 v105, v36, v10
  v_dot2c_f32_bf16 v106, v37, v165
  v_dot2c_f32_bf16 v107, v37, v10
  v_dot2c_f32_bf16 v108, v38, v165
  v_dot2c_f32_bf16 v109, v38, v10
  v_dot2c_f32_bf16 v110, v39, v165
  v_dot2c_f32_bf16 v111, v39, v10
  s_waitcnt vmcnt(2)
  buffer_load_dwordx4 v[52:55], v1, s[12:15], s67 offen offset:0 nt
  v_lshlrev_b32 v10, 16, v166
  v_dot2c_f32_bf16 v88, v40, v166
  v_dot2c_f32_bf16 v89, v40, v10
  v_dot2c_f32_bf16 v90, v41, v166
  v_dot2c_f32_bf16 v91, v41, v10
  v_dot2c_f32_bf16 v92, v42, v166
  v_dot2c_f32_bf16 v93, v42, v10
  v_dot2c_f32_bf16 v94, v43, v166
  v_dot2c_f32_bf16 v95, v43, v10
  s_waitcnt vmcnt(2)
  buffer_load_dwordx4 v[56:59], v1, s[12:15], s67 offen offset:128 nt
  v_dot2c_f32_bf16 v96, v44, v166
  v_dot2c_f32_bf16 v97, v44, v10
  v_dot2c_f32_bf16 v98, v45, v166
  v_dot2c_f32_bf16 v99, v45, v10
  v_dot2c_f32_bf16 v100, v46, v166
  v_dot2c_f32_bf16 v101, v46, v10
  v_dot2c_f32_bf16 v102, v47, v166
  v_dot2c_f32_bf16 v103, v47, v10
  s_waitcnt vmcnt(2)
  buffer_load_dwordx4 v[60:63], v1, s[12:15], s67 offen offset:256 nt
  s_mov_b64 exec, 1
  ds_add_u32 v2, v11 offset:644
  s_mov_b64 exec, -1
  v_dot2c_f32_bf16 v104, v48, v166
  v_dot2c_f32_bf16 v105, v48, v10
  v_dot2c_f32_bf16 v106, v49, v166
  v_dot2c_f32_bf16 v107, v49, v10
  v_dot2c_f32_bf16 v108, v50, v166
  v_dot2c_f32_bf16 v109, v50, v10
  v_dot2c_f32_bf16 v110, v51, v166
  v_dot2c_f32_bf16 v111, v51, v10
  s_mov_b32 s70, 200007
L_spin_3:
  ds_read_b128 v[12:15], v2 offset:672
  ds_read_b32 v7, v2 offset:656
  s_waitcnt lgkmcnt(0)
  v_cmp_eq_u32 vcc, 0, v15
  s_nop 0
  s_cbranch_vccz L_sdone_4
  s_sleep 1
  s_sub_u32 s70, s70, 1
  s_cbranch_scc0 L_spin_3
L_sdone_4:
  v_sub_f32 v9, v4, v12
  v_mul_f32 v9, s68, v9
  v_exp_f32 v9, v9
  v_readfirstlane_b32 s46, v7
  v_mul_f32 v9, v9, v13
  v_min_u32 v12, 47, v0
  v_lshlrev_b32 v13, 7, v12
  v_lshlrev_b32 v12, 4, v12
  s_mul_i32 s74, s6, 6144
  s_lshl4_add_u32 s74, s7, s74
  s_add_u32 s74, s74, 1114112
  s_lshl_b32 s75, s4, 9
  s_lshl4_add_u32 s75, s79, s75
  s_add_u32 s75, s75, 1064960
  s_mov_b32 s22, 0xaaaaaaaa
  s_mov_b32 s23, 0xaaaaaaaa
  v_mov_b32 v14, s30
  v_mov_b32 v15, s31
  s_waitcnt vmcnt(2)
  v_lshlrev_b32 v10, 16, v167
  v_dot2c_f32_bf16 v88, v52, v167
  v_dot2c_f32_bf16 v89, v52, v10
  v_dot2c_f32_bf16 v90, v53, v167
  v_dot2c_f32_bf16 v91, v53, v10
  v_dot2c_f32_bf16 v92, v54, v167
  v_dot2c_f32_bf16 v93, v54, v10
  v_dot2c_f32_bf16 v94, v55, v167
  v_dot2c_f32_bf16 v95, v55, v10
  v_permlane32_swap_b32 v88, v92
  v_permlane32_swap_b32 v89, v93
  v_permlane32_swap_b32 v90, v94
  v_permlane32_swap_b32 v91, v95
  v_add_f32 v88, v88, v92
  v_add_f32 v89, v89, v93
  v_add_f32 v90, v90, v94
  v_add_f32 v91, v91, v95
  s_nop 0
  v_permlane16_swap_b32 v88, v90
  v_permlane16_swap_b32 v89, v91
  v_add_f32 v88, v88, v90
  v_add_f32 v89, v89, v91
  s_nop 0
  v_add_f32_dpp v88, v88, v88 row_ror:8 row_mask:0xf bank_mask:0xf
  v_add_f32_dpp v89, v89, v89 row_ror:8 row_mask:0xf bank_mask:0xf
  v_mul_f32 v88, v9, v88
  v_mul_f32 v89, v9, v89
  ds_write_b64 v8, v[88:89] offset:1024
  s_waitcnt vmcnt(1)
  v_dot2c_f32_bf16 v96, v56, v167
  v_dot2c_f32_bf16 v97, v56, v10
  v_dot2c_f32_bf16 v98, v57, v167
  v_dot2c_f32_bf16 v99, v57, v10
  v_dot2c_f32_bf16 v100, v58, v167
  v_dot2c_f32_bf16 v101, v58, v10
  v_dot2c_f32_bf16 v102, v59, v167
  v_dot2c_f32_bf16 v103, v59, v10
  v_permlane32_swap_b32 v96, v100
  v_permlane32_swap_b32 v97, v101
  v_permlane32_swap_b32 v98, v102
  v_permlane32_swap_b32 v99, v103
  v_add_f32 v96, v96, v100
  v_add_f32 v97, v97, v101
  v_add_f32 v98, v98, v102
  v_add_f32 v99, v99, v103
  s_nop 0
  v_permlane16_swap_b32 v96, v98
  v_permlane16_swap_b32 v97, v99
  v_add_f32 v96, v96, v98
  v_add_f32 v97, v97, v99
  s_nop 0
  v_add_f32_dpp v96, v96, v96 row_ror:8 row_mask:0xf bank_mask:0xf
  v_add_f32_dpp v97, v97, v97 row_ror:8 row_mask:0xf bank_mask:0xf
  v_mul_f32 v96, v9, v96
  v_mul_f32 v97, v9, v97
  ds_write_b64 v8, v[96:97] offset:1280
  s_waitcnt vmcnt(0)
  v_dot2c_f32_bf16 v104, v60, v167
  v_dot2c_f32_bf16 v105, v60, v10
  v_dot2c_f32_bf16 v106, v61, v167
  v_dot2c_f32_bf16 v107, v61, v10
  v_dot2c_f32_bf16 v108, v62, v167
  v_dot2c_f32_bf16 v109, v62, v10
  v_dot2c_f32_bf16 v110, v63, v167
  v_dot2c_f32_bf16 v111, v63, v10
  v_permlane32_swap_b32 v104, v108
  v_permlane32_swap_b32 v105, v109
  v_permlane32_swap_b32 v106, v110
  v_permlane32_swap_b32 v107, v111
  v_add_f32 v104, v104, v108
  v_add_f32 v105, v105, v109
  v_add_f32 v106, v106, v110
  v_add_f32 v107, v107, v111
  s_nop 0
  v_permlane16_swap_b32 v104, v106
  v_permlane16_swap_b32 v105, v107
  v_add_f32 v104, v104, v106
  v_add_f32 v105, v105, v107
  s_nop 0
  v_add_f32_dpp v104, v104, v104 row_ror:8 row_mask:0xf bank_mask:0xf
  v_add_f32_dpp v105, v105, v105 row_ror:8 row_mask:0xf bank_mask:0xf
  v_mul_f32 v104, v9, v104
  v_mul_f32 v105, v9, v105
  ds_write_b64 v8, v[104:105] offset:1536
  s_mov_b64 exec, 1
  ds_add_rtn_u32 v10, v2, v11 offset:640
  s_waitcnt lgkmcnt(0)
  v_readfirstlane_b32 s68, v10
  s_mov_b64 exec, -1
  s_cmp_lg_u32 s68, 7
  s_cbranch_scc1 L_nopub
  ds_read_b128 v[16:19], v12 offset:1024
  ds_read_b128 v[20:23], v12 offset:1792
  ds_read_b128 v[24:27], v12 offset:2560
  ds_read_b128 v[28:31], v12 offset:3328
  ds_read_b128 v[32:35], v12 offset:4096
  ds_read_b128 v[36:39], v12 offset:4864
  ds_read_b128 v[40:43], v12 offset:5632
  ds_read_b128 v[44:47], v12 offset:6400
  s_waitcnt lgkmcnt(6)
  v_add_f32 v16, v16, v20
  v_add_f32 v17, v17, v21
  v_add_f32 v18, v18, v22
  v_add_f32 v19, v19, v23
  s_waitcnt lgkmcnt(4)
  v_add_f32 v24, v24, v28
  v_add_f32 v25, v25, v29
  v_add_f32 v26, v26, v30
  v_add_f32 v27, v27, v31
  v_add_f32 v16, v16, v24
  v_add_f32 v17, v17, v25
  v_add_f32 v18, v18, v26
  v_add_f32 v19, v19, v27
  s_waitcnt lgkmcnt(2)
  v_add_f32 v32, v32, v36
  v_add_f32 v33, v33, v37
  v_add_f32 v34, v34, v38
  v_add_f32 v35, v35, v39
  s_waitcnt lgkmcnt(0)
  v_add_f32 v40, v40, v44
  v_add_f32 v41, v41, v45
  v_add_f32 v42, v42, v46
  v_add_f32 v43, v43, v47
  v_add_f32 v32, v32, v40
  v_add_f32 v33, v33, v41
  v_add_f32 v34, v34, v42
  v_add_f32 v35, v35, v43
  v_add_f32 v4, v16, v32
  v_add_f32 v5, v17, v33
  v_add_f32 v6, v18, v34
  v_add_f32 v7, v19, v35
  v_cvt_pk_bf16_f32 v8, v4, v5
  v_cvt_pk_bf16_f32 v9, v6, v7
  v_cndmask_b32 v4, v8, v14, s[22:23]
  v_cndmask_b32 v5, v9, v15, s[22:23]
  v_cndmask_b32 v6, v14, v8, s[22:23]
  v_cndmask_b32 v7, v15, v9, s[22:23]
  s_mov_b32 exec_lo, 0xffffffff
  s_mov_b32 exec_hi, 0xffff
  buffer_store_dwordx4 v[4:7], v13, s[32:35], s74 offen
  s_mov_b64 exec, -1
  s_cmp_lg_u32 s46, 1
  s_cbranch_scc1 L_slow_5
L_back_6:
  s_mov_b64 exec, 1
  ds_write_b32 v2, v11 offset:660
  s_mov_b64 exec, -1
L_nopub:
  s_cmp_eq_u32 s3, 7
  s_cbranch_scc1 L_end
  v_mov_b32 v1, 0
  s_mov_b32 s70, 200007
L_spin_7:
  ds_read_b64 v[4:5], v1 offset:664
  s_waitcnt lgkmcnt(0)
  v_cmp_eq_u32 vcc, 0, v5
  s_nop 0
  s_cbranch_vccz L_sdone_8
  s_sleep 1
  s_sub_u32 s70, s70, 1
  s_cbranch_scc0 L_spin_7
L_sdone_8:
  v_readfirstlane_b32 s5, v5
  v_readfirstlane_b32 s47, v4
  s_sub_u32 s5, s5, 1
  s_cmp_lt_u32 s5, 12
  s_cbranch_scc1 L_ffn
  s_cmp_lt_u32 s5, 20
  s_cbranch_scc1 L_end
  s_cmp_lt_u32 s3, 5
  s_cbranch_scc1 L_f1
  s_endpgm
L_q2:
  s_mov_b32 s69, 0xffff0000
  s_mov_b32 s24, s58
  s_mov_b32 s25, s59
  s_mov_b32 s26, 4194304
  s_mov_b32 s27, 0x20000
  s_add_u32 s32, s58, 4194304
  s_addc_u32 s33, s59, 0
  s_mov_b32 s34, 4194304
  s_mov_b32 s35, 0x20000
  s_lshl3_add_u32 s71, s6, s7
  s_lshr_b32 s79, s2, 3
  s_waitcnt lgkmcnt(0)
  s_mul_i32 s30, s28, 0x2c9277b5
  s_add_u32 s30, s30, 0xac564b05
  s_mul_i32 s31, s29, 0x0019660d
  s_add_u32 s31, s31, 0x3c6ef35f
  s_waitcnt vmcnt(20)
  v_lshlrev_b32 v70, 16, v64
  v_and_b32 v71, s69, v64
  v_lshlrev_b32 v72, 16, v65
  v_and_b32 v73, s69, v65
  v_lshlrev_b32 v74, 16, v66
  v_and_b32 v75, s69, v66
  v_lshlrev_b32 v76, 16, v67
  v_and_b32 v77, s69, v67
  v_lshlrev_b32 v78, 16, v68
  v_and_b32 v79, s69, v68
  v_add_f32 v4, v70, v71
  v_add_f32 v5, v72, v73
  v_add_f32 v6, v74, v75
  v_add_f32 v7, v76, v77
  v_add_f32 v4, v4, v5
  v_add_f32 v6, v6, v7
  v_add_f32 v5, v78, v79
  v_add_f32 v4, v4, v6
  v_add_f32 v4, v4, v5
  s_nop 1
  v_add_f32_dpp v4, v4, v4 quad_perm:[1,0,3,2] row_mask:0xf bank_mask:0xf
  s_nop 1
  v_add_f32_dpp v4, v4, v4 quad_perm:[2,3,0,1] row_mask:0xf bank_mask:0xf
  s_nop 1
  v_add_f32_dpp v4, v4, v4 row_half_mirror row_mask:0xf bank_mask:0xf
  s_nop 1
  v_add_f32_dpp v4, v4, v4 row_mirror row_mask:0xf bank_mask:0xf
  v_mov_b32 v5, v4
  s_nop 1
  v_permlane16_swap_b32 v4, v5
  v_add_f32 v4, v4, v5
  v_mov_b32 v5, v4
  s_nop 1
  v_permlane32_swap_b32 v4, v5
  v_add_f32 v4, v4, v5
  v_mul_f32 v4, 0x3acccccd, v4
  v_sub_f32 v70, v70, v4
  v_sub_f32 v71, v71, v4
  v_sub_f32 v72, v72, v4
  v_sub_f32 v73, v73, v4
  v_sub_f32 v74, v74, v4
  v_sub_f32 v75, v75, v4
  v_sub_f32 v76, v76, v4
  v_sub_f32 v77, v77, v4
  v_sub_f32 v78, v78, v4
  v_sub_f32 v79, v79, v4
  v_mul_f32 v5, v70, v70
  v_fmac_f32 v5, v71, v71
  v_fmac_f32 v5, v72, v72
  v_fmac_f32 v5, v73, v73
  v_fmac_f32 v5, v74, v74
  v_fmac_f32 v5, v75, v75
  v_fmac_f32 v5, v76, v76
  v_fmac_f32 v5, v77, v77
  v_fmac_f32 v5, v78, v78
  v_fmac_f32 v5, v79, v79
  s_nop 1
  v_add_f32_dpp v5, v5, v5 quad_perm:[1,0,3,2] row_mask:0xf bank_mask:0xf
  s_nop 1
  v_add_f32_dpp v5, v5, v5 quad_perm:[2,3,0,1] row_mask:0xf bank_mask:0xf
  s_nop 1
  v_add_f32_dpp v5, v5, v5 row_half_mirror row_mask:0xf bank_mask:0xf
  s_nop 1
  v_add_f32_dpp v5, v5, v5 row_mirror row_mask:0xf bank_mask:0xf
  v_mov_b32 v6, v5
  s_nop 1
  v_permlane16_swap_b32 v5, v6
  v_add_f32 v5, v5, v6
  v_mov_b32 v6, v5
  s_nop 1
  v_permlane32_swap_b32 v5, v6
  v_add_f32 v5, v5, v6
  v_mul_f32 v5, 0x3acccccd, v5
  v_cvt_pk_bf16_f32 v4, v4, v4
  v_lshlrev_b32 v4, 16, v4
  v_cvt_pk_bf16_f32 v5, v5, v5
  v_lshlrev_b32 v5, 16, v5
  v_add_f32 v5, 0x3727c5ac, v5
  v_cvt_pk_bf16_f32 v5, v5, v5
  v_lshlrev_b32 v5, 16, v5
  v_sqrt_f32 v5, v5
  s_nop 0
  v_cvt_pk_bf16_f32 v5, v5, v5
  v_lshlrev_b32 v5, 16, v5
  v_rcp_f32 v5, v5
  v_mov_b32 v6, 0
  s_waitcnt vmcnt(10)
  v_lshlrev_b32 v8, 16, v8
  v_lshlrev_b32 v9, 16, v9
  v_lshlrev_b32 v10, 16, v10
  v_lshlrev_b32 v11, 16, v11
  v_lshlrev_b32 v12, 16, v12
  v_lshlrev_b32 v13, 16, v13
  v_lshlrev_b32 v14, 16, v14
  v_lshlrev_b32 v15, 16, v15
  v_lshlrev_b32 v16, 16, v16
  v_lshlrev_b32 v17, 16, v17
  v_sub_f32 v8, v8, v4
  v_sub_f32 v9, v9, v4
  v_sub_f32 v10, v10, v4
  v_sub_f32 v11, v11, v4
  v_sub_f32 v12, v12, v4
  v_sub_f32 v13, v13, v4
  v_sub_f32 v14, v14, v4
  v_sub_f32 v15, v15, v4
  v_sub_f32 v16, v16, v4
  v_sub_f32 v17, v17, v4
  v_cvt_pk_bf16_f32 v8, v6, v8
  v_cvt_pk_bf16_f32 v9, v6, v9
  v_cvt_pk_bf16_f32 v10, v6, v10
  v_cvt_pk_bf16_f32 v11, v6, v11
  v_cvt_pk_bf16_f32 v12, v6, v12
  v_cvt_pk_bf16_f32 v13, v6, v13
  v_cvt_pk_bf16_f32 v14, v6, v14
  v_cvt_pk_bf16_f32 v15, v6, v15
  v_cvt_pk_bf16_f32 v16, v6, v16
  v_cvt_pk_bf16_f32 v17, v6, v17
  v_mul_f32 v8, v8, v5
  v_mul_f32 v9, v9, v5
  v_mul_f32 v10, v10, v5
  v_mul_f32 v11, v11, v5
  v_mul_f32 v12, v12, v5
  v_mul_f32 v13, v13, v5
  v_mul_f32 v14, v14, v5
  v_mul_f32 v15, v15, v5
  v_mul_f32 v16, v16, v5
  v_mul_f32 v17, v17, v5
  v_cvt_pk_bf16_f32 v70, v6, v8
  v_cvt_pk_bf16_f32 v8, v8, v6
  v_cvt_pk_bf16_f32 v71, v6, v9
  v_cvt_pk_bf16_f32 v9, v9, v6
  v_cvt_pk_bf16_f32 v72, v6, v10
  v_cvt_pk_bf16_f32 v10, v10, v6
  v_cvt_pk_bf16_f32 v73, v6, v11
  v_cvt_pk_bf16_f32 v11, v11, v6
  v_cvt_pk_bf16_f32 v74, v6, v12
  v_cvt_pk_bf16_f32 v12, v12, v6
  v_cvt_pk_bf16_f32 v75, v6, v13
  v_cvt_pk_bf16_f32 v13, v13, v6
  v_cvt_pk_bf16_f32 v76, v6, v14
  v_cvt_pk_bf16_f32 v14, v14, v6
  v_cvt_pk_bf16_f32 v77, v6, v15
  v_cvt_pk_bf16_f32 v15, v15, v6
  v_cvt_pk_bf16_f32 v78, v6, v16
  v_cvt_pk_bf16_f32 v16, v16, v6
  v_cvt_pk_bf16_f32 v79, v6, v17
  v_cvt_pk_bf16_f32 v17, v17, v6
  v_mov_b32 v80, 0
  v_mov_b32 v81, 0
  v_mov_b32 v82, 0
  v_mov_b32 v83, 0
  v_mov_b32 v84, 0
  v_mov_b32 v85, 0
  v_mov_b32 v86, 0
  v_mov_b32 v87, 0
  v_and_b32 v90, 7, v0
  v_lshrrev_b32 v6, 4, v0
  v_lshl_add_u32 v90, v90, 2, v6
  v_lshlrev_b32 v90, 4, v90
  s_lshl_b32 s64, s71, 11
  s_lshl_b32 s69, s73, 9
  s_add_u32 s69, s69, 1310720
  s_add_u32 s64, s64, s69
  s_waitcnt vmcnt(9)
  v_dot2c_f32_bf16 v80, v24, v8
  v_dot2c_f32_bf16 v81, v24, v70
  v_dot2c_f32_bf16 v82, v25, v8
  v_dot2c_f32_bf16 v83, v25, v70
  v_dot2c_f32_bf16 v84, v26, v8
  v_dot2c_f32_bf16 v85, v26, v70
  v_dot2c_f32_bf16 v86, v27, v8
  v_dot2c_f32_bf16 v87, v27, v70
  s_waitcnt vmcnt(8)
  v_dot2c_f32_bf16 v80, v28, v9
  v_dot2c_f32_bf16 v81, v28, v71
  v_dot2c_f32_bf16 v82, v29, v9
  v_dot2c_f32_bf16 v83, v29, v71
  v_dot2c_f32_bf16 v84, v30, v9
  v_dot2c_f32_bf16 v85, v30, v71
  v_dot2c_f32_bf16 v86, v31, v9
  v_dot2c_f32_bf16 v87, v31, v71
  s_waitcnt vmcnt(7)
  v_dot2c_f32_bf16 v80, v32, v10
  v_dot2c_f32_bf16 v81, v32, v72
  v_dot2c_f32_bf16 v82, v33, v10
  v_dot2c_f32_bf16 v83, v33, v72
  v_dot2c_f32_bf16 v84, v34, v10
  v_dot2c_f32_bf16 v85, v34, v72
  v_dot2c_f32_bf16 v86, v35, v10
  v_dot2c_f32_bf16 v87, v35, v72
  s_waitcnt vmcnt(6)
  v_dot2c_f32_bf16 v80, v36, v11
  v_dot2c_f32_bf16 v81, v36, v73
  v_dot2c_f32_bf16 v82, v37, v11
  v_dot2c_f32_bf16 v83, v37, v73
  v_dot2c_f32_bf16 v84, v38, v11
  v_dot2c_f32_bf16 v85, v38, v73
  v_dot2c_f32_bf16 v86, v39, v11
  v_dot2c_f32_bf16 v87, v39, v73
  s_waitcnt vmcnt(5)
  v_dot2c_f32_bf16 v80, v40, v12
  v_dot2c_f32_bf16 v81, v40, v74
  v_dot2c_f32_bf16 v82, v41, v12
  v_dot2c_f32_bf16 v83, v41, v74
  v_dot2c_f32_bf16 v84, v42, v12
  v_dot2c_f32_bf16 v85, v42, v74
  v_dot2c_f32_bf16 v86, v43, v12
  v_dot2c_f32_bf16 v87, v43, v74
  s_waitcnt vmcnt(4)
  v_dot2c_f32_bf16 v80, v44, v13
  v_dot2c_f32_bf16 v81, v44, v75
  v_dot2c_f32_bf16 v82, v45, v13
  v_dot2c_f32_bf16 v83, v45, v75
  v_dot2c_f32_bf16 v84, v46, v13
  v_dot2c_f32_bf16 v85, v46, v75
  v_dot2c_f32_bf16 v86, v47, v13
  v_dot2c_f32_bf16 v87, v47, v75
  s_waitcnt vmcnt(3)
  v_dot2c_f32_bf16 v80, v48, v14
  v_dot2c_f32_bf16 v81, v48, v76
  v_dot2c_f32_bf16 v82, v49, v14
  v_dot2c_f32_bf16 v83, v49, v76
  v_dot2c_f32_bf16 v84, v50, v14
  v_dot2c_f32_bf16 v85, v50, v76
  v_dot2c_f32_bf16 v86, v51, v14
  v_dot2c_f32_bf16 v87, v51, v76
  s_waitcnt vmcnt(2)
  v_dot2c_f32_bf16 v80, v52, v15
  v_dot2c_f32_bf16 v81, v52, v77
  v_dot2c_f32_bf16 v82, v53, v15
  v_dot2c_f32_bf16 v83, v53, v77
  v_dot2c_f32_bf16 v84, v54, v15
  v_dot2c_f32_bf16 v85, v54, v77
  v_dot2c_f32_bf16 v86, v55, v15
  v_dot2c_f32_bf16 v87, v55, v77
  s_waitcnt vmcnt(1)
  v_dot2c_f32_bf16 v80, v56, v16
  v_dot2c_f32_bf16 v81, v56, v78
  v_dot2c_f32_bf16 v82, v57, v16
  v_dot2c_f32_bf16 v83, v57, v78
  v_dot2c_f32_bf16 v84, v58, v16
  v_dot2c_f32_bf16 v85, v58, v78
  v_dot2c_f32_bf16 v86, v59, v16
  v_dot2c_f32_bf16 v87, v59, v78
  s_waitcnt vmcnt(0)
  v_dot2c_f32_bf16 v80, v60, v17
  v_dot2c_f32_bf16 v81, v60, v79
  v_dot2c_f32_bf16 v82, v61, v17
  v_dot2c_f32_bf16 v83, v61, v79
  v_dot2c_f32_bf16 v84, v62, v17
  v_dot2c_f32_bf16 v85, v62, v79
  v_dot2c_f32_bf16 v86, v63, v17
  v_dot2c_f32_bf16 v87, v63, v79
  v_permlane32_swap_b32 v80, v84
  v_permlane32_swap_b32 v81, v85
  v_permlane32_swap_b32 v82, v86
  v_permlane32_swap_b32 v83, v87
  v_add_f32 v80, v80, v84
  v_add_f32 v81, v81, v85
  v_add_f32 v82, v82, v86
  v_add_f32 v83, v83, v87
  s_nop 0
  v_permlane16_swap_b32 v80, v82
  v_permlane16_swap_b32 v81, v83
  v_add_f32 v80, v80, v82
  v_add_f32 v81, v81, v83
  s_nop 0
  v_add_f32_dpp v80, v80, v80 row_ror:8 row_mask:0xf bank_mask:0xf
  v_add_f32_dpp v81, v81, v81 row_ror:8 row_mask:0xf bank_mask:0xf
  v_mov_b32 v82, s30
  v_mov_b32 v83, s31
  s_mov_b32 exec_lo, 0xff00ff
  s_mov_b32 exec_hi, 0xff00ff
  buffer_store_dwordx4 v[80:83], v90, s[32:35], s64 offen
  s_mov_b64 exec, -1
  v_and_b32 v3, 31, v0
  v_lshrrev_b32 v2, 5, v0
  v_lshlrev_b32 v2, 11, v2
  v_lshl_add_u32 v2, v3, 4, v2
  s_lshl_b32 s68, s6, 14
  s_add_u32 s60, s68, s69
  s_add_u32 s61, s60, 4096
  s_add_u32 s62, s60, 8192
  s_add_u32 s63, s60, 12288
  v_lshlrev_b32 v3, 2, v3
  s_lshl_b32 s69, s73, 7
  v_add_u32 v3, s69, v3
  v_mov_b32 v1, 0
  s_mov_b32 s65, 0
  s_sleep 40
  s_mov_b32 s16, s32
  s_mov_b32 s17, s33
  s_mov_b32 s18, 4194304
  s_mov_b32 s19, 0x20000
  s_mov_b32 s70, 200007
L_spin_9:
  buffer_load_dwordx4 v[8:11], v2, s[16:19], s60 offen sc1 nt
  buffer_load_dwordx4 v[12:15], v2, s[16:19], s61 offen sc1 nt
  buffer_load_dwordx4 v[16:19], v2, s[16:19], s62 offen sc1 nt
  buffer_load_dwordx4 v[20:23], v2, s[16:19], s63 offen sc1 nt
  s_waitcnt vmcnt(0)
  v_cmp_ne_u64 vcc, s[30:31], v[10:11]
  v_cmp_ne_u64 s[20:21], s[30:31], v[14:15]
  v_cmp_ne_u64 s[22:23], s[30:31], v[18:19]
  s_or_b64 vcc, vcc, s[20:21]
  v_cmp_ne_u64 s[20:21], s[30:31], v[22:23]
  s_or_b64 vcc, vcc, s[22:23]
  s_or_b64 vcc, vcc, s[20:21]
  s_nop 0
  s_cbranch_vccz L_sdone_10
  s_sleep 20
  ds_read_b32 v4, v1 offset:656
  s_waitcnt lgkmcnt(0)
  v_readfirstlane_b32 s46, v4
  s_nop 0
  s_sub_u32 s68, s46, s65
  s_cmp_lg_u32 s68, 2
  s_cbranch_scc1 L_qlazy_11
  s_mov_b32 exec_lo, 0xff00ff
  s_mov_b32 exec_hi, 0xff00ff
  buffer_store_dwordx4 v[80:83], v90, s[24:27], s64 offen sc1
  s_mov_b64 exec, -1
  s_mov_b32 s65, 1
L_qlazy_11:
  s_and_b32 s99, s70, 7
  s_cselect_b32 s16, s32, s24
  s_cselect_b32 s17, s33, s25
  s_sub_u32 s70, s70, 1
  s_cbranch_scc0 L_spin_9
L_sdone_10:
  v_add_f32 v8, v8, v12
  v_add_f32 v9, v9, v13
  v_add_f32 v16, v16, v20
  v_add_f32 v17, v17, v21
  v_add_f32 v8, v8, v16
  v_add_f32 v9, v9, v17
  v_mov_b32 v10, v8
  v_mov_b32 v11, v9
  s_nop 0
  v_permlane32_swap_b32 v8, v10
  v_permlane32_swap_b32 v9, v11
  v_add_f32 v8, v8, v10
  v_add_f32 v9, v9, v11
  v_cvt_pk_bf16_f32 v8, v8, v9
  ds_write_b32 v3, v8 offset:0
  s_lshl_b32 s69, s73, 3
  v_mov_b32 v4, s69
  v_mov_b32 v6, 1
  s_waitcnt lgkmcnt(0)
  ds_write_b32 v4, v6 offset:384
  v_mov_b32 v1, 0
  s_mov_b32 s70, 200007
L_spin_12:
  ds_read_b32 v4, v1 offset:656
  s_waitcnt lgkmcnt(0)
  v_cmp_gt_u32 vcc, 1, v4
  s_nop 0
  s_cbranch_vccz L_sdone_13
  s_sleep 2
  s_sub_u32 s70, s70, 1
  s_cbranch_scc0 L_spin_12
L_sdone_13:
  v_readfirstlane_b32 s46, v4
  ds_read_b32 v4, v1 offset:656
  s_waitcnt lgkmcnt(0)
  v_readfirstlane_b32 s46, v4
  s_nop 0
  s_sub_u32 s68, s46, s65
  s_cmp_lg_u32 s68, 2
  s_cbranch_scc1 L_qlazy_14
  s_mov_b32 exec_lo, 0xff00ff
  s_mov_b32 exec_hi, 0xff00ff
  buffer_store_dwordx4 v[80:83], v90, s[24:27], s64 offen sc1
  s_mov_b64 exec, -1
  s_mov_b32 s65, 1
L_qlazy_14:
  s_cmp_lg_u32 s3, 8
  s_cbranch_scc1 L_role
  v_mov_b32 v1, 0
  s_mov_b32 s70, 200007
L_spin_15:
  ds_read_b32 v4, v1 offset:648
  s_waitcnt lgkmcnt(0)
  v_cmp_gt_u32 vcc, 8, v4
  s_nop 0
  s_cbranch_vccz L_sdone_16
  s_sleep 2
  s_sub_u32 s70, s70, 1
  s_cbranch_scc0 L_spin_15
L_sdone_16:
  s_lshl_b32 s68, s4, 5
  v_mov_b32 v6, s68
  v_mov_b32 v5, 1
  s_mov_b64 exec, 1
  global_atomic_add v5, v6, v5, s[56:57] sc0 sc1
  s_waitcnt vmcnt(0)
  v_and_b32 v5, 31, v5
  v_add_u32 v5, 1, v5
  ds_write_b32 v1, v5 offset:668
  s_mov_b64 exec, -1
  s_branch L_role
L_misc2:
  s_getreg_b32 s64, hwreg(HW_REG_XCC_ID)
  s_mov_b32 s24, s58
  s_mov_b32 s25, s59
  s_mov_b32 s26, 4194304
  s_mov_b32 s27, 0x20000
  s_add_u32 s32, s58, 4194304
  s_addc_u32 s33, s59, 0
  s_mov_b32 s34, 4194304
  s_mov_b32 s35, 0x20000
  s_lshl3_add_u32 s71, s6, s7
  s_lshr_b32 s79, s2, 3
  v_and_b32 v1, 31, v0
  v_lshlrev_b32 v1, 4, v1
  v_lshrrev_b32 v2, 5, v0
  v_lshl_add_u32 v1, v2, 13, v1
  s_lshl_b32 s66, s2, 9
  s_and_b32 s68, s66, 0xffffe000
  s_add_u32 s66, s66, s68
  s_add_u32 s66, s66, 131072
  v_mov_b32 v6, 0
  v_mov_b32 v7, 0
  s_cmp_ge_u32 s79, 4
  s_cbranch_scc1 L_nopr0
  s_mov_b32 exec_lo, 0xffff
  s_mov_b32 exec_hi, 0xffff
  buffer_store_dwordx4 v[4:7], v1, s[24:27], s66 offen sc1
  s_mov_b64 exec, -1
L_nopr0:
  s_waitcnt lgkmcnt(0)
  s_mul_i32 s30, s28, 0x2c9277b5
  s_add_u32 s30, s30, 0xac564b05
  s_mul_i32 s31, s29, 0x0019660d
  s_add_u32 s31, s31, 0x3c6ef35f
  s_and_b32 s64, s64, 15
  v_mov_b32 v4, s30
  v_mov_b32 v5, s31
  v_mov_b32 v6, s64
  v_mov_b32 v7, s64
  s_lshl_b32 s68, s4, 9
  s_add_u32 s68, s68, 1056768
  s_lshl_b32 s69, s79, 4
  v_mov_b32 v1, s69
  s_mov_b64 exec, 1
  buffer_store_dwordx4 v[4:7], v1, s[32:35], s68 offen
  s_mov_b64 exec, -1
  v_and_b32 v1, 31, v0
  v_lshlrev_b32 v1, 4, v1
  s_mov_b32 s70, 12
  s_mov_b32 s46, 2
L_idpoll:
  s_sleep 16
  buffer_load_dwordx4 v[8:11], v1, s[32:35], s68 offen sc1 nt
  s_waitcnt vmcnt(0)
  v_cmp_ne_u64 vcc, s[30:31], v[8:9]
  s_nop 0
  s_cbranch_vccz L_iddone
  s_sub_u32 s70, s70, 1
  s_cbranch_scc0 L_idpoll
  s_branch L_idset
L_iddone:
  v_cmp_ne_u32 vcc, s64, v10
  s_nop 0
  s_cbranch_vccnz L_idset
  s_mov_b32 s46, 1
L_idset:
  v_mov_b32 v1, 0
  v_mov_b32 v4, s46
  ds_write_b32 v1, v4 offset:656
  s_mov_b32 s60, -1
  s_mov_b32 s61, -1
  s_lshl_b32 s67, s4, 9
  s_add_u32 s67, s67, 1069056
  s_cmp_ge_u32 s79, 4
  s_cbranch_scc1 L_nopr1
  s_waitcnt lgkmcnt(0)
  s_add_u32 s69, s66, 0
  s_memtime s[62:63]
  s_waitcnt lgkmcnt(0)
  s_load_dword s65, s[58:59], s69
  s_waitcnt lgkmcnt(0)
  s_memtime s[20:21]
  s_waitcnt lgkmcnt(0)
  s_sub_u32 s62, s20, s62
  s_min_u32 s60, s60, s62
  s_add_u32 s69, s66, 8192
  s_memtime s[62:63]
  s_waitcnt lgkmcnt(0)
  s_load_dword s65, s[58:59], s69
  s_waitcnt lgkmcnt(0)
  s_memtime s[20:21]
  s_waitcnt lgkmcnt(0)
  s_sub_u32 s62, s20, s62
  s_min_u32 s61, s61, s62
  s_add_u32 s69, s66, 128
  s_memtime s[62:63]
  s_waitcnt lgkmcnt(0)
  s_load_dword s65, s[58:59], s69
  s_waitcnt lgkmcnt(0)
  s_memtime s[20:21]
  s_waitcnt lgkmcnt(0)
  s_sub_u32 s62, s20, s62
  s_min_u32 s60, s60, s62
  s_add_u32 s69, s66, 8320
  s_memtime s[62:63]
  s_waitcnt lgkmcnt(0)
  s_load_dword s65, s[58:59], s69
  s_waitcnt lgkmcnt(0)
  s_memtime s[20:21]
  s_waitcnt lgkmcnt(0)
  s_sub_u32 s62, s20, s62
  s_min_u32 s61, s61, s62
  s_lshl_b32 s69, s79, 4
  v_mov_b32 v1, s69
  v_mov_b32 v4, s60
  v_mov_b32 v5, s61
  v_mov_b32 v6, s30
  v_mov_b32 v7, s31
  s_mov_b64 exec, 1
  buffer_store_dwordx4 v[4:7], v1, s[32:35], s67 offen
  s_mov_b64 exec, -1
L_nopr1:
  v_and_b32 v1, 7, v0
  v_lshlrev_b32 v1, 4, v1
  s_mov_b32 s70, 200007
L_spin_17:
  ds_read_b128 v[4:7], v1 offset:512
  s_waitcnt lgkmcnt(0)
  v_cmp_eq_u32 vcc, 0, v7
  s_nop 0
  s_cbranch_vccz L_sdone_18
  s_sleep 4
  s_sub_u32 s70, s70, 1
  s_cbranch_scc0 L_spin_17
L_sdone_18:
  s_mov_b32 s68, 0x3fb8aa3b
  v_mov_b32 v2, v4
  s_nop 1
  v_max_f32_dpp v2, v2, v2 quad_perm:[1,0,3,2] row_mask:0xf bank_mask:0xf
  s_nop 1
  v_max_f32_dpp v2, v2, v2 quad_perm:[2,3,0,1] row_mask:0xf bank_mask:0xf
  s_nop 1
  v_max_f32_dpp v2, v2, v2 row_half_mirror row_mask:0xf bank_mask:0xf
  v_sub_f32 v4, v4, v2
  v_mul_f32 v4, s68, v4
  v_exp_f32 v4, v4
  s_nop 0
  v_mul_f32 v3, v4, v5
  s_nop 1
  v_add_f32_dpp v3, v3, v3 quad_perm:[1,0,3,2] row_mask:0xf bank_mask:0xf
  s_nop 1
  v_add_f32_dpp v3, v3, v3 quad_perm:[2,3,0,1] row_mask:0xf bank_mask:0xf
  s_nop 1
  v_add_f32_dpp v3, v3, v3 row_half_mirror row_mask:0xf bank_mask:0xf
  s_lshl_b32 s68, s71, 4
  s_add_u32 s68, s68, 1052672
  v_mov_b32 v4, s30
  v_mov_b32 v5, s31
  s_mov_b32 exec_lo, 0x1
  s_mov_b32 exec_hi, 0x0
  buffer_store_dwordx4 v[2:5], v1, s[32:35], s68 offen
  s_mov_b64 exec, -1
  s_cmp_lg_u32 s46, 1
  s_cbranch_scc1 L_slow_19
L_back_20:
  s_cmp_lg_u32 s46, 1
  s_cbranch_scc1 L_noshare
  v_and_b32 v8, 7, v0
  v_lshlrev_b32 v8, 4, v8
  buffer_load_dwordx4 v[4:7], v8, s[32:35], s67 offen sc1 nt
  s_waitcnt vmcnt(0)
  v_cmp_eq_u64 vcc, s[30:31], v[6:7]
  s_nop 1
  v_cndmask_b32 v4, -1, v4, vcc
  v_cndmask_b32 v5, -1, v5, vcc
  s_nop 0
  v_min_u32_dpp v4, v4, v4 quad_perm:[1,0,3,2] row_mask:0xf bank_mask:0xf
  v_min_u32_dpp v5, v5, v5 quad_perm:[1,0,3,2] row_mask:0xf bank_mask:0xf
  s_nop 0
  v_min_u32_dpp v4, v4, v4 quad_perm:[2,3,0,1] row_mask:0xf bank_mask:0xf
  v_min_u32_dpp v5, v5, v5 quad_perm:[2,3,0,1] row_mask:0xf bank_mask:0xf
  s_nop 0
  v_min_u32_dpp v4, v4, v4 row_half_mirror row_mask:0xf bank_mask:0xf
  v_min_u32_dpp v5, v5, v5 row_half_mirror row_mask:0xf bank_mask:0xf
  s_nop 0
  v_min_u32_dpp v4, v4, v4 row_mirror row_mask:0xf bank_mask:0xf
  v_min_u32_dpp v5, v5, v5 row_mirror row_mask:0xf bank_mask:0xf
  v_mov_b32 v6, v4
  v_mov_b32 v7, v5
  s_nop 0
  v_permlane16_swap_b32 v4, v6
  v_permlane16_swap_b32 v5, v7
  v_min_u32 v4, v4, v6
  v_min_u32 v5, v5, v7
  v_readfirstlane_b32 s62, v4
  v_readfirstlane_b32 s63, v5
  s_min_u32 s60, s60, s62
  s_min_u32 s61, s61, s63
L_noshare:
  s_cmp_lt_u32 s61, s60
  s_cselect_b32 s47, 8192, 0
  v_mov_b32 v8, 0
  v_mov_b32 v4, s47
  ds_write_b32 v8, v4 offset:664
  s_lshl_b32 s74, s6, 7
  s_add_u32 s74, s74, 1052672
  s_mov_b32 s16, s32
  s_mov_b32 s17, s33
  s_mov_b32 s18, 4194304
  s_mov_b32 s19, 0x20000
  s_mov_b32 s70, 200007
L_spin_21:
  s_sleep 16
  buffer_load_dwordx4 v[4:7], v1, s[16:19], s74 offen sc1 nt
  s_waitcnt vmcnt(0)
  v_cmp_ne_u64 vcc, s[30:31], v[6:7]
  s_nop 0
  s_cbranch_vccz L_sdone_22
  s_and_b32 s99, s70, 7
  s_cmp_eq_u32 s46, 1
  s_cselect_b32 s99, 1, s99
  s_cmp_lg_u32 s99, 0
  s_cselect_b32 s16, s32, s24
  s_cselect_b32 s17, s33, s25
  s_sub_u32 s70, s70, 1
  s_cbranch_scc0 L_spin_21
L_sdone_22:
  s_mov_b32 s68, 0x3fb8aa3b
  v_mov_b32 v2, v4
  s_nop 1
  v_max_f32_dpp v2, v2, v2 quad_perm:[1,0,3,2] row_mask:0xf bank_mask:0xf
  s_nop 1
  v_max_f32_dpp v2, v2, v2 quad_perm:[2,3,0,1] row_mask:0xf bank_mask:0xf
  s_nop 1
  v_max_f32_dpp v2, v2, v2 row_half_mirror row_mask:0xf bank_mask:0xf
  v_sub_f32 v4, v4, v2
  v_mul_f32 v4, s68, v4
  v_exp_f32 v4, v4
  s_nop 0
  v_mul_f32 v3, v4, v5
  s_nop 1
  v_add_f32_dpp v3, v3, v3 quad_perm:[1,0,3,2] row_mask:0xf bank_mask:0xf
  s_nop 1
  v_add_f32_dpp v3, v3, v3 quad_perm:[2,3,0,1] row_mask:0xf bank_mask:0xf
  s_nop 1
  v_add_f32_dpp v3, v3, v3 row_half_mirror row_mask:0xf bank_mask:0xf
  v_rcp_f32 v3, v3
  v_mov_b32 v4, 1
  v_mov_b32 v5, 1
  v_mov_b32 v1, 0
  ds_write_b128 v1, v[2:5] offset:672
L_role:
  v_mov_b32 v1, 0
  s_mov_b32 s70, 200007
L_spin_23:
  ds_read_b64 v[4:5], v1 offset:664
  s_waitcnt lgkmcnt(0)
  v_cmp_eq_u32 vcc, 0, v5
  s_nop 0
  s_cbranch_vccz L_sdone_24
  s_sleep 4
  s_sub_u32 s70, s70, 1
  s_cbranch_scc0 L_spin_23
L_sdone_24:
  v_readfirstlane_b32 s5, v5
  v_readfirstlane_b32 s47, v4
  s_sub_u32 s5, s5, 1
  s_cmp_lt_u32 s5, 20
  s_cbranch_scc0 L_tiles
  s_mov_b32 s12, s44
  s_mov_b32 s13, s45
  s_mov_b32 s14, 7864320
  s_mov_b32 s15, 0x20000
  v_lshrrev_b32 v24, 4, v0
  v_lshlrev_b32 v24, 10, v24
  v_bfe_u32 v25, v0, 2, 2
  v_lshl_add_u32 v24, v25, 7, v24
  v_and_b32 v25, 3, v0
  v_lshl_add_u32 v24, v25, 3, v24
  s_cmp_ge_u32 s5, 10
  s_cselect_b32 s76, 1, 0
  s_mul_i32 s77, s76, 10
  s_sub_u32 s77, s5, s77
  s_lshl1_add_u32 s78, s4, s76
  s_lshl2_add_u32 s78, s78, s73
  v_lshrrev_b32 v2, 3, v0
  v_mul_u32_u24 v26, 1280, v2
  v_and_b32 v3, 7, v0
  v_lshl_add_u32 v26, v3, 4, v26
  s_mul_i32 s60, s78, 122880
  s_lshl_b32 s69, s77, 7
  s_add_u32 s60, s60, s69
  s_mul_i32 s61, s73, 12288
  v_add_u32 v24, s61, v24
  s_add_u32 s61, s61, 8704
  v_lshlrev_b32 v60, 4, v0
  s_mul_i32 s74, s78, 3072
  s_add_u32 s74, s74, 1114112
  v_lshlrev_b32 v62, 2, v0
  s_lshl_b32 s68, s73, 8
  v_add_u32 v61, s68, v62
  s_mul_i32 s75, s4, 5120
  s_lshl_b32 s69, s5, 8
  s_add_u32 s75, s75, s69
  s_and_b32 s69, s75, 0xffffe000
  s_add_u32 s75, s75, s69
  s_add_u32 s75, s75, 0
  s_xor_b32 s62, s47, 8192
  s_add_u32 s62, s62, s75
  s_add_u32 s63, s47, s75
  s_mov_b32 s66, 0xff00ff00
  s_mov_b32 s67, 0xff00ff00
  v_mov_b32 v50, s30
  v_mov_b32 v51, s31
  v_cndmask_b32 v52, 0, v50, s[66:67]
  v_cndmask_b32 v53, 0, v51, s[66:67]
  v_cndmask_b32 v54, v50, 0, s[66:67]
  v_cndmask_b32 v55, v51, 0, s[66:67]
  buffer_load_dwordx4 v[8:11], v60, s[32:35], s74 offen offset:0 sc1 nt
  buffer_load_dwordx4 v[12:15], v60, s[32:35], s74 offen offset:1024 sc1 nt
  buffer_load_dwordx4 v[16:19], v60, s[32:35], s74 offen offset:2048 sc1 nt
  v_mov_b32 v1, 0
  s_mov_b32 s70, 200007
L_spin_25:
  ds_read_b32 v4, v1 offset:644
  s_waitcnt lgkmcnt(0)
  v_cmp_gt_u32 vcc, 8, v4
  s_nop 0
  s_cbranch_vccz L_sdone_26
  s_sleep 1
  s_sub_u32 s70, s70, 1
  s_cbranch_scc0 L_spin_25
L_sdone_26:
  s_mov_b32 m0, s61
  s_nop 0
  buffer_load_dwordx4 v26, s[12:15], s60 offen nt lds
  s_add_u32 s60, s60, 10240
  s_add_u32 s61, s61, 1024
  s_mov_b32 m0, s61
  s_nop 0
  buffer_load_dwordx4 v26, s[12:15], s60 offen nt lds
  s_add_u32 s60, s60, 10240
  s_add_u32 s61, s61, 1024
  s_mov_b32 m0, s61
  s_nop 0
  buffer_load_dwordx4 v26, s[12:15], s60 offen nt lds
  s_add_u32 s60, s60, 10240
  s_add_u32 s61, s61, 1024
  s_mov_b32 m0, s61
  s_nop 0
  buffer_load_dwordx4 v26, s[12:15], s60 offen nt lds
  s_add_u32 s60, s60, 10240
  s_add_u32 s61, s61, 1024
  s_mov_b32 m0, s61
  s_nop 0
  buffer_load_dwordx4 v26, s[12:15], s60 offen nt lds
  s_add_u32 s60, s60, 10240
  s_add_u32 s61, s61, 1024
  s_mov_b32 m0, s61
  s_nop 0
  buffer_load_dwordx4 v26, s[12:15], s60 offen nt lds
  s_add_u32 s60, s60, 10240
  s_add_u32 s61, s61, 1024
  s_mov_b32 m0, s61
  s_nop 0
  buffer_load_dwordx4 v26, s[12:15], s60 offen nt lds
  s_add_u32 s60, s60, 10240
  s_add_u32 s61, s61, 1024
  s_mov_b32 m0, s61
  s_nop 0
  buffer_load_dwordx4 v26, s[12:15], s60 offen nt lds
  s_add_u32 s60, s60, 10240
  s_add_u32 s61, s61, 1024
  v_mov_b32 v1, 0
  s_mov_b32 s70, 200007
L_spin_27:
  ds_read_b32 v4, v1 offset:660
  s_waitcnt lgkmcnt(0)
  v_cmp_gt_u32 vcc, 1, v4
  s_nop 0
  s_cbranch_vccz L_sdone_28
  s_sleep 1
  s_sub_u32 s70, s70, 1
  s_cbranch_scc0 L_spin_27
L_sdone_28:
  s_mov_b32 m0, s61
  s_nop 0
  buffer_load_dwordx4 v26, s[12:15], s60 offen nt lds
  s_add_u32 s60, s60, 10240
  s_add_u32 s61, s61, 1024
  s_mov_b32 m0, s61
  s_nop 0
  buffer_load_dwordx4 v26, s[12:15], s60 offen nt lds
  s_add_u32 s60, s60, 10240
  s_add_u32 s61, s61, 1024
  s_mov_b32 m0, s61
  s_nop 0
  buffer_load_dwordx4 v26, s[12:15], s60 offen nt lds
  s_add_u32 s60, s60, 10240
  s_add_u32 s61, s61, 1024
  s_mov_b32 m0, s61
  s_nop 0
  buffer_load_dwordx4 v26, s[12:15], s60 offen nt lds
  s_waitcnt vmcnt(8)
  ds_read_b64_tr_b16 v[64:65], v24 offset:8704
  ds_read_b64_tr_b16 v[66:67], v24 offset:9216
  ds_read_b64_tr_b16 v[68:69], v24 offset:8736
  ds_read_b64_tr_b16 v[70:71], v24 offset:9248
  ds_read_b64_tr_b16 v[72:73], v24 offset:8768
  ds_read_b64_tr_b16 v[74:75], v24 offset:9280
  ds_read_b64_tr_b16 v[76:77], v24 offset:8800
  ds_read_b64_tr_b16 v[78:79], v24 offset:9312
  s_waitcnt vmcnt(4)
  ds_read_b64_tr_b16 v[80:81], v24 offset:12800
  ds_read_b64_tr_b16 v[82:83], v24 offset:13312
  ds_read_b64_tr_b16 v[84:85], v24 offset:12832
  ds_read_b64_tr_b16 v[86:87], v24 offset:13344
  ds_read_b64_tr_b16 v[88:89], v24 offset:12864
  ds_read_b64_tr_b16 v[90:91], v24 offset:13376
  ds_read_b64_tr_b16 v[92:93], v24 offset:12896
  ds_read_b64_tr_b16 v[94:95], v24 offset:13408
  s_waitcnt vmcnt(2)
  buffer_load_dwordx4 v[8:11], v60, s[32:35], s74 offen offset:0 sc1
  buffer_load_dwordx4 v[12:15], v60, s[32:35], s74 offen offset:1024 sc1
  buffer_load_dwordx4 v[16:19], v60, s[32:35], s74 offen offset:2048 sc1
  s_waitcnt vmcnt(3)
  ds_read_b64_tr_b16 v[96:97], v24 offset:16896
  ds_read_b64_tr_b16 v[98:99], v24 offset:17408
  ds_read_b64_tr_b16 v[100:101], v24 offset:16928
  ds_read_b64_tr_b16 v[102:103], v24 offset:17440
  ds_read_b64_tr_b16 v[104:105], v24 offset:16960
  ds_read_b64_tr_b16 v[106:107], v24 offset:17472
  ds_read_b64_tr_b16 v[108:109], v24 offset:16992
  ds_read_b64_tr_b16 v[110:111], v24 offset:17504
  s_waitcnt lgkmcnt(0)
  s_mov_b32 s16, s32
  s_mov_b32 s17, s33
  s_mov_b32 s18, 4194304
  s_mov_b32 s19, 0x20000
  s_mov_b32 s70, 200007
  s_branch L_opw0
L_spin_29:
  buffer_load_dwordx4 v[8:11], v60, s[16:19], s74 offen offset:0 sc1
  buffer_load_dwordx4 v[12:15], v60, s[16:19], s74 offen offset:1024 sc1
  buffer_load_dwordx4 v[16:19], v60, s[16:19], s74 offen offset:2048 sc1
L_opw0:
  s_waitcnt vmcnt(2)
  v_xor_b32 v8, v8, v52
  v_xor_b32 v9, v9, v53
  v_xor_b32 v10, v10, v54
  v_xor_b32 v11, v11, v55
  s_nop 1
  v_mfma_f32_16x16x32_bf16 v[32:35], v[8:11], v[64:67], 0
  v_mfma_f32_16x16x32_bf16 v[36:39], v[8:11], v[68:71], 0
  v_mfma_f32_16x16x32_bf16 v[40:43], v[8:11], v[72:75], 0
  v_mfma_f32_16x16x32_bf16 v[44:47], v[8:11], v[76:79], 0
  v_or_b32 v2, v8, v9
  v_or_b32 v3, v10, v11
  s_waitcnt vmcnt(1)
  v_xor_b32 v12, v12, v52
  v_xor_b32 v13, v13, v53
  v_xor_b32 v14, v14, v54
  v_xor_b32 v15, v15, v55
  s_nop 1
  v_mfma_f32_16x16x32_bf16 v[32:35], v[12:15], v[80:83], v[32:35]
  v_mfma_f32_16x16x32_bf16 v[36:39], v[12:15], v[84:87], v[36:39]
  v_mfma_f32_16x16x32_bf16 v[40:43], v[12:15], v[88:91], v[40:43]
  v_mfma_f32_16x16x32_bf16 v[44:47], v[12:15], v[92:95], v[44:47]
  v_or3_b32 v2, v2, v12, v13
  v_or3_b32 v3, v3, v14, v15
  s_waitcnt vmcnt(0)
  v_xor_b32 v16, v16, v52
  v_xor_b32 v17, v17, v53
  v_xor_b32 v18, v18, v54
  v_xor_b32 v19, v19, v55
  s_nop 1
  v_mfma_f32_16x16x32_bf16 v[32:35], v[16:19], v[96:99], v[32:35]
  v_mfma_f32_16x16x32_bf16 v[36:39], v[16:19], v[100:103], v[36:39]
  v_mfma_f32_16x16x32_bf16 v[40:43], v[16:19], v[104:107], v[40:43]
  v_mfma_f32_16x16x32_bf16 v[44:47], v[16:19], v[108:111], v[44:47]
  v_or3_b32 v2, v2, v16, v17
  v_or3_b32 v3, v3, v18, v19
  v_cndmask_b32 v2, v3, v2, s[66:67]
  v_cmp_ne_u32 vcc, 0, v2
  s_nop 0
  s_cbranch_vccz L_sdone_30
  s_and_b32 s99, s70, 7
  s_cmp_eq_u32 s46, 1
  s_cselect_b32 s99, 1, s99
  s_cmp_lg_u32 s99, 0
  s_cselect_b32 s16, s32, s24
  s_cselect_b32 s17, s33, s25
  s_sub_u32 s70, s70, 1
  s_cbranch_scc0 L_spin_29
L_sdone_30:
  v_add_f32 v4, v32, v33
  v_add_f32 v8, v34, v35
  v_add_f32 v5, v36, v37
  v_add_f32 v9, v38, v39
  v_add_f32 v6, v40, v41
  v_add_f32 v10, v42, v43
  v_add_f32 v7, v44, v45
  v_add_f32 v11, v46, v47
  v_add_f32 v4, v4, v8
  v_add_f32 v5, v5, v9
  v_add_f32 v6, v6, v10
  v_add_f32 v7, v7, v11
  s_nop 0
  v_permlane32_swap_b32 v4, v6
  v_permlane32_swap_b32 v5, v7
  v_add_f32 v4, v4, v6
  v_add_f32 v5, v5, v7
  s_nop 1
  v_permlane16_swap_b32 v4, v5
  v_add_f32 v4, v4, v5
  ds_write_b32 v61, v4 offset:7168
  s_cmp_lg_u32 s3, 8
  s_waitcnt lgkmcnt(0)
  s_barrier
  s_cbranch_scc1 L_end
  ds_read_b32 v5, v62 offset:7424
  ds_read_b32 v6, v62 offset:7680
  ds_read_b32 v7, v62 offset:7936
  s_waitcnt lgkmcnt(0)
  v_add_f32 v4, v4, v5
  v_add_f32 v6, v6, v7
  v_add_f32 v48, v4, v6
  s_nop 1
  v_mov_b32_dpp v49, v48 quad_perm:[1,0,3,2] row_mask:0xf bank_mask:0xf
  v_cvt_pk_bf16_f32 v48, v48, v49
  s_nop 1
  v_mov_b32_dpp v49, v48 quad_perm:[2,3,0,1] row_mask:0xf bank_mask:0xf
  s_mov_b32 exec_lo, 0x11111111
  s_mov_b32 exec_hi, 0x11111111
  buffer_store_dwordx4 v[48:51], v62, s[24:27], s62 offen sc1
  buffer_store_dwordx4 v[48:51], v62, s[24:27], s63 offen sc1
  s_barrier
  s_endpgm
L_tiles:
  s_mov_b32 s12, s48
  s_mov_b32 s13, s49
  s_mov_b32 s14, 1966080
  s_mov_b32 s15, 0x20000
  s_mov_b32 s16, s50
  s_mov_b32 s17, s51
  s_mov_b32 s18, 1966080
  s_mov_b32 s19, 0x20000
  s_sub_u32 s75, s5, 20
  s_lshr_b32 s78, s75, 2
  s_and_b32 s75, s75, 3
  s_mul_i32 s72, s75, 491520
  s_mul_i32 s68, s73, 24576
  s_add_u32 s72, s72, s68
  s_mul_i32 s68, s4, 3
  s_add_u32 s78, s78, s68
  s_lshl_b32 s68, s78, 7
  s_add_u32 s72, s72, s68
  s_lshl_b32 s61, s73, 10
  s_add_u32 s61, s61, 8704
  v_lshrrev_b32 v2, 3, v0
  v_and_b32 v3, 7, v0
  v_mul_u32_u24 v62, 3072, v2
  v_lshl_add_u32 v62, v3, 4, v62
  v_mov_b32 v1, 0
  s_mov_b32 s70, 200007
L_spin_31:
  ds_read_b32 v4, v1 offset:644
  s_waitcnt lgkmcnt(0)
  v_cmp_gt_u32 vcc, 8, v4
  s_nop 0
  s_cbranch_vccz L_sdone_32
  s_sleep 1
  s_sub_u32 s70, s70, 1
  s_cbranch_scc0 L_spin_31
L_sdone_32:
  s_add_u32 m0, s61, 0
  s_nop 0
  buffer_load_dwordx4 v62, s[12:15], s72 offen nt lds
  s_add_u32 m0, s61, 4096
  s_nop 0
  buffer_load_dwordx4 v62, s[16:19], s72 offen nt lds
  s_add_u32 s72, s72, 98304
  s_add_u32 m0, s61, 8192
  s_nop 0
  buffer_load_dwordx4 v62, s[12:15], s72 offen nt lds
  s_add_u32 m0, s61, 12288
  s_nop 0
  buffer_load_dwordx4 v62, s[16:19], s72 offen nt lds
  s_add_u32 s72, s72, 98304
  v_mov_b32 v1, 0
  s_mov_b32 s70, 200007
L_spin_33:
  ds_read_b32 v4, v1 offset:660
  s_waitcnt lgkmcnt(0)
  v_cmp_gt_u32 vcc, 1, v4
  s_nop 0
  s_cbranch_vccz L_sdone_34
  s_sleep 1
  s_sub_u32 s70, s70, 1
  s_cbranch_scc0 L_spin_33
L_sdone_34:
  s_add_u32 m0, s61, 16384
  s_nop 0
  buffer_load_dwordx4 v62, s[12:15], s72 offen nt lds
  s_add_u32 m0, s61, 20480
  s_nop 0
  buffer_load_dwordx4 v62, s[16:19], s72 offen nt lds
  s_add_u32 s72, s72, 98304
  s_add_u32 m0, s61, 24576
  s_nop 0
  buffer_load_dwordx4 v62, s[12:15], s72 offen nt lds
  s_add_u32 m0, s61, 28672
  s_nop 0
  buffer_load_dwordx4 v62, s[16:19], s72 offen nt lds
  s_add_u32 s72, s72, 98304
  s_add_u32 m0, s61, 32768
  s_nop 0
  buffer_load_dwordx4 v62, s[12:15], s72 offen nt lds
  s_add_u32 m0, s61, 36864
  s_nop 0
  buffer_load_dwordx4 v62, s[16:19], s72 offen nt lds
  s_waitcnt vmcnt(0)
  s_barrier
  s_endpgm
L_f1:
  v_lshrrev_b32 v58, 4, v0
  v_lshlrev_b32 v58, 10, v58
  v_bfe_u32 v5, v0, 2, 2
  v_lshl_add_u32 v58, v5, 7, v58
  v_and_b32 v5, 3, v0
  v_lshl_add_u32 v58, v5, 3, v58
  s_mov_b32 s12, s48
  s_mov_b32 s13, s49
  s_mov_b32 s14, 1966080
  s_mov_b32 s15, 0x20000
  s_mov_b32 s16, s50
  s_mov_b32 s17, s51
  s_mov_b32 s18, 1966080
  s_mov_b32 s19, 0x20000
  s_sub_u32 s75, s5, 20
  s_lshr_b32 s78, s75, 2
  s_mul_i32 s75, s75, 5
  s_add_u32 s75, s75, s3
  s_mul_i32 s68, s78, 20
  s_sub_u32 s74, s75, s68
  s_mul_i32 s68, s4, 3
  s_add_u32 s78, s78, s68
  s_mul_i32 s68, s4, 60
  s_add_u32 s75, s75, s68
  s_lshl_b32 s68, s3, 13
  v_add_u32 v58, s68, v58
  s_add_u32 s73, s68, 8704
  v_lshrrev_b32 v3, 4, v0
  v_and_b32 v2, 7, v0
  v_lshl_add_u32 v50, v2, 2, v3
  v_lshlrev_b32 v50, 1, v50
  s_lshl_b32 s68, s74, 6
  v_add_u32 v61, s68, v50
  s_lshl_b32 s68, s3, 6
  v_add_u32 v51, s68, v50
  v_lshlrev_b32 v52, 4, v3
  v_add_u32 v52, s68, v52
  v_lshlrev_b32 v54, 3, v2
  v_add_u32 v54, s68, v54
  v_lshrrev_b32 v53, 3, v0
  v_mul_u32_u24 v62, 3072, v53
  v_lshl_add_u32 v62, v2, 4, v62
  v_mul_u32_u24 v53, 2560, v53
  v_lshl_add_u32 v53, v2, 4, v53
  s_lshl_b32 s68, s74, 7
  v_add_u32 v53, s68, v53
  v_add_u32 v59, 20480, v53
  s_add_u32 s60, s47, 0
  v_and_b32 v55, 15, v0
  v_lshlrev_b32 v55, 4, v55
  v_mul_u32_u24 v63, 5120, v3
  v_add_u32 v55, v55, v63
  v_mov_b32 v57, 0
  v_cmp_eq_u32 s[62:63], 1, v3
  v_cmp_eq_u32 s[64:65], 2, v3
  v_cmp_eq_u32 s[66:67], 3, v3
  s_mul_i32 s76, s78, 20480
  s_lshl_b32 s68, s74, 8
  s_add_u32 s76, s76, s68
  s_add_u32 s76, s76, 2228224
  s_lshl_b32 s68, s78, 9
  s_lshl4_add_u32 s68, s74, s68
  s_add_u32 s68, s68, 2752512
  s_mul_i32 s69, s4, 2560
  s_lshl_b32 s61, s74, 7
  s_add_u32 s69, s69, s61
  s_add_u32 s69, s69, 2785280
  v_lshl_add_u32 v63, v2, 4, s69
  v_mov_b32 v4, s68
  s_mov_b32 s8, 0xff00
  s_mov_b32 s9, 0
  v_cndmask_b32 v63, v63, v4, s[8:9]
  s_cmp_lt_u32 s5, 24
  s_cselect_b32 s61, 0xff, 0
  s_or_b32 s61, s61, 0x100
  s_mov_b32 s77, 0xffff0000
  v_mov_b32 v14, s30
  v_mov_b32 v15, s31
  s_mul_i32 s72, s74, 98304
  s_lshl_b32 s68, s78, 7
  s_add_u32 s72, s72, s68
  v_and_b32 v4, 0xffffe000, v53
  v_add_u32 v53, v53, v4
  v_and_b32 v4, 0xffffe000, v59
  v_add_u32 v59, v59, v4
  global_load_ushort v56, v61, s[36:37]
  s_setprio 3
  s_barrier
  buffer_load_dwordx4 v[96:99], v53, s[24:27], s60 offen sc1
  buffer_load_dwordx4 v[100:103], v59, s[24:27], s60 offen sc1
  ds_read_b64_tr_b16 v[64:65], v58 offset:8704
  ds_read_b64_tr_b16 v[66:67], v58 offset:9216
  ds_read_b64_tr_b16 v[68:69], v58 offset:8736
  ds_read_b64_tr_b16 v[70:71], v58 offset:9248
  ds_read_b64_tr_b16 v[72:73], v58 offset:8768
  ds_read_b64_tr_b16 v[74:75], v58 offset:9280
  ds_read_b64_tr_b16 v[76:77], v58 offset:8800
  ds_read_b64_tr_b16 v[78:79], v58 offset:9312
  ds_read_b64_tr_b16 v[80:81], v58 offset:12800
  ds_read_b64_tr_b16 v[82:83], v58 offset:13312
  ds_read_b64_tr_b16 v[84:85], v58 offset:12832
  ds_read_b64_tr_b16 v[86:87], v58 offset:13344
  ds_read_b64_tr_b16 v[88:89], v58 offset:12864
  ds_read_b64_tr_b16 v[90:91], v58 offset:13376
  ds_read_b64_tr_b16 v[92:93], v58 offset:12896
  ds_read_b64_tr_b16 v[94:95], v58 offset:13408
  v_mov_b32 v8, 0x3f803f80
  v_mov_b32 v9, 0x3f803f80
  v_mov_b32 v10, 0x3f803f80
  v_mov_b32 v11, 0x3f803f80
  s_waitcnt lgkmcnt(0)
  s_nop 0
  v_mfma_f32_16x16x32_bf16 v[16:19], v[8:11], v[64:67], 0
  v_mfma_f32_16x16x32_bf16 v[20:23], v[8:11], v[68:71], 0
  v_mfma_f32_16x16x32_bf16 v[24:27], v[8:11], v[72:75], 0
  v_mfma_f32_16x16x32_bf16 v[28:31], v[8:11], v[76:79], 0
  v_mfma_f32_16x16x32_bf16 v[32:35], v[8:11], v[80:83], 0
  v_mfma_f32_16x16x32_bf16 v[36:39], v[8:11], v[84:87], 0
  v_mfma_f32_16x16x32_bf16 v[40:43], v[8:11], v[88:91], 0
  v_mfma_f32_16x16x32_bf16 v[44:47], v[8:11], v[92:95], 0
  s_nop 1
  v_cndmask_b32 v12, v16, v20, s[62:63]
  v_cndmask_b32 v12, v12, v24, s[64:65]
  v_cndmask_b32 v12, v12, v28, s[66:67]
  s_nop 0
  v_cndmask_b32 v13, v32, v36, s[62:63]
  v_cndmask_b32 v13, v13, v40, s[64:65]
  v_cndmask_b32 v13, v13, v44, s[66:67]
  v_cvt_pk_bf16_f32 v60, v12, v13
  s_waitcnt vmcnt(2)
  v_lshlrev_b32 v56, 16, v56
  s_mov_b32 s70, 200007
  s_branch L_ypw0
L_yppoll:
  buffer_load_dwordx4 v[96:99], v53, s[24:27], s60 offen sc1
  buffer_load_dwordx4 v[100:103], v59, s[24:27], s60 offen sc1
L_ypw0:
  s_waitcnt vmcnt(0)
  v_cmp_ne_u64 vcc, s[30:31], v[98:99]
  v_cmp_ne_u64 s[20:21], s[30:31], v[102:103]
  s_nop 0
  s_or_b64 vcc, vcc, s[20:21]
  s_nop 0
  s_cbranch_vccz L_ypok
  s_sub_u32 s70, s70, 1
  s_cbranch_scc0 L_yppoll
L_ypok:
  v_lshlrev_b32 v8, 16, v96
  v_lshlrev_b32 v24, 16, v100
  v_lshlrev_b32 v10, 16, v97
  v_lshlrev_b32 v26, 16, v101
  v_and_b32 v9, s77, v96
  v_and_b32 v25, s77, v100
  v_and_b32 v11, s77, v97
  v_and_b32 v27, s77, v101
  v_add_f32 v8, v8, v24
  v_add_f32 v10, v10, v26
  v_add_f32 v9, v9, v25
  v_add_f32 v11, v11, v27
  v_permlane32_swap_b32 v8, v10
  s_nop 0
  v_permlane32_swap_b32 v9, v11
  v_add_f32 v8, v8, v10
  v_add_f32 v9, v9, v11
  s_nop 1
  v_permlane16_swap_b32 v8, v9
  v_add_f32 v8, v8, v9
  s_nop 1
  v_add_f32_dpp v8, v8, v8 row_ror:8 row_mask:0xf bank_mask:0xf
  v_cvt_pk_bf16_f32 v8, v57, v8
  v_add_f32 v8, v8, v56
  v_cvt_pk_bf16_f32 v8, v8, v8
  ds_write_b16 v51, v8 offset:8192
  v_and_b32 v48, s77, v8
  v_mul_f32 v49, v48, v48
  s_waitcnt lgkmcnt(0)
  ds_read_b128 v[8:11], v52 offset:8192
  ds_read_b64 v[4:5], v54 offset:8192
  v_add_f32_dpp v48, v48, v48 quad_perm:[1,0,3,2] row_mask:0xf bank_mask:0xf
  v_add_f32_dpp v49, v49, v49 quad_perm:[1,0,3,2] row_mask:0xf bank_mask:0xf
  s_nop 0
  v_add_f32_dpp v48, v48, v48 quad_perm:[2,3,0,1] row_mask:0xf bank_mask:0xf
  v_add_f32_dpp v49, v49, v49 quad_perm:[2,3,0,1] row_mask:0xf bank_mask:0xf
  s_nop 0
  v_add_f32_dpp v48, v48, v48 row_half_mirror row_mask:0xf bank_mask:0xf
  v_add_f32_dpp v49, v49, v49 row_half_mirror row_mask:0xf bank_mask:0xf
  s_waitcnt lgkmcnt(0)
  v_mfma_f32_16x16x32_bf16 v[16:19], v[8:11], v[64:67], 0
  v_mfma_f32_16x16x32_bf16 v[20:23], v[8:11], v[68:71], 0
  v_mfma_f32_16x16x32_bf16 v[24:27], v[8:11], v[72:75], 0
  v_mfma_f32_16x16x32_bf16 v[28:31], v[8:11], v[76:79], 0
  v_mfma_f32_16x16x32_bf16 v[32:35], v[8:11], v[80:83], 0
  v_mfma_f32_16x16x32_bf16 v[36:39], v[8:11], v[84:87], 0
  v_mfma_f32_16x16x32_bf16 v[40:43], v[8:11], v[88:91], 0
  v_mfma_f32_16x16x32_bf16 v[44:47], v[8:11], v[92:95], 0
  v_mov_b32 v6, v48
  v_mov_b32 v7, v49
  s_nop 0
  v_permlane16_swap_b32 v48, v6
  v_permlane16_swap_b32 v49, v7
  v_add_f32 v48, v48, v6
  v_add_f32 v49, v49, v7
  v_mov_b32 v6, v48
  v_mov_b32 v7, v49
  s_nop 0
  v_permlane32_swap_b32 v48, v6
  v_permlane32_swap_b32 v49, v7
  v_add_f32 v48, v48, v6
  v_add_f32 v49, v49, v7
  v_mov_b32 v6, s30
  v_mov_b32 v7, s31
  v_cndmask_b32 v4, v4, v48, s[8:9]
  v_cndmask_b32 v5, v5, v49, s[8:9]
  v_cndmask_b32 v12, v16, v20, s[62:63]
  v_cndmask_b32 v12, v12, v24, s[64:65]
  v_cndmask_b32 v12, v12, v28, s[66:67]
  v_cndmask_b32 v13, v32, v36, s[62:63]
  v_cndmask_b32 v13, v13, v40, s[64:65]
  v_cndmask_b32 v13, v13, v44, s[66:67]
  v_cvt_pk_bf16_f32 v12, v12, v13
  v_mov_b32 v13, v60
  buffer_store_dwordx4 v[12:15], v55, s[32:35], s76 offen
  s_mov_b32 exec_lo, s61
  s_mov_b32 exec_hi, 0
  buffer_store_dwordx4 v[4:7], v63, s[32:35], 0 offen
  s_mov_b64 exec, -1
  s_cmp_lg_u32 s46, 1
  s_cbranch_scc1 L_slow_35
L_back_36:
  s_endpgm
L_ffn:
  v_mov_b32 v57, 0
  s_mul_i32 s72, s4, 12
  s_add_u32 s72, s72, s5
  s_cmp_lt_u32 s3, 5
  s_cbranch_scc1 L_f2
  s_cmp_eq_u32 s3, 5
  s_cbranch_scc1 L_hid
  s_cmp_ge_u32 s5, 10
  s_cbranch_scc1 L_end
  s_mul_i32 s72, s4, 10
  s_add_u32 s72, s72, s5
  v_lshrrev_b32 v2, 1, v0
  v_mul_u32_u24 v2, 2560, v2
  v_and_b32 v3, 1, v0
  v_lshl_add_u32 v96, v3, 4, v2
  s_lshl_b32 s68, s72, 5
  v_add_u32 v96, s68, v96
  v_add_u32 v100, 81920, v96
  v_add_u32 v101, 163840, v96
  s_add_u32 s10, s47, 524288
  v_lshrrev_b32 v4, 4, v0
  v_lshl_add_u32 v97, v3, 2, v4
  v_lshlrev_b32 v97, 1, v97
  v_lshlrev_b32 v99, 4, v3
  v_and_b32 v98, 16, v0
  s_mul_i32 s13, s4, 2560
  s_lshl_b32 s68, s72, 5
  s_add_u32 s13, s13, s68
  s_add_u32 s13, s13, 2785280
  s_lshl_b32 s14, s72, 4
  s_mov_b32 s69, 0xffff0000
  v_and_b32 v4, 0xffffe000, v96
  v_add_u32 v96, v96, v4
  v_and_b32 v4, 0xffffe000, v100
  v_add_u32 v100, v100, v4
  v_and_b32 v4, 0xffffe000, v101
  v_add_u32 v101, v101, v4
  s_mov_b32 s64, s54
  s_mov_b32 s65, s55
  s_mov_b32 s66, 1280
  s_mov_b32 s67, 0x20000
  v_cmp_lt_u32 s[62:63], 31, v0
  s_setprio 3
  s_barrier
  s_barrier
  buffer_load_dwordx4 v[8:11], v99, s[32:35], s13 offen nt
  v_mov_b32 v1, 0
  s_mov_b32 s70, 200007
L_spin_37:
  ds_read_b32 v4, v1 offset:652
  s_waitcnt lgkmcnt(0)
  v_cmp_gt_u32 vcc, 1, v4
  s_nop 0
  s_cbranch_vccz L_sdone_38
  s_sleep 2
  s_sub_u32 s70, s70, 1
  s_cbranch_scc0 L_spin_37
L_sdone_38:
  s_sleep 17
  s_mov_b32 s16, s32
  s_mov_b32 s17, s33
  s_mov_b32 s18, 4194304
  s_mov_b32 s19, 0x20000
  s_mov_b32 s70, 200007
L_spin_39:
  buffer_load_dwordx4 v[4:7], v99, s[16:19], s13 offen sc1
  buffer_load_dwordx4 v[16:19], v96, s[24:27], s10 offen sc1
  buffer_load_dwordx4 v[20:23], v100, s[24:27], s10 offen sc1
  buffer_load_dwordx4 v[24:27], v101, s[24:27], s10 offen sc1
  s_waitcnt vmcnt(0)
  v_cmp_ne_u64 vcc, s[30:31], v[6:7]
  v_cmp_ne_u64 s[20:21], s[30:31], v[18:19]
  v_cmp_ne_u64 s[22:23], s[30:31], v[22:23]
  s_or_b64 vcc, vcc, s[20:21]
  v_cmp_ne_u64 s[20:21], s[30:31], v[26:27]
  s_or_b64 vcc, vcc, s[22:23]
  s_or_b64 vcc, vcc, s[20:21]
  s_nop 0
  s_cbranch_vccz L_sdone_40
  s_and_b32 s99, s70, 7
  s_cmp_eq_u32 s46, 1
  s_cselect_b32 s99, 1, s99
  s_cmp_lg_u32 s99, 0
  s_cselect_b32 s16, s32, s24
  s_cselect_b32 s17, s33, s25
  s_sub_u32 s70, s70, 1
  s_cbranch_scc0 L_spin_39
L_sdone_40:
  v_lshlrev_b32 v40, 16, v16
  v_and_b32 v41, s69, v16
  v_lshlrev_b32 v42, 16, v17
  v_and_b32 v43, s69, v17
  v_lshlrev_b32 v44, 16, v20
  v_and_b32 v45, s69, v20
  v_lshlrev_b32 v46, 16, v21
  v_and_b32 v47, s69, v21
  v_lshlrev_b32 v48, 16, v24
  v_and_b32 v49, s69, v24
  v_lshlrev_b32 v50, 16, v25
  v_and_b32 v51, s69, v25
  v_add_f32 v8, v40, v44
  v_add_f32 v9, v41, v45
  v_add_f32 v10, v42, v46
  v_add_f32 v11, v43, v47
  v_add_f32 v8, v8, v48
  v_add_f32 v9, v9, v49
  v_add_f32 v10, v10, v50
  v_add_f32 v11, v11, v51
  v_cndmask_b32 v58, v4, v5, s[62:63]
  v_permlane32_swap_b32 v8, v10
  v_permlane32_swap_b32 v9, v11
  v_add_f32 v8, v8, v10
  v_add_f32 v9, v9, v11
  v_lshrrev_b32 v58, v98, v58
  v_lshlrev_b32 v58, 16, v58
  v_permlane16_swap_b32 v8, v9
  v_add_f32 v8, v8, v9
  s_nop 1
  v_add_f32_dpp v8, v8, v8 row_ror:8 row_mask:0xf bank_mask:0xf
  s_nop 1
  v_add_f32_dpp v8, v8, v8 row_ror:4 row_mask:0xf bank_mask:0xf
  s_nop 1
  v_add_f32_dpp v8, v8, v8 quad_perm:[2,3,0,1] row_mask:0xf bank_mask:0xf
  v_cvt_pk_bf16_f32 v8, v57, v8
  v_add_f32 v8, v8, v58
  v_cvt_pk_bf16_f32 v8, v8, v8
  s_mov_b32 exec_lo, 0x30003
  s_mov_b32 exec_hi, 0x30003
  buffer_store_short v8, v97, s[64:67], s14 offen
  s_cmp_lg_u32 s72, 0
  s_cbranch_scc1 L_fin_exit
  s_mov_b64 exec, 1
  v_mov_b32 v4, s30
  v_mov_b32 v5, s31
  s_mov_b32 s68, 1044480
  buffer_store_dwordx2 v[4:5], v57, s[24:27], s68 offen
L_fin_exit:
  s_endpgm
L_hid:
  v_and_b32 v62, 15, v0
  v_lshlrev_b32 v62, 1, v62
  v_lshlrev_b32 v60, 4, v0
  v_and_b32 v3, 31, v0
  v_lshlrev_b32 v61, 4, v3
  s_lshr_b32 s68, s72, 2
  s_lshl_b32 s65, s68, 9
  s_add_u32 s65, s65, 2752512
  s_mul_i32 s60, s72, 5120
  s_add_u32 s60, s60, 2228224
  s_add_u32 s61, s60, 4096
  v_mov_b32 v36, 0
  v_mov_b32 v37, 0
  v_mov_b32 v38, s30
  v_mov_b32 v39, s31
  v_mov_b32 v59, 1
  s_mov_b32 s69, 0xffff0000
  s_setprio 3
  s_barrier
  s_barrier
  s_mov_b32 exec_lo, 0xfffff
  s_mov_b32 exec_hi, 0xfffff
  buffer_load_dwordx4 v[36:39], v61, s[32:35], s65 offen sc1 nt
  s_mov_b64 exec, -1
  buffer_load_dwordx4 v[16:19], v60, s[32:35], s60 offen offset:0 sc1 nt
  buffer_load_dwordx4 v[20:23], v60, s[32:35], s60 offen offset:1024 sc1 nt
  buffer_load_dwordx4 v[24:27], v60, s[32:35], s60 offen offset:2048 sc1 nt
  buffer_load_dwordx4 v[28:31], v60, s[32:35], s60 offen offset:3072 sc1 nt
  buffer_load_dwordx4 v[32:35], v60, s[32:35], s61 offen offset:0 sc1 nt
  s_mov_b32 s16, s32
  s_mov_b32 s17, s33
  s_mov_b32 s18, 4194304
  s_mov_b32 s19, 0x20000
  s_mov_b32 s70, 200007
  s_branch L_paw0
L_spin_41:
  s_mov_b32 exec_lo, 0xfffff
  s_mov_b32 exec_hi, 0xfffff
  buffer_load_dwordx4 v[36:39], v61, s[16:19], s65 offen sc1
  s_mov_b64 exec, -1
  buffer_load_dwordx4 v[16:19], v60, s[16:19], s60 offen offset:0 sc1
  buffer_load_dwordx4 v[20:23], v60, s[16:19], s60 offen offset:1024 sc1
  buffer_load_dwordx4 v[24:27], v60, s[16:19], s60 offen offset:2048 sc1
  buffer_load_dwordx4 v[28:31], v60, s[16:19], s60 offen offset:3072 sc1
  buffer_load_dwordx4 v[32:35], v60, s[16:19], s61 offen offset:0 sc1
L_paw0:
  s_waitcnt vmcnt(0)
  v_cmp_ne_u64 vcc, s[30:31], v[38:39]
  v_cmp_ne_u64 s[20:21], s[30:31], v[18:19]
  v_cmp_ne_u64 s[22:23], s[30:31], v[22:23]
  s_or_b64 vcc, vcc, s[20:21]
  v_cmp_ne_u64 s[20:21], s[30:31], v[26:27]
  s_or_b64 vcc, vcc, s[22:23]
  v_cmp_ne_u64 s[22:23], s[30:31], v[30:31]
  s_or_b64 vcc, vcc, s[20:21]
  v_cmp_ne_u64 s[20:21], s[30:31], v[34:35]
  s_or_b64 vcc, vcc, s[22:23]
  s_or_b64 vcc, vcc, s[20:21]
  s_nop 0
  s_cbranch_vccz L_sdone_42
  s_and_b32 s99, s70, 7
  s_cmp_eq_u32 s46, 1
  s_cselect_b32 s99, 1, s99
  s_cmp_lg_u32 s99, 0
  s_cselect_b32 s16, s32, s24
  s_cselect_b32 s17, s33, s25
  s_sub_u32 s70, s70, 1
  s_cbranch_scc0 L_spin_41
L_sdone_42:
  v_add_f32_dpp v36, v36, v36 quad_perm:[1,0,3,2] row_mask:0xf bank_mask:0xf
  v_add_f32_dpp v37, v37, v37 quad_perm:[1,0,3,2] row_mask:0xf bank_mask:0xf
  v_lshlrev_b32 v8, 16, v16
  v_and_b32 v9, s69, v16
  v_lshlrev_b32 v10, 16, v17
  v_and_b32 v11, s69, v17
  v_add_f32_dpp v36, v36, v36 quad_perm:[2,3,0,1] row_mask:0xf bank_mask:0xf
  v_add_f32_dpp v37, v37, v37 quad_perm:[2,3,0,1] row_mask:0xf bank_mask:0xf
  v_lshlrev_b32 v40, 16, v20
  v_and_b32 v41, s69, v20
  v_lshlrev_b32 v42, 16, v21
  v_and_b32 v43, s69, v21
  v_add_f32_dpp v36, v36, v36 row_half_mirror row_mask:0xf bank_mask:0xf
  v_add_f32_dpp v37, v37, v37 row_half_mirror row_mask:0xf bank_mask:0xf
  v_lshlrev_b32 v44, 16, v24
  v_and_b32 v45, s69, v24
  v_lshlrev_b32 v46, 16, v25
  v_and_b32 v47, s69, v25
  v_add_f32_dpp v36, v36, v36 row_mirror row_mask:0xf bank_mask:0xf
  v_add_f32_dpp v37, v37, v37 row_mirror row_mask:0xf bank_mask:0xf
  v_lshlrev_b32 v48, 16, v28
  v_and_b32 v49, s69, v28
  v_lshlrev_b32 v50, 16, v29
  v_and_b32 v51, s69, v29
  v_mov_b32 v22, v36
  v_mov_b32 v23, v37
  v_lshlrev_b32 v52, 16, v32
  v_and_b32 v53, s69, v32
  v_lshlrev_b32 v54, 16, v33
  v_and_b32 v55, s69, v33
  v_permlane16_swap_b32 v36, v22
  v_permlane16_swap_b32 v37, v23
  v_add_f32 v8, v8, v40
  v_add_f32 v9, v9, v41
  v_add_f32 v10, v10, v42
  v_add_f32 v11, v11, v43
  v_add_f32 v36, v36, v22
  v_add_f32 v37, v37, v23
  v_add_f32 v44, v44, v48
  v_add_f32 v45, v45, v49
  v_add_f32 v46, v46, v50
  v_add_f32 v47, v47, v51
  v_mul_f32 v20, 0x3acccccd, v36
  v_mul_f32 v21, 0x3acccccd, v37
  v_add_f32 v8, v8, v52
  v_add_f32 v9, v9, v53
  v_add_f32 v10, v10, v54
  v_add_f32 v11, v11, v55
  v_fma_f32 v21, -v20, v20, v21
  v_max_f32 v21, 0, v21
  v_add_f32 v8, v8, v44
  v_add_f32 v9, v9, v45
  v_add_f32 v10, v10, v46
  v_add_f32 v11, v11, v47
  v_cvt_pk_bf16_f32 v20, v57, v20
  v_cvt_pk_bf16_f32 v21, v57, v21
  v_fma_f32 v8, -v20, v10, v8
  v_fma_f32 v9, -v20, v11, v9
  v_add_f32 v21, 0x3727c5ac, v21
  v_cvt_pk_bf16_f32 v21, v57, v21
  v_permlane32_swap_b32 v8, v9
  v_sqrt_f32 v21, v21
  v_add_f32 v8, v8, v9
  v_cvt_pk_bf16_f32 v21, v57, v21
  v_mov_b32 v10, v8
  v_rcp_f32 v21, v21
  s_nop 0
  v_permlane16_swap_b32 v8, v10
  v_add_f32 v8, v8, v10
  v_mul_f32 v8, v8, v21
  v_cvt_pk_bf16_f32 v8, v57, v8
  v_mov_b32 v9, v8
  s_nop 1
  v_permlane32_swap_b32 v8, v9
  v_mul_f32 v12, 0xbfb8aa3b, v8
  v_exp_f32 v12, v12
  s_nop 0
  v_add_f32 v12, 1.0, v12
  v_rcp_f32 v12, v12
  s_nop 0
  v_mul_f32 v8, v8, v12
  v_cvt_pk_bf16_f32 v8, v57, v8
  v_mul_f32 v8, v8, v9
  v_cvt_pk_bf16_f32 v8, v8, v8
  ds_write_b16 v62, v8 offset:896
  ds_write_b32 v57, v59 offset:652
  s_endpgm
L_f2:
  s_mov_b32 s8, s52
  s_mov_b32 s9, s53
  s_mov_b32 s10, 1966080
  s_mov_b32 s11, 0x20000
  s_lshl_b32 s68, s3, 8
  v_lshlrev_b32 v58, 2, v0
  v_add_u32 v58, s68, v58
  v_lshlrev_b32 v116, 1, v58
  s_mul_i32 s68, s72, 2560
  v_add_u32 v116, s68, v116
  s_xor_b32 s78, s47, 8192
  s_add_u32 s78, s78, 524288
  s_add_u32 s77, s47, 524288
  s_mov_b32 s60, 0x05040100
  s_mov_b32 s61, 0x07060302
  s_mul_i32 s62, s72, 20480
  v_and_b32 v4, 0xffffe000, v116
  v_add_u32 v116, v116, v4
  s_setprio 3
  s_barrier
  s_barrier
  buffer_load_dword v64, v58, s[8:11], s62 offen offset:0 nt
  buffer_load_dword v65, v58, s[8:11], s62 offen offset:1280 nt
  buffer_load_dword v66, v58, s[8:11], s62 offen offset:2560 nt
  s_add_u32 s62, s62, 3840
  buffer_load_dword v67, v58, s[8:11], s62 offen offset:0 nt
  buffer_load_dword v68, v58, s[8:11], s62 offen offset:1280 nt
  buffer_load_dword v69, v58, s[8:11], s62 offen offset:2560 nt
  s_add_u32 s62, s62, 3840
  buffer_load_dword v70, v58, s[8:11], s62 offen offset:0 nt
  buffer_load_dword v71, v58, s[8:11], s62 offen offset:1280 nt
  buffer_load_dword v72, v58, s[8:11], s62 offen offset:2560 nt
  s_add_u32 s62, s62, 3840
  buffer_load_dword v73, v58, s[8:11], s62 offen offset:0 nt
  buffer_load_dword v74, v58, s[8:11], s62 offen offset:1280 nt
  buffer_load_dword v75, v58, s[8:11], s62 offen offset:2560 nt
  s_add_u32 s62, s62, 3840
  buffer_load_dword v76, v58, s[8:11], s62 offen offset:0 nt
  buffer_load_dword v77, v58, s[8:11], s62 offen offset:1280 nt
  buffer_load_dword v78, v58, s[8:11], s62 offen offset:2560 nt
  s_add_u32 s62, s62, 3840
  buffer_load_dword v79, v58, s[8:11], s62 offen offset:0 nt
  s_waitcnt vmcnt(0)
  v_perm_b32 v80, v65, v64, s60
  v_perm_b32 v88, v65, v64, s61
  v_perm_b32 v81, v67, v66, s60
  v_perm_b32 v89, v67, v66, s61
  v_perm_b32 v82, v69, v68, s60
  v_perm_b32 v90, v69, v68, s61
  v_perm_b32 v83, v71, v70, s60
  v_perm_b32 v91, v71, v70, s61
  v_perm_b32 v84, v73, v72, s60
  v_perm_b32 v92, v73, v72, s61
  v_perm_b32 v85, v75, v74, s60
  v_perm_b32 v93, v75, v74, s61
  v_perm_b32 v86, v77, v76, s60
  v_perm_b32 v94, v77, v76, s61
  v_perm_b32 v87, v79, v78, s60
  v_perm_b32 v95, v79, v78, s61
  v_mov_b32 v16, 0
  v_mov_b32 v17, 0
  v_mov_b32 v6, s30
  v_mov_b32 v7, s31
  s_mov_b32 s70, 200007
L_spin_43:
  ds_read_b32 v4, v57 offset:652
  ds_read_b128 v[8:11], v57 offset:896
  ds_read_b128 v[12:15], v57 offset:912
  s_waitcnt lgkmcnt(0)
  v_cmp_eq_u32 vcc, 0, v4
  s_nop 0
  s_cbranch_vccz L_sdone_44
  s_sub_u32 s70, s70, 1
  s_cbranch_scc0 L_spin_43
L_sdone_44:
  v_dot2c_f32_bf16 v16, v8, v80
  v_dot2c_f32_bf16 v17, v8, v88
  v_dot2c_f32_bf16 v16, v9, v81
  v_dot2c_f32_bf16 v17, v9, v89
  v_dot2c_f32_bf16 v16, v10, v82
  v_dot2c_f32_bf16 v17, v10, v90
  v_dot2c_f32_bf16 v16, v11, v83
  v_dot2c_f32_bf16 v17, v11, v91
  v_dot2c_f32_bf16 v16, v12, v84
  v_dot2c_f32_bf16 v17, v12, v92
  v_dot2c_f32_bf16 v16, v13, v85
  v_dot2c_f32_bf16 v17, v13, v93
  v_dot2c_f32_bf16 v16, v14, v86
  v_dot2c_f32_bf16 v17, v14, v94
  v_dot2c_f32_bf16 v16, v15, v87
  v_dot2c_f32_bf16 v17, v15, v95
  s_nop 2
  v_cvt_pk_bf16_f32 v4, v16, v17
  s_nop 1
  v_mov_b32_dpp v5, v4 quad_perm:[1,0,3,2] row_mask:0xf bank_mask:0xf
  s_mov_b32 exec_lo, 0x55555555
  s_mov_b32 exec_hi, 0x55555555
  buffer_store_dwordx4 v[4:7], v116, s[24:27], s78 offen sc1
  buffer_store_dwordx4 v[4:7], v116, s[24:27], s77 offen sc1
L_end:
  s_endpgm
L_slow_5:
  s_mov_b32 exec_lo, 0xffffffff
  s_mov_b32 exec_hi, 0xffff
  buffer_store_dwordx4 v[4:7], v13, s[24:27], s74 offen sc1
  s_mov_b64 exec, -1
  s_nop 1
  s_branch L_back_6
L_slow_19:
  s_mov_b32 exec_lo, 0x1
  s_mov_b32 exec_hi, 0x0
  buffer_store_dwordx4 v[2:5], v1, s[24:27], s68 offen sc1
  s_mov_b64 exec, -1
  s_nop 1
  s_branch L_back_20
L_slow_35:
  buffer_store_dwordx4 v[12:15], v55, s[24:27], s76 offen sc1
  s_mov_b32 exec_lo, s61
  s_mov_b32 exec_hi, 0
  buffer_store_dwordx4 v[4:7], v63, s[24:27], 0 offen sc1
  s_mov_b64 exec, -1
  s_nop 1
  s_branch L_back_36
L_codeend:
.section .rodata,"a"
.p2align 6
.amdhsa_kernel sequential_preLN__sliding_block_cached__glu_gated_swiglu__decode_kernel
  .amdhsa_next_free_vgpr 168
  .amdhsa_next_free_sgpr 100
  .amdhsa_accum_offset 168
  .amdhsa_group_segment_fixed_size 0
  .amdhsa_kernarg_size 96
  .amdhsa_user_sgpr_count 2
  .amdhsa_user_sgpr_kernarg_segment_ptr 1
  .amdhsa_system_sgpr_workgroup_id_x 1
.end_amdhsa_kernel
```

```asm
; @launch grid=(256,1,1) block=(768,1,1) lds=57856
.amdgcn_target "amdgcn-amd-amdhsa--gfx950"
.text
.globl sequential_preLN__sliding_block_cached__glu_gated_swiglu__decode_kernel
.p2align 8
.type sequential_preLN__sliding_block_cached__glu_gated_swiglu__decode_kernel,@function
sequential_preLN__sliding_block_cached__glu_gated_swiglu__decode_kernel:
  s_cmp_ge_u32 s2, 256
  s_cbranch_scc1 L_end
  s_load_dwordx2 s[8:9], s[0:1], 8
  s_load_dwordx16 s[36:51], s[0:1], 0
  s_load_dwordx8 s[52:59], s[0:1], 64
  v_lshrrev_b32 v1, 6, v0
  v_and_b32 v0, 63, v0
  v_readfirstlane_b32 s3, v1
  s_and_b32 s4, s2, 7
  s_lshr_b32 s79, s2, 6
  s_lshl2_add_u32 s6, s4, s79
  s_bfe_u32 s7, s2, 0x30003
  s_cmp_lg_u32 s3, 0
  s_cbranch_scc1 L_nocpf
  s_getpc_b64 s[20:21]
L_pc0:
  s_mul_i32 s68, s7, 2048
  v_min_u32 v8, 15, v0
  v_lshl_add_u32 v8, v8, 7, s68
  v_min_u32 v8, L_codeend-L_pc0-4, v8
  global_load_dword v10, v8, s[20:21]
L_nocpf:
  v_lshrrev_b32 v2, 3, v0
  v_and_b32 v3, 7, v0
  v_lshlrev_b32 v3, 4, v3
  s_mov_b32 s11, 0x20000
  s_cmp_gt_u32 s3, 7
  s_cbranch_scc1 L_helper
  s_lshl3_add_u32 s68, s7, s3
  s_mul_i32 s60, s6, 4096
  s_add_u32 s60, s60, s68
  s_addk_i32 s60, 3584
  s_mul_i32 s60, s60, 3072
  v_mul_u32_u24 v2, 384, v2
  v_add_u32 v1, v2, v3
  s_mov_b32 s10, 402653184
  s_waitcnt lgkmcnt(0)
  buffer_load_dwordx4 v[16:19], v1, s[8:11], s60 offen offset:0 nt
  buffer_load_dwordx4 v[20:23], v1, s[8:11], s60 offen offset:128 nt
  buffer_load_dwordx4 v[24:27], v1, s[8:11], s60 offen offset:256 nt
  s_barrier
  s_branch L_stream
L_helper:
  v_lshlrev_b32 v1, 3, v0
  v_mov_b32 v4, 0
  v_mov_b32 v5, 0
  ds_write_b64 v1, v[4:5] offset:384
  s_sub_u32 s73, s3, 8
  s_cmp_eq_u32 s3, 11
  s_cbranch_scc1 L_misc
  s_mul_i32 s68, s7, 80
  v_add_u32 v7, s68, v2
  v_lshlrev_b32 v7, 1, v7
  v_mul_u32_u24 v2, 12288, v2
  v_add_u32 v2, v2, v3
  s_mul_i32 s68, s68, 12288
  s_mul_i32 s69, s6, 384
  s_add_u32 s68, s68, s69
  s_lshl_b32 s69, s73, 7
  s_add_u32 s68, s68, s69
  v_lshlrev_b32 v1, 2, v0
  s_setprio 3
  s_waitcnt lgkmcnt(0)
  s_barrier
  s_mov_b32 s8, s42
  s_mov_b32 s9, s43
  s_mov_b32 s10, 7864320
  global_load_dword v64, v1, s[36:37] offset:0
  global_load_dword v65, v1, s[36:37] offset:256
  global_load_dword v66, v1, s[36:37] offset:512
  global_load_dword v67, v1, s[36:37] offset:768
  global_load_dword v68, v1, s[36:37] offset:1024
  global_load_ushort v8, v7, s[36:37] offset:0
  global_load_ushort v9, v7, s[36:37] offset:16
  global_load_ushort v10, v7, s[36:37] offset:32
  global_load_ushort v11, v7, s[36:37] offset:48
  global_load_ushort v12, v7, s[36:37] offset:64
  global_load_ushort v13, v7, s[36:37] offset:80
  global_load_ushort v14, v7, s[36:37] offset:96
  global_load_ushort v15, v7, s[36:37] offset:112
  global_load_ushort v16, v7, s[36:37] offset:128
  global_load_ushort v17, v7, s[36:37] offset:144
  buffer_load_dwordx4 v[24:27], v2, s[8:11], s68 offen nt
  s_add_u32 s68, s68, 98304
  buffer_load_dwordx4 v[28:31], v2, s[8:11], s68 offen nt
  s_add_u32 s68, s68, 98304
  buffer_load_dwordx4 v[32:35], v2, s[8:11], s68 offen nt
  s_add_u32 s68, s68, 98304
  buffer_load_dwordx4 v[36:39], v2, s[8:11], s68 offen nt
  s_add_u32 s68, s68, 98304
  buffer_load_dwordx4 v[40:43], v2, s[8:11], s68 offen nt
  s_add_u32 s68, s68, 98304
  buffer_load_dwordx4 v[44:47], v2, s[8:11], s68 offen nt
  s_add_u32 s68, s68, 98304
  buffer_load_dwordx4 v[48:51], v2, s[8:11], s68 offen nt
  s_add_u32 s68, s68, 98304
  buffer_load_dwordx4 v[52:55], v2, s[8:11], s68 offen nt
  s_add_u32 s68, s68, 98304
  buffer_load_dwordx4 v[56:59], v2, s[8:11], s68 offen nt
  s_add_u32 s68, s68, 98304
  buffer_load_dwordx4 v[60:63], v2, s[8:11], s68 offen nt
  s_load_dwordx2 s[28:29], s[58:59], 1044480
  s_branch L_q2
L_misc:
  s_setprio 3
  s_waitcnt lgkmcnt(0)
  s_barrier
  s_load_dwordx2 s[28:29], s[58:59], 1044480
  s_branch L_misc2
L_stream:
  s_add_u32 s61, s60, 196608
  s_waitcnt vmcnt(2)
  buffer_load_dwordx4 v[28:31], v1, s[8:11], s61 offen offset:0 nt
  s_load_dwordx2 s[28:29], s[58:59], 1044480
  s_mov_b32 s24, s58
  s_mov_b32 s25, s59
  s_mov_b32 s26, 4194304
  s_mov_b32 s27, 0x20000
  s_add_u32 s32, s58, 4194304
  s_addc_u32 s33, s59, 0
  s_mov_b32 s34, 4194304
  s_mov_b32 s35, 0x20000
  s_lshl3_add_u32 s71, s6, s7
  s_lshr_b32 s79, s2, 3
  s_mov_b32 s12, s40
  s_mov_b32 s13, s41
  s_mov_b32 s14, 402653184
  s_mov_b32 s15, 0x20000
  s_waitcnt vmcnt(2)
  buffer_load_dwordx4 v[32:35], v1, s[8:11], s61 offen offset:128 nt
  s_waitcnt vmcnt(2)
  buffer_load_dwordx4 v[36:39], v1, s[8:11], s61 offen offset:256 nt
  s_add_u32 s62, s61, 196608
  s_waitcnt vmcnt(2)
  buffer_load_dwordx4 v[40:43], v1, s[8:11], s62 offen offset:0 nt
  s_waitcnt vmcnt(2)
  buffer_load_dwordx4 v[44:47], v1, s[8:11], s62 offen offset:128 nt
  s_waitcnt vmcnt(2)
  buffer_load_dwordx4 v[48:51], v1, s[8:11], s62 offen offset:256 nt
  s_add_u32 s63, s62, 196608
  s_waitcnt vmcnt(2)
  buffer_load_dwordx4 v[52:55], v1, s[8:11], s63 offen offset:0 nt
  s_waitcnt vmcnt(2)
  buffer_load_dwordx4 v[56:59], v1, s[8:11], s63 offen offset:128 nt
  s_waitcnt vmcnt(2)
  buffer_load_dwordx4 v[60:63], v1, s[8:11], s63 offen offset:256 nt
  s_add_u32 s64, s63, 196608
  s_waitcnt vmcnt(2)
  buffer_load_dwordx4 v[64:67], v1, s[8:11], s64 offen offset:0 nt
  s_waitcnt vmcnt(2)
  buffer_load_dwordx4 v[68:71], v1, s[8:11], s64 offen offset:128 nt
  s_waitcnt vmcnt(2)
  buffer_load_dwordx4 v[72:75], v1, s[8:11], s64 offen offset:256 nt
  s_add_u32 s65, s64, 196608
  s_waitcnt vmcnt(2)
  buffer_load_dwordx4 v[76:79], v1, s[8:11], s65 offen offset:0 nt
  s_waitcnt vmcnt(2)
  buffer_load_dwordx4 v[80:83], v1, s[8:11], s65 offen offset:128 nt
  s_waitcnt vmcnt(2)
  buffer_load_dwordx4 v[84:87], v1, s[8:11], s65 offen offset:256 nt
  s_add_u32 s66, s65, 196608
  s_waitcnt vmcnt(2)
  buffer_load_dwordx4 v[88:91], v1, s[8:11], s66 offen offset:0 nt
  s_waitcnt vmcnt(2)
  buffer_load_dwordx4 v[92:95], v1, s[8:11], s66 offen offset:128 nt
  s_waitcnt vmcnt(2)
  buffer_load_dwordx4 v[96:99], v1, s[8:11], s66 offen offset:256 nt
  s_add_u32 s67, s66, 196608
  s_waitcnt vmcnt(2)
  buffer_load_dwordx4 v[100:103], v1, s[8:11], s67 offen offset:0 nt
  s_waitcnt vmcnt(2)
  buffer_load_dwordx4 v[104:107], v1, s[8:11], s67 offen offset:128 nt
  s_waitcnt vmcnt(2)
  buffer_load_dwordx4 v[108:111], v1, s[8:11], s67 offen offset:256 nt
  s_waitcnt vmcnt(2)
  buffer_load_dwordx4 v[112:115], v1, s[12:15], s60 offen offset:0 nt
  s_waitcnt vmcnt(2)
  buffer_load_dwordx4 v[116:119], v1, s[12:15], s60 offen offset:128 nt
  s_waitcnt vmcnt(2)
  buffer_load_dwordx4 v[120:123], v1, s[12:15], s60 offen offset:256 nt
  s_waitcnt lgkmcnt(0)
  s_mul_i32 s30, s28, 0x2c9277b5
  s_add_u32 s30, s30, 0xac564b05
  s_mul_i32 s31, s29, 0x0019660d
  s_add_u32 s31, s31, 0x3c6ef35f
  v_and_b32 v2, 3, v0
  v_min_u32 v2, 2, v2
  v_lshlrev_b32 v2, 3, v2
  s_mov_b32 s70, 200007
L_spin_1:
  ds_read_b32 v4, v2 offset:384
  s_waitcnt lgkmcnt(0)
  v_cmp_eq_u32 vcc, 0, v4
  s_nop 0
  s_cbranch_vccz L_sdone_2
  s_sleep 1
  s_sub_u32 s70, s70, 1
  s_cbranch_scc0 L_spin_1
L_sdone_2:
  ds_read_b128 v[4:7], v3 offset:0
  ds_read_b128 v[8:11], v3 offset:128
  ds_read_b128 v[12:15], v3 offset:256
  v_mov_b32 v160, 0
  v_mov_b32 v161, 0
  v_mov_b32 v162, 0
  v_mov_b32 v163, 0
  v_mov_b32 v164, 0
  v_mov_b32 v165, 0
  v_mov_b32 v166, 0
  v_mov_b32 v167, 0
  s_waitcnt vmcnt(3) lgkmcnt(0)
  v_dot2c_f32_bf16 v160, v16, v4
  v_dot2c_f32_bf16 v161, v28, v4
  v_dot2c_f32_bf16 v162, v40, v4
  v_dot2c_f32_bf16 v163, v52, v4
  v_dot2c_f32_bf16 v160, v17, v5
  v_dot2c_f32_bf16 v161, v29, v5
  v_dot2c_f32_bf16 v162, v41, v5
  v_dot2c_f32_bf16 v163, v53, v5
  v_dot2c_f32_bf16 v160, v18, v6
  v_dot2c_f32_bf16 v161, v30, v6
  v_dot2c_f32_bf16 v162, v42, v6
  v_dot2c_f32_bf16 v163, v54, v6
  v_dot2c_f32_bf16 v160, v19, v7
  v_dot2c_f32_bf16 v161, v31, v7
  v_dot2c_f32_bf16 v162, v43, v7
  v_dot2c_f32_bf16 v163, v55, v7
  v_dot2c_f32_bf16 v160, v20, v8
  v_dot2c_f32_bf16 v161, v32, v8
  v_dot2c_f32_bf16 v162, v44, v8
  v_dot2c_f32_bf16 v163, v56, v8
  v_dot2c_f32_bf16 v160, v21, v9
  v_dot2c_f32_bf16 v161, v33, v9
  v_dot2c_f32_bf16 v162, v45, v9
  v_dot2c_f32_bf16 v163, v57, v9
  v_dot2c_f32_bf16 v160, v22, v10
  v_dot2c_f32_bf16 v161, v34, v10
  v_dot2c_f32_bf16 v162, v46, v10
  v_dot2c_f32_bf16 v163, v58, v10
  v_dot2c_f32_bf16 v160, v23, v11
  v_dot2c_f32_bf16 v161, v35, v11
  v_dot2c_f32_bf16 v162, v47, v11
  v_dot2c_f32_bf16 v163, v59, v11
  v_dot2c_f32_bf16 v160, v24, v12
  v_dot2c_f32_bf16 v161, v36, v12
  v_dot2c_f32_bf16 v162, v48, v12
  v_dot2c_f32_bf16 v163, v60, v12
  v_dot2c_f32_bf16 v160, v25, v13
  v_dot2c_f32_bf16 v161, v37, v13
  v_dot2c_f32_bf16 v162, v49, v13
  v_dot2c_f32_bf16 v163, v61, v13
  v_dot2c_f32_bf16 v160, v26, v14
  v_dot2c_f32_bf16 v161, v38, v14
  v_dot2c_f32_bf16 v162, v50, v14
  v_dot2c_f32_bf16 v163, v62, v14
  v_dot2c_f32_bf16 v160, v27, v15
  v_dot2c_f32_bf16 v161, v39, v15
  v_dot2c_f32_bf16 v162, v51, v15
  v_dot2c_f32_bf16 v163, v63, v15
  v_dot2c_f32_bf16 v164, v64, v4
  v_dot2c_f32_bf16 v165, v76, v4
  v_dot2c_f32_bf16 v166, v88, v4
  v_dot2c_f32_bf16 v167, v100, v4
  v_dot2c_f32_bf16 v164, v65, v5
  v_dot2c_f32_bf16 v165, v77, v5
  v_dot2c_f32_bf16 v166, v89, v5
  v_dot2c_f32_bf16 v167, v101, v5
  v_dot2c_f32_bf16 v164, v66, v6
  v_dot2c_f32_bf16 v165, v78, v6
  v_dot2c_f32_bf16 v166, v90, v6
  v_dot2c_f32_bf16 v167, v102, v6
  v_dot2c_f32_bf16 v164, v67, v7
  v_dot2c_f32_bf16 v165, v79, v7
  v_dot2c_f32_bf16 v166, v91, v7
  v_dot2c_f32_bf16 v167, v103, v7
  v_dot2c_f32_bf16 v164, v68, v8
  v_dot2c_f32_bf16 v165, v80, v8
  v_dot2c_f32_bf16 v166, v92, v8
  v_dot2c_f32_bf16 v167, v104, v8
  v_dot2c_f32_bf16 v164, v69, v9
  v_dot2c_f32_bf16 v165, v81, v9
  v_dot2c_f32_bf16 v166, v93, v9
  v_dot2c_f32_bf16 v167, v105, v9
  v_dot2c_f32_bf16 v164, v70, v10
  v_dot2c_f32_bf16 v165, v82, v10
  v_dot2c_f32_bf16 v166, v94, v10
  v_dot2c_f32_bf16 v167, v106, v10
  v_dot2c_f32_bf16 v164, v71, v11
  v_dot2c_f32_bf16 v165, v83, v11
  v_dot2c_f32_bf16 v166, v95, v11
  v_dot2c_f32_bf16 v167, v107, v11
  v_dot2c_f32_bf16 v164, v72, v12
  v_dot2c_f32_bf16 v165, v84, v12
  v_dot2c_f32_bf16 v166, v96, v12
  v_dot2c_f32_bf16 v167, v108, v12
  v_dot2c_f32_bf16 v164, v73, v13
  v_dot2c_f32_bf16 v165, v85, v13
  v_dot2c_f32_bf16 v166, v97, v13
  v_dot2c_f32_bf16 v167, v109, v13
  v_dot2c_f32_bf16 v164, v74, v14
  v_dot2c_f32_bf16 v165, v86, v14
  v_dot2c_f32_bf16 v166, v98, v14
  v_dot2c_f32_bf16 v167, v110, v14
  v_dot2c_f32_bf16 v164, v75, v15
  v_dot2c_f32_bf16 v165, v87, v15
  v_dot2c_f32_bf16 v166, v99, v15
  v_dot2c_f32_bf16 v167, v111, v15
  v_add_f32_dpp v160, v160, v160 quad_perm:[1,0,3,2] row_mask:0xf bank_mask:0xf
  v_add_f32_dpp v161, v161, v161 quad_perm:[1,0,3,2] row_mask:0xf bank_mask:0xf
  v_add_f32_dpp v162, v162, v162 quad_perm:[1,0,3,2] row_mask:0xf bank_mask:0xf
  v_add_f32_dpp v163, v163, v163 quad_perm:[1,0,3,2] row_mask:0xf bank_mask:0xf
  v_add_f32_dpp v164, v164, v164 quad_perm:[1,0,3,2] row_mask:0xf bank_mask:0xf
  v_add_f32_dpp v165, v165, v165 quad_perm:[1,0,3,2] row_mask:0xf bank_mask:0xf
  v_add_f32_dpp v166, v166, v166 quad_perm:[1,0,3,2] row_mask:0xf bank_mask:0xf
  v_add_f32_dpp v167, v167, v167 quad_perm:[1,0,3,2] row_mask:0xf bank_mask:0xf
  v_add_f32_dpp v160, v160, v160 quad_perm:[2,3,0,1] row_mask:0xf bank_mask:0xf
  v_add_f32_dpp v161, v161, v161 quad_perm:[2,3,0,1] row_mask:0xf bank_mask:0xf
  v_add_f32_dpp v162, v162, v162 quad_perm:[2,3,0,1] row_mask:0xf bank_mask:0xf
  v_add_f32_dpp v163, v163, v163 quad_perm:[2,3,0,1] row_mask:0xf bank_mask:0xf
  v_add_f32_dpp v164, v164, v164 quad_perm:[2,3,0,1] row_mask:0xf bank_mask:0xf
  v_add_f32_dpp v165, v165, v165 quad_perm:[2,3,0,1] row_mask:0xf bank_mask:0xf
  v_add_f32_dpp v166, v166, v166 quad_perm:[2,3,0,1] row_mask:0xf bank_mask:0xf
  v_add_f32_dpp v167, v167, v167 quad_perm:[2,3,0,1] row_mask:0xf bank_mask:0xf
  v_add_f32_dpp v160, v160, v160 row_half_mirror row_mask:0xf bank_mask:0xf
  v_add_f32_dpp v161, v161, v161 row_half_mirror row_mask:0xf bank_mask:0xf
  v_add_f32_dpp v162, v162, v162 row_half_mirror row_mask:0xf bank_mask:0xf
  v_add_f32_dpp v163, v163, v163 row_half_mirror row_mask:0xf bank_mask:0xf
  v_add_f32_dpp v164, v164, v164 row_half_mirror row_mask:0xf bank_mask:0xf
  v_add_f32_dpp v165, v165, v165 row_half_mirror row_mask:0xf bank_mask:0xf
  v_add_f32_dpp v166, v166, v166 row_half_mirror row_mask:0xf bank_mask:0xf
  v_add_f32_dpp v167, v167, v167 row_half_mirror row_mask:0xf bank_mask:0xf
  s_mov_b32 s68, 0x3d93cd3a
  v_mov_b32 v2, 0
  v_cvt_pk_bf16_f32 v160, v2, v160
  v_cvt_pk_bf16_f32 v161, v2, v161
  v_cvt_pk_bf16_f32 v162, v2, v162
  v_cvt_pk_bf16_f32 v163, v2, v163
  v_cvt_pk_bf16_f32 v164, v2, v164
  v_cvt_pk_bf16_f32 v165, v2, v165
  v_cvt_pk_bf16_f32 v166, v2, v166
  v_cvt_pk_bf16_f32 v167, v2, v167
  v_mul_f32 v160, s68, v160
  v_mul_f32 v161, s68, v161
  v_mul_f32 v162, s68, v162
  v_mul_f32 v163, s68, v163
  v_mul_f32 v164, s68, v164
  v_mul_f32 v165, s68, v165
  v_mul_f32 v166, s68, v166
  v_mul_f32 v167, s68, v167
  v_cvt_pk_bf16_f32 v160, v2, v160
  v_cvt_pk_bf16_f32 v161, v2, v161
  v_cvt_pk_bf16_f32 v162, v2, v162
  v_cvt_pk_bf16_f32 v163, v2, v163
  v_cvt_pk_bf16_f32 v164, v2, v164
  v_cvt_pk_bf16_f32 v165, v2, v165
  v_cvt_pk_bf16_f32 v166, v2, v166
  v_cvt_pk_bf16_f32 v167, v2, v167
  v_max_f32 v4, v160, v161
  v_max3_f32 v4, v4, v162, v163
  v_max3_f32 v4, v4, v164, v165
  v_max3_f32 v4, v4, v166, v167
  s_nop 1
  v_max_f32_dpp v4, v4, v4 row_ror:8 row_mask:0xf bank_mask:0xf
  v_mov_b32 v88, v4
  s_nop 1
  v_permlane16_swap_b32 v4, v88
  v_max_f32 v4, v4, v88
  v_mov_b32 v88, v4
  s_nop 1
  v_permlane32_swap_b32 v4, v88
  v_max_f32 v4, v4, v88
  s_mov_b32 s68, 0x3fb8aa3b
  v_sub_f32 v160, v160, v4
  v_sub_f32 v161, v161, v4
  v_sub_f32 v162, v162, v4
  v_sub_f32 v163, v163, v4
  v_sub_f32 v164, v164, v4
  v_sub_f32 v165, v165, v4
  v_sub_f32 v166, v166, v4
  v_sub_f32 v167, v167, v4
  v_mul_f32 v160, s68, v160
  v_mul_f32 v161, s68, v161
  v_mul_f32 v162, s68, v162
  v_mul_f32 v163, s68, v163
  v_mul_f32 v164, s68, v164
  v_mul_f32 v165, s68, v165
  v_mul_f32 v166, s68, v166
  v_mul_f32 v167, s68, v167
  v_exp_f32 v160, v160
  v_exp_f32 v161, v161
  v_exp_f32 v162, v162
  v_exp_f32 v163, v163
  v_exp_f32 v164, v164
  v_exp_f32 v165, v165
  v_exp_f32 v166, v166
  v_exp_f32 v167, v167
  v_add_f32 v5, v160, v161
  v_add_f32 v5, v5, v162
  v_add_f32 v5, v5, v163
  v_add_f32 v5, v5, v164
  v_add_f32 v5, v5, v165
  v_add_f32 v5, v5, v166
  v_add_f32 v5, v5, v167
  s_nop 1
  v_add_f32_dpp v5, v5, v5 row_ror:8 row_mask:0xf bank_mask:0xf
  v_mov_b32 v88, v5
  s_nop 1
  v_permlane16_swap_b32 v5, v88
  v_add_f32 v5, v5, v88
  v_mov_b32 v88, v5
  s_nop 1
  v_permlane32_swap_b32 v5, v88
  v_add_f32 v5, v5, v88
  s_lshl_b32 s69, s3, 4
  v_mov_b32 v88, s69
  v_mov_b32 v6, 1
  v_mov_b32 v7, 1
  ds_write_b128 v88, v[4:7] offset:512
  v_cvt_pk_bf16_f32 v160, v160, v2
  v_cvt_pk_bf16_f32 v161, v161, v2
  v_cvt_pk_bf16_f32 v162, v162, v2
  v_cvt_pk_bf16_f32 v163, v163, v2
  v_cvt_pk_bf16_f32 v164, v164, v2
  v_cvt_pk_bf16_f32 v165, v165, v2
  v_cvt_pk_bf16_f32 v166, v166, v2
  v_cvt_pk_bf16_f32 v167, v167, v2
  v_mov_b32 v88, 0
  v_mov_b32 v89, 0
  v_mov_b32 v90, 0
  v_mov_b32 v91, 0
  v_mov_b32 v92, 0
  v_mov_b32 v93, 0
  v_mov_b32 v94, 0
  v_mov_b32 v95, 0
  v_mov_b32 v96, 0
  v_mov_b32 v97, 0
  v_mov_b32 v98, 0
  v_mov_b32 v99, 0
  v_mov_b32 v100, 0
  v_mov_b32 v101, 0
  v_mov_b32 v102, 0
  v_mov_b32 v103, 0
  v_mov_b32 v104, 0
  v_mov_b32 v105, 0
  v_mov_b32 v106, 0
  v_mov_b32 v107, 0
  v_mov_b32 v108, 0
  v_mov_b32 v109, 0
  v_mov_b32 v110, 0
  v_mov_b32 v111, 0
  v_and_b32 v8, 7, v0
  v_lshlrev_b32 v8, 5, v8
  v_lshrrev_b32 v9, 4, v0
  v_lshl_add_u32 v8, v9, 3, v8
  s_mul_i32 s69, s3, 768
  v_add_u32 v8, s69, v8
  v_mov_b32 v11, 1
  s_waitcnt vmcnt(2)
  buffer_load_dwordx4 v[124:127], v1, s[12:15], s61 offen offset:0 nt
  v_lshlrev_b32 v10, 16, v160
  v_dot2c_f32_bf16 v88, v112, v160
  v_dot2c_f32_bf16 v89, v112, v10
  v_dot2c_f32_bf16 v90, v113, v160
  v_dot2c_f32_bf16 v91, v113, v10
  v_dot2c_f32_bf16 v92, v114, v160
  v_dot2c_f32_bf16 v93, v114, v10
  v_dot2c_f32_bf16 v94, v115, v160
  v_dot2c_f32_bf16 v95, v115, v10
  s_waitcnt vmcnt(2)
  buffer_load_dwordx4 v[128:131], v1, s[12:15], s61 offen offset:128 nt
  v_dot2c_f32_bf16 v96, v116, v160
  v_dot2c_f32_bf16 v97, v116, v10
  v_dot2c_f32_bf16 v98, v117, v160
  v_dot2c_f32_bf16 v99, v117, v10
  v_dot2c_f32_bf16 v100, v118, v160
  v_dot2c_f32_bf16 v101, v118, v10
  v_dot2c_f32_bf16 v102, v119, v160
  v_dot2c_f32_bf16 v103, v119, v10
  s_waitcnt vmcnt(2)
  buffer_load_dwordx4 v[132:135], v1, s[12:15], s61 offen offset:256 nt
  v_dot2c_f32_bf16 v104, v120, v160
  v_dot2c_f32_bf16 v105, v120, v10
  v_dot2c_f32_bf16 v106, v121, v160
  v_dot2c_f32_bf16 v107, v121, v10
  v_dot2c_f32_bf16 v108, v122, v160
  v_dot2c_f32_bf16 v109, v122, v10
  v_dot2c_f32_bf16 v110, v123, v160
  v_dot2c_f32_bf16 v111, v123, v10
  s_waitcnt vmcnt(2)
  buffer_load_dwordx4 v[136:139], v1, s[12:15], s62 offen offset:0 nt
  v_lshlrev_b32 v10, 16, v161
  v_dot2c_f32_bf16 v88, v124, v161
  v_dot2c_f32_bf16 v89, v124, v10
  v_dot2c_f32_bf16 v90, v125, v161
  v_dot2c_f32_bf16 v91, v125, v10
  v_dot2c_f32_bf16 v92, v126, v161
  v_dot2c_f32_bf16 v93, v126, v10
  v_dot2c_f32_bf16 v94, v127, v161
  v_dot2c_f32_bf16 v95, v127, v10
  s_waitcnt vmcnt(2)
  buffer_load_dwordx4 v[140:143], v1, s[12:15], s62 offen offset:128 nt
  v_dot2c_f32_bf16 v96, v128, v161
  v_dot2c_f32_bf16 v97, v128, v10
  v_dot2c_f32_bf16 v98, v129, v161
  v_dot2c_f32_bf16 v99, v129, v10
  v_dot2c_f32_bf16 v100, v130, v161
  v_dot2c_f32_bf16 v101, v130, v10
  v_dot2c_f32_bf16 v102, v131, v161
  v_dot2c_f32_bf16 v103, v131, v10
  s_waitcnt vmcnt(2)
  buffer_load_dwordx4 v[144:147], v1, s[12:15], s62 offen offset:256 nt
  v_dot2c_f32_bf16 v104, v132, v161
  v_dot2c_f32_bf16 v105, v132, v10
  v_dot2c_f32_bf16 v106, v133, v161
  v_dot2c_f32_bf16 v107, v133, v10
  v_dot2c_f32_bf16 v108, v134, v161
  v_dot2c_f32_bf16 v109, v134, v10
  v_dot2c_f32_bf16 v110, v135, v161
  v_dot2c_f32_bf16 v111, v135, v10
  s_waitcnt vmcnt(2)
  buffer_load_dwordx4 v[148:151], v1, s[12:15], s63 offen offset:0 nt
  v_lshlrev_b32 v10, 16, v162
  v_dot2c_f32_bf16 v88, v136, v162
  v_dot2c_f32_bf16 v89, v136, v10
  v_dot2c_f32_bf16 v90, v137, v162
  v_dot2c_f32_bf16 v91, v137, v10
  v_dot2c_f32_bf16 v92, v138, v162
  v_dot2c_f32_bf16 v93, v138, v10
  v_dot2c_f32_bf16 v94, v139, v162
  v_dot2c_f32_bf16 v95, v139, v10
  s_waitcnt vmcnt(2)
  buffer_load_dwordx4 v[152:155], v1, s[12:15], s63 offen offset:128 nt
  v_dot2c_f32_bf16 v96, v140, v162
  v_dot2c_f32_bf16 v97, v140, v10
  v_dot2c_f32_bf16 v98, v141, v162
  v_dot2c_f32_bf16 v99, v141, v10
  v_dot2c_f32_bf16 v100, v142, v162
  v_dot2c_f32_bf16 v101, v142, v10
  v_dot2c_f32_bf16 v102, v143, v162
  v_dot2c_f32_bf16 v103, v143, v10
  s_waitcnt vmcnt(2)
  buffer_load_dwordx4 v[156:159], v1, s[12:15], s63 offen offset:256 nt
  v_dot2c_f32_bf16 v104, v144, v162
  v_dot2c_f32_bf16 v105, v144, v10
  v_dot2c_f32_bf16 v106, v145, v162
  v_dot2c_f32_bf16 v107, v145, v10
  v_dot2c_f32_bf16 v108, v146, v162
  v_dot2c_f32_bf16 v109, v146, v10
  v_dot2c_f32_bf16 v110, v147, v162
  v_dot2c_f32_bf16 v111, v147, v10
  s_waitcnt vmcnt(2)
  buffer_load_dwordx4 v[16:19], v1, s[12:15], s64 offen offset:0 nt
  v_lshlrev_b32 v10, 16, v163
  v_dot2c_f32_bf16 v88, v148, v163
  v_dot2c_f32_bf16 v89, v148, v10
  v_dot2c_f32_bf16 v90, v149, v163
  v_dot2c_f32_bf16 v91, v149, v10
  v_dot2c_f32_bf16 v92, v150, v163
  v_dot2c_f32_bf16 v93, v150, v10
  v_dot2c_f32_bf16 v94, v151, v163
  v_dot2c_f32_bf16 v95, v151, v10
  s_waitcnt vmcnt(2)
  buffer_load_dwordx4 v[20:23], v1, s[12:15], s64 offen offset:128 nt
  v_dot2c_f32_bf16 v96, v152, v163
  v_dot2c_f32_bf16 v97, v152, v10
  v_dot2c_f32_bf16 v98, v153, v163
  v_dot2c_f32_bf16 v99, v153, v10
  v_dot2c_f32_bf16 v100, v154, v163
  v_dot2c_f32_bf16 v101, v154, v10
  v_dot2c_f32_bf16 v102, v155, v163
  v_dot2c_f32_bf16 v103, v155, v10
  s_waitcnt vmcnt(2)
  buffer_load_dwordx4 v[24:27], v1, s[12:15], s64 offen offset:256 nt
  v_dot2c_f32_bf16 v104, v156, v163
  v_dot2c_f32_bf16 v105, v156, v10
  v_dot2c_f32_bf16 v106, v157, v163
  v_dot2c_f32_bf16 v107, v157, v10
  v_dot2c_f32_bf16 v108, v158, v163
  v_dot2c_f32_bf16 v109, v158, v10
  v_dot2c_f32_bf16 v110, v159, v163
  v_dot2c_f32_bf16 v111, v159, v10
  s_waitcnt vmcnt(2)
  buffer_load_dwordx4 v[28:31], v1, s[12:15], s65 offen offset:0 nt
  v_lshlrev_b32 v10, 16, v164
  v_dot2c_f32_bf16 v88, v16, v164
  v_dot2c_f32_bf16 v89, v16, v10
  v_dot2c_f32_bf16 v90, v17, v164
  v_dot2c_f32_bf16 v91, v17, v10
  v_dot2c_f32_bf16 v92, v18, v164
  v_dot2c_f32_bf16 v93, v18, v10
  v_dot2c_f32_bf16 v94, v19, v164
  v_dot2c_f32_bf16 v95, v19, v10
  s_waitcnt vmcnt(2)
  buffer_load_dwordx4 v[32:35], v1, s[12:15], s65 offen offset:128 nt
  v_dot2c_f32_bf16 v96, v20, v164
  v_dot2c_f32_bf16 v97, v20, v10
  v_dot2c_f32_bf16 v98, v21, v164
  v_dot2c_f32_bf16 v99, v21, v10
  v_dot2c_f32_bf16 v100, v22, v164
  v_dot2c_f32_bf16 v101, v22, v10
  v_dot2c_f32_bf16 v102, v23, v164
  v_dot2c_f32_bf16 v103, v23, v10
  s_waitcnt vmcnt(2)
  buffer_load_dwordx4 v[36:39], v1, s[12:15], s65 offen offset:256 nt
  v_dot2c_f32_bf16 v104, v24, v164
  v_dot2c_f32_bf16 v105, v24, v10
  v_dot2c_f32_bf16 v106, v25, v164
  v_dot2c_f32_bf16 v107, v25, v10
  v_dot2c_f32_bf16 v108, v26, v164
  v_dot2c_f32_bf16 v109, v26, v10
  v_dot2c_f32_bf16 v110, v27, v164
  v_dot2c_f32_bf16 v111, v27, v10
  s_waitcnt vmcnt(2)
  buffer_load_dwordx4 v[40:43], v1, s[12:15], s66 offen offset:0 nt
  v_lshlrev_b32 v10, 16, v165
  v_dot2c_f32_bf16 v88, v28, v165
  v_dot2c_f32_bf16 v89, v28, v10
  v_dot2c_f32_bf16 v90, v29, v165
  v_dot2c_f32_bf16 v91, v29, v10
  v_dot2c_f32_bf16 v92, v30, v165
  v_dot2c_f32_bf16 v93, v30, v10
  v_dot2c_f32_bf16 v94, v31, v165
  v_dot2c_f32_bf16 v95, v31, v10
  s_waitcnt vmcnt(2)
  buffer_load_dwordx4 v[44:47], v1, s[12:15], s66 offen offset:128 nt
  v_dot2c_f32_bf16 v96, v32, v165
  v_dot2c_f32_bf16 v97, v32, v10
  v_dot2c_f32_bf16 v98, v33, v165
  v_dot2c_f32_bf16 v99, v33, v10
  v_dot2c_f32_bf16 v100, v34, v165
  v_dot2c_f32_bf16 v101, v34, v10
  v_dot2c_f32_bf16 v102, v35, v165
  v_dot2c_f32_bf16 v103, v35, v10
  s_waitcnt vmcnt(2)
  buffer_load_dwordx4 v[48:51], v1, s[12:15], s66 offen offset:256 nt
  s_mov_b64 exec, 1
  ds_add_u32 v2, v11 offset:648
  s_mov_b64 exec, -1
  v_dot2c_f32_bf16 v104, v36, v165
  v_dot2c_f32_bf16 v105, v36, v10
  v_dot2c_f32_bf16 v106, v37, v165
  v_dot2c_f32_bf16 v107, v37, v10
  v_dot2c_f32_bf16 v108, v38, v165
  v_dot2c_f32_bf16 v109, v38, v10
  v_dot2c_f32_bf16 v110, v39, v165
  v_dot2c_f32_bf16 v111, v39, v10
  s_waitcnt vmcnt(2)
  buffer_load_dwordx4 v[52:55], v1, s[12:15], s67 offen offset:0 nt
  v_lshlrev_b32 v10, 16, v166
  v_dot2c_f32_bf16 v88, v40, v166
  v_dot2c_f32_bf16 v89, v40, v10
  v_dot2c_f32_bf16 v90, v41, v166
  v_dot2c_f32_bf16 v91, v41, v10
  v_dot2c_f32_bf16 v92, v42, v166
  v_dot2c_f32_bf16 v93, v42, v10
  v_dot2c_f32_bf16 v94, v43, v166
  v_dot2c_f32_bf16 v95, v43, v10
  s_waitcnt vmcnt(2)
  buffer_load_dwordx4 v[56:59], v1, s[12:15], s67 offen offset:128 nt
  v_dot2c_f32_bf16 v96, v44, v166
  v_dot2c_f32_bf16 v97, v44, v10
  v_dot2c_f32_bf16 v98, v45, v166
  v_dot2c_f32_bf16 v99, v45, v10
  v_dot2c_f32_bf16 v100, v46, v166
  v_dot2c_f32_bf16 v101, v46, v10
  v_dot2c_f32_bf16 v102, v47, v166
  v_dot2c_f32_bf16 v103, v47, v10
  s_waitcnt vmcnt(2)
  buffer_load_dwordx4 v[60:63], v1, s[12:15], s67 offen offset:256 nt
  s_mov_b64 exec, 1
  ds_add_u32 v2, v11 offset:644
  s_mov_b64 exec, -1
  v_dot2c_f32_bf16 v104, v48, v166
  v_dot2c_f32_bf16 v105, v48, v10
  v_dot2c_f32_bf16 v106, v49, v166
  v_dot2c_f32_bf16 v107, v49, v10
  v_dot2c_f32_bf16 v108, v50, v166
  v_dot2c_f32_bf16 v109, v50, v10
  v_dot2c_f32_bf16 v110, v51, v166
  v_dot2c_f32_bf16 v111, v51, v10
  s_mov_b32 s70, 200007
L_spin_3:
  ds_read_b128 v[12:15], v2 offset:672
  ds_read_b32 v7, v2 offset:656
  s_waitcnt lgkmcnt(0)
  v_cmp_eq_u32 vcc, 0, v15
  s_nop 0
  s_cbranch_vccz L_sdone_4
  s_sleep 1
  s_sub_u32 s70, s70, 1
  s_cbranch_scc0 L_spin_3
L_sdone_4:
  v_sub_f32 v9, v4, v12
  v_mul_f32 v9, s68, v9
  v_exp_f32 v9, v9
  v_readfirstlane_b32 s46, v7
  v_mul_f32 v9, v9, v13
  v_min_u32 v12, 47, v0
  v_lshlrev_b32 v13, 7, v12
  v_lshlrev_b32 v12, 4, v12
  s_mul_i32 s74, s6, 6144
  s_lshl4_add_u32 s74, s7, s74
  s_add_u32 s74, s74, 1114112
  s_lshl_b32 s75, s4, 9
  s_lshl4_add_u32 s75, s79, s75
  s_add_u32 s75, s75, 1064960
  s_mov_b32 s22, 0xaaaaaaaa
  s_mov_b32 s23, 0xaaaaaaaa
  v_mov_b32 v14, s30
  v_mov_b32 v15, s31
  s_waitcnt vmcnt(2)
  v_lshlrev_b32 v10, 16, v167
  v_dot2c_f32_bf16 v88, v52, v167
  v_dot2c_f32_bf16 v89, v52, v10
  v_dot2c_f32_bf16 v90, v53, v167
  v_dot2c_f32_bf16 v91, v53, v10
  v_dot2c_f32_bf16 v92, v54, v167
  v_dot2c_f32_bf16 v93, v54, v10
  v_dot2c_f32_bf16 v94, v55, v167
  v_dot2c_f32_bf16 v95, v55, v10
  v_permlane32_swap_b32 v88, v92
  v_permlane32_swap_b32 v89, v93
  v_permlane32_swap_b32 v90, v94
  v_permlane32_swap_b32 v91, v95
  v_add_f32 v88, v88, v92
  v_add_f32 v89, v89, v93
  v_add_f32 v90, v90, v94
  v_add_f32 v91, v91, v95
  s_nop 0
  v_permlane16_swap_b32 v88, v90
  v_permlane16_swap_b32 v89, v91
  v_add_f32 v88, v88, v90
  v_add_f32 v89, v89, v91
  s_nop 0
  v_add_f32_dpp v88, v88, v88 row_ror:8 row_mask:0xf bank_mask:0xf
  v_add_f32_dpp v89, v89, v89 row_ror:8 row_mask:0xf bank_mask:0xf
  v_mul_f32 v88, v9, v88
  v_mul_f32 v89, v9, v89
  ds_write_b64 v8, v[88:89] offset:1024
  s_waitcnt vmcnt(1)
  v_dot2c_f32_bf16 v96, v56, v167
  v_dot2c_f32_bf16 v97, v56, v10
  v_dot2c_f32_bf16 v98, v57, v167
  v_dot2c_f32_bf16 v99, v57, v10
  v_dot2c_f32_bf16 v100, v58, v167
  v_dot2c_f32_bf16 v101, v58, v10
  v_dot2c_f32_bf16 v102, v59, v167
  v_dot2c_f32_bf16 v103, v59, v10
  v_permlane32_swap_b32 v96, v100
  v_permlane32_swap_b32 v97, v101
  v_permlane32_swap_b32 v98, v102
  v_permlane32_swap_b32 v99, v103
  v_add_f32 v96, v96, v100
  v_add_f32 v97, v97, v101
  v_add_f32 v98, v98, v102
  v_add_f32 v99, v99, v103
  s_nop 0
  v_permlane16_swap_b32 v96, v98
  v_permlane16_swap_b32 v97, v99
  v_add_f32 v96, v96, v98
  v_add_f32 v97, v97, v99
  s_nop 0
  v_add_f32_dpp v96, v96, v96 row_ror:8 row_mask:0xf bank_mask:0xf
  v_add_f32_dpp v97, v97, v97 row_ror:8 row_mask:0xf bank_mask:0xf
  v_mul_f32 v96, v9, v96
  v_mul_f32 v97, v9, v97
  ds_write_b64 v8, v[96:97] offset:1280
  s_waitcnt vmcnt(0)
  v_dot2c_f32_bf16 v104, v60, v167
  v_dot2c_f32_bf16 v105, v60, v10
  v_dot2c_f32_bf16 v106, v61, v167
  v_dot2c_f32_bf16 v107, v61, v10
  v_dot2c_f32_bf16 v108, v62, v167
  v_dot2c_f32_bf16 v109, v62, v10
  v_dot2c_f32_bf16 v110, v63, v167
  v_dot2c_f32_bf16 v111, v63, v10
  v_permlane32_swap_b32 v104, v108
  v_permlane32_swap_b32 v105, v109
  v_permlane32_swap_b32 v106, v110
  v_permlane32_swap_b32 v107, v111
  v_add_f32 v104, v104, v108
  v_add_f32 v105, v105, v109
  v_add_f32 v106, v106, v110
  v_add_f32 v107, v107, v111
  s_nop 0
  v_permlane16_swap_b32 v104, v106
  v_permlane16_swap_b32 v105, v107
  v_add_f32 v104, v104, v106
  v_add_f32 v105, v105, v107
  s_nop 0
  v_add_f32_dpp v104, v104, v104 row_ror:8 row_mask:0xf bank_mask:0xf
  v_add_f32_dpp v105, v105, v105 row_ror:8 row_mask:0xf bank_mask:0xf
  v_mul_f32 v104, v9, v104
  v_mul_f32 v105, v9, v105
  ds_write_b64 v8, v[104:105] offset:1536
  s_mov_b64 exec, 1
  ds_add_rtn_u32 v10, v2, v11 offset:640
  s_waitcnt lgkmcnt(0)
  v_readfirstlane_b32 s68, v10
  s_mov_b64 exec, -1
  s_cmp_lg_u32 s68, 7
  s_cbranch_scc1 L_nopub
  ds_read_b128 v[16:19], v12 offset:1024
  ds_read_b128 v[20:23], v12 offset:1792
  ds_read_b128 v[24:27], v12 offset:2560
  ds_read_b128 v[28:31], v12 offset:3328
  ds_read_b128 v[32:35], v12 offset:4096
  ds_read_b128 v[36:39], v12 offset:4864
  ds_read_b128 v[40:43], v12 offset:5632
  ds_read_b128 v[44:47], v12 offset:6400
  s_waitcnt lgkmcnt(6)
  v_add_f32 v16, v16, v20
  v_add_f32 v17, v17, v21
  v_add_f32 v18, v18, v22
  v_add_f32 v19, v19, v23
  s_waitcnt lgkmcnt(4)
  v_add_f32 v24, v24, v28
  v_add_f32 v25, v25, v29
  v_add_f32 v26, v26, v30
  v_add_f32 v27, v27, v31
  v_add_f32 v16, v16, v24
  v_add_f32 v17, v17, v25
  v_add_f32 v18, v18, v26
  v_add_f32 v19, v19, v27
  s_waitcnt lgkmcnt(2)
  v_add_f32 v32, v32, v36
  v_add_f32 v33, v33, v37
  v_add_f32 v34, v34, v38
  v_add_f32 v35, v35, v39
  s_waitcnt lgkmcnt(0)
  v_add_f32 v40, v40, v44
  v_add_f32 v41, v41, v45
  v_add_f32 v42, v42, v46
  v_add_f32 v43, v43, v47
  v_add_f32 v32, v32, v40
  v_add_f32 v33, v33, v41
  v_add_f32 v34, v34, v42
  v_add_f32 v35, v35, v43
  v_add_f32 v4, v16, v32
  v_add_f32 v5, v17, v33
  v_add_f32 v6, v18, v34
  v_add_f32 v7, v19, v35
  v_cvt_pk_bf16_f32 v8, v4, v5
  v_cvt_pk_bf16_f32 v9, v6, v7
  v_cndmask_b32 v4, v8, v14, s[22:23]
  v_cndmask_b32 v5, v9, v15, s[22:23]
  v_cndmask_b32 v6, v14, v8, s[22:23]
  v_cndmask_b32 v7, v15, v9, s[22:23]
  s_mov_b32 exec_lo, 0xffffffff
  s_mov_b32 exec_hi, 0xffff
  buffer_store_dwordx4 v[4:7], v13, s[32:35], s74 offen
  s_mov_b64 exec, -1
  s_cmp_lg_u32 s46, 1
  s_cbranch_scc1 L_slow_5
L_back_6:
  s_mov_b64 exec, 1
  ds_write_b32 v2, v11 offset:660
  s_mov_b64 exec, -1
L_nopub:
  s_cmp_eq_u32 s3, 7
  s_cbranch_scc1 L_end
  v_mov_b32 v1, 0
  s_mov_b32 s70, 200007
L_spin_7:
  ds_read_b64 v[4:5], v1 offset:664
  s_waitcnt lgkmcnt(0)
  v_cmp_eq_u32 vcc, 0, v5
  s_nop 0
  s_cbranch_vccz L_sdone_8
  s_sleep 1
  s_sub_u32 s70, s70, 1
  s_cbranch_scc0 L_spin_7
L_sdone_8:
  v_readfirstlane_b32 s5, v5
  v_readfirstlane_b32 s47, v4
  s_lshr_b32 s28, s5, 8
  s_and_b32 s5, s5, 0xff
  s_sub_u32 s5, s5, 1
  s_cmp_lt_u32 s5, 12
  s_cbranch_scc1 L_ffn
  s_cmp_lt_u32 s5, 20
  s_cbranch_scc1 L_end
  s_cmp_lt_u32 s3, 5
  s_cbranch_scc1 L_f1
  s_endpgm
L_q2:
  s_mov_b32 s69, 0xffff0000
  s_mov_b32 s24, s58
  s_mov_b32 s25, s59
  s_mov_b32 s26, 4194304
  s_mov_b32 s27, 0x20000
  s_add_u32 s32, s58, 4194304
  s_addc_u32 s33, s59, 0
  s_mov_b32 s34, 4194304
  s_mov_b32 s35, 0x20000
  s_lshl3_add_u32 s71, s6, s7
  s_lshr_b32 s79, s2, 3
  s_waitcnt lgkmcnt(0)
  s_mul_i32 s30, s28, 0x2c9277b5
  s_add_u32 s30, s30, 0xac564b05
  s_mul_i32 s31, s29, 0x0019660d
  s_add_u32 s31, s31, 0x3c6ef35f
  s_mul_i32 s64, s4, 768
  s_add_u32 s64, s64, 1081344
  s_add_u32 s65, s79, s73
  s_cmp_eq_u32 s65, 0
  s_cselect_b32 s64, s64, 4194304
  v_mov_b32 v92, 0
  v_mov_b32 v93, 0
  v_mov_b32 v94, s30
  v_mov_b32 v95, s31
  s_mov_b64 exec, 1
  buffer_store_dwordx4 v[92:95], off, s[24:27], s64 sc1
  s_mov_b64 exec, -1
  s_waitcnt vmcnt(21)
  v_lshlrev_b32 v70, 16, v64
  v_and_b32 v71, s69, v64
  v_lshlrev_b32 v72, 16, v65
  v_and_b32 v73, s69, v65
  v_lshlrev_b32 v74, 16, v66
  v_and_b32 v75, s69, v66
  v_lshlrev_b32 v76, 16, v67
  v_and_b32 v77, s69, v67
  v_lshlrev_b32 v78, 16, v68
  v_and_b32 v79, s69, v68
  v_add_f32 v4, v70, v71
  v_add_f32 v5, v72, v73
  v_add_f32 v6, v74, v75
  v_add_f32 v7, v76, v77
  v_add_f32 v4, v4, v5
  v_add_f32 v6, v6, v7
  v_add_f32 v5, v78, v79
  v_add_f32 v4, v4, v6
  v_add_f32 v4, v4, v5
  s_nop 1
  v_add_f32_dpp v4, v4, v4 quad_perm:[1,0,3,2] row_mask:0xf bank_mask:0xf
  s_nop 1
  v_add_f32_dpp v4, v4, v4 quad_perm:[2,3,0,1] row_mask:0xf bank_mask:0xf
  s_nop 1
  v_add_f32_dpp v4, v4, v4 row_half_mirror row_mask:0xf bank_mask:0xf
  s_nop 1
  v_add_f32_dpp v4, v4, v4 row_mirror row_mask:0xf bank_mask:0xf
  v_mov_b32 v5, v4
  s_nop 1
  v_permlane16_swap_b32 v4, v5
  v_add_f32 v4, v4, v5
  v_mov_b32 v5, v4
  s_nop 1
  v_permlane32_swap_b32 v4, v5
  v_add_f32 v4, v4, v5
  v_mul_f32 v4, 0x3acccccd, v4
  v_sub_f32 v70, v70, v4
  v_sub_f32 v71, v71, v4
  v_sub_f32 v72, v72, v4
  v_sub_f32 v73, v73, v4
  v_sub_f32 v74, v74, v4
  v_sub_f32 v75, v75, v4
  v_sub_f32 v76, v76, v4
  v_sub_f32 v77, v77, v4
  v_sub_f32 v78, v78, v4
  v_sub_f32 v79, v79, v4
  v_mul_f32 v5, v70, v70
  v_fmac_f32 v5, v71, v71
  v_fmac_f32 v5, v72, v72
  v_fmac_f32 v5, v73, v73
  v_fmac_f32 v5, v74, v74
  v_fmac_f32 v5, v75, v75
  v_fmac_f32 v5, v76, v76
  v_fmac_f32 v5, v77, v77
  v_fmac_f32 v5, v78, v78
  v_fmac_f32 v5, v79, v79
  s_nop 1
  v_add_f32_dpp v5, v5, v5 quad_perm:[1,0,3,2] row_mask:0xf bank_mask:0xf
  s_nop 1
  v_add_f32_dpp v5, v5, v5 quad_perm:[2,3,0,1] row_mask:0xf bank_mask:0xf
  s_nop 1
  v_add_f32_dpp v5, v5, v5 row_half_mirror row_mask:0xf bank_mask:0xf
  s_nop 1
  v_add_f32_dpp v5, v5, v5 row_mirror row_mask:0xf bank_mask:0xf
  v_mov_b32 v6, v5
  s_nop 1
  v_permlane16_swap_b32 v5, v6
  v_add_f32 v5, v5, v6
  v_mov_b32 v6, v5
  s_nop 1
  v_permlane32_swap_b32 v5, v6
  v_add_f32 v5, v5, v6
  v_mul_f32 v5, 0x3acccccd, v5
  v_cvt_pk_bf16_f32 v4, v4, v4
  v_lshlrev_b32 v4, 16, v4
  v_cvt_pk_bf16_f32 v5, v5, v5
  v_lshlrev_b32 v5, 16, v5
  v_add_f32 v5, 0x3727c5ac, v5
  v_cvt_pk_bf16_f32 v5, v5, v5
  v_lshlrev_b32 v5, 16, v5
  v_sqrt_f32 v5, v5
  s_nop 0
  v_cvt_pk_bf16_f32 v5, v5, v5
  v_lshlrev_b32 v5, 16, v5
  v_rcp_f32 v5, v5
  v_mov_b32 v6, 0
  s_waitcnt vmcnt(11)
  v_lshlrev_b32 v8, 16, v8
  v_lshlrev_b32 v9, 16, v9
  v_lshlrev_b32 v10, 16, v10
  v_lshlrev_b32 v11, 16, v11
  v_lshlrev_b32 v12, 16, v12
  v_lshlrev_b32 v13, 16, v13
  v_lshlrev_b32 v14, 16, v14
  v_lshlrev_b32 v15, 16, v15
  v_lshlrev_b32 v16, 16, v16
  v_lshlrev_b32 v17, 16, v17
  v_sub_f32 v8, v8, v4
  v_sub_f32 v9, v9, v4
  v_sub_f32 v10, v10, v4
  v_sub_f32 v11, v11, v4
  v_sub_f32 v12, v12, v4
  v_sub_f32 v13, v13, v4
  v_sub_f32 v14, v14, v4
  v_sub_f32 v15, v15, v4
  v_sub_f32 v16, v16, v4
  v_sub_f32 v17, v17, v4
  v_cvt_pk_bf16_f32 v8, v6, v8
  v_cvt_pk_bf16_f32 v9, v6, v9
  v_cvt_pk_bf16_f32 v10, v6, v10
  v_cvt_pk_bf16_f32 v11, v6, v11
  v_cvt_pk_bf16_f32 v12, v6, v12
  v_cvt_pk_bf16_f32 v13, v6, v13
  v_cvt_pk_bf16_f32 v14, v6, v14
  v_cvt_pk_bf16_f32 v15, v6, v15
  v_cvt_pk_bf16_f32 v16, v6, v16
  v_cvt_pk_bf16_f32 v17, v6, v17
  v_mul_f32 v8, v8, v5
  v_mul_f32 v9, v9, v5
  v_mul_f32 v10, v10, v5
  v_mul_f32 v11, v11, v5
  v_mul_f32 v12, v12, v5
  v_mul_f32 v13, v13, v5
  v_mul_f32 v14, v14, v5
  v_mul_f32 v15, v15, v5
  v_mul_f32 v16, v16, v5
  v_mul_f32 v17, v17, v5
  v_cvt_pk_bf16_f32 v70, v6, v8
  v_cvt_pk_bf16_f32 v8, v8, v6
  v_cvt_pk_bf16_f32 v71, v6, v9
  v_cvt_pk_bf16_f32 v9, v9, v6
  v_cvt_pk_bf16_f32 v72, v6, v10
  v_cvt_pk_bf16_f32 v10, v10, v6
  v_cvt_pk_bf16_f32 v73, v6, v11
  v_cvt_pk_bf16_f32 v11, v11, v6
  v_cvt_pk_bf16_f32 v74, v6, v12
  v_cvt_pk_bf16_f32 v12, v12, v6
  v_cvt_pk_bf16_f32 v75, v6, v13
  v_cvt_pk_bf16_f32 v13, v13, v6
  v_cvt_pk_bf16_f32 v76, v6, v14
  v_cvt_pk_bf16_f32 v14, v14, v6
  v_cvt_pk_bf16_f32 v77, v6, v15
  v_cvt_pk_bf16_f32 v15, v15, v6
  v_cvt_pk_bf16_f32 v78, v6, v16
  v_cvt_pk_bf16_f32 v16, v16, v6
  v_cvt_pk_bf16_f32 v79, v6, v17
  v_cvt_pk_bf16_f32 v17, v17, v6
  v_mov_b32 v80, 0
  v_mov_b32 v81, 0
  v_mov_b32 v82, 0
  v_mov_b32 v83, 0
  v_mov_b32 v84, 0
  v_mov_b32 v85, 0
  v_mov_b32 v86, 0
  v_mov_b32 v87, 0
  v_and_b32 v90, 7, v0
  v_lshrrev_b32 v6, 5, v0
  v_lshl_add_u32 v90, v90, 1, v6
  v_lshlrev_b32 v90, 4, v90
  s_mul_i32 s60, s6, 3
  s_add_u32 s60, s60, s73
  s_lshl_b32 s60, s60, 11
  s_add_u32 s60, s60, 1310720
  s_lshl_b32 s64, s7, 8
  s_add_u32 s64, s64, s60
  s_waitcnt vmcnt(10)
  v_dot2c_f32_bf16 v80, v24, v8
  v_dot2c_f32_bf16 v81, v24, v70
  v_dot2c_f32_bf16 v82, v25, v8
  v_dot2c_f32_bf16 v83, v25, v70
  v_dot2c_f32_bf16 v84, v26, v8
  v_dot2c_f32_bf16 v85, v26, v70
  v_dot2c_f32_bf16 v86, v27, v8
  v_dot2c_f32_bf16 v87, v27, v70
  s_waitcnt vmcnt(9)
  v_dot2c_f32_bf16 v80, v28, v9
  v_dot2c_f32_bf16 v81, v28, v71
  v_dot2c_f32_bf16 v82, v29, v9
  v_dot2c_f32_bf16 v83, v29, v71
  v_dot2c_f32_bf16 v84, v30, v9
  v_dot2c_f32_bf16 v85, v30, v71
  v_dot2c_f32_bf16 v86, v31, v9
  v_dot2c_f32_bf16 v87, v31, v71
  s_waitcnt vmcnt(8)
  v_dot2c_f32_bf16 v80, v32, v10
  v_dot2c_f32_bf16 v81, v32, v72
  v_dot2c_f32_bf16 v82, v33, v10
  v_dot2c_f32_bf16 v83, v33, v72
  v_dot2c_f32_bf16 v84, v34, v10
  v_dot2c_f32_bf16 v85, v34, v72
  v_dot2c_f32_bf16 v86, v35, v10
  v_dot2c_f32_bf16 v87, v35, v72
  s_waitcnt vmcnt(7)
  v_dot2c_f32_bf16 v80, v36, v11
  v_dot2c_f32_bf16 v81, v36, v73
  v_dot2c_f32_bf16 v82, v37, v11
  v_dot2c_f32_bf16 v83, v37, v73
  v_dot2c_f32_bf16 v84, v38, v11
  v_dot2c_f32_bf16 v85, v38, v73
  v_dot2c_f32_bf16 v86, v39, v11
  v_dot2c_f32_bf16 v87, v39, v73
  s_waitcnt vmcnt(6)
  v_dot2c_f32_bf16 v80, v40, v12
  v_dot2c_f32_bf16 v81, v40, v74
  v_dot2c_f32_bf16 v82, v41, v12
  v_dot2c_f32_bf16 v83, v41, v74
  v_dot2c_f32_bf16 v84, v42, v12
  v_dot2c_f32_bf16 v85, v42, v74
  v_dot2c_f32_bf16 v86, v43, v12
  v_dot2c_f32_bf16 v87, v43, v74
  s_waitcnt vmcnt(5)
  v_dot2c_f32_bf16 v80, v44, v13
  v_dot2c_f32_bf16 v81, v44, v75
  v_dot2c_f32_bf16 v82, v45, v13
  v_dot2c_f32_bf16 v83, v45, v75
  v_dot2c_f32_bf16 v84, v46, v13
  v_dot2c_f32_bf16 v85, v46, v75
  v_dot2c_f32_bf16 v86, v47, v13
  v_dot2c_f32_bf16 v87, v47, v75
  s_waitcnt vmcnt(4)
  v_dot2c_f32_bf16 v80, v48, v14
  v_dot2c_f32_bf16 v81, v48, v76
  v_dot2c_f32_bf16 v82, v49, v14
  v_dot2c_f32_bf16 v83, v49, v76
  v_dot2c_f32_bf16 v84, v50, v14
  v_dot2c_f32_bf16 v85, v50, v76
  v_dot2c_f32_bf16 v86, v51, v14
  v_dot2c_f32_bf16 v87, v51, v76
  s_waitcnt vmcnt(3)
  v_dot2c_f32_bf16 v80, v52, v15
  v_dot2c_f32_bf16 v81, v52, v77
  v_dot2c_f32_bf16 v82, v53, v15
  v_dot2c_f32_bf16 v83, v53, v77
  v_dot2c_f32_bf16 v84, v54, v15
  v_dot2c_f32_bf16 v85, v54, v77
  v_dot2c_f32_bf16 v86, v55, v15
  v_dot2c_f32_bf16 v87, v55, v77
  s_waitcnt vmcnt(2)
  v_dot2c_f32_bf16 v80, v56, v16
  v_dot2c_f32_bf16 v81, v56, v78
  v_dot2c_f32_bf16 v82, v57, v16
  v_dot2c_f32_bf16 v83, v57, v78
  v_dot2c_f32_bf16 v84, v58, v16
  v_dot2c_f32_bf16 v85, v58, v78
  v_dot2c_f32_bf16 v86, v59, v16
  v_dot2c_f32_bf16 v87, v59, v78
  s_waitcnt vmcnt(0)
  v_dot2c_f32_bf16 v80, v60, v17
  v_dot2c_f32_bf16 v81, v60, v79
  v_dot2c_f32_bf16 v82, v61, v17
  v_dot2c_f32_bf16 v83, v61, v79
  v_dot2c_f32_bf16 v84, v62, v17
  v_dot2c_f32_bf16 v85, v62, v79
  v_dot2c_f32_bf16 v86, v63, v17
  v_dot2c_f32_bf16 v87, v63, v79
  v_permlane32_swap_b32 v80, v84
  v_permlane32_swap_b32 v81, v85
  v_permlane32_swap_b32 v82, v86
  v_permlane32_swap_b32 v83, v87
  v_add_f32 v80, v80, v84
  v_add_f32 v81, v81, v85
  v_add_f32 v82, v82, v86
  v_add_f32 v83, v83, v87
  v_mov_b32 v84, v80
  v_mov_b32 v85, v81
  v_mov_b32 v86, v82
  v_mov_b32 v87, v83
  v_permlane16_swap_b32 v80, v84
  v_permlane16_swap_b32 v81, v85
  v_permlane16_swap_b32 v82, v86
  v_permlane16_swap_b32 v83, v87
  v_add_f32 v80, v80, v84
  v_add_f32 v81, v81, v85
  v_add_f32 v82, v82, v86
  v_add_f32 v83, v83, v87
  v_add_f32_dpp v80, v80, v80 row_ror:8 row_mask:0xf bank_mask:0xf
  v_add_f32_dpp v81, v81, v81 row_ror:8 row_mask:0xf bank_mask:0xf
  v_add_f32_dpp v82, v82, v82 row_ror:8 row_mask:0xf bank_mask:0xf
  v_add_f32_dpp v83, v83, v83 row_ror:8 row_mask:0xf bank_mask:0xf
  s_mov_b32 s68, 0x07060501
  v_perm_b32 v80, v80, v83, s68
  s_mov_b32 s68, 0x07060502
  v_perm_b32 v81, v81, v83, s68
  s_mov_b32 s68, 0x07060503
  v_perm_b32 v82, v82, v83, s68
  v_mov_b32 v83, s30
  s_mov_b32 exec_lo, 0xff
  s_mov_b32 exec_hi, 0xff
  buffer_store_dwordx4 v[80:83], v90, s[32:35], s64 offen
  s_mov_b64 exec, -1
  v_lshlrev_b32 v2, 4, v0
  v_and_b32 v3, 15, v0
  v_lshl_add_u32 v3, v3, 1, v6
  v_lshlrev_b32 v3, 2, v3
  s_lshl_b32 s69, s73, 7
  v_add_u32 v3, s69, v3
  v_mov_b32 v1, 0
  s_mov_b32 s65, 0
  s_mov_b32 s61, 0x0c04000c
  s_mov_b32 s62, 0x0402010c
  s_sleep 40
  s_mov_b32 s16, s32
  s_mov_b32 s17, s33
  s_mov_b32 s18, 4194304
  s_mov_b32 s19, 0x20000
  s_mov_b32 s70, 200007
L_spin_9:
  buffer_load_dwordx4 v[8:11], v2, s[16:19], s60 offen offset:0 sc1 nt
  buffer_load_dwordx4 v[12:15], v2, s[16:19], s60 offen offset:1024 sc1 nt
  s_waitcnt vmcnt(0)
  v_cmp_ne_u32 vcc, s30, v11
  v_cmp_ne_u32 s[20:21], s30, v15
  s_nop 0
  s_or_b64 vcc, vcc, s[20:21]
  s_nop 0
  s_cbranch_vccz L_sdone_10
  s_sleep 20
  ds_read_b32 v4, v1 offset:656
  s_waitcnt lgkmcnt(0)
  v_readfirstlane_b32 s46, v4
  s_nop 0
  s_sub_u32 s68, s46, s65
  s_cmp_lg_u32 s68, 2
  s_cbranch_scc1 L_qlazy_11
  s_mov_b32 exec_lo, 0xff
  s_mov_b32 exec_hi, 0xff
  buffer_store_dwordx4 v[80:83], v90, s[24:27], s64 offen sc1
  s_mov_b64 exec, -1
  s_mov_b32 s65, 1
L_qlazy_11:
  s_and_b32 s99, s70, 7
  s_cselect_b32 s16, s32, s24
  s_cselect_b32 s17, s33, s25
  s_sub_u32 s70, s70, 1
  s_cbranch_scc0 L_spin_9
L_sdone_10:
  v_perm_b32 v11, v9, v8, s61
  v_perm_b32 v11, v10, v11, s62
  v_perm_b32 v15, v13, v12, s61
  v_perm_b32 v15, v14, v15, s62
  v_add_f32 v8, v8, v12
  v_add_f32 v9, v9, v13
  v_add_f32 v10, v10, v14
  v_add_f32 v11, v11, v15
  s_nop 0
  v_permlane32_swap_b32 v8, v10
  v_permlane32_swap_b32 v9, v11
  v_add_f32 v8, v8, v10
  v_add_f32 v9, v9, v11
  v_mov_b32 v10, v8
  v_mov_b32 v11, v9
  s_nop 0
  v_permlane16_swap_b32 v8, v10
  v_permlane16_swap_b32 v9, v11
  v_add_f32 v8, v8, v10
  v_add_f32 v9, v9, v11
  v_cvt_pk_bf16_f32 v8, v8, v9
  ds_write_b32 v3, v8 offset:0
  s_lshl_b32 s69, s73, 3
  v_mov_b32 v4, s69
  v_mov_b32 v6, 1
  s_waitcnt lgkmcnt(0)
  ds_write_b32 v4, v6 offset:384
  v_mov_b32 v1, 0
  s_mov_b32 s70, 200007
L_spin_12:
  ds_read_b32 v4, v1 offset:656
  s_waitcnt lgkmcnt(0)
  v_cmp_gt_u32 vcc, 1, v4
  s_nop 0
  s_cbranch_vccz L_sdone_13
  s_sleep 2
  s_sub_u32 s70, s70, 1
  s_cbranch_scc0 L_spin_12
L_sdone_13:
  v_readfirstlane_b32 s46, v4
  ds_read_b32 v4, v1 offset:656
  s_waitcnt lgkmcnt(0)
  v_readfirstlane_b32 s46, v4
  s_nop 0
  s_sub_u32 s68, s46, s65
  s_cmp_lg_u32 s68, 2
  s_cbranch_scc1 L_qlazy_14
  s_mov_b32 exec_lo, 0xff
  s_mov_b32 exec_hi, 0xff
  buffer_store_dwordx4 v[80:83], v90, s[24:27], s64 offen sc1
  s_mov_b64 exec, -1
  s_mov_b32 s65, 1
L_qlazy_14:
  s_cmp_lg_u32 s3, 8
  s_cbranch_scc1 L_role
  s_mul_i32 s66, s4, 768
  s_add_u32 s66, s66, 1081344
  s_mov_b32 s70, 200007
  s_load_dwordx4 s[20:23], s[58:59], s66
  s_branch L_tkw0
L_tkchk:
  s_load_dwordx4 s[20:23], s[58:59], s66 glc
L_tkw0:
  s_waitcnt lgkmcnt(0)
  s_cmp_eq_u64 s[22:23], s[30:31]
  s_cbranch_scc1 L_tkok
  s_sleep 20
  s_sub_u32 s70, s70, 1
  s_cbranch_scc0 L_tkchk
L_tkok:
  v_mov_b32 v1, 0
  s_mov_b32 s70, 200007
L_spin_15:
  ds_read_b32 v4, v1 offset:648
  s_waitcnt lgkmcnt(0)
  v_cmp_gt_u32 vcc, 8, v4
  s_nop 0
  s_cbranch_vccz L_sdone_16
  s_sleep 1
  s_sub_u32 s70, s70, 1
  s_cbranch_scc0 L_spin_15
L_sdone_16:
  s_mov_b32 s20, 1
  s_atomic_add s20, s[58:59], s66 glc
  s_mov_b32 s21, 0
  s_mov_b64 exec, 1
  s_waitcnt lgkmcnt(0)
  s_and_b32 s20, s20, 31
  s_add_u32 s20, s20, 1
  s_add_u32 s20, s20, s21
  v_mov_b32 v5, s20
  ds_write_b32 v1, v5 offset:668
  s_mov_b64 exec, -1
  s_branch L_role
L_misc2:
  s_getreg_b32 s64, hwreg(HW_REG_XCC_ID)
  s_mov_b32 s24, s58
  s_mov_b32 s25, s59
  s_mov_b32 s26, 4194304
  s_mov_b32 s27, 0x20000
  s_add_u32 s32, s58, 4194304
  s_addc_u32 s33, s59, 0
  s_mov_b32 s34, 4194304
  s_mov_b32 s35, 0x20000
  s_lshl3_add_u32 s71, s6, s7
  s_lshr_b32 s79, s2, 3
  v_and_b32 v1, 31, v0
  v_lshlrev_b32 v1, 4, v1
  v_lshrrev_b32 v2, 5, v0
  v_lshl_add_u32 v1, v2, 13, v1
  s_lshl_b32 s66, s2, 9
  s_and_b32 s68, s66, 0xffffe000
  s_add_u32 s66, s66, s68
  s_add_u32 s66, s66, 131072
  v_mov_b32 v6, 0
  v_mov_b32 v7, 0
  s_cmp_ge_u32 s79, 4
  s_cbranch_scc1 L_nopr0
  s_mov_b32 exec_lo, 0xffff
  s_mov_b32 exec_hi, 0xffff
  buffer_store_dwordx4 v[4:7], v1, s[24:27], s66 offen sc1
  s_mov_b64 exec, -1
L_nopr0:
  s_waitcnt lgkmcnt(0)
  s_mul_i32 s30, s28, 0x2c9277b5
  s_add_u32 s30, s30, 0xac564b05
  s_mul_i32 s31, s29, 0x0019660d
  s_add_u32 s31, s31, 0x3c6ef35f
  s_and_b32 s64, s64, 15
  v_mov_b32 v4, s30
  v_mov_b32 v5, s31
  v_mov_b32 v6, s64
  v_mov_b32 v7, s64
  s_lshl_b32 s68, s4, 9
  s_add_u32 s68, s68, 1056768
  s_lshl_b32 s69, s79, 4
  v_mov_b32 v1, s69
  s_mov_b64 exec, 1
  buffer_store_dwordx4 v[4:7], v1, s[32:35], s68 offen
  s_mov_b64 exec, -1
  v_and_b32 v1, 31, v0
  v_lshlrev_b32 v1, 4, v1
  s_mov_b32 s70, 12
  s_mov_b32 s46, 2
L_idpoll:
  s_sleep 16
  buffer_load_dwordx4 v[8:11], v1, s[32:35], s68 offen sc1 nt
  s_waitcnt vmcnt(0)
  v_cmp_ne_u64 vcc, s[30:31], v[8:9]
  s_nop 0
  s_cbranch_vccz L_iddone
  s_sub_u32 s70, s70, 1
  s_cbranch_scc0 L_idpoll
  s_branch L_idset
L_iddone:
  v_cmp_ne_u32 vcc, s64, v10
  s_nop 0
  s_cbranch_vccnz L_idset
  s_mov_b32 s46, 1
L_idset:
  v_mov_b32 v1, 0
  v_mov_b32 v4, s46
  ds_write_b32 v1, v4 offset:656
  s_mov_b32 s60, -1
  s_mov_b32 s61, -1
  s_lshl_b32 s67, s4, 9
  s_add_u32 s67, s67, 1069056
  s_cmp_ge_u32 s79, 4
  s_cbranch_scc1 L_nopr1
  s_waitcnt lgkmcnt(0)
  s_add_u32 s69, s66, 0
  s_memtime s[62:63]
  s_waitcnt lgkmcnt(0)
  s_load_dword s65, s[58:59], s69
  s_waitcnt lgkmcnt(0)
  s_memtime s[20:21]
  s_waitcnt lgkmcnt(0)
  s_sub_u32 s62, s20, s62
  s_min_u32 s60, s60, s62
  s_add_u32 s69, s66, 8192
  s_memtime s[62:63]
  s_waitcnt lgkmcnt(0)
  s_load_dword s65, s[58:59], s69
  s_waitcnt lgkmcnt(0)
  s_memtime s[20:21]
  s_waitcnt lgkmcnt(0)
  s_sub_u32 s62, s20, s62
  s_min_u32 s61, s61, s62
  s_add_u32 s69, s66, 128
  s_memtime s[62:63]
  s_waitcnt lgkmcnt(0)
  s_load_dword s65, s[58:59], s69
  s_waitcnt lgkmcnt(0)
  s_memtime s[20:21]
  s_waitcnt lgkmcnt(0)
  s_sub_u32 s62, s20, s62
  s_min_u32 s60, s60, s62
  s_add_u32 s69, s66, 8320
  s_memtime s[62:63]
  s_waitcnt lgkmcnt(0)
  s_load_dword s65, s[58:59], s69
  s_waitcnt lgkmcnt(0)
  s_memtime s[20:21]
  s_waitcnt lgkmcnt(0)
  s_sub_u32 s62, s20, s62
  s_min_u32 s61, s61, s62
  s_lshl_b32 s69, s79, 4
  v_mov_b32 v1, s69
  v_mov_b32 v4, s60
  v_mov_b32 v5, s61
  v_mov_b32 v6, s30
  v_mov_b32 v7, s31
  s_mov_b64 exec, 1
  buffer_store_dwordx4 v[4:7], v1, s[32:35], s67 offen
  s_mov_b64 exec, -1
L_nopr1:
  v_and_b32 v1, 7, v0
  v_lshlrev_b32 v1, 4, v1
  s_mov_b32 s70, 200007
L_spin_17:
  ds_read_b128 v[4:7], v1 offset:512
  s_waitcnt lgkmcnt(0)
  v_cmp_eq_u32 vcc, 0, v7
  s_nop 0
  s_cbranch_vccz L_sdone_18
  s_sleep 4
  s_sub_u32 s70, s70, 1
  s_cbranch_scc0 L_spin_17
L_sdone_18:
  s_mov_b32 s68, 0x3fb8aa3b
  v_mov_b32 v2, v4
  s_nop 1
  v_max_f32_dpp v2, v2, v2 quad_perm:[1,0,3,2] row_mask:0xf bank_mask:0xf
  s_nop 1
  v_max_f32_dpp v2, v2, v2 quad_perm:[2,3,0,1] row_mask:0xf bank_mask:0xf
  s_nop 1
  v_max_f32_dpp v2, v2, v2 row_half_mirror row_mask:0xf bank_mask:0xf
  v_sub_f32 v4, v4, v2
  v_mul_f32 v4, s68, v4
  v_exp_f32 v4, v4
  s_nop 0
  v_mul_f32 v3, v4, v5
  s_nop 1
  v_add_f32_dpp v3, v3, v3 quad_perm:[1,0,3,2] row_mask:0xf bank_mask:0xf
  s_nop 1
  v_add_f32_dpp v3, v3, v3 quad_perm:[2,3,0,1] row_mask:0xf bank_mask:0xf
  s_nop 1
  v_add_f32_dpp v3, v3, v3 row_half_mirror row_mask:0xf bank_mask:0xf
  s_lshl_b32 s68, s71, 4
  s_add_u32 s68, s68, 1052672
  v_mov_b32 v4, s30
  v_mov_b32 v5, s31
  s_mov_b32 exec_lo, 0x1
  s_mov_b32 exec_hi, 0x0
  buffer_store_dwordx4 v[2:5], v1, s[32:35], s68 offen
  s_mov_b64 exec, -1
  s_cmp_lg_u32 s46, 1
  s_cbranch_scc1 L_slow_19
L_back_20:
  s_cmp_lg_u32 s46, 1
  s_cbranch_scc1 L_noshare
  v_and_b32 v8, 7, v0
  v_lshlrev_b32 v8, 4, v8
  buffer_load_dwordx4 v[4:7], v8, s[32:35], s67 offen sc1 nt
  s_waitcnt vmcnt(0)
  v_cmp_eq_u64 vcc, s[30:31], v[6:7]
  s_nop 1
  v_cndmask_b32 v4, -1, v4, vcc
  v_cndmask_b32 v5, -1, v5, vcc
  s_nop 0
  v_min_u32_dpp v4, v4, v4 quad_perm:[1,0,3,2] row_mask:0xf bank_mask:0xf
  v_min_u32_dpp v5, v5, v5 quad_perm:[1,0,3,2] row_mask:0xf bank_mask:0xf
  s_nop 0
  v_min_u32_dpp v4, v4, v4 quad_perm:[2,3,0,1] row_mask:0xf bank_mask:0xf
  v_min_u32_dpp v5, v5, v5 quad_perm:[2,3,0,1] row_mask:0xf bank_mask:0xf
  s_nop 0
  v_min_u32_dpp v4, v4, v4 row_half_mirror row_mask:0xf bank_mask:0xf
  v_min_u32_dpp v5, v5, v5 row_half_mirror row_mask:0xf bank_mask:0xf
  s_nop 0
  v_min_u32_dpp v4, v4, v4 row_mirror row_mask:0xf bank_mask:0xf
  v_min_u32_dpp v5, v5, v5 row_mirror row_mask:0xf bank_mask:0xf
  v_mov_b32 v6, v4
  v_mov_b32 v7, v5
  s_nop 0
  v_permlane16_swap_b32 v4, v6
  v_permlane16_swap_b32 v5, v7
  v_min_u32 v4, v4, v6
  v_min_u32 v5, v5, v7
  v_readfirstlane_b32 s62, v4
  v_readfirstlane_b32 s63, v5
  s_min_u32 s60, s60, s62
  s_min_u32 s61, s61, s63
L_noshare:
  s_cmp_lt_u32 s61, s60
  s_cselect_b32 s47, 8192, 0
  v_mov_b32 v8, 0
  v_mov_b32 v4, s47
  ds_write_b32 v8, v4 offset:664
  s_lshl_b32 s74, s6, 7
  s_add_u32 s74, s74, 1052672
  s_mov_b32 s16, s32
  s_mov_b32 s17, s33
  s_mov_b32 s18, 4194304
  s_mov_b32 s19, 0x20000
  s_mov_b32 s70, 200007
L_spin_21:
  s_sleep 16
  buffer_load_dwordx4 v[4:7], v1, s[16:19], s74 offen sc1 nt
  s_waitcnt vmcnt(0)
  v_cmp_ne_u64 vcc, s[30:31], v[6:7]
  s_nop 0
  s_cbranch_vccz L_sdone_22
  s_and_b32 s99, s70, 7
  s_cmp_eq_u32 s46, 1
  s_cselect_b32 s99, 1, s99
  s_cmp_lg_u32 s99, 0
  s_cselect_b32 s16, s32, s24
  s_cselect_b32 s17, s33, s25
  s_sub_u32 s70, s70, 1
  s_cbranch_scc0 L_spin_21
L_sdone_22:
  s_mov_b32 s68, 0x3fb8aa3b
  v_mov_b32 v2, v4
  s_nop 1
  v_max_f32_dpp v2, v2, v2 quad_perm:[1,0,3,2] row_mask:0xf bank_mask:0xf
  s_nop 1
  v_max_f32_dpp v2, v2, v2 quad_perm:[2,3,0,1] row_mask:0xf bank_mask:0xf
  s_nop 1
  v_max_f32_dpp v2, v2, v2 row_half_mirror row_mask:0xf bank_mask:0xf
  v_sub_f32 v4, v4, v2
  v_mul_f32 v4, s68, v4
  v_exp_f32 v4, v4
  s_nop 0
  v_mul_f32 v3, v4, v5
  s_nop 1
  v_add_f32_dpp v3, v3, v3 quad_perm:[1,0,3,2] row_mask:0xf bank_mask:0xf
  s_nop 1
  v_add_f32_dpp v3, v3, v3 quad_perm:[2,3,0,1] row_mask:0xf bank_mask:0xf
  s_nop 1
  v_add_f32_dpp v3, v3, v3 row_half_mirror row_mask:0xf bank_mask:0xf
  v_rcp_f32 v3, v3
  v_mov_b32 v4, 1
  v_mov_b32 v5, 1
  v_mov_b32 v1, 0
  ds_write_b128 v1, v[2:5] offset:672
L_role:
  v_mov_b32 v1, 0
  s_mov_b32 s70, 200007
L_spin_23:
  ds_read_b64 v[4:5], v1 offset:664
  s_waitcnt lgkmcnt(0)
  v_cmp_eq_u32 vcc, 0, v5
  s_nop 0
  s_cbranch_vccz L_sdone_24
  s_sleep 4
  s_sub_u32 s70, s70, 1
  s_cbranch_scc0 L_spin_23
L_sdone_24:
  v_readfirstlane_b32 s5, v5
  v_readfirstlane_b32 s47, v4
  s_lshr_b32 s28, s5, 8
  s_and_b32 s5, s5, 0xff
  s_sub_u32 s5, s5, 1
  s_cmp_lt_u32 s5, 20
  s_cbranch_scc0 L_tiles
  s_mov_b32 s12, s44
  s_mov_b32 s13, s45
  s_mov_b32 s14, 7864320
  s_mov_b32 s15, 0x20000
  v_lshrrev_b32 v24, 4, v0
  v_lshlrev_b32 v24, 10, v24
  v_bfe_u32 v25, v0, 2, 2
  v_lshl_add_u32 v24, v25, 7, v24
  v_and_b32 v25, 3, v0
  v_lshl_add_u32 v24, v25, 3, v24
  s_cmp_ge_u32 s5, 10
  s_cselect_b32 s76, 1, 0
  s_mul_i32 s77, s76, 10
  s_sub_u32 s77, s5, s77
  s_lshl1_add_u32 s78, s4, s76
  s_lshl2_add_u32 s78, s78, s73
  v_lshrrev_b32 v2, 3, v0
  v_mul_u32_u24 v26, 1280, v2
  v_and_b32 v3, 7, v0
  v_lshl_add_u32 v26, v3, 4, v26
  s_mul_i32 s60, s78, 122880
  s_lshl_b32 s69, s77, 7
  s_add_u32 s60, s60, s69
  s_mul_i32 s61, s73, 12288
  v_add_u32 v24, s61, v24
  s_add_u32 s61, s61, 8704
  v_lshlrev_b32 v60, 4, v0
  s_mul_i32 s74, s78, 3072
  s_add_u32 s74, s74, 1114112
  v_lshlrev_b32 v62, 2, v0
  s_lshl_b32 s68, s73, 8
  v_add_u32 v61, s68, v62
  s_mul_i32 s75, s4, 5120
  s_lshl_b32 s69, s5, 8
  s_add_u32 s75, s75, s69
  s_and_b32 s69, s75, 0xffffe000
  s_add_u32 s75, s75, s69
  s_add_u32 s75, s75, 0
  s_xor_b32 s62, s47, 8192
  s_add_u32 s62, s62, s75
  s_add_u32 s63, s47, s75
  s_mov_b32 s66, 0xff00ff00
  s_mov_b32 s67, 0xff00ff00
  v_mov_b32 v50, s30
  v_mov_b32 v51, s31
  v_cndmask_b32 v52, 0, v50, s[66:67]
  v_cndmask_b32 v53, 0, v51, s[66:67]
  v_cndmask_b32 v54, v50, 0, s[66:67]
  v_cndmask_b32 v55, v51, 0, s[66:67]
  buffer_load_dwordx4 v[8:11], v60, s[32:35], s74 offen offset:0 sc1 nt
  buffer_load_dwordx4 v[12:15], v60, s[32:35], s74 offen offset:1024 sc1 nt
  buffer_load_dwordx4 v[16:19], v60, s[32:35], s74 offen offset:2048 sc1 nt
  v_mov_b32 v1, 0
  s_mov_b32 s70, 200007
L_spin_25:
  ds_read_b32 v4, v1 offset:644
  s_waitcnt lgkmcnt(0)
  v_cmp_gt_u32 vcc, 8, v4
  s_nop 0
  s_cbranch_vccz L_sdone_26
  s_sleep 1
  s_sub_u32 s70, s70, 1
  s_cbranch_scc0 L_spin_25
L_sdone_26:
  s_mov_b32 m0, s61
  s_nop 0
  buffer_load_dwordx4 v26, s[12:15], s60 offen nt lds
  s_add_u32 s60, s60, 10240
  s_add_u32 s61, s61, 1024
  s_mov_b32 m0, s61
  s_nop 0
  buffer_load_dwordx4 v26, s[12:15], s60 offen nt lds
  s_add_u32 s60, s60, 10240
  s_add_u32 s61, s61, 1024
  s_mov_b32 m0, s61
  s_nop 0
  buffer_load_dwordx4 v26, s[12:15], s60 offen nt lds
  s_add_u32 s60, s60, 10240
  s_add_u32 s61, s61, 1024
  s_mov_b32 m0, s61
  s_nop 0
  buffer_load_dwordx4 v26, s[12:15], s60 offen nt lds
  s_add_u32 s60, s60, 10240
  s_add_u32 s61, s61, 1024
  s_mov_b32 m0, s61
  s_nop 0
  buffer_load_dwordx4 v26, s[12:15], s60 offen nt lds
  s_add_u32 s60, s60, 10240
  s_add_u32 s61, s61, 1024
  s_mov_b32 m0, s61
  s_nop 0
  buffer_load_dwordx4 v26, s[12:15], s60 offen nt lds
  s_add_u32 s60, s60, 10240
  s_add_u32 s61, s61, 1024
  s_mov_b32 m0, s61
  s_nop 0
  buffer_load_dwordx4 v26, s[12:15], s60 offen nt lds
  s_add_u32 s60, s60, 10240
  s_add_u32 s61, s61, 1024
  s_mov_b32 m0, s61
  s_nop 0
  buffer_load_dwordx4 v26, s[12:15], s60 offen nt lds
  s_add_u32 s60, s60, 10240
  s_add_u32 s61, s61, 1024
  v_mov_b32 v1, 0
  s_mov_b32 s70, 200007
L_spin_27:
  ds_read_b32 v4, v1 offset:660
  s_waitcnt lgkmcnt(0)
  v_cmp_gt_u32 vcc, 1, v4
  s_nop 0
  s_cbranch_vccz L_sdone_28
  s_sleep 1
  s_sub_u32 s70, s70, 1
  s_cbranch_scc0 L_spin_27
L_sdone_28:
  s_mov_b32 m0, s61
  s_nop 0
  buffer_load_dwordx4 v26, s[12:15], s60 offen nt lds
  s_add_u32 s60, s60, 10240
  s_add_u32 s61, s61, 1024
  s_mov_b32 m0, s61
  s_nop 0
  buffer_load_dwordx4 v26, s[12:15], s60 offen nt lds
  s_add_u32 s60, s60, 10240
  s_add_u32 s61, s61, 1024
  s_mov_b32 m0, s61
  s_nop 0
  buffer_load_dwordx4 v26, s[12:15], s60 offen nt lds
  s_add_u32 s60, s60, 10240
  s_add_u32 s61, s61, 1024
  s_mov_b32 m0, s61
  s_nop 0
  buffer_load_dwordx4 v26, s[12:15], s60 offen nt lds
L_wodone:
  s_cmp_eq_u32 s46, 1
  s_cselect_b32 s16, s32, s24
  s_cselect_b32 s17, s33, s25
  s_mov_b32 s18, 4194304
  s_mov_b32 s19, 0x20000
  s_mov_b32 s70, 200007
  s_waitcnt vmcnt(8)
  ds_read_b64_tr_b16 v[64:65], v24 offset:8704
  ds_read_b64_tr_b16 v[66:67], v24 offset:9216
  ds_read_b64_tr_b16 v[68:69], v24 offset:8736
  ds_read_b64_tr_b16 v[70:71], v24 offset:9248
  ds_read_b64_tr_b16 v[72:73], v24 offset:8768
  ds_read_b64_tr_b16 v[74:75], v24 offset:9280
  ds_read_b64_tr_b16 v[76:77], v24 offset:8800
  ds_read_b64_tr_b16 v[78:79], v24 offset:9312
  s_waitcnt vmcnt(4)
  ds_read_b64_tr_b16 v[80:81], v24 offset:12800
  ds_read_b64_tr_b16 v[82:83], v24 offset:13312
  ds_read_b64_tr_b16 v[84:85], v24 offset:12832
  ds_read_b64_tr_b16 v[86:87], v24 offset:13344
  ds_read_b64_tr_b16 v[88:89], v24 offset:12864
  ds_read_b64_tr_b16 v[90:91], v24 offset:13376
  ds_read_b64_tr_b16 v[92:93], v24 offset:12896
  ds_read_b64_tr_b16 v[94:95], v24 offset:13408
  s_waitcnt vmcnt(2)
  buffer_load_dwordx4 v[8:11], v60, s[32:35], s74 offen offset:0 sc1
  buffer_load_dwordx4 v[12:15], v60, s[32:35], s74 offen offset:1024 sc1
  buffer_load_dwordx4 v[16:19], v60, s[32:35], s74 offen offset:2048 sc1
  s_waitcnt vmcnt(3)
  ds_read_b64_tr_b16 v[96:97], v24 offset:16896
  ds_read_b64_tr_b16 v[98:99], v24 offset:17408
  ds_read_b64_tr_b16 v[100:101], v24 offset:16928
  ds_read_b64_tr_b16 v[102:103], v24 offset:17440
  ds_read_b64_tr_b16 v[104:105], v24 offset:16960
  ds_read_b64_tr_b16 v[106:107], v24 offset:17472
  ds_read_b64_tr_b16 v[108:109], v24 offset:16992
  ds_read_b64_tr_b16 v[110:111], v24 offset:17504
  s_waitcnt lgkmcnt(8)
L_opp:
  buffer_load_dwordx4 v[124:127], v60, s[16:19], s74 offen offset:0 sc1
  buffer_load_dwordx4 v[128:131], v60, s[16:19], s74 offen offset:1024 sc1
  buffer_load_dwordx4 v[132:135], v60, s[16:19], s74 offen offset:2048 sc1
  s_waitcnt vmcnt(5)
  v_xor_b32 v8, v8, v52
  v_xor_b32 v9, v9, v53
  v_xor_b32 v10, v10, v54
  v_xor_b32 v11, v11, v55
  s_nop 1
  v_mfma_f32_16x16x32_bf16 v[32:35], v[8:11], v[64:67], 0
  v_mfma_f32_16x16x32_bf16 v[36:39], v[8:11], v[68:71], 0
  v_mfma_f32_16x16x32_bf16 v[40:43], v[8:11], v[72:75], 0
  v_mfma_f32_16x16x32_bf16 v[44:47], v[8:11], v[76:79], 0
  v_or_b32 v2, v8, v9
  v_or_b32 v3, v10, v11
  s_waitcnt vmcnt(4)
  v_xor_b32 v12, v12, v52
  v_xor_b32 v13, v13, v53
  v_xor_b32 v14, v14, v54
  v_xor_b32 v15, v15, v55
  s_nop 1
  v_mfma_f32_16x16x32_bf16 v[32:35], v[12:15], v[80:83], v[32:35]
  v_mfma_f32_16x16x32_bf16 v[36:39], v[12:15], v[84:87], v[36:39]
  v_mfma_f32_16x16x32_bf16 v[40:43], v[12:15], v[88:91], v[40:43]
  v_mfma_f32_16x16x32_bf16 v[44:47], v[12:15], v[92:95], v[44:47]
  v_or3_b32 v2, v2, v12, v13
  v_or3_b32 v3, v3, v14, v15
  s_waitcnt vmcnt(3) lgkmcnt(0)
  v_xor_b32 v16, v16, v52
  v_xor_b32 v17, v17, v53
  v_xor_b32 v18, v18, v54
  v_xor_b32 v19, v19, v55
  s_nop 1
  v_mfma_f32_16x16x32_bf16 v[32:35], v[16:19], v[96:99], v[32:35]
  v_mfma_f32_16x16x32_bf16 v[36:39], v[16:19], v[100:103], v[36:39]
  v_mfma_f32_16x16x32_bf16 v[40:43], v[16:19], v[104:107], v[40:43]
  v_mfma_f32_16x16x32_bf16 v[44:47], v[16:19], v[108:111], v[44:47]
  v_or3_b32 v2, v2, v16, v17
  v_or3_b32 v3, v3, v18, v19
  v_cndmask_b32 v2, v3, v2, s[66:67]
  v_cmp_ne_u32 vcc, 0, v2
  s_nop 0
  s_cbranch_vccz L_opd
  buffer_load_dwordx4 v[8:11], v60, s[32:35], s74 offen offset:0 sc1
  buffer_load_dwordx4 v[12:15], v60, s[32:35], s74 offen offset:1024 sc1
  buffer_load_dwordx4 v[16:19], v60, s[32:35], s74 offen offset:2048 sc1
  s_waitcnt vmcnt(5)
  v_xor_b32 v124, v124, v52
  v_xor_b32 v125, v125, v53
  v_xor_b32 v126, v126, v54
  v_xor_b32 v127, v127, v55
  s_nop 1
  v_mfma_f32_16x16x32_bf16 v[32:35], v[124:127], v[64:67], 0
  v_mfma_f32_16x16x32_bf16 v[36:39], v[124:127], v[68:71], 0
  v_mfma_f32_16x16x32_bf16 v[40:43], v[124:127], v[72:75], 0
  v_mfma_f32_16x16x32_bf16 v[44:47], v[124:127], v[76:79], 0
  v_or_b32 v2, v124, v125
  v_or_b32 v3, v126, v127
  s_waitcnt vmcnt(4)
  v_xor_b32 v128, v128, v52
  v_xor_b32 v129, v129, v53
  v_xor_b32 v130, v130, v54
  v_xor_b32 v131, v131, v55
  s_nop 1
  v_mfma_f32_16x16x32_bf16 v[32:35], v[128:131], v[80:83], v[32:35]
  v_mfma_f32_16x16x32_bf16 v[36:39], v[128:131], v[84:87], v[36:39]
  v_mfma_f32_16x16x32_bf16 v[40:43], v[128:131], v[88:91], v[40:43]
  v_mfma_f32_16x16x32_bf16 v[44:47], v[128:131], v[92:95], v[44:47]
  v_or3_b32 v2, v2, v128, v129
  v_or3_b32 v3, v3, v130, v131
  s_waitcnt vmcnt(3) lgkmcnt(0)
  v_xor_b32 v132, v132, v52
  v_xor_b32 v133, v133, v53
  v_xor_b32 v134, v134, v54
  v_xor_b32 v135, v135, v55
  s_nop 1
  v_mfma_f32_16x16x32_bf16 v[32:35], v[132:135], v[96:99], v[32:35]
  v_mfma_f32_16x16x32_bf16 v[36:39], v[132:135], v[100:103], v[36:39]
  v_mfma_f32_16x16x32_bf16 v[40:43], v[132:135], v[104:107], v[40:43]
  v_mfma_f32_16x16x32_bf16 v[44:47], v[132:135], v[108:111], v[44:47]
  v_or3_b32 v2, v2, v132, v133
  v_or3_b32 v3, v3, v134, v135
  v_cndmask_b32 v2, v3, v2, s[66:67]
  v_cmp_ne_u32 vcc, 0, v2
  s_nop 0
  s_cbranch_vccz L_opd
  s_sub_u32 s70, s70, 1
  s_cbranch_scc0 L_opp
L_opd:
  v_add_f32 v4, v32, v33
  v_add_f32 v20, v34, v35
  v_add_f32 v5, v36, v37
  v_add_f32 v21, v38, v39
  v_add_f32 v6, v40, v41
  v_add_f32 v22, v42, v43
  v_add_f32 v7, v44, v45
  v_add_f32 v23, v46, v47
  v_add_f32 v4, v4, v20
  v_add_f32 v5, v5, v21
  v_add_f32 v6, v6, v22
  v_add_f32 v7, v7, v23
  s_nop 0
  v_permlane32_swap_b32 v4, v6
  v_permlane32_swap_b32 v5, v7
  v_add_f32 v4, v4, v6
  v_add_f32 v5, v5, v7
  s_nop 1
  v_permlane16_swap_b32 v4, v5
  v_add_f32 v4, v4, v5
  ds_write_b32 v61, v4 offset:7168
  s_cmp_lg_u32 s3, 8
  s_waitcnt lgkmcnt(0)
  s_barrier
  s_cbranch_scc1 L_end
  ds_read_b32 v5, v62 offset:7424
  ds_read_b32 v6, v62 offset:7680
  ds_read_b32 v7, v62 offset:7936
  s_waitcnt lgkmcnt(0)
  v_add_f32 v4, v4, v5
  v_add_f32 v6, v6, v7
  v_add_f32 v48, v4, v6
  s_nop 1
  v_mov_b32_dpp v49, v48 quad_perm:[1,0,3,2] row_mask:0xf bank_mask:0xf
  v_cvt_pk_bf16_f32 v48, v48, v49
  s_nop 1
  v_mov_b32_dpp v49, v48 quad_perm:[2,3,0,1] row_mask:0xf bank_mask:0xf
  s_mov_b32 exec_lo, 0x11111111
  s_mov_b32 exec_hi, 0x11111111
  buffer_store_dwordx4 v[48:51], v62, s[24:27], s62 offen sc1
  buffer_store_dwordx4 v[48:51], v62, s[24:27], s63 offen sc1
  s_barrier
  s_endpgm
L_tiles:
  s_mov_b32 s12, s48
  s_mov_b32 s13, s49
  s_mov_b32 s14, 1966080
  s_mov_b32 s15, 0x20000
  s_mov_b32 s16, s50
  s_mov_b32 s17, s51
  s_mov_b32 s18, 1966080
  s_mov_b32 s19, 0x20000
  s_sub_u32 s75, s5, 20
  s_lshr_b32 s78, s75, 2
  s_and_b32 s75, s75, 3
  s_mul_i32 s72, s75, 491520
  s_mul_i32 s68, s73, 24576
  s_add_u32 s72, s72, s68
  s_mul_i32 s68, s4, 3
  s_add_u32 s78, s78, s68
  s_lshl_b32 s68, s78, 7
  s_add_u32 s72, s72, s68
  s_lshl_b32 s61, s73, 10
  s_add_u32 s61, s61, 8704
  v_lshrrev_b32 v2, 3, v0
  v_and_b32 v3, 7, v0
  v_mul_u32_u24 v62, 3072, v2
  v_lshl_add_u32 v62, v3, 4, v62
  v_mov_b32 v1, 0
  s_mov_b32 s70, 200007
L_spin_29:
  ds_read_b32 v4, v1 offset:644
  s_waitcnt lgkmcnt(0)
  v_cmp_gt_u32 vcc, 8, v4
  s_nop 0
  s_cbranch_vccz L_sdone_30
  s_sleep 1
  s_sub_u32 s70, s70, 1
  s_cbranch_scc0 L_spin_29
L_sdone_30:
  s_add_u32 m0, s61, 0
  s_nop 0
  buffer_load_dwordx4 v62, s[12:15], s72 offen nt lds
  s_add_u32 m0, s61, 4096
  s_nop 0
  buffer_load_dwordx4 v62, s[16:19], s72 offen nt lds
  s_add_u32 s72, s72, 98304
  s_add_u32 m0, s61, 8192
  s_nop 0
  buffer_load_dwordx4 v62, s[12:15], s72 offen nt lds
  s_add_u32 m0, s61, 12288
  s_nop 0
  buffer_load_dwordx4 v62, s[16:19], s72 offen nt lds
  s_add_u32 s72, s72, 98304
  v_mov_b32 v1, 0
  s_mov_b32 s70, 200007
L_spin_31:
  ds_read_b32 v4, v1 offset:660
  s_waitcnt lgkmcnt(0)
  v_cmp_gt_u32 vcc, 1, v4
  s_nop 0
  s_cbranch_vccz L_sdone_32
  s_sleep 1
  s_sub_u32 s70, s70, 1
  s_cbranch_scc0 L_spin_31
L_sdone_32:
  s_add_u32 m0, s61, 16384
  s_nop 0
  buffer_load_dwordx4 v62, s[12:15], s72 offen nt lds
  s_add_u32 m0, s61, 20480
  s_nop 0
  buffer_load_dwordx4 v62, s[16:19], s72 offen nt lds
  s_add_u32 s72, s72, 98304
  s_add_u32 m0, s61, 24576
  s_nop 0
  buffer_load_dwordx4 v62, s[12:15], s72 offen nt lds
  s_add_u32 m0, s61, 28672
  s_nop 0
  buffer_load_dwordx4 v62, s[16:19], s72 offen nt lds
  s_add_u32 s72, s72, 98304
  s_add_u32 m0, s61, 32768
  s_nop 0
  buffer_load_dwordx4 v62, s[12:15], s72 offen nt lds
  s_add_u32 m0, s61, 36864
  s_nop 0
  buffer_load_dwordx4 v62, s[16:19], s72 offen nt lds
L_tdone:
  s_waitcnt vmcnt(0)
  s_barrier
  s_endpgm
L_f1:
  v_lshrrev_b32 v58, 4, v0
  v_lshlrev_b32 v58, 10, v58
  v_bfe_u32 v5, v0, 2, 2
  v_lshl_add_u32 v58, v5, 7, v58
  v_and_b32 v5, 3, v0
  v_lshl_add_u32 v58, v5, 3, v58
  s_sub_u32 s75, s5, 20
  s_lshr_b32 s78, s75, 2
  s_and_b32 s75, s75, 3
  s_mul_i32 s74, s75, 5
  s_add_u32 s74, s74, s3
  s_mul_i32 s68, s4, 3
  s_add_u32 s78, s78, s68
  s_lshl_b32 s68, s3, 5
  v_add_u32 v58, s68, v58
  v_lshrrev_b32 v3, 4, v0
  v_and_b32 v2, 7, v0
  v_lshl_add_u32 v50, v2, 2, v3
  v_lshlrev_b32 v50, 1, v50
  s_lshl_b32 s68, s74, 6
  v_add_u32 v61, s68, v50
  s_lshl_b32 s68, s3, 6
  v_add_u32 v51, s68, v50
  v_lshlrev_b32 v52, 4, v3
  v_lshlrev_b32 v54, 3, v0
  v_lshrrev_b32 v53, 3, v0
  v_mul_u32_u24 v53, 2560, v53
  v_lshl_add_u32 v53, v2, 4, v53
  s_lshl_b32 s68, s74, 7
  v_add_u32 v53, s68, v53
  v_add_u32 v59, 20480, v53
  s_add_u32 s60, s47, 0
  v_lshlrev_b32 v55, 4, v0
  v_mov_b32 v57, 0
  s_lshl2_add_u32 s76, s78, s3
  s_lshl2_add_u32 s76, s76, s75
  s_lshl_b32 s76, s76, 8
  s_add_u32 s76, s76, 2228224
  s_lshl3_add_u32 s68, s78, s75
  s_lshl_b32 s68, s68, 4
  s_add_u32 s68, s68, 2752512
  s_lshl2_add_u32 s69, s4, s75
  s_mul_i32 s69, s69, 640
  s_add_u32 s69, s69, 2785280
  v_add_u32 v63, s69, v55
  v_mov_b32 v4, s68
  s_mov_b32 s8, 0
  s_mov_b32 s9, 0x100
  v_cndmask_b32 v63, v63, v4, s[8:9]
  s_cmp_lt_u32 s5, 24
  s_cselect_b32 s62, -1, 0
  s_cselect_b32 s63, 0xff, 0
  s_or_b32 s63, s63, 0x100
  v_mov_b32 v14, s30
  v_mov_b32 v15, s31
  v_mov_b32 v44, 0x3f803f80
  v_mov_b32 v45, 0x3f803f80
  v_mov_b32 v46, 0x3f803f80
  v_mov_b32 v47, 0x3f803f80
  v_mov_b32 v8, 0
  v_mov_b32 v9, 0
  v_mov_b32 v10, 0
  v_mov_b32 v11, 0
  v_mov_b32 v112, 0x3f80
  v_mov_b32 v113, 0x3f800000
  v_and_b32 v4, 0xffffe000, v53
  v_add_u32 v53, v53, v4
  v_and_b32 v4, 0xffffe000, v59
  v_add_u32 v59, v59, v4
  global_load_ushort v56, v61, s[36:37]
  s_setprio 3
  s_barrier
  buffer_load_dwordx4 v[104:107], v53, s[24:27], s60 offen sc1
  buffer_load_dwordx4 v[108:111], v59, s[24:27], s60 offen sc1
  s_cmp_eq_u32 s3, 4
  s_cbranch_scc1 L_f1nob
  ds_read_b64_tr_b16 v[64:65], v58 offset:8704
  ds_read_b64_tr_b16 v[66:67], v58 offset:9216
  ds_read_b64_tr_b16 v[68:69], v58 offset:12800
  ds_read_b64_tr_b16 v[70:71], v58 offset:13312
  ds_read_b64_tr_b16 v[72:73], v58 offset:16896
  ds_read_b64_tr_b16 v[74:75], v58 offset:17408
  ds_read_b64_tr_b16 v[76:77], v58 offset:20992
  ds_read_b64_tr_b16 v[78:79], v58 offset:21504
  ds_read_b64_tr_b16 v[80:81], v58 offset:25088
  ds_read_b64_tr_b16 v[82:83], v58 offset:25600
  ds_read_b64_tr_b16 v[84:85], v58 offset:29184
  ds_read_b64_tr_b16 v[86:87], v58 offset:29696
  ds_read_b64_tr_b16 v[88:89], v58 offset:33280
  ds_read_b64_tr_b16 v[90:91], v58 offset:33792
  ds_read_b64_tr_b16 v[92:93], v58 offset:37376
  ds_read_b64_tr_b16 v[94:95], v58 offset:37888
  ds_read_b64_tr_b16 v[96:97], v58 offset:41472
  ds_read_b64_tr_b16 v[98:99], v58 offset:41984
  ds_read_b64_tr_b16 v[100:101], v58 offset:45568
  ds_read_b64_tr_b16 v[102:103], v58 offset:46080
  s_waitcnt lgkmcnt(0)
  v_mfma_f32_16x16x32_bf16 v[116:119], v[44:47], v[64:67], 0
  v_mfma_f32_16x16x32_bf16 v[124:127], v[44:47], v[68:71], 0
  v_mfma_f32_16x16x32_bf16 v[116:119], v[44:47], v[72:75], v[116:119]
  v_mfma_f32_16x16x32_bf16 v[124:127], v[44:47], v[76:79], v[124:127]
  v_mfma_f32_16x16x32_bf16 v[116:119], v[44:47], v[80:83], v[116:119]
  v_mfma_f32_16x16x32_bf16 v[124:127], v[44:47], v[84:87], v[124:127]
  v_mfma_f32_16x16x32_bf16 v[116:119], v[44:47], v[88:91], v[116:119]
  v_mfma_f32_16x16x32_bf16 v[124:127], v[44:47], v[92:95], v[124:127]
  v_mfma_f32_16x16x32_bf16 v[116:119], v[44:47], v[96:99], v[116:119]
  v_mfma_f32_16x16x32_bf16 v[124:127], v[44:47], v[100:103], v[124:127]
L_f1nob:
  s_waitcnt vmcnt(2)
  v_lshlrev_b32 v56, 16, v56
  s_mov_b32 s70, 200007
  s_branch L_ypw0
L_yppoll:
  buffer_load_dwordx4 v[104:107], v53, s[24:27], s60 offen sc1
  buffer_load_dwordx4 v[108:111], v59, s[24:27], s60 offen sc1
L_ypw0:
  s_waitcnt vmcnt(0)
  v_cmp_ne_u64 vcc, s[30:31], v[106:107]
  v_cmp_ne_u64 s[20:21], s[30:31], v[110:111]
  s_nop 0
  s_or_b64 vcc, vcc, s[20:21]
  s_nop 0
  s_cbranch_vccz L_ypok
  s_sub_u32 s70, s70, 1
  s_cbranch_scc0 L_yppoll
L_ypok:
  v_dot2c_f32_bf16 v8, v104, v112
  v_dot2c_f32_bf16 v10, v105, v112
  v_dot2c_f32_bf16 v9, v104, v113
  v_dot2c_f32_bf16 v11, v105, v113
  v_dot2c_f32_bf16 v8, v108, v112
  v_dot2c_f32_bf16 v10, v109, v112
  v_dot2c_f32_bf16 v9, v108, v113
  v_dot2c_f32_bf16 v11, v109, v113
  s_nop 0
  v_permlane32_swap_b32 v8, v10
  s_nop 0
  v_permlane32_swap_b32 v9, v11
  v_add_f32 v8, v8, v10
  v_add_f32 v9, v9, v11
  s_nop 1
  v_permlane16_swap_b32 v8, v9
  v_add_f32 v8, v8, v9
  s_nop 1
  v_add_f32_dpp v8, v8, v8 row_ror:8 row_mask:0xf bank_mask:0xf
  v_cvt_pk_bf16_f32 v8, v57, v8
  v_add_f32 v8, v8, v56
  v_cvt_pk_bf16_f32 v8, v8, v8
  ds_write_b16 v51, v8 offset:8192
  s_cmp_eq_u32 s3, 4
  s_waitcnt lgkmcnt(0)
  s_barrier
  ds_read_b128 v[24:27], v52 offset:8192
  ds_read_b128 v[28:31], v52 offset:8256
  ds_read_b128 v[32:35], v52 offset:8320
  ds_read_b128 v[36:39], v52 offset:8384
  ds_read_b128 v[40:43], v52 offset:8448
  s_cbranch_scc1 L_f1st
  s_waitcnt lgkmcnt(4)
  v_mfma_f32_16x16x32_bf16 v[16:19], v[24:27], v[64:67], 0
  v_mfma_f32_16x16x32_bf16 v[20:23], v[24:27], v[68:71], 0
  s_waitcnt lgkmcnt(3)
  v_mfma_f32_16x16x32_bf16 v[16:19], v[28:31], v[72:75], v[16:19]
  v_mfma_f32_16x16x32_bf16 v[20:23], v[28:31], v[76:79], v[20:23]
  s_waitcnt lgkmcnt(2)
  v_mfma_f32_16x16x32_bf16 v[16:19], v[32:35], v[80:83], v[16:19]
  v_mfma_f32_16x16x32_bf16 v[20:23], v[32:35], v[84:87], v[20:23]
  s_waitcnt lgkmcnt(1)
  v_mfma_f32_16x16x32_bf16 v[16:19], v[36:39], v[88:91], v[16:19]
  v_mfma_f32_16x16x32_bf16 v[20:23], v[36:39], v[92:95], v[20:23]
  s_waitcnt lgkmcnt(0)
  v_mfma_f32_16x16x32_bf16 v[16:19], v[40:43], v[96:99], v[16:19]
  v_mfma_f32_16x16x32_bf16 v[20:23], v[40:43], v[100:103], v[20:23]
  s_nop 6
  v_cvt_pk_bf16_f32 v12, v16, v116
  v_cvt_pk_bf16_f32 v13, v20, v124
  s_mov_b32 exec_lo, 0xffff
  s_mov_b32 exec_hi, 0x0
  buffer_store_dwordx4 v[12:15], v55, s[32:35], s76 offen
  s_mov_b64 exec, -1
  s_cmp_lg_u32 s46, 1
  s_cbranch_scc1 L_slow_33
L_back_34:
  s_endpgm
L_f1st:
  ds_read_b64 v[12:13], v54 offset:8192
  s_waitcnt lgkmcnt(5)
  v_mfma_f32_16x16x32_bf16 v[16:19], v[24:27], v[44:47], 0
  v_mfma_f32_16x16x32_bf16 v[20:23], v[24:27], v[24:27], 0
  s_waitcnt lgkmcnt(4)
  v_mfma_f32_16x16x32_bf16 v[16:19], v[28:31], v[44:47], v[16:19]
  v_mfma_f32_16x16x32_bf16 v[20:23], v[28:31], v[28:31], v[20:23]
  s_waitcnt lgkmcnt(3)
  v_mfma_f32_16x16x32_bf16 v[16:19], v[32:35], v[44:47], v[16:19]
  v_mfma_f32_16x16x32_bf16 v[20:23], v[32:35], v[32:35], v[20:23]
  s_waitcnt lgkmcnt(2)
  v_mfma_f32_16x16x32_bf16 v[16:19], v[36:39], v[44:47], v[16:19]
  v_mfma_f32_16x16x32_bf16 v[20:23], v[36:39], v[36:39], v[20:23]
  s_waitcnt lgkmcnt(1)
  v_mfma_f32_16x16x32_bf16 v[16:19], v[40:43], v[44:47], v[16:19]
  v_mfma_f32_16x16x32_bf16 v[20:23], v[40:43], v[40:43], v[20:23]
  s_waitcnt lgkmcnt(0)
  s_nop 5
  v_cndmask_b32 v12, v12, v16, s[8:9]
  v_cndmask_b32 v13, v13, v20, s[8:9]
  s_mov_b64 exec, s[62:63]
  buffer_store_dwordx4 v[12:15], v63, s[32:35], 0 offen
  s_mov_b64 exec, -1
  s_cmp_lg_u32 s46, 1
  s_cbranch_scc1 L_slow_35
L_back_36:
  s_endpgm
L_ffn:
  v_mov_b32 v57, 0
  s_mul_i32 s72, s4, 12
  s_add_u32 s72, s72, s5
  s_cmp_lt_u32 s3, 5
  s_cbranch_scc1 L_f2
  s_cmp_eq_u32 s3, 5
  s_cbranch_scc1 L_hid
  s_cmp_ge_u32 s5, 10
  s_cbranch_scc1 L_end
  s_mul_i32 s72, s4, 10
  s_add_u32 s72, s72, s5
  v_lshrrev_b32 v2, 1, v0
  v_mul_u32_u24 v2, 2560, v2
  v_and_b32 v3, 1, v0
  v_lshl_add_u32 v96, v3, 4, v2
  s_lshl_b32 s68, s72, 5
  v_add_u32 v96, s68, v96
  v_add_u32 v100, 81920, v96
  v_add_u32 v101, 163840, v96
  s_add_u32 s10, s47, 524288
  v_lshrrev_b32 v4, 4, v0
  v_lshl_add_u32 v97, v3, 2, v4
  v_lshlrev_b32 v97, 1, v97
  v_lshlrev_b32 v99, 4, v3
  v_and_b32 v98, 16, v0
  s_mul_i32 s13, s4, 2560
  s_lshl_b32 s68, s72, 5
  s_add_u32 s13, s13, s68
  s_add_u32 s13, s13, 2785280
  s_lshl_b32 s14, s72, 4
  s_mov_b32 s69, 0xffff0000
  v_and_b32 v4, 0xffffe000, v96
  v_add_u32 v96, v96, v4
  v_and_b32 v4, 0xffffe000, v100
  v_add_u32 v100, v100, v4
  v_and_b32 v4, 0xffffe000, v101
  v_add_u32 v101, v101, v4
  s_mov_b32 s64, s54
  s_mov_b32 s65, s55
  s_mov_b32 s66, 1280
  s_mov_b32 s67, 0x20000
  v_cmp_lt_u32 s[62:63], 31, v0
  s_setprio 3
  s_barrier
  s_barrier
  buffer_load_dwordx4 v[12:15], v99, s[32:35], s13 offen nt
  v_mov_b32 v8, 0
  v_mov_b32 v9, 0
  v_mov_b32 v10, 0
  v_mov_b32 v11, 0
  v_mov_b32 v112, 0x3f80
  v_mov_b32 v113, 0x3f800000
  s_barrier
  s_sleep 17
  s_mov_b32 s16, s32
  s_mov_b32 s17, s33
  s_mov_b32 s18, 4194304
  s_mov_b32 s19, 0x20000
  s_mov_b32 s70, 200007
L_spin_37:
  buffer_load_dwordx4 v[4:7], v99, s[16:19], s13 offen sc1
  buffer_load_dwordx4 v[16:19], v96, s[24:27], s10 offen sc1
  buffer_load_dwordx4 v[20:23], v100, s[24:27], s10 offen sc1
  buffer_load_dwordx4 v[24:27], v101, s[24:27], s10 offen sc1
  s_waitcnt vmcnt(0)
  v_cmp_ne_u64 vcc, s[30:31], v[6:7]
  v_cmp_ne_u64 s[20:21], s[30:31], v[18:19]
  v_cmp_ne_u64 s[22:23], s[30:31], v[22:23]
  s_or_b64 vcc, vcc, s[20:21]
  v_cmp_ne_u64 s[20:21], s[30:31], v[26:27]
  s_or_b64 vcc, vcc, s[22:23]
  s_or_b64 vcc, vcc, s[20:21]
  s_nop 0
  s_cbranch_vccz L_sdone_38
  s_and_b32 s99, s70, 7
  s_cmp_eq_u32 s46, 1
  s_cselect_b32 s99, 1, s99
  s_cmp_lg_u32 s99, 0
  s_cselect_b32 s16, s32, s24
  s_cselect_b32 s17, s33, s25
  s_sub_u32 s70, s70, 1
  s_cbranch_scc0 L_spin_37
L_sdone_38:
  v_dot2c_f32_bf16 v8, v16, v112
  v_dot2c_f32_bf16 v10, v17, v112
  v_dot2c_f32_bf16 v9, v16, v113
  v_dot2c_f32_bf16 v11, v17, v113
  v_dot2c_f32_bf16 v8, v20, v112
  v_dot2c_f32_bf16 v10, v21, v112
  v_dot2c_f32_bf16 v9, v20, v113
  v_dot2c_f32_bf16 v11, v21, v113
  v_dot2c_f32_bf16 v8, v24, v112
  v_dot2c_f32_bf16 v10, v25, v112
  v_dot2c_f32_bf16 v9, v24, v113
  v_dot2c_f32_bf16 v11, v25, v113
  v_cndmask_b32 v58, v4, v5, s[62:63]
  v_lshrrev_b32 v58, v98, v58
  v_permlane32_swap_b32 v8, v10
  v_permlane32_swap_b32 v9, v11
  v_add_f32 v8, v8, v10
  v_add_f32 v9, v9, v11
  v_lshlrev_b32 v58, 16, v58
  s_nop 0
  v_permlane16_swap_b32 v8, v9
  v_add_f32 v8, v8, v9
  s_nop 1
  v_add_f32_dpp v8, v8, v8 row_ror:8 row_mask:0xf bank_mask:0xf
  s_nop 1
  v_add_f32_dpp v8, v8, v8 row_ror:4 row_mask:0xf bank_mask:0xf
  s_nop 1
  v_add_f32_dpp v8, v8, v8 quad_perm:[2,3,0,1] row_mask:0xf bank_mask:0xf
  v_cvt_pk_bf16_f32 v8, v57, v8
  v_add_f32 v8, v8, v58
  v_cvt_pk_bf16_f32 v8, v8, v8
  s_mov_b32 exec_lo, 0x30003
  s_mov_b32 exec_hi, 0x30003
  buffer_store_short v8, v97, s[64:67], s14 offen
  s_cmp_lg_u32 s72, 0
  s_cbranch_scc1 L_fin_exit
  s_mov_b64 exec, 1
  v_mov_b32 v4, s30
  v_mov_b32 v5, s31
  s_mov_b32 s68, 1044480
  buffer_store_dwordx2 v[4:5], v57, s[24:27], s68 offen
L_fin_exit:
  s_endpgm
L_hid:
  v_and_b32 v62, 15, v0
  v_lshlrev_b32 v62, 1, v62
  v_lshlrev_b32 v60, 4, v0
  v_and_b32 v61, 48, v60
  s_lshr_b32 s68, s72, 2
  s_lshl_b32 s65, s68, 7
  s_add_u32 s65, s65, 2752512
  s_lshl_b32 s60, s72, 10
  s_add_u32 s60, s60, 2228224
  v_mov_b32 v59, 1
  v_mov_b32 v8, 0
  v_mov_b32 v9, 0
  s_cmp_eq_u32 s46, 1
  s_cselect_b32 s16, s32, s24
  s_cselect_b32 s17, s33, s25
  s_mov_b32 s18, 4194304
  s_mov_b32 s19, 0x20000
  s_mov_b32 s70, 200007
  s_setprio 3
  s_barrier
  s_barrier
  buffer_load_dwordx4 v[20:23], v61, s[32:35], s65 offen sc1 nt
  buffer_load_dwordx4 v[16:19], v60, s[32:35], s60 offen sc1 nt
L_pap:
  buffer_load_dwordx4 v[28:31], v61, s[16:19], s65 offen sc1
  buffer_load_dwordx4 v[24:27], v60, s[16:19], s60 offen sc1
  s_waitcnt vmcnt(2)
  v_cmp_ne_u64 vcc, s[30:31], v[18:19]
  v_cmp_ne_u64 s[20:21], s[30:31], v[22:23]
  s_nop 0
  s_or_b64 vcc, vcc, s[20:21]
  s_nop 0
  s_cbranch_vccz L_pad0
  buffer_load_dwordx4 v[20:23], v61, s[32:35], s65 offen sc1
  buffer_load_dwordx4 v[16:19], v60, s[32:35], s60 offen sc1
  s_waitcnt vmcnt(2)
  v_cmp_ne_u64 vcc, s[30:31], v[26:27]
  v_cmp_ne_u64 s[20:21], s[30:31], v[30:31]
  s_nop 0
  s_or_b64 vcc, vcc, s[20:21]
  s_nop 0
  s_cbranch_vccz L_pad1
  s_sub_u32 s70, s70, 1
  s_cbranch_scc0 L_pap
L_pad1:
  v_add_f32_dpp v4, v28, v28 quad_perm:[1,0,3,2] row_mask:0xf bank_mask:0xf
  v_add_f32_dpp v5, v29, v29 quad_perm:[1,0,3,2] row_mask:0xf bank_mask:0xf
  s_nop 0
  v_add_f32_dpp v4, v4, v4 quad_perm:[2,3,0,1] row_mask:0xf bank_mask:0xf
  v_add_f32_dpp v5, v5, v5 quad_perm:[2,3,0,1] row_mask:0xf bank_mask:0xf
  v_mul_f32 v6, 0xbacccccd, v4
  v_mul_f32 v5, 0x3acccccd, v5
  v_cvt_pk_bf16_f32 v4, 1.0, v6
  v_fma_f32 v5, -v6, v6, v5
  v_dot2c_f32_bf16 v8, v24, v4
  v_dot2c_f32_bf16 v9, v25, v4
  s_branch L_paj
L_pad0:
  v_add_f32_dpp v4, v20, v20 quad_perm:[1,0,3,2] row_mask:0xf bank_mask:0xf
  v_add_f32_dpp v5, v21, v21 quad_perm:[1,0,3,2] row_mask:0xf bank_mask:0xf
  s_nop 0
  v_add_f32_dpp v4, v4, v4 quad_perm:[2,3,0,1] row_mask:0xf bank_mask:0xf
  v_add_f32_dpp v5, v5, v5 quad_perm:[2,3,0,1] row_mask:0xf bank_mask:0xf
  v_mul_f32 v6, 0xbacccccd, v4
  v_mul_f32 v5, 0x3acccccd, v5
  v_cvt_pk_bf16_f32 v4, 1.0, v6
  v_fma_f32 v5, -v6, v6, v5
  v_dot2c_f32_bf16 v8, v16, v4
  v_dot2c_f32_bf16 v9, v17, v4
L_paj:
  v_max_f32 v5, 0, v5
  v_cvt_pk_bf16_f32 v5, v57, v5
  v_add_f32 v5, 0x3727c5ac, v5
  v_permlane32_swap_b32 v8, v9
  v_cvt_pk_bf16_f32 v5, v57, v5
  v_add_f32 v8, v8, v9
  v_sqrt_f32 v5, v5
  v_mov_b32 v10, v8
  v_cvt_pk_bf16_f32 v5, v57, v5
  v_rcp_f32 v5, v5
  v_permlane16_swap_b32 v8, v10
  v_add_f32 v8, v8, v10
  v_mul_f32 v8, v8, v5
  v_cvt_pk_bf16_f32 v8, v57, v8
  v_mul_f32 v12, 0xbfb8aa3b, v8
  v_mov_b32 v9, v8
  v_exp_f32 v12, v12
  s_nop 0
  v_permlane32_swap_b32 v8, v9
  v_add_f32 v12, 1.0, v12
  v_rcp_f32 v12, v12
  s_nop 0
  v_mul_f32 v8, v8, v12
  v_cvt_pk_bf16_f32 v8, v57, v8
  v_mul_f32 v8, v8, v9
  v_cvt_pk_bf16_f32 v8, v8, v8
  s_mov_b64 exec, 0xffff
  ds_write_b16 v62, v8 offset:896
  s_waitcnt lgkmcnt(0)
  s_barrier
  s_endpgm
L_f2:
  s_mov_b32 s8, s52
  s_mov_b32 s9, s53
  s_mov_b32 s10, 1966080
  s_mov_b32 s11, 0x20000
  s_lshl_b32 s68, s3, 8
  v_lshlrev_b32 v58, 2, v0
  v_add_u32 v58, s68, v58
  v_lshlrev_b32 v116, 1, v58
  s_mul_i32 s68, s72, 2560
  v_add_u32 v116, s68, v116
  s_xor_b32 s78, s47, 8192
  s_add_u32 s78, s78, 524288
  s_add_u32 s77, s47, 524288
  s_mov_b32 s60, 0x05040100
  s_mov_b32 s61, 0x07060302
  s_mul_i32 s62, s72, 20480
  v_and_b32 v4, 0xffffe000, v116
  v_add_u32 v116, v116, v4
  s_setprio 3
  s_barrier
  s_barrier
  buffer_load_dword v64, v58, s[8:11], s62 offen offset:0 nt
  buffer_load_dword v65, v58, s[8:11], s62 offen offset:1280 nt
  buffer_load_dword v66, v58, s[8:11], s62 offen offset:2560 nt
  s_add_u32 s62, s62, 3840
  buffer_load_dword v67, v58, s[8:11], s62 offen offset:0 nt
  buffer_load_dword v68, v58, s[8:11], s62 offen offset:1280 nt
  buffer_load_dword v69, v58, s[8:11], s62 offen offset:2560 nt
  s_add_u32 s62, s62, 3840
  buffer_load_dword v70, v58, s[8:11], s62 offen offset:0 nt
  buffer_load_dword v71, v58, s[8:11], s62 offen offset:1280 nt
  buffer_load_dword v72, v58, s[8:11], s62 offen offset:2560 nt
  s_add_u32 s62, s62, 3840
  buffer_load_dword v73, v58, s[8:11], s62 offen offset:0 nt
  buffer_load_dword v74, v58, s[8:11], s62 offen offset:1280 nt
  buffer_load_dword v75, v58, s[8:11], s62 offen offset:2560 nt
  s_add_u32 s62, s62, 3840
  buffer_load_dword v76, v58, s[8:11], s62 offen offset:0 nt
  buffer_load_dword v77, v58, s[8:11], s62 offen offset:1280 nt
  buffer_load_dword v78, v58, s[8:11], s62 offen offset:2560 nt
  s_add_u32 s62, s62, 3840
  buffer_load_dword v79, v58, s[8:11], s62 offen offset:0 nt
  s_waitcnt vmcnt(0)
  v_perm_b32 v80, v65, v64, s60
  v_perm_b32 v88, v65, v64, s61
  v_perm_b32 v81, v67, v66, s60
  v_perm_b32 v89, v67, v66, s61
  v_perm_b32 v82, v69, v68, s60
  v_perm_b32 v90, v69, v68, s61
  v_perm_b32 v83, v71, v70, s60
  v_perm_b32 v91, v71, v70, s61
  v_perm_b32 v84, v73, v72, s60
  v_perm_b32 v92, v73, v72, s61
  v_perm_b32 v85, v75, v74, s60
  v_perm_b32 v93, v75, v74, s61
  v_perm_b32 v86, v77, v76, s60
  v_perm_b32 v94, v77, v76, s61
  v_perm_b32 v87, v79, v78, s60
  v_perm_b32 v95, v79, v78, s61
  v_mov_b32 v16, 0
  v_mov_b32 v17, 0
  v_mov_b32 v6, s30
  v_mov_b32 v7, s31
  s_barrier
  ds_read_b128 v[8:11], v57 offset:896
  ds_read_b128 v[12:15], v57 offset:912
  s_waitcnt lgkmcnt(1)
  v_dot2c_f32_bf16 v16, v8, v80
  v_dot2c_f32_bf16 v17, v8, v88
  v_dot2c_f32_bf16 v16, v9, v81
  v_dot2c_f32_bf16 v17, v9, v89
  v_dot2c_f32_bf16 v16, v10, v82
  v_dot2c_f32_bf16 v17, v10, v90
  v_dot2c_f32_bf16 v16, v11, v83
  v_dot2c_f32_bf16 v17, v11, v91
  s_waitcnt lgkmcnt(0)
  v_dot2c_f32_bf16 v16, v12, v84
  v_dot2c_f32_bf16 v17, v12, v92
  v_dot2c_f32_bf16 v16, v13, v85
  v_dot2c_f32_bf16 v17, v13, v93
  v_dot2c_f32_bf16 v16, v14, v86
  v_dot2c_f32_bf16 v17, v14, v94
  v_dot2c_f32_bf16 v16, v15, v87
  v_dot2c_f32_bf16 v17, v15, v95
  s_nop 2
  v_cvt_pk_bf16_f32 v4, v16, v17
  s_nop 1
  v_mov_b32_dpp v5, v4 quad_perm:[1,0,3,2] row_mask:0xf bank_mask:0xf
  s_mov_b32 exec_lo, 0x55555555
  s_mov_b32 exec_hi, 0x55555555
  buffer_store_dwordx4 v[4:7], v116, s[24:27], s78 offen sc1
  buffer_store_dwordx4 v[4:7], v116, s[24:27], s77 offen sc1
L_end:
  s_endpgm
L_slow_5:
  s_mov_b32 exec_lo, 0xffffffff
  s_mov_b32 exec_hi, 0xffff
  buffer_store_dwordx4 v[4:7], v13, s[24:27], s74 offen sc1
  s_mov_b64 exec, -1
  s_nop 1
  s_branch L_back_6
L_slow_19:
  s_mov_b32 exec_lo, 0x1
  s_mov_b32 exec_hi, 0x0
  buffer_store_dwordx4 v[2:5], v1, s[24:27], s68 offen sc1
  s_mov_b64 exec, -1
  s_nop 1
  s_branch L_back_20
L_slow_33:
  s_mov_b32 exec_lo, 0xffff
  s_mov_b32 exec_hi, 0x0
  buffer_store_dwordx4 v[12:15], v55, s[24:27], s76 offen sc1
  s_mov_b64 exec, -1
  s_nop 1
  s_branch L_back_34
L_slow_35:
  s_mov_b64 exec, s[62:63]
  buffer_store_dwordx4 v[12:15], v63, s[24:27], 0 offen sc1
  s_mov_b64 exec, -1
  s_nop 1
  s_branch L_back_36
L_codeend:
.section .rodata,"a"
.p2align 6
.amdhsa_kernel sequential_preLN__sliding_block_cached__glu_gated_swiglu__decode_kernel
  .amdhsa_next_free_vgpr 168
  .amdhsa_next_free_sgpr 100
  .amdhsa_accum_offset 168
  .amdhsa_group_segment_fixed_size 0
  .amdhsa_kernarg_size 96
  .amdhsa_user_sgpr_count 2
  .amdhsa_user_sgpr_kernarg_segment_ptr 1
  .amdhsa_system_sgpr_workgroup_id_x 1
.end_amdhsa_kernel
```

```asm
; @launch grid=(256,1,1) block=(768,1,1) lds=57856
.amdgcn_target "amdgcn-amd-amdhsa--gfx950"
.text
.globl sequential_preLN__sliding_block_cached__glu_gated_swiglu__decode_kernel
.p2align 8
.type sequential_preLN__sliding_block_cached__glu_gated_swiglu__decode_kernel,@function
sequential_preLN__sliding_block_cached__glu_gated_swiglu__decode_kernel:
  s_cmp_ge_u32 s2, 256
  s_cbranch_scc1 L_end
  s_load_dwordx2 s[8:9], s[0:1], 8
  s_load_dwordx16 s[36:51], s[0:1], 0
  s_load_dwordx8 s[52:59], s[0:1], 64
  v_lshrrev_b32 v1, 6, v0
  v_and_b32 v0, 63, v0
  v_readfirstlane_b32 s3, v1
  s_and_b32 s4, s2, 7
  s_lshr_b32 s79, s2, 6
  s_lshl2_add_u32 s6, s4, s79
  s_bfe_u32 s7, s2, 0x30003
  s_cmp_lg_u32 s3, 0
  s_cbranch_scc1 L_nocpf
  s_getpc_b64 s[20:21]
L_pc0:
  s_mul_i32 s68, s7, 2048
  v_min_u32 v8, 15, v0
  v_lshl_add_u32 v8, v8, 7, s68
  v_min_u32 v8, L_codeend-L_pc0-4, v8
  global_load_dword v10, v8, s[20:21]
L_nocpf:
  v_lshrrev_b32 v2, 3, v0
  v_and_b32 v3, 7, v0
  v_lshlrev_b32 v3, 4, v3
  s_mov_b32 s11, 0x20000
  s_cmp_gt_u32 s3, 7
  s_cbranch_scc1 L_helper
  s_lshl3_add_u32 s68, s7, s3
  s_mul_i32 s60, s6, 4096
  s_add_u32 s60, s60, s68
  s_addk_i32 s60, 3584
  s_mul_i32 s60, s60, 3072
  v_mul_u32_u24 v2, 384, v2
  v_add_u32 v1, v2, v3
  s_mov_b32 s10, 402653184
  s_waitcnt lgkmcnt(0)
  buffer_load_dwordx4 v[16:19], v1, s[8:11], s60 offen offset:0 nt
  buffer_load_dwordx4 v[20:23], v1, s[8:11], s60 offen offset:128 nt
  buffer_load_dwordx4 v[24:27], v1, s[8:11], s60 offen offset:256 nt
  s_barrier
  s_branch L_stream
L_helper:
  v_lshlrev_b32 v1, 3, v0
  v_mov_b32 v4, 0
  v_mov_b32 v5, 0
  ds_write_b64 v1, v[4:5] offset:384
  s_sub_u32 s73, s3, 8
  s_cmp_eq_u32 s3, 11
  s_cbranch_scc1 L_misc
  s_mul_i32 s68, s7, 80
  v_add_u32 v7, s68, v2
  v_lshlrev_b32 v7, 1, v7
  v_mul_u32_u24 v2, 12288, v2
  v_add_u32 v2, v2, v3
  s_mul_i32 s68, s68, 12288
  s_mul_i32 s69, s6, 384
  s_add_u32 s68, s68, s69
  s_lshl_b32 s69, s73, 7
  s_add_u32 s68, s68, s69
  v_lshlrev_b32 v1, 2, v0
  s_setprio 3
  s_waitcnt lgkmcnt(0)
  s_barrier
  s_mov_b32 s8, s42
  s_mov_b32 s9, s43
  s_mov_b32 s10, 7864320
  global_load_dword v64, v1, s[36:37] offset:0
  global_load_dword v65, v1, s[36:37] offset:256
  global_load_dword v66, v1, s[36:37] offset:512
  global_load_dword v67, v1, s[36:37] offset:768
  global_load_dword v68, v1, s[36:37] offset:1024
  global_load_ushort v8, v7, s[36:37] offset:0
  global_load_ushort v9, v7, s[36:37] offset:16
  global_load_ushort v10, v7, s[36:37] offset:32
  global_load_ushort v11, v7, s[36:37] offset:48
  global_load_ushort v12, v7, s[36:37] offset:64
  global_load_ushort v13, v7, s[36:37] offset:80
  global_load_ushort v14, v7, s[36:37] offset:96
  global_load_ushort v15, v7, s[36:37] offset:112
  global_load_ushort v16, v7, s[36:37] offset:128
  global_load_ushort v17, v7, s[36:37] offset:144
  buffer_load_dwordx4 v[24:27], v2, s[8:11], s68 offen nt
  s_add_u32 s68, s68, 98304
  buffer_load_dwordx4 v[28:31], v2, s[8:11], s68 offen nt
  s_add_u32 s68, s68, 98304
  buffer_load_dwordx4 v[32:35], v2, s[8:11], s68 offen nt
  s_add_u32 s68, s68, 98304
  buffer_load_dwordx4 v[36:39], v2, s[8:11], s68 offen nt
  s_add_u32 s68, s68, 98304
  buffer_load_dwordx4 v[40:43], v2, s[8:11], s68 offen nt
  s_add_u32 s68, s68, 98304
  buffer_load_dwordx4 v[44:47], v2, s[8:11], s68 offen nt
  s_add_u32 s68, s68, 98304
  buffer_load_dwordx4 v[48:51], v2, s[8:11], s68 offen nt
  s_add_u32 s68, s68, 98304
  buffer_load_dwordx4 v[52:55], v2, s[8:11], s68 offen nt
  s_add_u32 s68, s68, 98304
  buffer_load_dwordx4 v[56:59], v2, s[8:11], s68 offen nt
  s_add_u32 s68, s68, 98304
  buffer_load_dwordx4 v[60:63], v2, s[8:11], s68 offen nt
  s_load_dwordx2 s[28:29], s[58:59], 1044480
  s_branch L_q2
L_misc:
  s_setprio 3
  s_waitcnt lgkmcnt(0)
  s_barrier
  s_load_dwordx2 s[28:29], s[58:59], 1044480
  s_branch L_misc2
L_stream:
  s_add_u32 s61, s60, 196608
  s_waitcnt vmcnt(2)
  buffer_load_dwordx4 v[28:31], v1, s[8:11], s61 offen offset:0 nt
  s_load_dwordx2 s[28:29], s[58:59], 1044480
  s_mov_b32 s24, s58
  s_mov_b32 s25, s59
  s_mov_b32 s26, 4194304
  s_mov_b32 s27, 0x20000
  s_add_u32 s32, s58, 4194304
  s_addc_u32 s33, s59, 0
  s_mov_b32 s34, 4194304
  s_mov_b32 s35, 0x20000
  s_lshl3_add_u32 s71, s6, s7
  s_lshr_b32 s79, s2, 3
  s_mov_b32 s12, s40
  s_mov_b32 s13, s41
  s_mov_b32 s14, 402653184
  s_mov_b32 s15, 0x20000
  s_waitcnt vmcnt(2)
  buffer_load_dwordx4 v[32:35], v1, s[8:11], s61 offen offset:128 nt
  s_waitcnt vmcnt(2)
  buffer_load_dwordx4 v[36:39], v1, s[8:11], s61 offen offset:256 nt
  s_add_u32 s62, s61, 196608
  s_waitcnt vmcnt(2)
  buffer_load_dwordx4 v[40:43], v1, s[8:11], s62 offen offset:0 nt
  s_waitcnt vmcnt(2)
  buffer_load_dwordx4 v[44:47], v1, s[8:11], s62 offen offset:128 nt
  s_waitcnt vmcnt(2)
  buffer_load_dwordx4 v[48:51], v1, s[8:11], s62 offen offset:256 nt
  s_add_u32 s63, s62, 196608
  s_waitcnt vmcnt(2)
  buffer_load_dwordx4 v[52:55], v1, s[8:11], s63 offen offset:0 nt
  s_waitcnt vmcnt(2)
  buffer_load_dwordx4 v[56:59], v1, s[8:11], s63 offen offset:128 nt
  s_waitcnt vmcnt(2)
  buffer_load_dwordx4 v[60:63], v1, s[8:11], s63 offen offset:256 nt
  s_add_u32 s64, s63, 196608
  s_waitcnt vmcnt(2)
  buffer_load_dwordx4 v[64:67], v1, s[8:11], s64 offen offset:0 nt
  s_waitcnt vmcnt(2)
  buffer_load_dwordx4 v[68:71], v1, s[8:11], s64 offen offset:128 nt
  s_waitcnt vmcnt(2)
  buffer_load_dwordx4 v[72:75], v1, s[8:11], s64 offen offset:256 nt
  s_add_u32 s65, s64, 196608
  s_waitcnt vmcnt(2)
  buffer_load_dwordx4 v[76:79], v1, s[8:11], s65 offen offset:0 nt
  s_waitcnt vmcnt(2)
  buffer_load_dwordx4 v[80:83], v1, s[8:11], s65 offen offset:128 nt
  s_waitcnt vmcnt(2)
  buffer_load_dwordx4 v[84:87], v1, s[8:11], s65 offen offset:256 nt
  s_add_u32 s66, s65, 196608
  s_waitcnt vmcnt(2)
  buffer_load_dwordx4 v[88:91], v1, s[8:11], s66 offen offset:0 nt
  s_waitcnt vmcnt(2)
  buffer_load_dwordx4 v[92:95], v1, s[8:11], s66 offen offset:128 nt
  s_waitcnt vmcnt(2)
  buffer_load_dwordx4 v[96:99], v1, s[8:11], s66 offen offset:256 nt
  s_add_u32 s67, s66, 196608
  s_waitcnt vmcnt(2)
  buffer_load_dwordx4 v[100:103], v1, s[8:11], s67 offen offset:0 nt
  s_waitcnt vmcnt(2)
  buffer_load_dwordx4 v[104:107], v1, s[8:11], s67 offen offset:128 nt
  s_waitcnt vmcnt(2)
  buffer_load_dwordx4 v[108:111], v1, s[8:11], s67 offen offset:256 nt
  s_waitcnt vmcnt(2)
  buffer_load_dwordx4 v[112:115], v1, s[12:15], s60 offen offset:0 nt
  s_waitcnt vmcnt(2)
  buffer_load_dwordx4 v[116:119], v1, s[12:15], s60 offen offset:128 nt
  s_waitcnt vmcnt(2)
  buffer_load_dwordx4 v[120:123], v1, s[12:15], s60 offen offset:256 nt
  s_waitcnt lgkmcnt(0)
  s_mul_i32 s30, s28, 0x2c9277b5
  s_add_u32 s30, s30, 0xac564b05
  s_mul_i32 s31, s29, 0x0019660d
  s_add_u32 s31, s31, 0x3c6ef35f
  v_and_b32 v2, 3, v0
  v_min_u32 v2, 2, v2
  v_lshlrev_b32 v2, 3, v2
  s_mov_b32 s70, 200007
L_spin_1:
  ds_read_b32 v4, v2 offset:384
  s_waitcnt lgkmcnt(0)
  v_cmp_eq_u32 vcc, 0, v4
  s_nop 0
  s_cbranch_vccz L_sdone_2
  s_sleep 1
  s_sub_u32 s70, s70, 1
  s_cbranch_scc0 L_spin_1
L_sdone_2:
  ds_read_b128 v[4:7], v3 offset:0
  ds_read_b128 v[8:11], v3 offset:128
  ds_read_b128 v[12:15], v3 offset:256
  v_mov_b32 v160, 0
  v_mov_b32 v161, 0
  v_mov_b32 v162, 0
  v_mov_b32 v163, 0
  v_mov_b32 v164, 0
  v_mov_b32 v165, 0
  v_mov_b32 v166, 0
  v_mov_b32 v167, 0
  s_waitcnt vmcnt(3) lgkmcnt(0)
  v_dot2c_f32_bf16 v160, v16, v4
  v_dot2c_f32_bf16 v161, v28, v4
  v_dot2c_f32_bf16 v162, v40, v4
  v_dot2c_f32_bf16 v163, v52, v4
  v_dot2c_f32_bf16 v160, v17, v5
  v_dot2c_f32_bf16 v161, v29, v5
  v_dot2c_f32_bf16 v162, v41, v5
  v_dot2c_f32_bf16 v163, v53, v5
  v_dot2c_f32_bf16 v160, v18, v6
  v_dot2c_f32_bf16 v161, v30, v6
  v_dot2c_f32_bf16 v162, v42, v6
  v_dot2c_f32_bf16 v163, v54, v6
  v_dot2c_f32_bf16 v160, v19, v7
  v_dot2c_f32_bf16 v161, v31, v7
  v_dot2c_f32_bf16 v162, v43, v7
  v_dot2c_f32_bf16 v163, v55, v7
  v_dot2c_f32_bf16 v160, v20, v8
  v_dot2c_f32_bf16 v161, v32, v8
  v_dot2c_f32_bf16 v162, v44, v8
  v_dot2c_f32_bf16 v163, v56, v8
  v_dot2c_f32_bf16 v160, v21, v9
  v_dot2c_f32_bf16 v161, v33, v9
  v_dot2c_f32_bf16 v162, v45, v9
  v_dot2c_f32_bf16 v163, v57, v9
  v_dot2c_f32_bf16 v160, v22, v10
  v_dot2c_f32_bf16 v161, v34, v10
  v_dot2c_f32_bf16 v162, v46, v10
  v_dot2c_f32_bf16 v163, v58, v10
  v_dot2c_f32_bf16 v160, v23, v11
  v_dot2c_f32_bf16 v161, v35, v11
  v_dot2c_f32_bf16 v162, v47, v11
  v_dot2c_f32_bf16 v163, v59, v11
  v_dot2c_f32_bf16 v160, v24, v12
  v_dot2c_f32_bf16 v161, v36, v12
  v_dot2c_f32_bf16 v162, v48, v12
  v_dot2c_f32_bf16 v163, v60, v12
  v_dot2c_f32_bf16 v160, v25, v13
  v_dot2c_f32_bf16 v161, v37, v13
  v_dot2c_f32_bf16 v162, v49, v13
  v_dot2c_f32_bf16 v163, v61, v13
  v_dot2c_f32_bf16 v160, v26, v14
  v_dot2c_f32_bf16 v161, v38, v14
  v_dot2c_f32_bf16 v162, v50, v14
  v_dot2c_f32_bf16 v163, v62, v14
  v_dot2c_f32_bf16 v160, v27, v15
  v_dot2c_f32_bf16 v161, v39, v15
  v_dot2c_f32_bf16 v162, v51, v15
  v_dot2c_f32_bf16 v163, v63, v15
  v_dot2c_f32_bf16 v164, v64, v4
  v_dot2c_f32_bf16 v165, v76, v4
  v_dot2c_f32_bf16 v166, v88, v4
  v_dot2c_f32_bf16 v167, v100, v4
  v_dot2c_f32_bf16 v164, v65, v5
  v_dot2c_f32_bf16 v165, v77, v5
  v_dot2c_f32_bf16 v166, v89, v5
  v_dot2c_f32_bf16 v167, v101, v5
  v_dot2c_f32_bf16 v164, v66, v6
  v_dot2c_f32_bf16 v165, v78, v6
  v_dot2c_f32_bf16 v166, v90, v6
  v_dot2c_f32_bf16 v167, v102, v6
  v_dot2c_f32_bf16 v164, v67, v7
  v_dot2c_f32_bf16 v165, v79, v7
  v_dot2c_f32_bf16 v166, v91, v7
  v_dot2c_f32_bf16 v167, v103, v7
  v_dot2c_f32_bf16 v164, v68, v8
  v_dot2c_f32_bf16 v165, v80, v8
  v_dot2c_f32_bf16 v166, v92, v8
  v_dot2c_f32_bf16 v167, v104, v8
  v_dot2c_f32_bf16 v164, v69, v9
  v_dot2c_f32_bf16 v165, v81, v9
  v_dot2c_f32_bf16 v166, v93, v9
  v_dot2c_f32_bf16 v167, v105, v9
  v_dot2c_f32_bf16 v164, v70, v10
  v_dot2c_f32_bf16 v165, v82, v10
  v_dot2c_f32_bf16 v166, v94, v10
  v_dot2c_f32_bf16 v167, v106, v10
  v_dot2c_f32_bf16 v164, v71, v11
  v_dot2c_f32_bf16 v165, v83, v11
  v_dot2c_f32_bf16 v166, v95, v11
  v_dot2c_f32_bf16 v167, v107, v11
  v_dot2c_f32_bf16 v164, v72, v12
  v_dot2c_f32_bf16 v165, v84, v12
  v_dot2c_f32_bf16 v166, v96, v12
  v_dot2c_f32_bf16 v167, v108, v12
  v_dot2c_f32_bf16 v164, v73, v13
  v_dot2c_f32_bf16 v165, v85, v13
  v_dot2c_f32_bf16 v166, v97, v13
  v_dot2c_f32_bf16 v167, v109, v13
  v_dot2c_f32_bf16 v164, v74, v14
  v_dot2c_f32_bf16 v165, v86, v14
  v_dot2c_f32_bf16 v166, v98, v14
  v_dot2c_f32_bf16 v167, v110, v14
  v_dot2c_f32_bf16 v164, v75, v15
  v_dot2c_f32_bf16 v165, v87, v15
  v_dot2c_f32_bf16 v166, v99, v15
  v_dot2c_f32_bf16 v167, v111, v15
  v_add_f32_dpp v160, v160, v160 quad_perm:[1,0,3,2] row_mask:0xf bank_mask:0xf
  v_add_f32_dpp v161, v161, v161 quad_perm:[1,0,3,2] row_mask:0xf bank_mask:0xf
  v_add_f32_dpp v162, v162, v162 quad_perm:[1,0,3,2] row_mask:0xf bank_mask:0xf
  v_add_f32_dpp v163, v163, v163 quad_perm:[1,0,3,2] row_mask:0xf bank_mask:0xf
  v_add_f32_dpp v164, v164, v164 quad_perm:[1,0,3,2] row_mask:0xf bank_mask:0xf
  v_add_f32_dpp v165, v165, v165 quad_perm:[1,0,3,2] row_mask:0xf bank_mask:0xf
  v_add_f32_dpp v166, v166, v166 quad_perm:[1,0,3,2] row_mask:0xf bank_mask:0xf
  v_add_f32_dpp v167, v167, v167 quad_perm:[1,0,3,2] row_mask:0xf bank_mask:0xf
  v_add_f32_dpp v160, v160, v160 quad_perm:[2,3,0,1] row_mask:0xf bank_mask:0xf
  v_add_f32_dpp v161, v161, v161 quad_perm:[2,3,0,1] row_mask:0xf bank_mask:0xf
  v_add_f32_dpp v162, v162, v162 quad_perm:[2,3,0,1] row_mask:0xf bank_mask:0xf
  v_add_f32_dpp v163, v163, v163 quad_perm:[2,3,0,1] row_mask:0xf bank_mask:0xf
  v_add_f32_dpp v164, v164, v164 quad_perm:[2,3,0,1] row_mask:0xf bank_mask:0xf
  v_add_f32_dpp v165, v165, v165 quad_perm:[2,3,0,1] row_mask:0xf bank_mask:0xf
  v_add_f32_dpp v166, v166, v166 quad_perm:[2,3,0,1] row_mask:0xf bank_mask:0xf
  v_add_f32_dpp v167, v167, v167 quad_perm:[2,3,0,1] row_mask:0xf bank_mask:0xf
  v_add_f32_dpp v160, v160, v160 row_half_mirror row_mask:0xf bank_mask:0xf
  v_add_f32_dpp v161, v161, v161 row_half_mirror row_mask:0xf bank_mask:0xf
  v_add_f32_dpp v162, v162, v162 row_half_mirror row_mask:0xf bank_mask:0xf
  v_add_f32_dpp v163, v163, v163 row_half_mirror row_mask:0xf bank_mask:0xf
  v_add_f32_dpp v164, v164, v164 row_half_mirror row_mask:0xf bank_mask:0xf
  v_add_f32_dpp v165, v165, v165 row_half_mirror row_mask:0xf bank_mask:0xf
  v_add_f32_dpp v166, v166, v166 row_half_mirror row_mask:0xf bank_mask:0xf
  v_add_f32_dpp v167, v167, v167 row_half_mirror row_mask:0xf bank_mask:0xf
  s_mov_b32 s68, 0x3d93cd3a
  v_mov_b32 v2, 0
  v_cvt_pk_bf16_f32 v160, v2, v160
  v_cvt_pk_bf16_f32 v161, v2, v161
  v_cvt_pk_bf16_f32 v162, v2, v162
  v_cvt_pk_bf16_f32 v163, v2, v163
  v_cvt_pk_bf16_f32 v164, v2, v164
  v_cvt_pk_bf16_f32 v165, v2, v165
  v_cvt_pk_bf16_f32 v166, v2, v166
  v_cvt_pk_bf16_f32 v167, v2, v167
  v_mul_f32 v160, s68, v160
  v_mul_f32 v161, s68, v161
  v_mul_f32 v162, s68, v162
  v_mul_f32 v163, s68, v163
  v_mul_f32 v164, s68, v164
  v_mul_f32 v165, s68, v165
  v_mul_f32 v166, s68, v166
  v_mul_f32 v167, s68, v167
  v_cvt_pk_bf16_f32 v160, v2, v160
  v_cvt_pk_bf16_f32 v161, v2, v161
  v_cvt_pk_bf16_f32 v162, v2, v162
  v_cvt_pk_bf16_f32 v163, v2, v163
  v_cvt_pk_bf16_f32 v164, v2, v164
  v_cvt_pk_bf16_f32 v165, v2, v165
  v_cvt_pk_bf16_f32 v166, v2, v166
  v_cvt_pk_bf16_f32 v167, v2, v167
  v_max_f32 v4, v160, v161
  v_max3_f32 v4, v4, v162, v163
  v_max3_f32 v4, v4, v164, v165
  v_max3_f32 v4, v4, v166, v167
  s_nop 1
  v_max_f32_dpp v4, v4, v4 row_ror:8 row_mask:0xf bank_mask:0xf
  v_mov_b32 v88, v4
  s_nop 1
  v_permlane16_swap_b32 v4, v88
  v_max_f32 v4, v4, v88
  v_mov_b32 v88, v4
  s_nop 1
  v_permlane32_swap_b32 v4, v88
  v_max_f32 v4, v4, v88
  s_mov_b32 s68, 0x3fb8aa3b
  v_sub_f32 v160, v160, v4
  v_sub_f32 v161, v161, v4
  v_sub_f32 v162, v162, v4
  v_sub_f32 v163, v163, v4
  v_sub_f32 v164, v164, v4
  v_sub_f32 v165, v165, v4
  v_sub_f32 v166, v166, v4
  v_sub_f32 v167, v167, v4
  v_mul_f32 v160, s68, v160
  v_mul_f32 v161, s68, v161
  v_mul_f32 v162, s68, v162
  v_mul_f32 v163, s68, v163
  v_mul_f32 v164, s68, v164
  v_mul_f32 v165, s68, v165
  v_mul_f32 v166, s68, v166
  v_mul_f32 v167, s68, v167
  v_exp_f32 v160, v160
  v_exp_f32 v161, v161
  v_exp_f32 v162, v162
  v_exp_f32 v163, v163
  v_exp_f32 v164, v164
  v_exp_f32 v165, v165
  v_exp_f32 v166, v166
  v_exp_f32 v167, v167
  v_add_f32 v5, v160, v161
  v_add_f32 v5, v5, v162
  v_add_f32 v5, v5, v163
  v_add_f32 v5, v5, v164
  v_add_f32 v5, v5, v165
  v_add_f32 v5, v5, v166
  v_add_f32 v5, v5, v167
  s_nop 1
  v_add_f32_dpp v5, v5, v5 row_ror:8 row_mask:0xf bank_mask:0xf
  v_mov_b32 v88, v5
  s_nop 1
  v_permlane16_swap_b32 v5, v88
  v_add_f32 v5, v5, v88
  v_mov_b32 v88, v5
  s_nop 1
  v_permlane32_swap_b32 v5, v88
  v_add_f32 v5, v5, v88
  s_lshl_b32 s69, s3, 4
  v_mov_b32 v88, s69
  v_mov_b32 v6, 1
  v_mov_b32 v7, 1
  ds_write_b128 v88, v[4:7] offset:512
  v_cvt_pk_bf16_f32 v160, v160, v2
  v_cvt_pk_bf16_f32 v161, v161, v2
  v_cvt_pk_bf16_f32 v162, v162, v2
  v_cvt_pk_bf16_f32 v163, v163, v2
  v_cvt_pk_bf16_f32 v164, v164, v2
  v_cvt_pk_bf16_f32 v165, v165, v2
  v_cvt_pk_bf16_f32 v166, v166, v2
  v_cvt_pk_bf16_f32 v167, v167, v2
  v_mov_b32 v88, 0
  v_mov_b32 v89, 0
  v_mov_b32 v90, 0
  v_mov_b32 v91, 0
  v_mov_b32 v92, 0
  v_mov_b32 v93, 0
  v_mov_b32 v94, 0
  v_mov_b32 v95, 0
  v_mov_b32 v96, 0
  v_mov_b32 v97, 0
  v_mov_b32 v98, 0
  v_mov_b32 v99, 0
  v_mov_b32 v100, 0
  v_mov_b32 v101, 0
  v_mov_b32 v102, 0
  v_mov_b32 v103, 0
  v_mov_b32 v104, 0
  v_mov_b32 v105, 0
  v_mov_b32 v106, 0
  v_mov_b32 v107, 0
  v_mov_b32 v108, 0
  v_mov_b32 v109, 0
  v_mov_b32 v110, 0
  v_mov_b32 v111, 0
  v_and_b32 v8, 7, v0
  v_lshlrev_b32 v8, 5, v8
  v_lshrrev_b32 v9, 4, v0
  v_lshl_add_u32 v8, v9, 3, v8
  s_mul_i32 s69, s3, 768
  v_add_u32 v8, s69, v8
  v_mov_b32 v11, 1
  s_waitcnt vmcnt(2)
  buffer_load_dwordx4 v[124:127], v1, s[12:15], s61 offen offset:0 nt
  v_lshlrev_b32 v10, 16, v160
  v_dot2c_f32_bf16 v88, v112, v160
  v_dot2c_f32_bf16 v89, v112, v10
  v_dot2c_f32_bf16 v90, v113, v160
  v_dot2c_f32_bf16 v91, v113, v10
  v_dot2c_f32_bf16 v92, v114, v160
  v_dot2c_f32_bf16 v93, v114, v10
  v_dot2c_f32_bf16 v94, v115, v160
  v_dot2c_f32_bf16 v95, v115, v10
  s_waitcnt vmcnt(2)
  buffer_load_dwordx4 v[128:131], v1, s[12:15], s61 offen offset:128 nt
  v_dot2c_f32_bf16 v96, v116, v160
  v_dot2c_f32_bf16 v97, v116, v10
  v_dot2c_f32_bf16 v98, v117, v160
  v_dot2c_f32_bf16 v99, v117, v10
  v_dot2c_f32_bf16 v100, v118, v160
  v_dot2c_f32_bf16 v101, v118, v10
  v_dot2c_f32_bf16 v102, v119, v160
  v_dot2c_f32_bf16 v103, v119, v10
  s_waitcnt vmcnt(2)
  buffer_load_dwordx4 v[132:135], v1, s[12:15], s61 offen offset:256 nt
  v_dot2c_f32_bf16 v104, v120, v160
  v_dot2c_f32_bf16 v105, v120, v10
  v_dot2c_f32_bf16 v106, v121, v160
  v_dot2c_f32_bf16 v107, v121, v10
  v_dot2c_f32_bf16 v108, v122, v160
  v_dot2c_f32_bf16 v109, v122, v10
  v_dot2c_f32_bf16 v110, v123, v160
  v_dot2c_f32_bf16 v111, v123, v10
  s_waitcnt vmcnt(2)
  buffer_load_dwordx4 v[136:139], v1, s[12:15], s62 offen offset:0 nt
  v_lshlrev_b32 v10, 16, v161
  v_dot2c_f32_bf16 v88, v124, v161
  v_dot2c_f32_bf16 v89, v124, v10
  v_dot2c_f32_bf16 v90, v125, v161
  v_dot2c_f32_bf16 v91, v125, v10
  v_dot2c_f32_bf16 v92, v126, v161
  v_dot2c_f32_bf16 v93, v126, v10
  v_dot2c_f32_bf16 v94, v127, v161
  v_dot2c_f32_bf16 v95, v127, v10
  s_waitcnt vmcnt(2)
  buffer_load_dwordx4 v[140:143], v1, s[12:15], s62 offen offset:128 nt
  v_dot2c_f32_bf16 v96, v128, v161
  v_dot2c_f32_bf16 v97, v128, v10
  v_dot2c_f32_bf16 v98, v129, v161
  v_dot2c_f32_bf16 v99, v129, v10
  v_dot2c_f32_bf16 v100, v130, v161
  v_dot2c_f32_bf16 v101, v130, v10
  v_dot2c_f32_bf16 v102, v131, v161
  v_dot2c_f32_bf16 v103, v131, v10
  s_waitcnt vmcnt(2)
  buffer_load_dwordx4 v[144:147], v1, s[12:15], s62 offen offset:256 nt
  v_dot2c_f32_bf16 v104, v132, v161
  v_dot2c_f32_bf16 v105, v132, v10
  v_dot2c_f32_bf16 v106, v133, v161
  v_dot2c_f32_bf16 v107, v133, v10
  v_dot2c_f32_bf16 v108, v134, v161
  v_dot2c_f32_bf16 v109, v134, v10
  v_dot2c_f32_bf16 v110, v135, v161
  v_dot2c_f32_bf16 v111, v135, v10
  s_waitcnt vmcnt(2)
  buffer_load_dwordx4 v[148:151], v1, s[12:15], s63 offen offset:0 nt
  v_lshlrev_b32 v10, 16, v162
  v_dot2c_f32_bf16 v88, v136, v162
  v_dot2c_f32_bf16 v89, v136, v10
  v_dot2c_f32_bf16 v90, v137, v162
  v_dot2c_f32_bf16 v91, v137, v10
  v_dot2c_f32_bf16 v92, v138, v162
  v_dot2c_f32_bf16 v93, v138, v10
  v_dot2c_f32_bf16 v94, v139, v162
  v_dot2c_f32_bf16 v95, v139, v10
  s_waitcnt vmcnt(2)
  buffer_load_dwordx4 v[152:155], v1, s[12:15], s63 offen offset:128 nt
  v_dot2c_f32_bf16 v96, v140, v162
  v_dot2c_f32_bf16 v97, v140, v10
  v_dot2c_f32_bf16 v98, v141, v162
  v_dot2c_f32_bf16 v99, v141, v10
  v_dot2c_f32_bf16 v100, v142, v162
  v_dot2c_f32_bf16 v101, v142, v10
  v_dot2c_f32_bf16 v102, v143, v162
  v_dot2c_f32_bf16 v103, v143, v10
  s_waitcnt vmcnt(2)
  buffer_load_dwordx4 v[156:159], v1, s[12:15], s63 offen offset:256 nt
  v_dot2c_f32_bf16 v104, v144, v162
  v_dot2c_f32_bf16 v105, v144, v10
  v_dot2c_f32_bf16 v106, v145, v162
  v_dot2c_f32_bf16 v107, v145, v10
  v_dot2c_f32_bf16 v108, v146, v162
  v_dot2c_f32_bf16 v109, v146, v10
  v_dot2c_f32_bf16 v110, v147, v162
  v_dot2c_f32_bf16 v111, v147, v10
  s_waitcnt vmcnt(2)
  buffer_load_dwordx4 v[16:19], v1, s[12:15], s64 offen offset:0 nt
  v_lshlrev_b32 v10, 16, v163
  v_dot2c_f32_bf16 v88, v148, v163
  v_dot2c_f32_bf16 v89, v148, v10
  v_dot2c_f32_bf16 v90, v149, v163
  v_dot2c_f32_bf16 v91, v149, v10
  v_dot2c_f32_bf16 v92, v150, v163
  v_dot2c_f32_bf16 v93, v150, v10
  v_dot2c_f32_bf16 v94, v151, v163
  v_dot2c_f32_bf16 v95, v151, v10
  s_waitcnt vmcnt(2)
  buffer_load_dwordx4 v[20:23], v1, s[12:15], s64 offen offset:128 nt
  v_dot2c_f32_bf16 v96, v152, v163
  v_dot2c_f32_bf16 v97, v152, v10
  v_dot2c_f32_bf16 v98, v153, v163
  v_dot2c_f32_bf16 v99, v153, v10
  v_dot2c_f32_bf16 v100, v154, v163
  v_dot2c_f32_bf16 v101, v154, v10
  v_dot2c_f32_bf16 v102, v155, v163
  v_dot2c_f32_bf16 v103, v155, v10
  s_waitcnt vmcnt(2)
  buffer_load_dwordx4 v[24:27], v1, s[12:15], s64 offen offset:256 nt
  v_dot2c_f32_bf16 v104, v156, v163
  v_dot2c_f32_bf16 v105, v156, v10
  v_dot2c_f32_bf16 v106, v157, v163
  v_dot2c_f32_bf16 v107, v157, v10
  v_dot2c_f32_bf16 v108, v158, v163
  v_dot2c_f32_bf16 v109, v158, v10
  v_dot2c_f32_bf16 v110, v159, v163
  v_dot2c_f32_bf16 v111, v159, v10
  s_waitcnt vmcnt(2)
  buffer_load_dwordx4 v[28:31], v1, s[12:15], s65 offen offset:0 nt
  v_lshlrev_b32 v10, 16, v164
  v_dot2c_f32_bf16 v88, v16, v164
  v_dot2c_f32_bf16 v89, v16, v10
  v_dot2c_f32_bf16 v90, v17, v164
  v_dot2c_f32_bf16 v91, v17, v10
  v_dot2c_f32_bf16 v92, v18, v164
  v_dot2c_f32_bf16 v93, v18, v10
  v_dot2c_f32_bf16 v94, v19, v164
  v_dot2c_f32_bf16 v95, v19, v10
  s_waitcnt vmcnt(2)
  buffer_load_dwordx4 v[32:35], v1, s[12:15], s65 offen offset:128 nt
  v_dot2c_f32_bf16 v96, v20, v164
  v_dot2c_f32_bf16 v97, v20, v10
  v_dot2c_f32_bf16 v98, v21, v164
  v_dot2c_f32_bf16 v99, v21, v10
  v_dot2c_f32_bf16 v100, v22, v164
  v_dot2c_f32_bf16 v101, v22, v10
  v_dot2c_f32_bf16 v102, v23, v164
  v_dot2c_f32_bf16 v103, v23, v10
  s_waitcnt vmcnt(2)
  buffer_load_dwordx4 v[36:39], v1, s[12:15], s65 offen offset:256 nt
  v_dot2c_f32_bf16 v104, v24, v164
  v_dot2c_f32_bf16 v105, v24, v10
  v_dot2c_f32_bf16 v106, v25, v164
  v_dot2c_f32_bf16 v107, v25, v10
  v_dot2c_f32_bf16 v108, v26, v164
  v_dot2c_f32_bf16 v109, v26, v10
  v_dot2c_f32_bf16 v110, v27, v164
  v_dot2c_f32_bf16 v111, v27, v10
  s_waitcnt vmcnt(2)
  buffer_load_dwordx4 v[40:43], v1, s[12:15], s66 offen offset:0 nt
  v_lshlrev_b32 v10, 16, v165
  v_dot2c_f32_bf16 v88, v28, v165
  v_dot2c_f32_bf16 v89, v28, v10
  v_dot2c_f32_bf16 v90, v29, v165
  v_dot2c_f32_bf16 v91, v29, v10
  v_dot2c_f32_bf16 v92, v30, v165
  v_dot2c_f32_bf16 v93, v30, v10
  v_dot2c_f32_bf16 v94, v31, v165
  v_dot2c_f32_bf16 v95, v31, v10
  s_waitcnt vmcnt(2)
  buffer_load_dwordx4 v[44:47], v1, s[12:15], s66 offen offset:128 nt
  v_dot2c_f32_bf16 v96, v32, v165
  v_dot2c_f32_bf16 v97, v32, v10
  v_dot2c_f32_bf16 v98, v33, v165
  v_dot2c_f32_bf16 v99, v33, v10
  v_dot2c_f32_bf16 v100, v34, v165
  v_dot2c_f32_bf16 v101, v34, v10
  v_dot2c_f32_bf16 v102, v35, v165
  v_dot2c_f32_bf16 v103, v35, v10
  s_waitcnt vmcnt(2)
  buffer_load_dwordx4 v[48:51], v1, s[12:15], s66 offen offset:256 nt
  s_mov_b64 exec, 1
  ds_add_u32 v2, v11 offset:648
  s_mov_b64 exec, -1
  v_dot2c_f32_bf16 v104, v36, v165
  v_dot2c_f32_bf16 v105, v36, v10
  v_dot2c_f32_bf16 v106, v37, v165
  v_dot2c_f32_bf16 v107, v37, v10
  v_dot2c_f32_bf16 v108, v38, v165
  v_dot2c_f32_bf16 v109, v38, v10
  v_dot2c_f32_bf16 v110, v39, v165
  v_dot2c_f32_bf16 v111, v39, v10
  s_waitcnt vmcnt(2)
  buffer_load_dwordx4 v[52:55], v1, s[12:15], s67 offen offset:0 nt
  v_lshlrev_b32 v10, 16, v166
  v_dot2c_f32_bf16 v88, v40, v166
  v_dot2c_f32_bf16 v89, v40, v10
  v_dot2c_f32_bf16 v90, v41, v166
  v_dot2c_f32_bf16 v91, v41, v10
  v_dot2c_f32_bf16 v92, v42, v166
  v_dot2c_f32_bf16 v93, v42, v10
  v_dot2c_f32_bf16 v94, v43, v166
  v_dot2c_f32_bf16 v95, v43, v10
  s_waitcnt vmcnt(2)
  buffer_load_dwordx4 v[56:59], v1, s[12:15], s67 offen offset:128 nt
  v_dot2c_f32_bf16 v96, v44, v166
  v_dot2c_f32_bf16 v97, v44, v10
  v_dot2c_f32_bf16 v98, v45, v166
  v_dot2c_f32_bf16 v99, v45, v10
  v_dot2c_f32_bf16 v100, v46, v166
  v_dot2c_f32_bf16 v101, v46, v10
  v_dot2c_f32_bf16 v102, v47, v166
  v_dot2c_f32_bf16 v103, v47, v10
  s_waitcnt vmcnt(2)
  buffer_load_dwordx4 v[60:63], v1, s[12:15], s67 offen offset:256 nt
  s_mov_b64 exec, 1
  ds_add_u32 v2, v11 offset:644
  s_mov_b64 exec, -1
  v_dot2c_f32_bf16 v104, v48, v166
  v_dot2c_f32_bf16 v105, v48, v10
  v_dot2c_f32_bf16 v106, v49, v166
  v_dot2c_f32_bf16 v107, v49, v10
  v_dot2c_f32_bf16 v108, v50, v166
  v_dot2c_f32_bf16 v109, v50, v10
  v_dot2c_f32_bf16 v110, v51, v166
  v_dot2c_f32_bf16 v111, v51, v10
  s_mov_b32 s70, 200007
L_spin_3:
  ds_read_b128 v[12:15], v2 offset:672
  ds_read_b32 v7, v2 offset:656
  s_waitcnt lgkmcnt(0)
  v_cmp_eq_u32 vcc, 0, v15
  s_nop 0
  s_cbranch_vccz L_sdone_4
  s_sleep 1
  s_sub_u32 s70, s70, 1
  s_cbranch_scc0 L_spin_3
L_sdone_4:
  v_sub_f32 v9, v4, v12
  v_mul_f32 v9, s68, v9
  v_exp_f32 v9, v9
  v_readfirstlane_b32 s46, v7
  v_mul_f32 v9, v9, v13
  v_min_u32 v12, 47, v0
  v_lshlrev_b32 v13, 7, v12
  v_lshlrev_b32 v12, 4, v12
  s_mul_i32 s74, s6, 6144
  s_lshl4_add_u32 s74, s7, s74
  s_add_u32 s74, s74, 1114112
  s_lshl_b32 s75, s4, 9
  s_lshl4_add_u32 s75, s79, s75
  s_add_u32 s75, s75, 1064960
  s_mov_b32 s22, 0xaaaaaaaa
  s_mov_b32 s23, 0xaaaaaaaa
  v_mov_b32 v14, s30
  v_mov_b32 v15, s31
  s_waitcnt vmcnt(2)
  v_lshlrev_b32 v10, 16, v167
  v_dot2c_f32_bf16 v88, v52, v167
  v_dot2c_f32_bf16 v89, v52, v10
  v_dot2c_f32_bf16 v90, v53, v167
  v_dot2c_f32_bf16 v91, v53, v10
  v_dot2c_f32_bf16 v92, v54, v167
  v_dot2c_f32_bf16 v93, v54, v10
  v_dot2c_f32_bf16 v94, v55, v167
  v_dot2c_f32_bf16 v95, v55, v10
  v_permlane32_swap_b32 v88, v92
  v_permlane32_swap_b32 v89, v93
  v_permlane32_swap_b32 v90, v94
  v_permlane32_swap_b32 v91, v95
  v_add_f32 v88, v88, v92
  v_add_f32 v89, v89, v93
  v_add_f32 v90, v90, v94
  v_add_f32 v91, v91, v95
  s_nop 0
  v_permlane16_swap_b32 v88, v90
  v_permlane16_swap_b32 v89, v91
  v_add_f32 v88, v88, v90
  v_add_f32 v89, v89, v91
  s_nop 0
  v_add_f32_dpp v88, v88, v88 row_ror:8 row_mask:0xf bank_mask:0xf
  v_add_f32_dpp v89, v89, v89 row_ror:8 row_mask:0xf bank_mask:0xf
  v_mul_f32 v88, v9, v88
  v_mul_f32 v89, v9, v89
  ds_write_b64 v8, v[88:89] offset:1024
  s_waitcnt vmcnt(1)
  v_dot2c_f32_bf16 v96, v56, v167
  v_dot2c_f32_bf16 v97, v56, v10
  v_dot2c_f32_bf16 v98, v57, v167
  v_dot2c_f32_bf16 v99, v57, v10
  v_dot2c_f32_bf16 v100, v58, v167
  v_dot2c_f32_bf16 v101, v58, v10
  v_dot2c_f32_bf16 v102, v59, v167
  v_dot2c_f32_bf16 v103, v59, v10
  v_permlane32_swap_b32 v96, v100
  v_permlane32_swap_b32 v97, v101
  v_permlane32_swap_b32 v98, v102
  v_permlane32_swap_b32 v99, v103
  v_add_f32 v96, v96, v100
  v_add_f32 v97, v97, v101
  v_add_f32 v98, v98, v102
  v_add_f32 v99, v99, v103
  s_nop 0
  v_permlane16_swap_b32 v96, v98
  v_permlane16_swap_b32 v97, v99
  v_add_f32 v96, v96, v98
  v_add_f32 v97, v97, v99
  s_nop 0
  v_add_f32_dpp v96, v96, v96 row_ror:8 row_mask:0xf bank_mask:0xf
  v_add_f32_dpp v97, v97, v97 row_ror:8 row_mask:0xf bank_mask:0xf
  v_mul_f32 v96, v9, v96
  v_mul_f32 v97, v9, v97
  ds_write_b64 v8, v[96:97] offset:1280
  s_waitcnt vmcnt(0)
  v_dot2c_f32_bf16 v104, v60, v167
  v_dot2c_f32_bf16 v105, v60, v10
  v_dot2c_f32_bf16 v106, v61, v167
  v_dot2c_f32_bf16 v107, v61, v10
  v_dot2c_f32_bf16 v108, v62, v167
  v_dot2c_f32_bf16 v109, v62, v10
  v_dot2c_f32_bf16 v110, v63, v167
  v_dot2c_f32_bf16 v111, v63, v10
  v_permlane32_swap_b32 v104, v108
  v_permlane32_swap_b32 v105, v109
  v_permlane32_swap_b32 v106, v110
  v_permlane32_swap_b32 v107, v111
  v_add_f32 v104, v104, v108
  v_add_f32 v105, v105, v109
  v_add_f32 v106, v106, v110
  v_add_f32 v107, v107, v111
  s_nop 0
  v_permlane16_swap_b32 v104, v106
  v_permlane16_swap_b32 v105, v107
  v_add_f32 v104, v104, v106
  v_add_f32 v105, v105, v107
  s_nop 0
  v_add_f32_dpp v104, v104, v104 row_ror:8 row_mask:0xf bank_mask:0xf
  v_add_f32_dpp v105, v105, v105 row_ror:8 row_mask:0xf bank_mask:0xf
  v_mul_f32 v104, v9, v104
  v_mul_f32 v105, v9, v105
  ds_write_b64 v8, v[104:105] offset:1536
  s_mov_b64 exec, 1
  ds_add_rtn_u32 v10, v2, v11 offset:640
  s_mov_b64 exec, -1
  ds_read_b128 v[16:19], v12 offset:1024
  ds_read_b128 v[20:23], v12 offset:1792
  ds_read_b128 v[24:27], v12 offset:2560
  ds_read_b128 v[28:31], v12 offset:3328
  ds_read_b128 v[32:35], v12 offset:4096
  ds_read_b128 v[36:39], v12 offset:4864
  ds_read_b128 v[40:43], v12 offset:5632
  ds_read_b128 v[44:47], v12 offset:6400
  s_waitcnt lgkmcnt(8)
  v_readfirstlane_b32 s68, v10
  s_nop 0
  s_cmp_lg_u32 s68, 7
  s_cbranch_scc1 L_nopub
  s_waitcnt lgkmcnt(6)
  v_add_f32 v16, v16, v20
  v_add_f32 v17, v17, v21
  v_add_f32 v18, v18, v22
  v_add_f32 v19, v19, v23
  s_waitcnt lgkmcnt(4)
  v_add_f32 v24, v24, v28
  v_add_f32 v25, v25, v29
  v_add_f32 v26, v26, v30
  v_add_f32 v27, v27, v31
  v_add_f32 v16, v16, v24
  v_add_f32 v17, v17, v25
  v_add_f32 v18, v18, v26
  v_add_f32 v19, v19, v27
  s_waitcnt lgkmcnt(2)
  v_add_f32 v32, v32, v36
  v_add_f32 v33, v33, v37
  v_add_f32 v34, v34, v38
  v_add_f32 v35, v35, v39
  s_waitcnt lgkmcnt(0)
  v_add_f32 v40, v40, v44
  v_add_f32 v41, v41, v45
  v_add_f32 v42, v42, v46
  v_add_f32 v43, v43, v47
  v_add_f32 v32, v32, v40
  v_add_f32 v33, v33, v41
  v_add_f32 v34, v34, v42
  v_add_f32 v35, v35, v43
  v_add_f32 v4, v16, v32
  v_add_f32 v5, v17, v33
  v_add_f32 v6, v18, v34
  v_add_f32 v7, v19, v35
  v_cvt_pk_bf16_f32 v8, v4, v5
  v_cvt_pk_bf16_f32 v9, v6, v7
  v_cndmask_b32 v4, v8, v14, s[22:23]
  v_cndmask_b32 v5, v9, v15, s[22:23]
  v_cndmask_b32 v6, v14, v8, s[22:23]
  v_cndmask_b32 v7, v15, v9, s[22:23]
  s_mov_b32 exec_lo, 0xffffffff
  s_mov_b32 exec_hi, 0xffff
  buffer_store_dwordx4 v[4:7], v13, s[32:35], s74 offen
  s_mov_b64 exec, -1
  s_cmp_lg_u32 s46, 1
  s_cbranch_scc1 L_slow_5
L_back_6:
  s_mov_b64 exec, 1
  ds_write_b32 v2, v11 offset:660
  s_mov_b64 exec, -1
L_nopub:
  s_cmp_eq_u32 s3, 7
  s_cbranch_scc1 L_end
  v_mov_b32 v1, 0
  s_mov_b32 s70, 200007
L_spin_7:
  ds_read_b64 v[4:5], v1 offset:664
  s_waitcnt lgkmcnt(0)
  v_cmp_eq_u32 vcc, 0, v5
  s_nop 0
  s_cbranch_vccz L_sdone_8
  s_sleep 1
  s_sub_u32 s70, s70, 1
  s_cbranch_scc0 L_spin_7
L_sdone_8:
  v_readfirstlane_b32 s5, v5
  v_readfirstlane_b32 s47, v4
  s_lshr_b32 s28, s5, 8
  s_and_b32 s5, s5, 0xff
  s_sub_u32 s5, s5, 1
  s_cmp_lt_u32 s5, 12
  s_cbranch_scc1 L_ffn
  s_cmp_lt_u32 s5, 20
  s_cbranch_scc1 L_end
  s_cmp_lt_u32 s3, 5
  s_cbranch_scc1 L_f1
  s_endpgm
L_q2:
  s_mov_b32 s69, 0xffff0000
  s_mov_b32 s24, s58
  s_mov_b32 s25, s59
  s_mov_b32 s26, 4194304
  s_mov_b32 s27, 0x20000
  s_add_u32 s32, s58, 4194304
  s_addc_u32 s33, s59, 0
  s_mov_b32 s34, 4194304
  s_mov_b32 s35, 0x20000
  s_lshl3_add_u32 s71, s6, s7
  s_lshr_b32 s79, s2, 3
  s_waitcnt lgkmcnt(0)
  s_mul_i32 s30, s28, 0x2c9277b5
  s_add_u32 s30, s30, 0xac564b05
  s_mul_i32 s31, s29, 0x0019660d
  s_add_u32 s31, s31, 0x3c6ef35f
  s_mul_i32 s64, s4, 768
  s_add_u32 s64, s64, 1081344
  s_add_u32 s65, s79, s73
  s_cmp_eq_u32 s65, 0
  s_cselect_b32 s64, s64, 4194304
  v_mov_b32 v92, 0
  v_mov_b32 v93, 0
  v_mov_b32 v94, s30
  v_mov_b32 v95, s31
  s_mov_b64 exec, 1
  buffer_store_dwordx4 v[92:95], off, s[24:27], s64 sc1
  s_mov_b64 exec, -1
  s_waitcnt vmcnt(21)
  v_lshlrev_b32 v70, 16, v64
  v_and_b32 v71, s69, v64
  v_lshlrev_b32 v72, 16, v65
  v_and_b32 v73, s69, v65
  v_lshlrev_b32 v74, 16, v66
  v_and_b32 v75, s69, v66
  v_lshlrev_b32 v76, 16, v67
  v_and_b32 v77, s69, v67
  v_lshlrev_b32 v78, 16, v68
  v_and_b32 v79, s69, v68
  v_add_f32 v4, v70, v71
  v_add_f32 v5, v72, v73
  v_add_f32 v6, v74, v75
  v_add_f32 v7, v76, v77
  v_add_f32 v4, v4, v5
  v_add_f32 v6, v6, v7
  v_add_f32 v5, v78, v79
  v_add_f32 v4, v4, v6
  v_add_f32 v4, v4, v5
  s_nop 1
  v_add_f32_dpp v4, v4, v4 quad_perm:[1,0,3,2] row_mask:0xf bank_mask:0xf
  s_nop 1
  v_add_f32_dpp v4, v4, v4 quad_perm:[2,3,0,1] row_mask:0xf bank_mask:0xf
  s_nop 1
  v_add_f32_dpp v4, v4, v4 row_half_mirror row_mask:0xf bank_mask:0xf
  s_nop 1
  v_add_f32_dpp v4, v4, v4 row_mirror row_mask:0xf bank_mask:0xf
  v_mov_b32 v5, v4
  s_nop 1
  v_permlane16_swap_b32 v4, v5
  v_add_f32 v4, v4, v5
  v_mov_b32 v5, v4
  s_nop 1
  v_permlane32_swap_b32 v4, v5
  v_add_f32 v4, v4, v5
  v_mul_f32 v4, 0x3acccccd, v4
  v_sub_f32 v70, v70, v4
  v_sub_f32 v71, v71, v4
  v_sub_f32 v72, v72, v4
  v_sub_f32 v73, v73, v4
  v_sub_f32 v74, v74, v4
  v_sub_f32 v75, v75, v4
  v_sub_f32 v76, v76, v4
  v_sub_f32 v77, v77, v4
  v_sub_f32 v78, v78, v4
  v_sub_f32 v79, v79, v4
  v_mul_f32 v5, v70, v70
  v_fmac_f32 v5, v71, v71
  v_fmac_f32 v5, v72, v72
  v_fmac_f32 v5, v73, v73
  v_fmac_f32 v5, v74, v74
  v_fmac_f32 v5, v75, v75
  v_fmac_f32 v5, v76, v76
  v_fmac_f32 v5, v77, v77
  v_fmac_f32 v5, v78, v78
  v_fmac_f32 v5, v79, v79
  s_nop 1
  v_add_f32_dpp v5, v5, v5 quad_perm:[1,0,3,2] row_mask:0xf bank_mask:0xf
  s_nop 1
  v_add_f32_dpp v5, v5, v5 quad_perm:[2,3,0,1] row_mask:0xf bank_mask:0xf
  s_nop 1
  v_add_f32_dpp v5, v5, v5 row_half_mirror row_mask:0xf bank_mask:0xf
  s_nop 1
  v_add_f32_dpp v5, v5, v5 row_mirror row_mask:0xf bank_mask:0xf
  v_mov_b32 v6, v5
  s_nop 1
  v_permlane16_swap_b32 v5, v6
  v_add_f32 v5, v5, v6
  v_mov_b32 v6, v5
  s_nop 1
  v_permlane32_swap_b32 v5, v6
  v_add_f32 v5, v5, v6
  v_mul_f32 v5, 0x3acccccd, v5
  v_cvt_pk_bf16_f32 v4, v4, v4
  v_lshlrev_b32 v4, 16, v4
  v_cvt_pk_bf16_f32 v5, v5, v5
  v_lshlrev_b32 v5, 16, v5
  v_add_f32 v5, 0x3727c5ac, v5
  v_cvt_pk_bf16_f32 v5, v5, v5
  v_lshlrev_b32 v5, 16, v5
  v_sqrt_f32 v5, v5
  s_nop 0
  v_cvt_pk_bf16_f32 v5, v5, v5
  v_lshlrev_b32 v5, 16, v5
  v_rcp_f32 v5, v5
  v_mov_b32 v6, 0
  s_waitcnt vmcnt(11)
  v_lshlrev_b32 v8, 16, v8
  v_lshlrev_b32 v9, 16, v9
  v_lshlrev_b32 v10, 16, v10
  v_lshlrev_b32 v11, 16, v11
  v_lshlrev_b32 v12, 16, v12
  v_lshlrev_b32 v13, 16, v13
  v_lshlrev_b32 v14, 16, v14
  v_lshlrev_b32 v15, 16, v15
  v_lshlrev_b32 v16, 16, v16
  v_lshlrev_b32 v17, 16, v17
  v_sub_f32 v8, v8, v4
  v_sub_f32 v9, v9, v4
  v_sub_f32 v10, v10, v4
  v_sub_f32 v11, v11, v4
  v_sub_f32 v12, v12, v4
  v_sub_f32 v13, v13, v4
  v_sub_f32 v14, v14, v4
  v_sub_f32 v15, v15, v4
  v_sub_f32 v16, v16, v4
  v_sub_f32 v17, v17, v4
  v_cvt_pk_bf16_f32 v8, v6, v8
  v_cvt_pk_bf16_f32 v9, v6, v9
  v_cvt_pk_bf16_f32 v10, v6, v10
  v_cvt_pk_bf16_f32 v11, v6, v11
  v_cvt_pk_bf16_f32 v12, v6, v12
  v_cvt_pk_bf16_f32 v13, v6, v13
  v_cvt_pk_bf16_f32 v14, v6, v14
  v_cvt_pk_bf16_f32 v15, v6, v15
  v_cvt_pk_bf16_f32 v16, v6, v16
  v_cvt_pk_bf16_f32 v17, v6, v17
  v_mul_f32 v8, v8, v5
  v_mul_f32 v9, v9, v5
  v_mul_f32 v10, v10, v5
  v_mul_f32 v11, v11, v5
  v_mul_f32 v12, v12, v5
  v_mul_f32 v13, v13, v5
  v_mul_f32 v14, v14, v5
  v_mul_f32 v15, v15, v5
  v_mul_f32 v16, v16, v5
  v_mul_f32 v17, v17, v5
  v_cvt_pk_bf16_f32 v70, v6, v8
  v_cvt_pk_bf16_f32 v8, v8, v6
  v_cvt_pk_bf16_f32 v71, v6, v9
  v_cvt_pk_bf16_f32 v9, v9, v6
  v_cvt_pk_bf16_f32 v72, v6, v10
  v_cvt_pk_bf16_f32 v10, v10, v6
  v_cvt_pk_bf16_f32 v73, v6, v11
  v_cvt_pk_bf16_f32 v11, v11, v6
  v_cvt_pk_bf16_f32 v74, v6, v12
  v_cvt_pk_bf16_f32 v12, v12, v6
  v_cvt_pk_bf16_f32 v75, v6, v13
  v_cvt_pk_bf16_f32 v13, v13, v6
  v_cvt_pk_bf16_f32 v76, v6, v14
  v_cvt_pk_bf16_f32 v14, v14, v6
  v_cvt_pk_bf16_f32 v77, v6, v15
  v_cvt_pk_bf16_f32 v15, v15, v6
  v_cvt_pk_bf16_f32 v78, v6, v16
  v_cvt_pk_bf16_f32 v16, v16, v6
  v_cvt_pk_bf16_f32 v79, v6, v17
  v_cvt_pk_bf16_f32 v17, v17, v6
  v_mov_b32 v80, 0
  v_mov_b32 v81, 0
  v_mov_b32 v82, 0
  v_mov_b32 v83, 0
  v_mov_b32 v84, 0
  v_mov_b32 v85, 0
  v_mov_b32 v86, 0
  v_mov_b32 v87, 0
  v_and_b32 v90, 7, v0
  v_lshrrev_b32 v6, 5, v0
  v_lshl_add_u32 v90, v90, 1, v6
  v_lshlrev_b32 v90, 4, v90
  s_mul_i32 s60, s6, 3
  s_add_u32 s60, s60, s73
  s_lshl_b32 s60, s60, 11
  s_add_u32 s60, s60, 1114112
  s_lshl_b32 s64, s7, 8
  s_add_u32 s64, s64, s60
  s_waitcnt vmcnt(10)
  v_dot2c_f32_bf16 v80, v24, v8
  v_dot2c_f32_bf16 v81, v24, v70
  v_dot2c_f32_bf16 v82, v25, v8
  v_dot2c_f32_bf16 v83, v25, v70
  v_dot2c_f32_bf16 v84, v26, v8
  v_dot2c_f32_bf16 v85, v26, v70
  v_dot2c_f32_bf16 v86, v27, v8
  v_dot2c_f32_bf16 v87, v27, v70
  s_waitcnt vmcnt(9)
  v_dot2c_f32_bf16 v80, v28, v9
  v_dot2c_f32_bf16 v81, v28, v71
  v_dot2c_f32_bf16 v82, v29, v9
  v_dot2c_f32_bf16 v83, v29, v71
  v_dot2c_f32_bf16 v84, v30, v9
  v_dot2c_f32_bf16 v85, v30, v71
  v_dot2c_f32_bf16 v86, v31, v9
  v_dot2c_f32_bf16 v87, v31, v71
  s_waitcnt vmcnt(8)
  v_dot2c_f32_bf16 v80, v32, v10
  v_dot2c_f32_bf16 v81, v32, v72
  v_dot2c_f32_bf16 v82, v33, v10
  v_dot2c_f32_bf16 v83, v33, v72
  v_dot2c_f32_bf16 v84, v34, v10
  v_dot2c_f32_bf16 v85, v34, v72
  v_dot2c_f32_bf16 v86, v35, v10
  v_dot2c_f32_bf16 v87, v35, v72
  s_waitcnt vmcnt(7)
  v_dot2c_f32_bf16 v80, v36, v11
  v_dot2c_f32_bf16 v81, v36, v73
  v_dot2c_f32_bf16 v82, v37, v11
  v_dot2c_f32_bf16 v83, v37, v73
  v_dot2c_f32_bf16 v84, v38, v11
  v_dot2c_f32_bf16 v85, v38, v73
  v_dot2c_f32_bf16 v86, v39, v11
  v_dot2c_f32_bf16 v87, v39, v73
  s_waitcnt vmcnt(6)
  v_dot2c_f32_bf16 v80, v40, v12
  v_dot2c_f32_bf16 v81, v40, v74
  v_dot2c_f32_bf16 v82, v41, v12
  v_dot2c_f32_bf16 v83, v41, v74
  v_dot2c_f32_bf16 v84, v42, v12
  v_dot2c_f32_bf16 v85, v42, v74
  v_dot2c_f32_bf16 v86, v43, v12
  v_dot2c_f32_bf16 v87, v43, v74
  s_waitcnt vmcnt(5)
  v_dot2c_f32_bf16 v80, v44, v13
  v_dot2c_f32_bf16 v81, v44, v75
  v_dot2c_f32_bf16 v82, v45, v13
  v_dot2c_f32_bf16 v83, v45, v75
  v_dot2c_f32_bf16 v84, v46, v13
  v_dot2c_f32_bf16 v85, v46, v75
  v_dot2c_f32_bf16 v86, v47, v13
  v_dot2c_f32_bf16 v87, v47, v75
  s_waitcnt vmcnt(4)
  v_dot2c_f32_bf16 v80, v48, v14
  v_dot2c_f32_bf16 v81, v48, v76
  v_dot2c_f32_bf16 v82, v49, v14
  v_dot2c_f32_bf16 v83, v49, v76
  v_dot2c_f32_bf16 v84, v50, v14
  v_dot2c_f32_bf16 v85, v50, v76
  v_dot2c_f32_bf16 v86, v51, v14
  v_dot2c_f32_bf16 v87, v51, v76
  s_waitcnt vmcnt(3)
  v_dot2c_f32_bf16 v80, v52, v15
  v_dot2c_f32_bf16 v81, v52, v77
  v_dot2c_f32_bf16 v82, v53, v15
  v_dot2c_f32_bf16 v83, v53, v77
  v_dot2c_f32_bf16 v84, v54, v15
  v_dot2c_f32_bf16 v85, v54, v77
  v_dot2c_f32_bf16 v86, v55, v15
  v_dot2c_f32_bf16 v87, v55, v77
  s_waitcnt vmcnt(2)
  v_dot2c_f32_bf16 v80, v56, v16
  v_dot2c_f32_bf16 v81, v56, v78
  v_dot2c_f32_bf16 v82, v57, v16
  v_dot2c_f32_bf16 v83, v57, v78
  v_dot2c_f32_bf16 v84, v58, v16
  v_dot2c_f32_bf16 v85, v58, v78
  v_dot2c_f32_bf16 v86, v59, v16
  v_dot2c_f32_bf16 v87, v59, v78
  s_waitcnt vmcnt(0)
  v_dot2c_f32_bf16 v80, v60, v17
  v_dot2c_f32_bf16 v81, v60, v79
  v_dot2c_f32_bf16 v82, v61, v17
  v_dot2c_f32_bf16 v83, v61, v79
  v_dot2c_f32_bf16 v84, v62, v17
  v_dot2c_f32_bf16 v85, v62, v79
  v_dot2c_f32_bf16 v86, v63, v17
  v_dot2c_f32_bf16 v87, v63, v79
  v_permlane32_swap_b32 v80, v84
  v_permlane32_swap_b32 v81, v85
  v_permlane32_swap_b32 v82, v86
  v_permlane32_swap_b32 v83, v87
  v_add_f32 v80, v80, v84
  v_add_f32 v81, v81, v85
  v_add_f32 v82, v82, v86
  v_add_f32 v83, v83, v87
  v_mov_b32 v84, v80
  v_mov_b32 v85, v81
  v_mov_b32 v86, v82
  v_mov_b32 v87, v83
  v_permlane16_swap_b32 v80, v84
  v_permlane16_swap_b32 v81, v85
  v_permlane16_swap_b32 v82, v86
  v_permlane16_swap_b32 v83, v87
  v_add_f32 v80, v80, v84
  v_add_f32 v81, v81, v85
  v_add_f32 v82, v82, v86
  v_add_f32 v83, v83, v87
  v_add_f32_dpp v80, v80, v80 row_ror:8 row_mask:0xf bank_mask:0xf
  v_add_f32_dpp v81, v81, v81 row_ror:8 row_mask:0xf bank_mask:0xf
  v_add_f32_dpp v82, v82, v82 row_ror:8 row_mask:0xf bank_mask:0xf
  v_add_f32_dpp v83, v83, v83 row_ror:8 row_mask:0xf bank_mask:0xf
  s_mov_b32 s68, 0x07060501
  v_perm_b32 v80, v80, v83, s68
  s_mov_b32 s68, 0x07060502
  v_perm_b32 v81, v81, v83, s68
  s_mov_b32 s68, 0x07060503
  v_perm_b32 v82, v82, v83, s68
  v_mov_b32 v83, s30
  s_mov_b32 exec_lo, 0xff
  s_mov_b32 exec_hi, 0xff
  buffer_store_dwordx4 v[80:83], v90, s[32:35], s64 offen
  s_mov_b64 exec, -1
  v_lshlrev_b32 v2, 4, v0
  v_and_b32 v3, 15, v0
  v_lshl_add_u32 v3, v3, 1, v6
  v_lshlrev_b32 v3, 2, v3
  s_lshl_b32 s69, s73, 7
  v_add_u32 v3, s69, v3
  v_mov_b32 v1, 0
  s_mov_b32 s65, 0
  s_mov_b32 s61, 0x0c04000c
  s_mov_b32 s62, 0x0402010c
  s_sleep 40
  s_mov_b32 s16, s32
  s_mov_b32 s17, s33
  s_mov_b32 s18, 4194304
  s_mov_b32 s19, 0x20000
  s_mov_b32 s70, 200007
L_spin_9:
  buffer_load_dwordx4 v[8:11], v2, s[16:19], s60 offen offset:0 sc1 nt
  buffer_load_dwordx4 v[12:15], v2, s[16:19], s60 offen offset:1024 sc1 nt
  s_waitcnt vmcnt(0)
  v_cmp_ne_u32 vcc, s30, v11
  v_cmp_ne_u32 s[20:21], s30, v15
  s_nop 0
  s_or_b64 vcc, vcc, s[20:21]
  s_nop 0
  s_cbranch_vccz L_sdone_10
  s_sleep 20
  ds_read_b32 v4, v1 offset:656
  s_waitcnt lgkmcnt(0)
  v_readfirstlane_b32 s46, v4
  s_nop 0
  s_sub_u32 s68, s46, s65
  s_cmp_lg_u32 s68, 2
  s_cbranch_scc1 L_qlazy_11
  s_mov_b32 exec_lo, 0xff
  s_mov_b32 exec_hi, 0xff
  buffer_store_dwordx4 v[80:83], v90, s[24:27], s64 offen sc1
  s_mov_b64 exec, -1
  s_mov_b32 s65, 1
L_qlazy_11:
  s_and_b32 s99, s70, 7
  s_cselect_b32 s16, s32, s24
  s_cselect_b32 s17, s33, s25
  s_sub_u32 s70, s70, 1
  s_cbranch_scc0 L_spin_9
L_sdone_10:
  v_perm_b32 v11, v9, v8, s61
  v_perm_b32 v11, v10, v11, s62
  v_perm_b32 v15, v13, v12, s61
  v_perm_b32 v15, v14, v15, s62
  v_add_f32 v8, v8, v12
  v_add_f32 v9, v9, v13
  v_add_f32 v10, v10, v14
  v_add_f32 v11, v11, v15
  s_nop 0
  v_permlane32_swap_b32 v8, v10
  v_permlane32_swap_b32 v9, v11
  v_add_f32 v8, v8, v10
  v_add_f32 v9, v9, v11
  v_mov_b32 v10, v8
  v_mov_b32 v11, v9
  s_nop 0
  v_permlane16_swap_b32 v8, v10
  v_permlane16_swap_b32 v9, v11
  v_add_f32 v8, v8, v10
  v_add_f32 v9, v9, v11
  v_cvt_pk_bf16_f32 v8, v8, v9
  ds_write_b32 v3, v8 offset:0
  v_mov_b32 v1, 0
  s_mov_b32 s70, 200007
L_spin_12:
  ds_read_b32 v4, v1 offset:656
  s_waitcnt lgkmcnt(0)
  v_cmp_gt_u32 vcc, 1, v4
  s_nop 0
  s_cbranch_vccz L_sdone_13
  s_sleep 2
  s_sub_u32 s70, s70, 1
  s_cbranch_scc0 L_spin_12
L_sdone_13:
  v_readfirstlane_b32 s46, v4
  ds_read_b32 v4, v1 offset:656
  s_waitcnt lgkmcnt(0)
  v_readfirstlane_b32 s46, v4
  s_nop 0
  s_sub_u32 s68, s46, s65
  s_cmp_lg_u32 s68, 2
  s_cbranch_scc1 L_qlazy_14
  s_mov_b32 exec_lo, 0xff
  s_mov_b32 exec_hi, 0xff
  buffer_store_dwordx4 v[80:83], v90, s[24:27], s64 offen sc1
  s_mov_b64 exec, -1
  s_mov_b32 s65, 1
L_qlazy_14:
  s_lshl_b32 s69, s73, 3
  v_mov_b32 v4, s69
  v_mov_b32 v6, 1
  s_waitcnt vmcnt(0) lgkmcnt(0)
  ds_write_b32 v4, v6 offset:384
  s_cmp_lg_u32 s3, 8
  s_cbranch_scc1 L_role
  s_mul_i32 s66, s4, 768
  s_add_u32 s66, s66, 1081344
  s_mov_b32 s70, 200007
  s_load_dwordx4 s[20:23], s[58:59], s66
  s_branch L_tkw0
L_tkchk:
  s_load_dwordx4 s[20:23], s[58:59], s66 glc
L_tkw0:
  s_waitcnt lgkmcnt(0)
  s_cmp_eq_u64 s[22:23], s[30:31]
  s_cbranch_scc1 L_tkok
  s_sleep 20
  s_sub_u32 s70, s70, 1
  s_cbranch_scc0 L_tkchk
L_tkok:
  v_mov_b32 v1, 0
  s_mov_b32 s70, 200007
L_spin_15:
  ds_read_b32 v4, v1 offset:648
  s_waitcnt lgkmcnt(0)
  v_cmp_gt_u32 vcc, 8, v4
  s_nop 0
  s_cbranch_vccz L_sdone_16
  s_sleep 1
  s_sub_u32 s70, s70, 1
  s_cbranch_scc0 L_spin_15
L_sdone_16:
  s_mov_b32 s20, 1
  s_atomic_add s20, s[58:59], s66 glc
  s_mov_b32 s21, 0
  s_mov_b64 exec, 1
  s_waitcnt lgkmcnt(0)
  s_and_b32 s20, s20, 31
  s_add_u32 s20, s20, 1
  s_add_u32 s20, s20, s21
  v_mov_b32 v5, s20
  ds_write_b32 v1, v5 offset:668
  s_mov_b64 exec, -1
  s_branch L_role
L_misc2:
  s_getreg_b32 s64, hwreg(HW_REG_XCC_ID)
  s_mov_b32 s24, s58
  s_mov_b32 s25, s59
  s_mov_b32 s26, 4194304
  s_mov_b32 s27, 0x20000
  s_add_u32 s32, s58, 4194304
  s_addc_u32 s33, s59, 0
  s_mov_b32 s34, 4194304
  s_mov_b32 s35, 0x20000
  s_lshl3_add_u32 s71, s6, s7
  s_lshr_b32 s79, s2, 3
  v_and_b32 v1, 31, v0
  v_lshlrev_b32 v1, 4, v1
  v_lshrrev_b32 v2, 5, v0
  v_lshl_add_u32 v1, v2, 13, v1
  s_lshl_b32 s66, s2, 9
  s_and_b32 s68, s66, 0xffffe000
  s_add_u32 s66, s66, s68
  s_add_u32 s66, s66, 131072
  v_mov_b32 v6, 0
  v_mov_b32 v7, 0
  s_cmp_ge_u32 s79, 4
  s_cbranch_scc1 L_nopr0
  s_mov_b32 exec_lo, 0xffff
  s_mov_b32 exec_hi, 0xffff
  buffer_store_dwordx4 v[4:7], v1, s[24:27], s66 offen sc1
  s_mov_b64 exec, -1
L_nopr0:
  s_waitcnt lgkmcnt(0)
  s_mul_i32 s30, s28, 0x2c9277b5
  s_add_u32 s30, s30, 0xac564b05
  s_mul_i32 s31, s29, 0x0019660d
  s_add_u32 s31, s31, 0x3c6ef35f
  s_and_b32 s64, s64, 15
  v_mov_b32 v4, s30
  v_mov_b32 v5, s31
  v_mov_b32 v6, s64
  v_mov_b32 v7, s64
  s_lshl_b32 s68, s4, 9
  s_add_u32 s68, s68, 1056768
  s_lshl_b32 s69, s79, 4
  v_mov_b32 v1, s69
  s_mov_b64 exec, 1
  buffer_store_dwordx4 v[4:7], v1, s[32:35], s68 offen
  s_mov_b64 exec, -1
  v_and_b32 v1, 31, v0
  v_lshlrev_b32 v1, 4, v1
  s_mov_b32 s70, 12
  s_mov_b32 s46, 2
L_idpoll:
  s_sleep 16
  buffer_load_dwordx4 v[8:11], v1, s[32:35], s68 offen sc1 nt
  s_waitcnt vmcnt(0)
  v_cmp_ne_u64 vcc, s[30:31], v[8:9]
  s_nop 0
  s_cbranch_vccz L_iddone
  s_sub_u32 s70, s70, 1
  s_cbranch_scc0 L_idpoll
  s_branch L_idset
L_iddone:
  v_cmp_ne_u32 vcc, s64, v10
  s_nop 0
  s_cbranch_vccnz L_idset
  s_mov_b32 s46, 1
L_idset:
  v_mov_b32 v1, 0
  v_mov_b32 v4, s46
  ds_write_b32 v1, v4 offset:656
  s_mov_b32 s60, -1
  s_mov_b32 s61, -1
  s_lshl_b32 s67, s4, 9
  s_add_u32 s67, s67, 1069056
  s_cmp_ge_u32 s79, 4
  s_cbranch_scc1 L_nopr1
  s_waitcnt lgkmcnt(0)
  s_add_u32 s69, s66, 0
  s_memtime s[62:63]
  s_waitcnt lgkmcnt(0)
  s_load_dword s65, s[58:59], s69
  s_waitcnt lgkmcnt(0)
  s_memtime s[20:21]
  s_waitcnt lgkmcnt(0)
  s_sub_u32 s62, s20, s62
  s_min_u32 s60, s60, s62
  s_add_u32 s69, s66, 8192
  s_memtime s[62:63]
  s_waitcnt lgkmcnt(0)
  s_load_dword s65, s[58:59], s69
  s_waitcnt lgkmcnt(0)
  s_memtime s[20:21]
  s_waitcnt lgkmcnt(0)
  s_sub_u32 s62, s20, s62
  s_min_u32 s61, s61, s62
  s_add_u32 s69, s66, 128
  s_memtime s[62:63]
  s_waitcnt lgkmcnt(0)
  s_load_dword s65, s[58:59], s69
  s_waitcnt lgkmcnt(0)
  s_memtime s[20:21]
  s_waitcnt lgkmcnt(0)
  s_sub_u32 s62, s20, s62
  s_min_u32 s60, s60, s62
  s_add_u32 s69, s66, 8320
  s_memtime s[62:63]
  s_waitcnt lgkmcnt(0)
  s_load_dword s65, s[58:59], s69
  s_waitcnt lgkmcnt(0)
  s_memtime s[20:21]
  s_waitcnt lgkmcnt(0)
  s_sub_u32 s62, s20, s62
  s_min_u32 s61, s61, s62
  s_lshl_b32 s69, s79, 4
  v_mov_b32 v1, s69
  v_mov_b32 v4, s60
  v_mov_b32 v5, s61
  v_mov_b32 v6, s30
  v_mov_b32 v7, s31
  s_mov_b64 exec, 1
  buffer_store_dwordx4 v[4:7], v1, s[32:35], s67 offen
  s_mov_b64 exec, -1
L_nopr1:
  v_and_b32 v1, 7, v0
  v_lshlrev_b32 v1, 4, v1
  s_mov_b32 s70, 200007
L_spin_17:
  ds_read_b128 v[4:7], v1 offset:512
  s_waitcnt lgkmcnt(0)
  v_cmp_eq_u32 vcc, 0, v7
  s_nop 0
  s_cbranch_vccz L_sdone_18
  s_sleep 4
  s_sub_u32 s70, s70, 1
  s_cbranch_scc0 L_spin_17
L_sdone_18:
  s_mov_b32 s68, 0x3fb8aa3b
  v_mov_b32 v2, v4
  s_nop 1
  v_max_f32_dpp v2, v2, v2 quad_perm:[1,0,3,2] row_mask:0xf bank_mask:0xf
  s_nop 1
  v_max_f32_dpp v2, v2, v2 quad_perm:[2,3,0,1] row_mask:0xf bank_mask:0xf
  s_nop 1
  v_max_f32_dpp v2, v2, v2 row_half_mirror row_mask:0xf bank_mask:0xf
  v_sub_f32 v4, v4, v2
  v_mul_f32 v4, s68, v4
  v_exp_f32 v4, v4
  s_nop 0
  v_mul_f32 v3, v4, v5
  s_nop 1
  v_add_f32_dpp v3, v3, v3 quad_perm:[1,0,3,2] row_mask:0xf bank_mask:0xf
  s_nop 1
  v_add_f32_dpp v3, v3, v3 quad_perm:[2,3,0,1] row_mask:0xf bank_mask:0xf
  s_nop 1
  v_add_f32_dpp v3, v3, v3 row_half_mirror row_mask:0xf bank_mask:0xf
  s_lshl_b32 s68, s71, 4
  s_add_u32 s68, s68, 1052672
  v_mov_b32 v4, s30
  v_mov_b32 v5, s31
  s_mov_b32 exec_lo, 0x1
  s_mov_b32 exec_hi, 0x0
  buffer_store_dwordx4 v[2:5], v1, s[32:35], s68 offen
  s_mov_b64 exec, -1
  s_cmp_lg_u32 s46, 1
  s_cbranch_scc1 L_slow_19
L_back_20:
  s_cmp_lg_u32 s46, 1
  s_cbranch_scc1 L_noshare
  v_and_b32 v8, 7, v0
  v_lshlrev_b32 v8, 4, v8
  buffer_load_dwordx4 v[4:7], v8, s[32:35], s67 offen sc1 nt
  s_waitcnt vmcnt(0)
  v_cmp_eq_u64 vcc, s[30:31], v[6:7]
  s_nop 1
  v_cndmask_b32 v4, -1, v4, vcc
  v_cndmask_b32 v5, -1, v5, vcc
  s_nop 0
  v_min_u32_dpp v4, v4, v4 quad_perm:[1,0,3,2] row_mask:0xf bank_mask:0xf
  v_min_u32_dpp v5, v5, v5 quad_perm:[1,0,3,2] row_mask:0xf bank_mask:0xf
  s_nop 0
  v_min_u32_dpp v4, v4, v4 quad_perm:[2,3,0,1] row_mask:0xf bank_mask:0xf
  v_min_u32_dpp v5, v5, v5 quad_perm:[2,3,0,1] row_mask:0xf bank_mask:0xf
  s_nop 0
  v_min_u32_dpp v4, v4, v4 row_half_mirror row_mask:0xf bank_mask:0xf
  v_min_u32_dpp v5, v5, v5 row_half_mirror row_mask:0xf bank_mask:0xf
  s_nop 0
  v_min_u32_dpp v4, v4, v4 row_mirror row_mask:0xf bank_mask:0xf
  v_min_u32_dpp v5, v5, v5 row_mirror row_mask:0xf bank_mask:0xf
  v_mov_b32 v6, v4
  v_mov_b32 v7, v5
  s_nop 0
  v_permlane16_swap_b32 v4, v6
  v_permlane16_swap_b32 v5, v7
  v_min_u32 v4, v4, v6
  v_min_u32 v5, v5, v7
  v_readfirstlane_b32 s62, v4
  v_readfirstlane_b32 s63, v5
  s_min_u32 s60, s60, s62
  s_min_u32 s61, s61, s63
L_noshare:
  s_cmp_lt_u32 s61, s60
  s_cselect_b32 s47, 8192, 0
  v_mov_b32 v8, 0
  v_mov_b32 v4, s47
  ds_write_b32 v8, v4 offset:664
  s_lshl_b32 s74, s6, 7
  s_add_u32 s74, s74, 1052672
  s_mov_b32 s16, s32
  s_mov_b32 s17, s33
  s_mov_b32 s18, 4194304
  s_mov_b32 s19, 0x20000
  s_mov_b32 s70, 200007
L_spin_21:
  s_sleep 16
  buffer_load_dwordx4 v[4:7], v1, s[16:19], s74 offen sc1 nt
  s_waitcnt vmcnt(0)
  v_cmp_ne_u64 vcc, s[30:31], v[6:7]
  s_nop 0
  s_cbranch_vccz L_sdone_22
  s_and_b32 s99, s70, 7
  s_cmp_eq_u32 s46, 1
  s_cselect_b32 s99, 1, s99
  s_cmp_lg_u32 s99, 0
  s_cselect_b32 s16, s32, s24
  s_cselect_b32 s17, s33, s25
  s_sub_u32 s70, s70, 1
  s_cbranch_scc0 L_spin_21
L_sdone_22:
  s_mov_b32 s68, 0x3fb8aa3b
  v_mov_b32 v2, v4
  s_nop 1
  v_max_f32_dpp v2, v2, v2 quad_perm:[1,0,3,2] row_mask:0xf bank_mask:0xf
  s_nop 1
  v_max_f32_dpp v2, v2, v2 quad_perm:[2,3,0,1] row_mask:0xf bank_mask:0xf
  s_nop 1
  v_max_f32_dpp v2, v2, v2 row_half_mirror row_mask:0xf bank_mask:0xf
  v_sub_f32 v4, v4, v2
  v_mul_f32 v4, s68, v4
  v_exp_f32 v4, v4
  s_nop 0
  v_mul_f32 v3, v4, v5
  s_nop 1
  v_add_f32_dpp v3, v3, v3 quad_perm:[1,0,3,2] row_mask:0xf bank_mask:0xf
  s_nop 1
  v_add_f32_dpp v3, v3, v3 quad_perm:[2,3,0,1] row_mask:0xf bank_mask:0xf
  s_nop 1
  v_add_f32_dpp v3, v3, v3 row_half_mirror row_mask:0xf bank_mask:0xf
  v_rcp_f32 v3, v3
  v_mov_b32 v4, 1
  v_mov_b32 v5, 1
  v_mov_b32 v1, 0
  ds_write_b128 v1, v[2:5] offset:672
L_role:
  v_mov_b32 v1, 0
  s_mov_b32 s70, 200007
L_spin_23:
  ds_read_b64 v[4:5], v1 offset:664
  s_waitcnt lgkmcnt(0)
  v_cmp_eq_u32 vcc, 0, v5
  s_nop 0
  s_cbranch_vccz L_sdone_24
  s_sleep 4
  s_sub_u32 s70, s70, 1
  s_cbranch_scc0 L_spin_23
L_sdone_24:
  v_readfirstlane_b32 s5, v5
  v_readfirstlane_b32 s47, v4
  s_lshr_b32 s28, s5, 8
  s_and_b32 s5, s5, 0xff
  s_sub_u32 s5, s5, 1
  s_cmp_lt_u32 s5, 20
  s_cbranch_scc0 L_tiles
  s_mov_b32 s12, s44
  s_mov_b32 s13, s45
  s_mov_b32 s14, 7864320
  s_mov_b32 s15, 0x20000
  v_lshrrev_b32 v24, 4, v0
  v_lshlrev_b32 v24, 10, v24
  v_bfe_u32 v25, v0, 2, 2
  v_lshl_add_u32 v24, v25, 7, v24
  v_and_b32 v25, 3, v0
  v_lshl_add_u32 v24, v25, 3, v24
  s_cmp_ge_u32 s5, 10
  s_cselect_b32 s76, 1, 0
  s_mul_i32 s77, s76, 10
  s_sub_u32 s77, s5, s77
  s_lshl1_add_u32 s78, s4, s76
  s_lshl2_add_u32 s78, s78, s73
  v_lshrrev_b32 v2, 3, v0
  v_mul_u32_u24 v26, 1280, v2
  v_and_b32 v3, 7, v0
  v_lshl_add_u32 v26, v3, 4, v26
  s_mul_i32 s60, s78, 122880
  s_lshl_b32 s69, s77, 7
  s_add_u32 s60, s60, s69
  s_mul_i32 s61, s73, 12288
  v_add_u32 v24, s61, v24
  s_add_u32 s61, s61, 8704
  v_lshlrev_b32 v60, 4, v0
  s_mul_i32 s74, s78, 3072
  s_add_u32 s74, s74, 1114112
  v_lshlrev_b32 v62, 2, v0
  s_lshl_b32 s68, s73, 8
  v_add_u32 v61, s68, v62
  s_mul_i32 s75, s4, 5120
  s_lshl_b32 s69, s5, 8
  s_add_u32 s75, s75, s69
  s_and_b32 s69, s75, 0xffffe000
  s_add_u32 s75, s75, s69
  s_add_u32 s75, s75, 0
  s_xor_b32 s62, s47, 8192
  s_add_u32 s62, s62, s75
  s_add_u32 s63, s47, s75
  s_mov_b32 s66, 0xff00ff00
  s_mov_b32 s67, 0xff00ff00
  v_mov_b32 v50, s30
  v_mov_b32 v51, s31
  v_mov_b32 v28, 0
  v_mov_b32 v29, 1
  v_cndmask_b32 v52, 0, v50, s[66:67]
  v_cndmask_b32 v53, 0, v51, s[66:67]
  v_cndmask_b32 v54, v50, 0, s[66:67]
  v_cndmask_b32 v55, v51, 0, s[66:67]
  buffer_load_dwordx4 v[8:11], v60, s[32:35], s74 offen offset:0 sc1 nt
  buffer_load_dwordx4 v[12:15], v60, s[32:35], s74 offen offset:1024 sc1 nt
  buffer_load_dwordx4 v[16:19], v60, s[32:35], s74 offen offset:2048 sc1 nt
  v_mov_b32 v1, 0
  s_mov_b32 s70, 200007
L_spin_25:
  ds_read_b32 v4, v1 offset:644
  s_waitcnt lgkmcnt(0)
  v_cmp_gt_u32 vcc, 8, v4
  s_nop 0
  s_cbranch_vccz L_sdone_26
  s_sleep 1
  s_sub_u32 s70, s70, 1
  s_cbranch_scc0 L_spin_25
L_sdone_26:
  s_mov_b32 m0, s61
  s_nop 0
  buffer_load_dwordx4 v26, s[12:15], s60 offen nt lds
  s_add_u32 s60, s60, 10240
  s_add_u32 s61, s61, 1024
  s_mov_b32 m0, s61
  s_nop 0
  buffer_load_dwordx4 v26, s[12:15], s60 offen nt lds
  s_add_u32 s60, s60, 10240
  s_add_u32 s61, s61, 1024
  s_mov_b32 m0, s61
  s_nop 0
  buffer_load_dwordx4 v26, s[12:15], s60 offen nt lds
  s_add_u32 s60, s60, 10240
  s_add_u32 s61, s61, 1024
  s_mov_b32 m0, s61
  s_nop 0
  buffer_load_dwordx4 v26, s[12:15], s60 offen nt lds
  s_add_u32 s60, s60, 10240
  s_add_u32 s61, s61, 1024
  s_mov_b32 m0, s61
  s_nop 0
  buffer_load_dwordx4 v26, s[12:15], s60 offen nt lds
  s_add_u32 s60, s60, 10240
  s_add_u32 s61, s61, 1024
  s_mov_b32 m0, s61
  s_nop 0
  buffer_load_dwordx4 v26, s[12:15], s60 offen nt lds
  s_add_u32 s60, s60, 10240
  s_add_u32 s61, s61, 1024
  s_mov_b32 m0, s61
  s_nop 0
  buffer_load_dwordx4 v26, s[12:15], s60 offen nt lds
  s_add_u32 s60, s60, 10240
  s_add_u32 s61, s61, 1024
  s_mov_b32 m0, s61
  s_nop 0
  buffer_load_dwordx4 v26, s[12:15], s60 offen nt lds
  s_add_u32 s60, s60, 10240
  s_add_u32 s61, s61, 1024
  v_mov_b32 v1, 0
  s_mov_b32 s70, 200007
L_spin_27:
  ds_read_b32 v4, v1 offset:660
  s_waitcnt lgkmcnt(0)
  v_cmp_gt_u32 vcc, 1, v4
  s_nop 0
  s_cbranch_vccz L_sdone_28
  s_sleep 1
  s_sub_u32 s70, s70, 1
  s_cbranch_scc0 L_spin_27
L_sdone_28:
  s_mov_b32 m0, s61
  s_nop 0
  buffer_load_dwordx4 v26, s[12:15], s60 offen nt lds
  s_add_u32 s60, s60, 10240
  s_add_u32 s61, s61, 1024
  s_mov_b32 m0, s61
  s_nop 0
  buffer_load_dwordx4 v26, s[12:15], s60 offen nt lds
  s_add_u32 s60, s60, 10240
  s_add_u32 s61, s61, 1024
  s_mov_b32 m0, s61
  s_nop 0
  buffer_load_dwordx4 v26, s[12:15], s60 offen nt lds
  s_add_u32 s60, s60, 10240
  s_add_u32 s61, s61, 1024
  s_mov_b32 m0, s61
  s_nop 0
  buffer_load_dwordx4 v26, s[12:15], s60 offen nt lds
L_wodone:
  s_cmp_eq_u32 s46, 1
  s_cselect_b32 s16, s32, s24
  s_cselect_b32 s17, s33, s25
  s_mov_b32 s18, 4194304
  s_mov_b32 s19, 0x20000
  s_mov_b32 s70, 200007
  s_waitcnt vmcnt(8)
  ds_read_b64_tr_b16 v[64:65], v24 offset:8704
  ds_read_b64_tr_b16 v[66:67], v24 offset:9216
  ds_read_b64_tr_b16 v[68:69], v24 offset:8736
  ds_read_b64_tr_b16 v[70:71], v24 offset:9248
  ds_read_b64_tr_b16 v[72:73], v24 offset:8768
  ds_read_b64_tr_b16 v[74:75], v24 offset:9280
  ds_read_b64_tr_b16 v[76:77], v24 offset:8800
  ds_read_b64_tr_b16 v[78:79], v24 offset:9312
  s_waitcnt vmcnt(4)
  ds_read_b64_tr_b16 v[80:81], v24 offset:12800
  ds_read_b64_tr_b16 v[82:83], v24 offset:13312
  ds_read_b64_tr_b16 v[84:85], v24 offset:12832
  ds_read_b64_tr_b16 v[86:87], v24 offset:13344
  ds_read_b64_tr_b16 v[88:89], v24 offset:12864
  ds_read_b64_tr_b16 v[90:91], v24 offset:13376
  ds_read_b64_tr_b16 v[92:93], v24 offset:12896
  ds_read_b64_tr_b16 v[94:95], v24 offset:13408
  s_waitcnt vmcnt(2)
  buffer_load_dwordx4 v[8:11], v60, s[32:35], s74 offen offset:0 sc1
  buffer_load_dwordx4 v[12:15], v60, s[32:35], s74 offen offset:1024 sc1
  buffer_load_dwordx4 v[16:19], v60, s[32:35], s74 offen offset:2048 sc1
  s_waitcnt vmcnt(3)
  ds_read_b64_tr_b16 v[96:97], v24 offset:16896
  ds_read_b64_tr_b16 v[98:99], v24 offset:17408
  ds_read_b64_tr_b16 v[100:101], v24 offset:16928
  ds_read_b64_tr_b16 v[102:103], v24 offset:17440
  ds_read_b64_tr_b16 v[104:105], v24 offset:16960
  ds_read_b64_tr_b16 v[106:107], v24 offset:17472
  ds_read_b64_tr_b16 v[108:109], v24 offset:16992
  ds_read_b64_tr_b16 v[110:111], v24 offset:17504
  s_waitcnt lgkmcnt(8)
L_opp:
  buffer_load_dwordx4 v[124:127], v60, s[16:19], s74 offen offset:0 sc1
  buffer_load_dwordx4 v[128:131], v60, s[16:19], s74 offen offset:1024 sc1
  buffer_load_dwordx4 v[132:135], v60, s[16:19], s74 offen offset:2048 sc1
  s_waitcnt vmcnt(5)
  v_xor_b32 v8, v8, v52
  v_xor_b32 v9, v9, v53
  v_xor_b32 v10, v10, v54
  v_xor_b32 v11, v11, v55
  s_nop 1
  v_mfma_f32_16x16x32_bf16 v[32:35], v[8:11], v[64:67], 0
  v_mfma_f32_16x16x32_bf16 v[36:39], v[8:11], v[68:71], 0
  v_mfma_f32_16x16x32_bf16 v[40:43], v[8:11], v[72:75], 0
  v_mfma_f32_16x16x32_bf16 v[44:47], v[8:11], v[76:79], 0
  v_or_b32 v2, v8, v9
  v_or_b32 v3, v10, v11
  s_waitcnt vmcnt(4)
  v_xor_b32 v12, v12, v52
  v_xor_b32 v13, v13, v53
  v_xor_b32 v14, v14, v54
  v_xor_b32 v15, v15, v55
  s_nop 1
  v_mfma_f32_16x16x32_bf16 v[32:35], v[12:15], v[80:83], v[32:35]
  v_mfma_f32_16x16x32_bf16 v[36:39], v[12:15], v[84:87], v[36:39]
  v_mfma_f32_16x16x32_bf16 v[40:43], v[12:15], v[88:91], v[40:43]
  v_mfma_f32_16x16x32_bf16 v[44:47], v[12:15], v[92:95], v[44:47]
  v_or3_b32 v2, v2, v12, v13
  v_or3_b32 v3, v3, v14, v15
  s_waitcnt vmcnt(3) lgkmcnt(0)
  v_xor_b32 v16, v16, v52
  v_xor_b32 v17, v17, v53
  v_xor_b32 v18, v18, v54
  v_xor_b32 v19, v19, v55
  s_nop 1
  v_mfma_f32_16x16x32_bf16 v[32:35], v[16:19], v[96:99], v[32:35]
  v_mfma_f32_16x16x32_bf16 v[36:39], v[16:19], v[100:103], v[36:39]
  v_mfma_f32_16x16x32_bf16 v[40:43], v[16:19], v[104:107], v[40:43]
  v_mfma_f32_16x16x32_bf16 v[44:47], v[16:19], v[108:111], v[44:47]
  v_or3_b32 v2, v2, v16, v17
  v_or3_b32 v3, v3, v18, v19
  v_cndmask_b32 v2, v3, v2, s[66:67]
  v_cmp_ne_u32 vcc, 0, v2
  s_nop 0
  s_cbranch_vccz L_opd
  buffer_load_dwordx4 v[8:11], v60, s[32:35], s74 offen offset:0 sc1
  buffer_load_dwordx4 v[12:15], v60, s[32:35], s74 offen offset:1024 sc1
  buffer_load_dwordx4 v[16:19], v60, s[32:35], s74 offen offset:2048 sc1
  s_waitcnt vmcnt(5)
  v_xor_b32 v124, v124, v52
  v_xor_b32 v125, v125, v53
  v_xor_b32 v126, v126, v54
  v_xor_b32 v127, v127, v55
  s_nop 1
  v_mfma_f32_16x16x32_bf16 v[32:35], v[124:127], v[64:67], 0
  v_mfma_f32_16x16x32_bf16 v[36:39], v[124:127], v[68:71], 0
  v_mfma_f32_16x16x32_bf16 v[40:43], v[124:127], v[72:75], 0
  v_mfma_f32_16x16x32_bf16 v[44:47], v[124:127], v[76:79], 0
  v_or_b32 v2, v124, v125
  v_or_b32 v3, v126, v127
  s_waitcnt vmcnt(4)
  v_xor_b32 v128, v128, v52
  v_xor_b32 v129, v129, v53
  v_xor_b32 v130, v130, v54
  v_xor_b32 v131, v131, v55
  s_nop 1
  v_mfma_f32_16x16x32_bf16 v[32:35], v[128:131], v[80:83], v[32:35]
  v_mfma_f32_16x16x32_bf16 v[36:39], v[128:131], v[84:87], v[36:39]
  v_mfma_f32_16x16x32_bf16 v[40:43], v[128:131], v[88:91], v[40:43]
  v_mfma_f32_16x16x32_bf16 v[44:47], v[128:131], v[92:95], v[44:47]
  v_or3_b32 v2, v2, v128, v129
  v_or3_b32 v3, v3, v130, v131
  s_waitcnt vmcnt(3) lgkmcnt(0)
  v_xor_b32 v132, v132, v52
  v_xor_b32 v133, v133, v53
  v_xor_b32 v134, v134, v54
  v_xor_b32 v135, v135, v55
  s_nop 1
  v_mfma_f32_16x16x32_bf16 v[32:35], v[132:135], v[96:99], v[32:35]
  v_mfma_f32_16x16x32_bf16 v[36:39], v[132:135], v[100:103], v[36:39]
  v_mfma_f32_16x16x32_bf16 v[40:43], v[132:135], v[104:107], v[40:43]
  v_mfma_f32_16x16x32_bf16 v[44:47], v[132:135], v[108:111], v[44:47]
  v_or3_b32 v2, v2, v132, v133
  v_or3_b32 v3, v3, v134, v135
  v_cndmask_b32 v2, v3, v2, s[66:67]
  v_cmp_ne_u32 vcc, 0, v2
  s_nop 0
  s_cbranch_vccz L_opd
  s_sub_u32 s70, s70, 1
  s_cbranch_scc0 L_opp
L_opd:
  v_add_f32 v4, v32, v33
  v_add_f32 v20, v34, v35
  v_add_f32 v5, v36, v37
  v_add_f32 v21, v38, v39
  v_add_f32 v6, v40, v41
  v_add_f32 v22, v42, v43
  v_add_f32 v7, v44, v45
  v_add_f32 v23, v46, v47
  v_add_f32 v4, v4, v20
  v_add_f32 v5, v5, v21
  v_add_f32 v6, v6, v22
  v_add_f32 v7, v7, v23
  s_nop 0
  v_permlane32_swap_b32 v4, v6
  v_permlane32_swap_b32 v5, v7
  v_add_f32 v4, v4, v6
  v_add_f32 v5, v5, v7
  s_nop 1
  v_permlane16_swap_b32 v4, v5
  v_add_f32 v4, v4, v5
  ds_write_b32 v61, v4 offset:7168
  s_mov_b64 exec, 1
  ds_add_rtn_u32 v27, v28, v29 offset:652
  s_mov_b64 exec, -1
  ds_read2st64_b32 v[4:5], v62 offset0:28 offset1:29
  ds_read2st64_b32 v[6:7], v62 offset0:30 offset1:31
  s_waitcnt lgkmcnt(2)
  v_readfirstlane_b32 s68, v27
  s_nop 0
  s_cmp_lg_u32 s68, 3
  s_cbranch_scc1 L_end
  s_waitcnt lgkmcnt(0)
  v_add_f32 v4, v4, v5
  v_add_f32 v6, v6, v7
  v_add_f32 v48, v4, v6
  s_nop 1
  v_mov_b32_dpp v49, v48 quad_perm:[1,0,3,2] row_mask:0xf bank_mask:0xf
  v_cvt_pk_bf16_f32 v48, v48, v49
  s_nop 1
  v_mov_b32_dpp v49, v48 quad_perm:[2,3,0,1] row_mask:0xf bank_mask:0xf
  s_mov_b32 exec_lo, 0x11111111
  s_mov_b32 exec_hi, 0x11111111
  buffer_store_dwordx4 v[48:51], v62, s[24:27], s62 offen sc1
  buffer_store_dwordx4 v[48:51], v62, s[24:27], s63 offen sc1
  s_barrier
  s_endpgm
L_tiles:
  s_mov_b32 s12, s48
  s_mov_b32 s13, s49
  s_mov_b32 s14, 1966080
  s_mov_b32 s15, 0x20000
  s_mov_b32 s16, s50
  s_mov_b32 s17, s51
  s_mov_b32 s18, 1966080
  s_mov_b32 s19, 0x20000
  s_sub_u32 s75, s5, 20
  s_lshr_b32 s78, s75, 2
  s_and_b32 s75, s75, 3
  s_mul_i32 s72, s75, 491520
  s_mul_i32 s68, s73, 24576
  s_add_u32 s72, s72, s68
  s_mul_i32 s68, s4, 3
  s_add_u32 s78, s78, s68
  s_lshl_b32 s68, s78, 7
  s_add_u32 s72, s72, s68
  s_lshl_b32 s61, s73, 10
  s_add_u32 s61, s61, 8704
  v_lshrrev_b32 v2, 3, v0
  v_and_b32 v3, 7, v0
  v_mul_u32_u24 v62, 3072, v2
  v_lshl_add_u32 v62, v3, 4, v62
  v_mov_b32 v1, 0
  s_mov_b32 s70, 200007
L_spin_29:
  ds_read_b32 v4, v1 offset:644
  s_waitcnt lgkmcnt(0)
  v_cmp_gt_u32 vcc, 8, v4
  s_nop 0
  s_cbranch_vccz L_sdone_30
  s_sleep 1
  s_sub_u32 s70, s70, 1
  s_cbranch_scc0 L_spin_29
L_sdone_30:
  s_add_u32 m0, s61, 0
  s_nop 0
  buffer_load_dwordx4 v62, s[12:15], s72 offen nt lds
  s_add_u32 m0, s61, 4096
  s_nop 0
  buffer_load_dwordx4 v62, s[16:19], s72 offen nt lds
  s_add_u32 s72, s72, 98304
  s_add_u32 m0, s61, 8192
  s_nop 0
  buffer_load_dwordx4 v62, s[12:15], s72 offen nt lds
  s_add_u32 m0, s61, 12288
  s_nop 0
  buffer_load_dwordx4 v62, s[16:19], s72 offen nt lds
  s_add_u32 s72, s72, 98304
  v_mov_b32 v1, 0
  s_mov_b32 s70, 200007
L_spin_31:
  ds_read_b32 v4, v1 offset:660
  s_waitcnt lgkmcnt(0)
  v_cmp_gt_u32 vcc, 1, v4
  s_nop 0
  s_cbranch_vccz L_sdone_32
  s_sleep 1
  s_sub_u32 s70, s70, 1
  s_cbranch_scc0 L_spin_31
L_sdone_32:
  s_add_u32 m0, s61, 16384
  s_nop 0
  buffer_load_dwordx4 v62, s[12:15], s72 offen nt lds
  s_add_u32 m0, s61, 20480
  s_nop 0
  buffer_load_dwordx4 v62, s[16:19], s72 offen nt lds
  s_add_u32 s72, s72, 98304
  s_add_u32 m0, s61, 24576
  s_nop 0
  buffer_load_dwordx4 v62, s[12:15], s72 offen nt lds
  s_add_u32 m0, s61, 28672
  s_nop 0
  buffer_load_dwordx4 v62, s[16:19], s72 offen nt lds
  s_add_u32 s72, s72, 98304
  s_add_u32 m0, s61, 32768
  s_nop 0
  buffer_load_dwordx4 v62, s[12:15], s72 offen nt lds
  s_add_u32 m0, s61, 36864
  s_nop 0
  buffer_load_dwordx4 v62, s[16:19], s72 offen nt lds
L_tdone:
  s_waitcnt vmcnt(0)
  s_barrier
  s_endpgm
L_f1:
  v_lshrrev_b32 v58, 4, v0
  v_lshlrev_b32 v58, 10, v58
  v_bfe_u32 v5, v0, 2, 2
  v_lshl_add_u32 v58, v5, 7, v58
  v_and_b32 v5, 3, v0
  v_lshl_add_u32 v58, v5, 3, v58
  s_sub_u32 s75, s5, 20
  s_lshr_b32 s78, s75, 2
  s_and_b32 s75, s75, 3
  s_mul_i32 s74, s75, 5
  s_add_u32 s74, s74, s3
  s_mul_i32 s68, s4, 3
  s_add_u32 s78, s78, s68
  s_lshl_b32 s68, s3, 5
  v_add_u32 v58, s68, v58
  v_lshrrev_b32 v3, 4, v0
  v_and_b32 v2, 7, v0
  v_lshl_add_u32 v50, v2, 2, v3
  v_lshlrev_b32 v50, 1, v50
  s_lshl_b32 s68, s74, 6
  v_add_u32 v61, s68, v50
  s_lshl_b32 s68, s3, 6
  v_add_u32 v51, s68, v50
  v_lshlrev_b32 v52, 4, v3
  v_lshlrev_b32 v54, 3, v0
  v_lshrrev_b32 v53, 3, v0
  v_mul_u32_u24 v53, 2560, v53
  v_lshl_add_u32 v53, v2, 4, v53
  s_lshl_b32 s68, s74, 7
  v_add_u32 v53, s68, v53
  v_add_u32 v59, 20480, v53
  s_add_u32 s60, s47, 0
  v_lshlrev_b32 v55, 4, v0
  v_mov_b32 v57, 0
  s_lshl2_add_u32 s76, s78, s3
  s_lshl2_add_u32 s76, s76, s75
  s_lshl_b32 s76, s76, 8
  s_add_u32 s76, s76, 2228224
  s_lshl3_add_u32 s68, s78, s75
  s_lshl_b32 s68, s68, 4
  s_add_u32 s68, s68, 2752512
  s_lshl2_add_u32 s69, s4, s75
  s_mul_i32 s69, s69, 640
  s_add_u32 s69, s69, 2785280
  v_add_u32 v63, s69, v55
  v_mov_b32 v4, s68
  s_mov_b32 s8, 0
  s_mov_b32 s9, 0x100
  v_cndmask_b32 v63, v63, v4, s[8:9]
  s_cmp_lt_u32 s5, 24
  s_cselect_b32 s62, -1, 0
  s_cselect_b32 s63, 0xff, 0
  s_or_b32 s63, s63, 0x100
  v_mov_b32 v14, s30
  v_mov_b32 v15, s31
  v_mov_b32 v44, 0x3f803f80
  v_mov_b32 v45, 0x3f803f80
  v_mov_b32 v46, 0x3f803f80
  v_mov_b32 v47, 0x3f803f80
  v_mov_b32 v8, 0
  v_mov_b32 v9, 0
  v_mov_b32 v10, 0
  v_mov_b32 v11, 0
  v_mov_b32 v112, 0x3f80
  v_mov_b32 v113, 0x3f800000
  v_and_b32 v4, 0xffffe000, v53
  v_add_u32 v53, v53, v4
  v_and_b32 v4, 0xffffe000, v59
  v_add_u32 v59, v59, v4
  global_load_ushort v56, v61, s[36:37]
  s_setprio 3
  s_barrier
  buffer_load_dwordx4 v[104:107], v53, s[24:27], s60 offen sc1
  buffer_load_dwordx4 v[108:111], v59, s[24:27], s60 offen sc1
  s_cmp_eq_u32 s3, 4
  s_cbranch_scc1 L_f1nob
  ds_read_b64_tr_b16 v[64:65], v58 offset:8704
  ds_read_b64_tr_b16 v[66:67], v58 offset:9216
  ds_read_b64_tr_b16 v[68:69], v58 offset:12800
  ds_read_b64_tr_b16 v[70:71], v58 offset:13312
  ds_read_b64_tr_b16 v[72:73], v58 offset:16896
  ds_read_b64_tr_b16 v[74:75], v58 offset:17408
  ds_read_b64_tr_b16 v[76:77], v58 offset:20992
  ds_read_b64_tr_b16 v[78:79], v58 offset:21504
  ds_read_b64_tr_b16 v[80:81], v58 offset:25088
  ds_read_b64_tr_b16 v[82:83], v58 offset:25600
  ds_read_b64_tr_b16 v[84:85], v58 offset:29184
  ds_read_b64_tr_b16 v[86:87], v58 offset:29696
  ds_read_b64_tr_b16 v[88:89], v58 offset:33280
  ds_read_b64_tr_b16 v[90:91], v58 offset:33792
  ds_read_b64_tr_b16 v[92:93], v58 offset:37376
  ds_read_b64_tr_b16 v[94:95], v58 offset:37888
  ds_read_b64_tr_b16 v[96:97], v58 offset:41472
  ds_read_b64_tr_b16 v[98:99], v58 offset:41984
  ds_read_b64_tr_b16 v[100:101], v58 offset:45568
  ds_read_b64_tr_b16 v[102:103], v58 offset:46080
  s_waitcnt lgkmcnt(0)
  v_mfma_f32_16x16x32_bf16 v[116:119], v[44:47], v[64:67], 0
  v_mfma_f32_16x16x32_bf16 v[124:127], v[44:47], v[68:71], 0
  v_mfma_f32_16x16x32_bf16 v[116:119], v[44:47], v[72:75], v[116:119]
  v_mfma_f32_16x16x32_bf16 v[124:127], v[44:47], v[76:79], v[124:127]
  v_mfma_f32_16x16x32_bf16 v[116:119], v[44:47], v[80:83], v[116:119]
  v_mfma_f32_16x16x32_bf16 v[124:127], v[44:47], v[84:87], v[124:127]
  v_mfma_f32_16x16x32_bf16 v[116:119], v[44:47], v[88:91], v[116:119]
  v_mfma_f32_16x16x32_bf16 v[124:127], v[44:47], v[92:95], v[124:127]
  v_mfma_f32_16x16x32_bf16 v[116:119], v[44:47], v[96:99], v[116:119]
  v_mfma_f32_16x16x32_bf16 v[124:127], v[44:47], v[100:103], v[124:127]
L_f1nob:
  s_waitcnt vmcnt(2)
  v_lshlrev_b32 v56, 16, v56
  s_mov_b32 s70, 200007
  s_branch L_ypw0
L_yppoll:
  buffer_load_dwordx4 v[104:107], v53, s[24:27], s60 offen sc1
  buffer_load_dwordx4 v[108:111], v59, s[24:27], s60 offen sc1
L_ypw0:
  s_waitcnt vmcnt(0)
  v_cmp_ne_u64 vcc, s[30:31], v[106:107]
  v_cmp_ne_u64 s[20:21], s[30:31], v[110:111]
  s_nop 0
  s_or_b64 vcc, vcc, s[20:21]
  s_nop 0
  s_cbranch_vccz L_ypok
  s_sub_u32 s70, s70, 1
  s_cbranch_scc0 L_yppoll
L_ypok:
  v_dot2c_f32_bf16 v8, v104, v112
  v_dot2c_f32_bf16 v10, v105, v112
  v_dot2c_f32_bf16 v9, v104, v113
  v_dot2c_f32_bf16 v11, v105, v113
  v_dot2c_f32_bf16 v8, v108, v112
  v_dot2c_f32_bf16 v10, v109, v112
  v_dot2c_f32_bf16 v9, v108, v113
  v_dot2c_f32_bf16 v11, v109, v113
  s_nop 0
  v_permlane32_swap_b32 v8, v10
  s_nop 0
  v_permlane32_swap_b32 v9, v11
  v_add_f32 v8, v8, v10
  v_add_f32 v9, v9, v11
  s_nop 1
  v_permlane16_swap_b32 v8, v9
  v_add_f32 v8, v8, v9
  s_nop 1
  v_add_f32_dpp v8, v8, v8 row_ror:8 row_mask:0xf bank_mask:0xf
  v_cvt_pk_bf16_f32 v8, v57, v8
  v_add_f32 v8, v8, v56
  v_cvt_pk_bf16_f32 v8, v8, v8
  ds_write_b16 v51, v8 offset:8192
  s_cmp_eq_u32 s3, 4
  s_waitcnt lgkmcnt(0)
  s_barrier
  ds_read_b128 v[24:27], v52 offset:8192
  ds_read_b128 v[28:31], v52 offset:8256
  ds_read_b128 v[32:35], v52 offset:8320
  ds_read_b128 v[36:39], v52 offset:8384
  ds_read_b128 v[40:43], v52 offset:8448
  s_cbranch_scc1 L_f1st
  s_waitcnt lgkmcnt(4)
  v_mfma_f32_16x16x32_bf16 v[16:19], v[24:27], v[64:67], 0
  v_mfma_f32_16x16x32_bf16 v[20:23], v[24:27], v[68:71], 0
  s_waitcnt lgkmcnt(3)
  v_mfma_f32_16x16x32_bf16 v[16:19], v[28:31], v[72:75], v[16:19]
  v_mfma_f32_16x16x32_bf16 v[20:23], v[28:31], v[76:79], v[20:23]
  s_waitcnt lgkmcnt(2)
  v_mfma_f32_16x16x32_bf16 v[16:19], v[32:35], v[80:83], v[16:19]
  v_mfma_f32_16x16x32_bf16 v[20:23], v[32:35], v[84:87], v[20:23]
  s_waitcnt lgkmcnt(1)
  v_mfma_f32_16x16x32_bf16 v[16:19], v[36:39], v[88:91], v[16:19]
  v_mfma_f32_16x16x32_bf16 v[20:23], v[36:39], v[92:95], v[20:23]
  s_waitcnt lgkmcnt(0)
  v_mfma_f32_16x16x32_bf16 v[16:19], v[40:43], v[96:99], v[16:19]
  v_mfma_f32_16x16x32_bf16 v[20:23], v[40:43], v[100:103], v[20:23]
  s_nop 6
  v_cvt_pk_bf16_f32 v12, v16, v116
  v_cvt_pk_bf16_f32 v13, v20, v124
  s_mov_b32 exec_lo, 0xffff
  s_mov_b32 exec_hi, 0x0
  buffer_store_dwordx4 v[12:15], v55, s[32:35], s76 offen
  s_mov_b64 exec, -1
  s_cmp_lg_u32 s46, 1
  s_cbranch_scc1 L_slow_33
L_back_34:
  s_endpgm
L_f1st:
  ds_read_b64 v[12:13], v54 offset:8192
  s_waitcnt lgkmcnt(5)
  v_mfma_f32_16x16x32_bf16 v[16:19], v[24:27], v[44:47], 0
  v_mfma_f32_16x16x32_bf16 v[20:23], v[24:27], v[24:27], 0
  s_waitcnt lgkmcnt(4)
  v_mfma_f32_16x16x32_bf16 v[16:19], v[28:31], v[44:47], v[16:19]
  v_mfma_f32_16x16x32_bf16 v[20:23], v[28:31], v[28:31], v[20:23]
  s_waitcnt lgkmcnt(3)
  v_mfma_f32_16x16x32_bf16 v[16:19], v[32:35], v[44:47], v[16:19]
  v_mfma_f32_16x16x32_bf16 v[20:23], v[32:35], v[32:35], v[20:23]
  s_waitcnt lgkmcnt(2)
  v_mfma_f32_16x16x32_bf16 v[16:19], v[36:39], v[44:47], v[16:19]
  v_mfma_f32_16x16x32_bf16 v[20:23], v[36:39], v[36:39], v[20:23]
  s_waitcnt lgkmcnt(1)
  v_mfma_f32_16x16x32_bf16 v[16:19], v[40:43], v[44:47], v[16:19]
  v_mfma_f32_16x16x32_bf16 v[20:23], v[40:43], v[40:43], v[20:23]
  s_waitcnt lgkmcnt(0)
  s_nop 5
  v_cndmask_b32 v12, v12, v16, s[8:9]
  v_cndmask_b32 v13, v13, v20, s[8:9]
  s_mov_b64 exec, s[62:63]
  buffer_store_dwordx4 v[12:15], v63, s[32:35], 0 offen
  s_mov_b64 exec, -1
  s_cmp_lg_u32 s46, 1
  s_cbranch_scc1 L_slow_35
L_back_36:
  s_endpgm
L_ffn:
  v_mov_b32 v57, 0
  s_mul_i32 s72, s4, 12
  s_add_u32 s72, s72, s5
  s_cmp_lt_u32 s3, 5
  s_cbranch_scc1 L_f2
  s_cmp_eq_u32 s3, 5
  s_cbranch_scc1 L_hid
  s_cmp_ge_u32 s5, 10
  s_cbranch_scc1 L_end
  s_mul_i32 s72, s4, 10
  s_add_u32 s72, s72, s5
  v_lshrrev_b32 v2, 1, v0
  v_mul_u32_u24 v2, 2560, v2
  v_and_b32 v3, 1, v0
  v_lshl_add_u32 v96, v3, 4, v2
  s_lshl_b32 s68, s72, 5
  v_add_u32 v96, s68, v96
  v_add_u32 v100, 81920, v96
  v_add_u32 v101, 163840, v96
  s_add_u32 s10, s47, 524288
  v_lshrrev_b32 v4, 4, v0
  v_lshl_add_u32 v97, v3, 2, v4
  v_lshlrev_b32 v97, 1, v97
  v_lshlrev_b32 v99, 4, v3
  v_and_b32 v98, 16, v0
  s_mul_i32 s13, s4, 2560
  s_lshl_b32 s68, s72, 5
  s_add_u32 s13, s13, s68
  s_add_u32 s13, s13, 2785280
  s_lshl_b32 s14, s72, 4
  s_mov_b32 s69, 0xffff0000
  v_and_b32 v4, 0xffffe000, v96
  v_add_u32 v96, v96, v4
  v_and_b32 v4, 0xffffe000, v100
  v_add_u32 v100, v100, v4
  v_and_b32 v4, 0xffffe000, v101
  v_add_u32 v101, v101, v4
  s_mov_b32 s64, s54
  s_mov_b32 s65, s55
  s_mov_b32 s66, 1280
  s_mov_b32 s67, 0x20000
  v_cmp_lt_u32 s[62:63], 31, v0
  s_setprio 3
  s_barrier
  buffer_load_dwordx4 v[12:15], v99, s[32:35], s13 offen nt
  v_mov_b32 v8, 0
  v_mov_b32 v9, 0
  v_mov_b32 v10, 0
  v_mov_b32 v11, 0
  v_mov_b32 v112, 0x3f80
  v_mov_b32 v113, 0x3f800000
  s_barrier
  s_mov_b32 s16, s32
  s_mov_b32 s17, s33
  s_mov_b32 s18, 4194304
  s_mov_b32 s19, 0x20000
  s_mov_b32 s70, 200007
L_spin_37:
  buffer_load_dwordx4 v[4:7], v99, s[16:19], s13 offen sc1
  buffer_load_dwordx4 v[16:19], v96, s[24:27], s10 offen sc1
  buffer_load_dwordx4 v[20:23], v100, s[24:27], s10 offen sc1
  buffer_load_dwordx4 v[24:27], v101, s[24:27], s10 offen sc1
  s_waitcnt vmcnt(0)
  v_cmp_ne_u64 vcc, s[30:31], v[6:7]
  v_cmp_ne_u64 s[20:21], s[30:31], v[18:19]
  v_cmp_ne_u64 s[22:23], s[30:31], v[22:23]
  s_or_b64 vcc, vcc, s[20:21]
  v_cmp_ne_u64 s[20:21], s[30:31], v[26:27]
  s_or_b64 vcc, vcc, s[22:23]
  s_or_b64 vcc, vcc, s[20:21]
  s_nop 0
  s_cbranch_vccz L_sdone_38
  s_and_b32 s99, s70, 7
  s_cmp_eq_u32 s46, 1
  s_cselect_b32 s99, 1, s99
  s_cmp_lg_u32 s99, 0
  s_cselect_b32 s16, s32, s24
  s_cselect_b32 s17, s33, s25
  s_sub_u32 s70, s70, 1
  s_cbranch_scc0 L_spin_37
L_sdone_38:
  v_dot2c_f32_bf16 v8, v16, v112
  v_dot2c_f32_bf16 v10, v17, v112
  v_dot2c_f32_bf16 v9, v16, v113
  v_dot2c_f32_bf16 v11, v17, v113
  v_dot2c_f32_bf16 v8, v20, v112
  v_dot2c_f32_bf16 v10, v21, v112
  v_dot2c_f32_bf16 v9, v20, v113
  v_dot2c_f32_bf16 v11, v21, v113
  v_dot2c_f32_bf16 v8, v24, v112
  v_dot2c_f32_bf16 v10, v25, v112
  v_dot2c_f32_bf16 v9, v24, v113
  v_dot2c_f32_bf16 v11, v25, v113
  v_cndmask_b32 v58, v4, v5, s[62:63]
  v_lshrrev_b32 v58, v98, v58
  v_permlane32_swap_b32 v8, v10
  v_permlane32_swap_b32 v9, v11
  v_add_f32 v8, v8, v10
  v_add_f32 v9, v9, v11
  v_lshlrev_b32 v58, 16, v58
  s_nop 0
  v_permlane16_swap_b32 v8, v9
  v_add_f32 v8, v8, v9
  s_nop 1
  v_add_f32_dpp v8, v8, v8 row_ror:8 row_mask:0xf bank_mask:0xf
  s_nop 1
  v_add_f32_dpp v8, v8, v8 row_ror:4 row_mask:0xf bank_mask:0xf
  s_nop 1
  v_add_f32_dpp v8, v8, v8 quad_perm:[2,3,0,1] row_mask:0xf bank_mask:0xf
  v_cvt_pk_bf16_f32 v8, v57, v8
  v_add_f32 v8, v8, v58
  v_cvt_pk_bf16_f32 v8, v8, v8
  s_mov_b32 exec_lo, 0x30003
  s_mov_b32 exec_hi, 0x30003
  buffer_store_short v8, v97, s[64:67], s14 offen
  s_cmp_lg_u32 s72, 0
  s_cbranch_scc1 L_fin_exit
  s_mov_b64 exec, 1
  v_mov_b32 v4, s30
  v_mov_b32 v5, s31
  s_mov_b32 s68, 1044480
  buffer_store_dwordx2 v[4:5], v57, s[24:27], s68 offen
L_fin_exit:
  s_endpgm
L_hid:
  s_endpgm
L_f2:
  s_mov_b32 s8, s52
  s_mov_b32 s9, s53
  s_mov_b32 s10, 1966080
  s_mov_b32 s11, 0x20000
  s_lshl_b32 s68, s3, 8
  v_lshlrev_b32 v58, 2, v0
  v_add_u32 v58, s68, v58
  v_lshlrev_b32 v116, 1, v58
  s_mul_i32 s68, s72, 2560
  v_add_u32 v116, s68, v116
  s_xor_b32 s78, s47, 8192
  s_add_u32 s78, s78, 524288
  s_add_u32 s77, s47, 524288
  s_mov_b32 s60, 0x05040100
  s_mov_b32 s61, 0x07060302
  s_mul_i32 s62, s72, 20480
  v_mov_b32 v40, 0
  v_mov_b32 v41, 0
  v_mov_b32 v46, s30
  v_mov_b32 v47, s31
  v_and_b32 v4, 0xffffe000, v116
  v_add_u32 v116, v116, v4
  v_lshlrev_b32 v60, 4, v0
  v_and_b32 v61, 48, v60
  s_lshr_b32 s68, s72, 2
  s_lshl_b32 s65, s68, 7
  s_add_u32 s65, s65, 2752512
  s_lshl_b32 s64, s72, 10
  s_add_u32 s64, s64, 2228224
  v_mov_b32 v8, 0
  v_mov_b32 v9, 0
  s_cmp_eq_u32 s46, 1
  s_cselect_b32 s16, s32, s24
  s_cselect_b32 s17, s33, s25
  s_mov_b32 s18, 4194304
  s_mov_b32 s19, 0x20000
  s_mov_b32 s70, 200007
  s_setprio 3
  s_barrier
  buffer_load_dword v64, v58, s[8:11], s62 offen offset:0 nt
  buffer_load_dword v65, v58, s[8:11], s62 offen offset:1280 nt
  buffer_load_dword v66, v58, s[8:11], s62 offen offset:2560 nt
  s_add_u32 s62, s62, 3840
  buffer_load_dword v67, v58, s[8:11], s62 offen offset:0 nt
  buffer_load_dword v68, v58, s[8:11], s62 offen offset:1280 nt
  buffer_load_dword v69, v58, s[8:11], s62 offen offset:2560 nt
  s_add_u32 s62, s62, 3840
  buffer_load_dword v70, v58, s[8:11], s62 offen offset:0 nt
  buffer_load_dword v71, v58, s[8:11], s62 offen offset:1280 nt
  buffer_load_dword v72, v58, s[8:11], s62 offen offset:2560 nt
  s_add_u32 s62, s62, 3840
  buffer_load_dword v73, v58, s[8:11], s62 offen offset:0 nt
  buffer_load_dword v74, v58, s[8:11], s62 offen offset:1280 nt
  buffer_load_dword v75, v58, s[8:11], s62 offen offset:2560 nt
  s_add_u32 s62, s62, 3840
  buffer_load_dword v76, v58, s[8:11], s62 offen offset:0 nt
  buffer_load_dword v77, v58, s[8:11], s62 offen offset:1280 nt
  buffer_load_dword v78, v58, s[8:11], s62 offen offset:2560 nt
  s_add_u32 s62, s62, 3840
  buffer_load_dword v79, v58, s[8:11], s62 offen offset:0 nt
  buffer_load_dwordx4 v[20:23], v61, s[32:35], s65 offen sc1 nt
  buffer_load_dwordx4 v[16:19], v60, s[32:35], s64 offen sc1 nt
  s_waitcnt vmcnt(2)
  v_perm_b32 v80, v65, v64, s60
  v_perm_b32 v88, v65, v64, s61
  v_perm_b32 v81, v67, v66, s60
  v_perm_b32 v89, v67, v66, s61
  v_perm_b32 v82, v69, v68, s60
  v_perm_b32 v90, v69, v68, s61
  v_perm_b32 v83, v71, v70, s60
  v_perm_b32 v91, v71, v70, s61
  v_perm_b32 v84, v73, v72, s60
  v_perm_b32 v92, v73, v72, s61
  v_perm_b32 v85, v75, v74, s60
  v_perm_b32 v93, v75, v74, s61
  v_perm_b32 v86, v77, v76, s60
  v_perm_b32 v94, v77, v76, s61
  v_perm_b32 v87, v79, v78, s60
  v_perm_b32 v95, v79, v78, s61
L_pap:
  buffer_load_dwordx4 v[28:31], v61, s[16:19], s65 offen sc1
  buffer_load_dwordx4 v[24:27], v60, s[16:19], s64 offen sc1
  s_waitcnt vmcnt(2)
  v_cmp_ne_u64 vcc, s[30:31], v[18:19]
  v_cmp_ne_u64 s[20:21], s[30:31], v[22:23]
  s_nop 0
  s_or_b64 vcc, vcc, s[20:21]
  s_nop 0
  s_cbranch_vccz L_pad0
  buffer_load_dwordx4 v[20:23], v61, s[32:35], s65 offen sc1
  buffer_load_dwordx4 v[16:19], v60, s[32:35], s64 offen sc1
  s_waitcnt vmcnt(2)
  v_cmp_ne_u64 vcc, s[30:31], v[26:27]
  v_cmp_ne_u64 s[20:21], s[30:31], v[30:31]
  s_nop 0
  s_or_b64 vcc, vcc, s[20:21]
  s_nop 0
  s_cbranch_vccz L_pad1
  s_sub_u32 s70, s70, 1
  s_cbranch_scc0 L_pap
L_pad1:
  v_add_f32_dpp v4, v28, v28 quad_perm:[1,0,3,2] row_mask:0xf bank_mask:0xf
  v_add_f32_dpp v5, v29, v29 quad_perm:[1,0,3,2] row_mask:0xf bank_mask:0xf
  s_nop 0
  v_add_f32_dpp v4, v4, v4 quad_perm:[2,3,0,1] row_mask:0xf bank_mask:0xf
  v_add_f32_dpp v5, v5, v5 quad_perm:[2,3,0,1] row_mask:0xf bank_mask:0xf
  v_mul_f32 v6, 0xbacccccd, v4
  v_mul_f32 v5, 0x3acccccd, v5
  v_cvt_pk_bf16_f32 v4, 1.0, v6
  v_fma_f32 v5, -v6, v6, v5
  v_dot2c_f32_bf16 v8, v24, v4
  v_dot2c_f32_bf16 v9, v25, v4
  s_branch L_paj
L_pad0:
  v_add_f32_dpp v4, v20, v20 quad_perm:[1,0,3,2] row_mask:0xf bank_mask:0xf
  v_add_f32_dpp v5, v21, v21 quad_perm:[1,0,3,2] row_mask:0xf bank_mask:0xf
  s_nop 0
  v_add_f32_dpp v4, v4, v4 quad_perm:[2,3,0,1] row_mask:0xf bank_mask:0xf
  v_add_f32_dpp v5, v5, v5 quad_perm:[2,3,0,1] row_mask:0xf bank_mask:0xf
  v_mul_f32 v6, 0xbacccccd, v4
  v_mul_f32 v5, 0x3acccccd, v5
  v_cvt_pk_bf16_f32 v4, 1.0, v6
  v_fma_f32 v5, -v6, v6, v5
  v_dot2c_f32_bf16 v8, v16, v4
  v_dot2c_f32_bf16 v9, v17, v4
L_paj:
  v_max_f32 v5, 0, v5
  v_cvt_pk_bf16_f32 v5, v57, v5
  v_add_f32 v5, 0x3727c5ac, v5
  v_permlane32_swap_b32 v8, v9
  v_cvt_pk_bf16_f32 v5, v57, v5
  v_add_f32 v8, v8, v9
  v_sqrt_f32 v5, v5
  v_mov_b32 v10, v8
  v_cvt_pk_bf16_f32 v5, v57, v5
  v_rcp_f32 v5, v5
  v_permlane16_swap_b32 v8, v10
  v_add_f32 v8, v8, v10
  v_mul_f32 v8, v8, v5
  v_cvt_pk_bf16_f32 v8, v57, v8
  v_mul_f32 v12, 0xbfb8aa3b, v8
  v_mov_b32 v9, v8
  v_exp_f32 v12, v12
  s_nop 0
  v_permlane32_swap_b32 v8, v9
  v_add_f32 v12, 1.0, v12
  v_rcp_f32 v12, v12
  s_nop 0
  v_mul_f32 v8, v8, v12
  v_cvt_pk_bf16_f32 v8, v57, v8
  v_mul_f32 v8, v8, v9
  s_nop 1
  v_mov_b32_dpp v9, v8 quad_perm:[1,0,3,2] row_mask:0xf bank_mask:0xf
  v_cvt_pk_bf16_f32 v8, v8, v9
  s_nop 0
  v_readlane_b32 s8, v8, 0
  v_readlane_b32 s9, v8, 2
  v_readlane_b32 s10, v8, 4
  v_readlane_b32 s11, v8, 6
  v_readlane_b32 s12, v8, 8
  v_readlane_b32 s13, v8, 10
  v_readlane_b32 s14, v8, 12
  v_readlane_b32 s15, v8, 14
  v_dot2c_f32_bf16 v40, s8, v80
  v_dot2c_f32_bf16 v41, s8, v88
  v_dot2c_f32_bf16 v40, s9, v81
  v_dot2c_f32_bf16 v41, s9, v89
  v_dot2c_f32_bf16 v40, s10, v82
  v_dot2c_f32_bf16 v41, s10, v90
  v_dot2c_f32_bf16 v40, s11, v83
  v_dot2c_f32_bf16 v41, s11, v91
  v_dot2c_f32_bf16 v40, s12, v84
  v_dot2c_f32_bf16 v41, s12, v92
  v_dot2c_f32_bf16 v40, s13, v85
  v_dot2c_f32_bf16 v41, s13, v93
  v_dot2c_f32_bf16 v40, s14, v86
  v_dot2c_f32_bf16 v41, s14, v94
  v_dot2c_f32_bf16 v40, s15, v87
  v_dot2c_f32_bf16 v41, s15, v95
  s_nop 2
  v_cvt_pk_bf16_f32 v44, v40, v41
  s_nop 1
  v_mov_b32_dpp v45, v44 quad_perm:[1,0,3,2] row_mask:0xf bank_mask:0xf
  s_mov_b32 exec_lo, 0x55555555
  s_mov_b32 exec_hi, 0x55555555
  buffer_store_dwordx4 v[44:47], v116, s[24:27], s78 offen sc1
  buffer_store_dwordx4 v[44:47], v116, s[24:27], s77 offen sc1
L_end:
  s_endpgm
L_slow_5:
  s_mov_b32 exec_lo, 0xffffffff
  s_mov_b32 exec_hi, 0xffff
  buffer_store_dwordx4 v[4:7], v13, s[24:27], s74 offen sc1
  s_mov_b64 exec, -1
  s_nop 1
  s_branch L_back_6
L_slow_19:
  s_mov_b32 exec_lo, 0x1
  s_mov_b32 exec_hi, 0x0
  buffer_store_dwordx4 v[2:5], v1, s[24:27], s68 offen sc1
  s_mov_b64 exec, -1
  s_nop 1
  s_branch L_back_20
L_slow_33:
  s_mov_b32 exec_lo, 0xffff
  s_mov_b32 exec_hi, 0x0
  buffer_store_dwordx4 v[12:15], v55, s[24:27], s76 offen sc1
  s_mov_b64 exec, -1
  s_nop 1
  s_branch L_back_34
L_slow_35:
  s_mov_b64 exec, s[62:63]
  buffer_store_dwordx4 v[12:15], v63, s[24:27], 0 offen sc1
  s_mov_b64 exec, -1
  s_nop 1
  s_branch L_back_36
L_codeend:
.section .rodata,"a"
.p2align 6
.amdhsa_kernel sequential_preLN__sliding_block_cached__glu_gated_swiglu__decode_kernel
  .amdhsa_next_free_vgpr 168
  .amdhsa_next_free_sgpr 100
  .amdhsa_accum_offset 168
  .amdhsa_group_segment_fixed_size 0
  .amdhsa_kernarg_size 96
  .amdhsa_user_sgpr_count 2
  .amdhsa_user_sgpr_kernarg_segment_ptr 1
  .amdhsa_system_sgpr_workgroup_id_x 1
.end_amdhsa_kernel
```

```asm
; @launch grid=(256,1,1) block=(768,1,1) lds=57856
.amdgcn_target "amdgcn-amd-amdhsa--gfx950"
.text
.globl sequential_preLN__sliding_block_cached__glu_gated_swiglu__decode_kernel
.p2align 8
.type sequential_preLN__sliding_block_cached__glu_gated_swiglu__decode_kernel,@function
sequential_preLN__sliding_block_cached__glu_gated_swiglu__decode_kernel:
  s_cmp_ge_u32 s2, 256
  s_cbranch_scc1 L_end
  s_load_dwordx2 s[8:9], s[0:1], 8
  s_load_dwordx16 s[36:51], s[0:1], 0
  s_load_dwordx8 s[52:59], s[0:1], 64
  v_lshrrev_b32 v1, 6, v0
  v_and_b32 v0, 63, v0
  v_readfirstlane_b32 s3, v1
  s_and_b32 s4, s2, 7
  s_lshr_b32 s79, s2, 6
  s_lshl2_add_u32 s6, s4, s79
  s_bfe_u32 s7, s2, 0x30003
  s_cmp_lg_u32 s3, 0
  s_cbranch_scc1 L_nocpf
  s_getpc_b64 s[20:21]
L_pc0:
  s_mul_i32 s68, s7, 2048
  v_min_u32 v8, 15, v0
  v_lshl_add_u32 v8, v8, 7, s68
  v_min_u32 v8, L_codeend-L_pc0-4, v8
  global_load_dword v10, v8, s[20:21]
L_nocpf:
  v_lshrrev_b32 v2, 3, v0
  v_and_b32 v3, 7, v0
  v_lshlrev_b32 v3, 4, v3
  s_mov_b32 s11, 0x20000
  s_cmp_gt_u32 s3, 7
  s_cbranch_scc1 L_helper
  s_lshl3_add_u32 s68, s7, s3
  s_mul_i32 s60, s6, 4096
  s_add_u32 s60, s60, s68
  s_addk_i32 s60, 3584
  s_mul_i32 s60, s60, 3072
  v_mul_u32_u24 v2, 384, v2
  v_add_u32 v1, v2, v3
  s_mov_b32 s10, 402653184
  s_waitcnt lgkmcnt(0)
  buffer_load_dwordx4 v[16:19], v1, s[8:11], s60 offen offset:0 nt
  buffer_load_dwordx4 v[20:23], v1, s[8:11], s60 offen offset:128 nt
  buffer_load_dwordx4 v[24:27], v1, s[8:11], s60 offen offset:256 nt
  s_barrier
  s_branch L_stream
L_helper:
  v_lshlrev_b32 v1, 3, v0
  v_mov_b32 v4, 0
  v_mov_b32 v5, 0
  ds_write_b64 v1, v[4:5] offset:384
  s_sub_u32 s73, s3, 8
  s_cmp_eq_u32 s3, 11
  s_cbranch_scc1 L_misc
  s_mul_i32 s68, s7, 80
  v_add_u32 v7, s68, v2
  v_lshlrev_b32 v7, 1, v7
  v_mul_u32_u24 v2, 12288, v2
  v_add_u32 v2, v2, v3
  s_mul_i32 s68, s68, 12288
  s_mul_i32 s69, s6, 384
  s_add_u32 s68, s68, s69
  s_lshl_b32 s69, s73, 7
  s_add_u32 s68, s68, s69
  v_lshlrev_b32 v1, 2, v0
  s_setprio 3
  s_waitcnt lgkmcnt(0)
  s_barrier
  s_mov_b32 s8, s42
  s_mov_b32 s9, s43
  s_mov_b32 s10, 7864320
  global_load_dword v64, v1, s[36:37] offset:0
  global_load_dword v65, v1, s[36:37] offset:256
  global_load_dword v66, v1, s[36:37] offset:512
  global_load_dword v67, v1, s[36:37] offset:768
  global_load_dword v68, v1, s[36:37] offset:1024
  global_load_ushort v8, v7, s[36:37] offset:0
  global_load_ushort v9, v7, s[36:37] offset:16
  global_load_ushort v10, v7, s[36:37] offset:32
  global_load_ushort v11, v7, s[36:37] offset:48
  global_load_ushort v12, v7, s[36:37] offset:64
  global_load_ushort v13, v7, s[36:37] offset:80
  global_load_ushort v14, v7, s[36:37] offset:96
  global_load_ushort v15, v7, s[36:37] offset:112
  global_load_ushort v16, v7, s[36:37] offset:128
  global_load_ushort v17, v7, s[36:37] offset:144
  buffer_load_dwordx4 v[24:27], v2, s[8:11], s68 offen nt
  s_add_u32 s68, s68, 98304
  buffer_load_dwordx4 v[28:31], v2, s[8:11], s68 offen nt
  s_add_u32 s68, s68, 98304
  buffer_load_dwordx4 v[32:35], v2, s[8:11], s68 offen nt
  s_add_u32 s68, s68, 98304
  buffer_load_dwordx4 v[36:39], v2, s[8:11], s68 offen nt
  s_add_u32 s68, s68, 98304
  buffer_load_dwordx4 v[40:43], v2, s[8:11], s68 offen nt
  s_add_u32 s68, s68, 98304
  buffer_load_dwordx4 v[44:47], v2, s[8:11], s68 offen nt
  s_add_u32 s68, s68, 98304
  buffer_load_dwordx4 v[48:51], v2, s[8:11], s68 offen nt
  s_add_u32 s68, s68, 98304
  buffer_load_dwordx4 v[52:55], v2, s[8:11], s68 offen nt
  s_add_u32 s68, s68, 98304
  buffer_load_dwordx4 v[56:59], v2, s[8:11], s68 offen nt
  s_add_u32 s68, s68, 98304
  buffer_load_dwordx4 v[60:63], v2, s[8:11], s68 offen nt
  s_load_dwordx2 s[28:29], s[58:59], 1044480
  s_branch L_q2
L_misc:
  s_setprio 3
  s_waitcnt lgkmcnt(0)
  s_barrier
  s_load_dwordx2 s[28:29], s[58:59], 1044480
  s_branch L_misc2
L_stream:
  s_add_u32 s61, s60, 196608
  s_waitcnt vmcnt(2)
  buffer_load_dwordx4 v[28:31], v1, s[8:11], s61 offen offset:0 nt
  s_load_dwordx2 s[28:29], s[58:59], 1044480
  s_mov_b32 s24, s58
  s_mov_b32 s25, s59
  s_mov_b32 s26, 4194304
  s_mov_b32 s27, 0x20000
  s_add_u32 s32, s58, 4194304
  s_addc_u32 s33, s59, 0
  s_mov_b32 s34, 4194304
  s_mov_b32 s35, 0x20000
  s_lshl3_add_u32 s71, s6, s7
  s_lshr_b32 s79, s2, 3
  s_mov_b32 s12, s40
  s_mov_b32 s13, s41
  s_mov_b32 s14, 402653184
  s_mov_b32 s15, 0x20000
  s_waitcnt vmcnt(2)
  buffer_load_dwordx4 v[32:35], v1, s[8:11], s61 offen offset:128 nt
  s_waitcnt vmcnt(2)
  buffer_load_dwordx4 v[36:39], v1, s[8:11], s61 offen offset:256 nt
  s_add_u32 s62, s61, 196608
  s_waitcnt vmcnt(2)
  buffer_load_dwordx4 v[40:43], v1, s[8:11], s62 offen offset:0 nt
  s_waitcnt vmcnt(2)
  buffer_load_dwordx4 v[44:47], v1, s[8:11], s62 offen offset:128 nt
  s_waitcnt vmcnt(2)
  buffer_load_dwordx4 v[48:51], v1, s[8:11], s62 offen offset:256 nt
  s_add_u32 s63, s62, 196608
  s_waitcnt vmcnt(2)
  buffer_load_dwordx4 v[52:55], v1, s[8:11], s63 offen offset:0 nt
  s_waitcnt vmcnt(2)
  buffer_load_dwordx4 v[56:59], v1, s[8:11], s63 offen offset:128 nt
  s_waitcnt vmcnt(2)
  buffer_load_dwordx4 v[60:63], v1, s[8:11], s63 offen offset:256 nt
  s_add_u32 s64, s63, 196608
  s_waitcnt vmcnt(2)
  buffer_load_dwordx4 v[64:67], v1, s[8:11], s64 offen offset:0 nt
  s_waitcnt vmcnt(2)
  buffer_load_dwordx4 v[68:71], v1, s[8:11], s64 offen offset:128 nt
  s_waitcnt vmcnt(2)
  buffer_load_dwordx4 v[72:75], v1, s[8:11], s64 offen offset:256 nt
  s_add_u32 s65, s64, 196608
  s_waitcnt vmcnt(2)
  buffer_load_dwordx4 v[76:79], v1, s[8:11], s65 offen offset:0 nt
  s_waitcnt vmcnt(2)
  buffer_load_dwordx4 v[80:83], v1, s[8:11], s65 offen offset:128 nt
  s_waitcnt vmcnt(2)
  buffer_load_dwordx4 v[84:87], v1, s[8:11], s65 offen offset:256 nt
  s_add_u32 s66, s65, 196608
  s_waitcnt vmcnt(2)
  buffer_load_dwordx4 v[88:91], v1, s[8:11], s66 offen offset:0 nt
  s_waitcnt vmcnt(2)
  buffer_load_dwordx4 v[92:95], v1, s[8:11], s66 offen offset:128 nt
  s_waitcnt vmcnt(2)
  buffer_load_dwordx4 v[96:99], v1, s[8:11], s66 offen offset:256 nt
  s_add_u32 s67, s66, 196608
  s_waitcnt vmcnt(2)
  buffer_load_dwordx4 v[100:103], v1, s[8:11], s67 offen offset:0 nt
  s_waitcnt vmcnt(2)
  buffer_load_dwordx4 v[104:107], v1, s[8:11], s67 offen offset:128 nt
  s_waitcnt vmcnt(2)
  buffer_load_dwordx4 v[108:111], v1, s[8:11], s67 offen offset:256 nt
  s_waitcnt vmcnt(2)
  buffer_load_dwordx4 v[112:115], v1, s[12:15], s60 offen offset:0 nt
  s_waitcnt vmcnt(2)
  buffer_load_dwordx4 v[116:119], v1, s[12:15], s60 offen offset:128 nt
  s_waitcnt vmcnt(2)
  buffer_load_dwordx4 v[120:123], v1, s[12:15], s60 offen offset:256 nt
  s_waitcnt lgkmcnt(0)
  s_mul_i32 s30, s28, 0x2c9277b5
  s_add_u32 s30, s30, 0xac564b05
  s_or_b32 s30, s30, 1
  s_mul_i32 s31, s29, 0x0019660d
  s_add_u32 s31, s31, 0x3c6ef35f
  v_and_b32 v2, 3, v0
  v_min_u32 v2, 2, v2
  v_lshlrev_b32 v2, 3, v2
  s_mov_b32 s70, 200007
L_spin_1:
  ds_read_b32 v4, v2 offset:384
  s_waitcnt lgkmcnt(0)
  v_cmp_eq_u32 vcc, 0, v4
  s_nop 0
  s_cbranch_vccz L_sdone_2
  s_sleep 1
  s_sub_u32 s70, s70, 1
  s_cbranch_scc0 L_spin_1
L_sdone_2:
  ds_read_b128 v[4:7], v3 offset:0
  ds_read_b128 v[8:11], v3 offset:128
  ds_read_b128 v[12:15], v3 offset:256
  v_mov_b32 v160, 0
  v_mov_b32 v161, 0
  v_mov_b32 v162, 0
  v_mov_b32 v163, 0
  v_mov_b32 v164, 0
  v_mov_b32 v165, 0
  v_mov_b32 v166, 0
  v_mov_b32 v167, 0
  s_waitcnt vmcnt(3) lgkmcnt(0)
  v_dot2c_f32_bf16 v160, v16, v4
  v_dot2c_f32_bf16 v161, v28, v4
  v_dot2c_f32_bf16 v162, v40, v4
  v_dot2c_f32_bf16 v163, v52, v4
  v_dot2c_f32_bf16 v160, v17, v5
  v_dot2c_f32_bf16 v161, v29, v5
  v_dot2c_f32_bf16 v162, v41, v5
  v_dot2c_f32_bf16 v163, v53, v5
  v_dot2c_f32_bf16 v160, v18, v6
  v_dot2c_f32_bf16 v161, v30, v6
  v_dot2c_f32_bf16 v162, v42, v6
  v_dot2c_f32_bf16 v163, v54, v6
  v_dot2c_f32_bf16 v160, v19, v7
  v_dot2c_f32_bf16 v161, v31, v7
  v_dot2c_f32_bf16 v162, v43, v7
  v_dot2c_f32_bf16 v163, v55, v7
  v_dot2c_f32_bf16 v160, v20, v8
  v_dot2c_f32_bf16 v161, v32, v8
  v_dot2c_f32_bf16 v162, v44, v8
  v_dot2c_f32_bf16 v163, v56, v8
  v_dot2c_f32_bf16 v160, v21, v9
  v_dot2c_f32_bf16 v161, v33, v9
  v_dot2c_f32_bf16 v162, v45, v9
  v_dot2c_f32_bf16 v163, v57, v9
  v_dot2c_f32_bf16 v160, v22, v10
  v_dot2c_f32_bf16 v161, v34, v10
  v_dot2c_f32_bf16 v162, v46, v10
  v_dot2c_f32_bf16 v163, v58, v10
  v_dot2c_f32_bf16 v160, v23, v11
  v_dot2c_f32_bf16 v161, v35, v11
  v_dot2c_f32_bf16 v162, v47, v11
  v_dot2c_f32_bf16 v163, v59, v11
  v_dot2c_f32_bf16 v160, v24, v12
  v_dot2c_f32_bf16 v161, v36, v12
  v_dot2c_f32_bf16 v162, v48, v12
  v_dot2c_f32_bf16 v163, v60, v12
  v_dot2c_f32_bf16 v160, v25, v13
  v_dot2c_f32_bf16 v161, v37, v13
  v_dot2c_f32_bf16 v162, v49, v13
  v_dot2c_f32_bf16 v163, v61, v13
  v_dot2c_f32_bf16 v160, v26, v14
  v_dot2c_f32_bf16 v161, v38, v14
  v_dot2c_f32_bf16 v162, v50, v14
  v_dot2c_f32_bf16 v163, v62, v14
  v_dot2c_f32_bf16 v160, v27, v15
  v_dot2c_f32_bf16 v161, v39, v15
  v_dot2c_f32_bf16 v162, v51, v15
  v_dot2c_f32_bf16 v163, v63, v15
  v_dot2c_f32_bf16 v164, v64, v4
  v_dot2c_f32_bf16 v165, v76, v4
  v_dot2c_f32_bf16 v166, v88, v4
  v_dot2c_f32_bf16 v167, v100, v4
  v_dot2c_f32_bf16 v164, v65, v5
  v_dot2c_f32_bf16 v165, v77, v5
  v_dot2c_f32_bf16 v166, v89, v5
  v_dot2c_f32_bf16 v167, v101, v5
  v_dot2c_f32_bf16 v164, v66, v6
  v_dot2c_f32_bf16 v165, v78, v6
  v_dot2c_f32_bf16 v166, v90, v6
  v_dot2c_f32_bf16 v167, v102, v6
  v_dot2c_f32_bf16 v164, v67, v7
  v_dot2c_f32_bf16 v165, v79, v7
  v_dot2c_f32_bf16 v166, v91, v7
  v_dot2c_f32_bf16 v167, v103, v7
  v_dot2c_f32_bf16 v164, v68, v8
  v_dot2c_f32_bf16 v165, v80, v8
  v_dot2c_f32_bf16 v166, v92, v8
  v_dot2c_f32_bf16 v167, v104, v8
  v_dot2c_f32_bf16 v164, v69, v9
  v_dot2c_f32_bf16 v165, v81, v9
  v_dot2c_f32_bf16 v166, v93, v9
  v_dot2c_f32_bf16 v167, v105, v9
  v_dot2c_f32_bf16 v164, v70, v10
  v_dot2c_f32_bf16 v165, v82, v10
  v_dot2c_f32_bf16 v166, v94, v10
  v_dot2c_f32_bf16 v167, v106, v10
  v_dot2c_f32_bf16 v164, v71, v11
  v_dot2c_f32_bf16 v165, v83, v11
  v_dot2c_f32_bf16 v166, v95, v11
  v_dot2c_f32_bf16 v167, v107, v11
  v_dot2c_f32_bf16 v164, v72, v12
  v_dot2c_f32_bf16 v165, v84, v12
  v_dot2c_f32_bf16 v166, v96, v12
  v_dot2c_f32_bf16 v167, v108, v12
  v_dot2c_f32_bf16 v164, v73, v13
  v_dot2c_f32_bf16 v165, v85, v13
  v_dot2c_f32_bf16 v166, v97, v13
  v_dot2c_f32_bf16 v167, v109, v13
  v_dot2c_f32_bf16 v164, v74, v14
  v_dot2c_f32_bf16 v165, v86, v14
  v_dot2c_f32_bf16 v166, v98, v14
  v_dot2c_f32_bf16 v167, v110, v14
  v_dot2c_f32_bf16 v164, v75, v15
  v_dot2c_f32_bf16 v165, v87, v15
  v_dot2c_f32_bf16 v166, v99, v15
  v_dot2c_f32_bf16 v167, v111, v15
  v_add_f32_dpp v160, v160, v160 quad_perm:[1,0,3,2] row_mask:0xf bank_mask:0xf
  v_add_f32_dpp v161, v161, v161 quad_perm:[1,0,3,2] row_mask:0xf bank_mask:0xf
  v_add_f32_dpp v162, v162, v162 quad_perm:[1,0,3,2] row_mask:0xf bank_mask:0xf
  v_add_f32_dpp v163, v163, v163 quad_perm:[1,0,3,2] row_mask:0xf bank_mask:0xf
  v_add_f32_dpp v164, v164, v164 quad_perm:[1,0,3,2] row_mask:0xf bank_mask:0xf
  v_add_f32_dpp v165, v165, v165 quad_perm:[1,0,3,2] row_mask:0xf bank_mask:0xf
  v_add_f32_dpp v166, v166, v166 quad_perm:[1,0,3,2] row_mask:0xf bank_mask:0xf
  v_add_f32_dpp v167, v167, v167 quad_perm:[1,0,3,2] row_mask:0xf bank_mask:0xf
  v_add_f32_dpp v160, v160, v160 quad_perm:[2,3,0,1] row_mask:0xf bank_mask:0xf
  v_add_f32_dpp v161, v161, v161 quad_perm:[2,3,0,1] row_mask:0xf bank_mask:0xf
  v_add_f32_dpp v162, v162, v162 quad_perm:[2,3,0,1] row_mask:0xf bank_mask:0xf
  v_add_f32_dpp v163, v163, v163 quad_perm:[2,3,0,1] row_mask:0xf bank_mask:0xf
  v_add_f32_dpp v164, v164, v164 quad_perm:[2,3,0,1] row_mask:0xf bank_mask:0xf
  v_add_f32_dpp v165, v165, v165 quad_perm:[2,3,0,1] row_mask:0xf bank_mask:0xf
  v_add_f32_dpp v166, v166, v166 quad_perm:[2,3,0,1] row_mask:0xf bank_mask:0xf
  v_add_f32_dpp v167, v167, v167 quad_perm:[2,3,0,1] row_mask:0xf bank_mask:0xf
  v_add_f32_dpp v160, v160, v160 row_half_mirror row_mask:0xf bank_mask:0xf
  v_add_f32_dpp v161, v161, v161 row_half_mirror row_mask:0xf bank_mask:0xf
  v_add_f32_dpp v162, v162, v162 row_half_mirror row_mask:0xf bank_mask:0xf
  v_add_f32_dpp v163, v163, v163 row_half_mirror row_mask:0xf bank_mask:0xf
  v_add_f32_dpp v164, v164, v164 row_half_mirror row_mask:0xf bank_mask:0xf
  v_add_f32_dpp v165, v165, v165 row_half_mirror row_mask:0xf bank_mask:0xf
  v_add_f32_dpp v166, v166, v166 row_half_mirror row_mask:0xf bank_mask:0xf
  v_add_f32_dpp v167, v167, v167 row_half_mirror row_mask:0xf bank_mask:0xf
  s_mov_b32 s68, 0x3d93cd3a
  v_mov_b32 v2, 0
  v_cvt_pk_bf16_f32 v160, v2, v160
  v_cvt_pk_bf16_f32 v161, v2, v161
  v_cvt_pk_bf16_f32 v162, v2, v162
  v_cvt_pk_bf16_f32 v163, v2, v163
  v_cvt_pk_bf16_f32 v164, v2, v164
  v_cvt_pk_bf16_f32 v165, v2, v165
  v_cvt_pk_bf16_f32 v166, v2, v166
  v_cvt_pk_bf16_f32 v167, v2, v167
  v_mul_f32 v160, s68, v160
  v_mul_f32 v161, s68, v161
  v_mul_f32 v162, s68, v162
  v_mul_f32 v163, s68, v163
  v_mul_f32 v164, s68, v164
  v_mul_f32 v165, s68, v165
  v_mul_f32 v166, s68, v166
  v_mul_f32 v167, s68, v167
  v_cvt_pk_bf16_f32 v160, v2, v160
  v_cvt_pk_bf16_f32 v161, v2, v161
  v_cvt_pk_bf16_f32 v162, v2, v162
  v_cvt_pk_bf16_f32 v163, v2, v163
  v_cvt_pk_bf16_f32 v164, v2, v164
  v_cvt_pk_bf16_f32 v165, v2, v165
  v_cvt_pk_bf16_f32 v166, v2, v166
  v_cvt_pk_bf16_f32 v167, v2, v167
  v_max_f32 v4, v160, v161
  v_max3_f32 v4, v4, v162, v163
  v_max3_f32 v4, v4, v164, v165
  v_max3_f32 v4, v4, v166, v167
  s_nop 1
  v_max_f32_dpp v4, v4, v4 row_ror:8 row_mask:0xf bank_mask:0xf
  v_mov_b32 v88, v4
  s_nop 1
  v_permlane16_swap_b32 v4, v88
  v_max_f32 v4, v4, v88
  v_mov_b32 v88, v4
  s_nop 1
  v_permlane32_swap_b32 v4, v88
  v_max_f32 v4, v4, v88
  s_mov_b32 s68, 0x3fb8aa3b
  v_sub_f32 v160, v160, v4
  v_sub_f32 v161, v161, v4
  v_sub_f32 v162, v162, v4
  v_sub_f32 v163, v163, v4
  v_sub_f32 v164, v164, v4
  v_sub_f32 v165, v165, v4
  v_sub_f32 v166, v166, v4
  v_sub_f32 v167, v167, v4
  v_mul_f32 v160, s68, v160
  v_mul_f32 v161, s68, v161
  v_mul_f32 v162, s68, v162
  v_mul_f32 v163, s68, v163
  v_mul_f32 v164, s68, v164
  v_mul_f32 v165, s68, v165
  v_mul_f32 v166, s68, v166
  v_mul_f32 v167, s68, v167
  v_exp_f32 v160, v160
  v_exp_f32 v161, v161
  v_exp_f32 v162, v162
  v_exp_f32 v163, v163
  v_exp_f32 v164, v164
  v_exp_f32 v165, v165
  v_exp_f32 v166, v166
  v_exp_f32 v167, v167
  v_add_f32 v5, v160, v161
  v_add_f32 v5, v5, v162
  v_add_f32 v5, v5, v163
  v_add_f32 v5, v5, v164
  v_add_f32 v5, v5, v165
  v_add_f32 v5, v5, v166
  v_add_f32 v5, v5, v167
  s_nop 1
  v_add_f32_dpp v5, v5, v5 row_ror:8 row_mask:0xf bank_mask:0xf
  v_mov_b32 v88, v5
  s_nop 1
  v_permlane16_swap_b32 v5, v88
  v_add_f32 v5, v5, v88
  v_mov_b32 v88, v5
  s_nop 1
  v_permlane32_swap_b32 v5, v88
  v_add_f32 v5, v5, v88
  s_lshl_b32 s69, s3, 4
  v_mov_b32 v88, s69
  v_mov_b32 v6, 1
  v_mov_b32 v7, 1
  ds_write_b128 v88, v[4:7] offset:512
  v_cvt_pk_bf16_f32 v160, v160, v2
  v_cvt_pk_bf16_f32 v161, v161, v2
  v_cvt_pk_bf16_f32 v162, v162, v2
  v_cvt_pk_bf16_f32 v163, v163, v2
  v_cvt_pk_bf16_f32 v164, v164, v2
  v_cvt_pk_bf16_f32 v165, v165, v2
  v_cvt_pk_bf16_f32 v166, v166, v2
  v_cvt_pk_bf16_f32 v167, v167, v2
  v_mov_b32 v88, 0
  v_mov_b32 v89, 0
  v_mov_b32 v90, 0
  v_mov_b32 v91, 0
  v_mov_b32 v92, 0
  v_mov_b32 v93, 0
  v_mov_b32 v94, 0
  v_mov_b32 v95, 0
  v_mov_b32 v96, 0
  v_mov_b32 v97, 0
  v_mov_b32 v98, 0
  v_mov_b32 v99, 0
  v_mov_b32 v100, 0
  v_mov_b32 v101, 0
  v_mov_b32 v102, 0
  v_mov_b32 v103, 0
  v_mov_b32 v104, 0
  v_mov_b32 v105, 0
  v_mov_b32 v106, 0
  v_mov_b32 v107, 0
  v_mov_b32 v108, 0
  v_mov_b32 v109, 0
  v_mov_b32 v110, 0
  v_mov_b32 v111, 0
  v_and_b32 v8, 7, v0
  v_lshlrev_b32 v8, 5, v8
  v_lshrrev_b32 v9, 4, v0
  v_lshl_add_u32 v8, v9, 3, v8
  s_mul_i32 s69, s3, 768
  v_add_u32 v8, s69, v8
  v_mov_b32 v11, 1
  v_min_u32 v3, 47, v0
  v_lshlrev_b32 v3, 3, v3
  s_waitcnt vmcnt(2)
  buffer_load_dwordx4 v[124:127], v1, s[12:15], s61 offen offset:0 nt
  s_waitcnt vmcnt(2)
  buffer_load_dwordx4 v[128:131], v1, s[12:15], s61 offen offset:128 nt
  s_waitcnt vmcnt(2)
  buffer_load_dwordx4 v[132:135], v1, s[12:15], s61 offen offset:256 nt
  v_lshlrev_b32 v10, 16, v160
  v_dot2c_f32_bf16 v88, v112, v160
  v_dot2c_f32_bf16 v89, v112, v10
  v_dot2c_f32_bf16 v90, v113, v160
  v_dot2c_f32_bf16 v91, v113, v10
  v_dot2c_f32_bf16 v92, v114, v160
  v_dot2c_f32_bf16 v93, v114, v10
  v_dot2c_f32_bf16 v94, v115, v160
  v_dot2c_f32_bf16 v95, v115, v10
  v_dot2c_f32_bf16 v96, v116, v160
  v_dot2c_f32_bf16 v97, v116, v10
  v_dot2c_f32_bf16 v98, v117, v160
  v_dot2c_f32_bf16 v99, v117, v10
  v_dot2c_f32_bf16 v100, v118, v160
  v_dot2c_f32_bf16 v101, v118, v10
  v_dot2c_f32_bf16 v102, v119, v160
  v_dot2c_f32_bf16 v103, v119, v10
  v_dot2c_f32_bf16 v104, v120, v160
  v_dot2c_f32_bf16 v105, v120, v10
  v_dot2c_f32_bf16 v106, v121, v160
  v_dot2c_f32_bf16 v107, v121, v10
  v_dot2c_f32_bf16 v108, v122, v160
  v_dot2c_f32_bf16 v109, v122, v10
  v_dot2c_f32_bf16 v110, v123, v160
  v_dot2c_f32_bf16 v111, v123, v10
  s_waitcnt vmcnt(2)
  buffer_load_dwordx4 v[136:139], v1, s[12:15], s62 offen offset:0 nt
  s_waitcnt vmcnt(2)
  buffer_load_dwordx4 v[140:143], v1, s[12:15], s62 offen offset:128 nt
  s_waitcnt vmcnt(2)
  buffer_load_dwordx4 v[144:147], v1, s[12:15], s62 offen offset:256 nt
  v_lshlrev_b32 v10, 16, v161
  v_dot2c_f32_bf16 v88, v124, v161
  v_dot2c_f32_bf16 v89, v124, v10
  v_dot2c_f32_bf16 v90, v125, v161
  v_dot2c_f32_bf16 v91, v125, v10
  v_dot2c_f32_bf16 v92, v126, v161
  v_dot2c_f32_bf16 v93, v126, v10
  v_dot2c_f32_bf16 v94, v127, v161
  v_dot2c_f32_bf16 v95, v127, v10
  v_dot2c_f32_bf16 v96, v128, v161
  v_dot2c_f32_bf16 v97, v128, v10
  v_dot2c_f32_bf16 v98, v129, v161
  v_dot2c_f32_bf16 v99, v129, v10
  v_dot2c_f32_bf16 v100, v130, v161
  v_dot2c_f32_bf16 v101, v130, v10
  v_dot2c_f32_bf16 v102, v131, v161
  v_dot2c_f32_bf16 v103, v131, v10
  v_dot2c_f32_bf16 v104, v132, v161
  v_dot2c_f32_bf16 v105, v132, v10
  v_dot2c_f32_bf16 v106, v133, v161
  v_dot2c_f32_bf16 v107, v133, v10
  v_dot2c_f32_bf16 v108, v134, v161
  v_dot2c_f32_bf16 v109, v134, v10
  v_dot2c_f32_bf16 v110, v135, v161
  v_dot2c_f32_bf16 v111, v135, v10
  s_waitcnt vmcnt(2)
  buffer_load_dwordx4 v[148:151], v1, s[12:15], s63 offen offset:0 nt
  s_waitcnt vmcnt(2)
  buffer_load_dwordx4 v[152:155], v1, s[12:15], s63 offen offset:128 nt
  s_waitcnt vmcnt(2)
  buffer_load_dwordx4 v[156:159], v1, s[12:15], s63 offen offset:256 nt
  v_lshlrev_b32 v10, 16, v162
  v_dot2c_f32_bf16 v88, v136, v162
  v_dot2c_f32_bf16 v89, v136, v10
  v_dot2c_f32_bf16 v90, v137, v162
  v_dot2c_f32_bf16 v91, v137, v10
  v_dot2c_f32_bf16 v92, v138, v162
  v_dot2c_f32_bf16 v93, v138, v10
  v_dot2c_f32_bf16 v94, v139, v162
  v_dot2c_f32_bf16 v95, v139, v10
  v_dot2c_f32_bf16 v96, v140, v162
  v_dot2c_f32_bf16 v97, v140, v10
  v_dot2c_f32_bf16 v98, v141, v162
  v_dot2c_f32_bf16 v99, v141, v10
  v_dot2c_f32_bf16 v100, v142, v162
  v_dot2c_f32_bf16 v101, v142, v10
  v_dot2c_f32_bf16 v102, v143, v162
  v_dot2c_f32_bf16 v103, v143, v10
  v_dot2c_f32_bf16 v104, v144, v162
  v_dot2c_f32_bf16 v105, v144, v10
  v_dot2c_f32_bf16 v106, v145, v162
  v_dot2c_f32_bf16 v107, v145, v10
  v_dot2c_f32_bf16 v108, v146, v162
  v_dot2c_f32_bf16 v109, v146, v10
  v_dot2c_f32_bf16 v110, v147, v162
  v_dot2c_f32_bf16 v111, v147, v10
  s_waitcnt vmcnt(2)
  buffer_load_dwordx4 v[16:19], v1, s[12:15], s64 offen offset:0 nt
  s_waitcnt vmcnt(2)
  buffer_load_dwordx4 v[20:23], v1, s[12:15], s64 offen offset:128 nt
  s_waitcnt vmcnt(2)
  buffer_load_dwordx4 v[24:27], v1, s[12:15], s64 offen offset:256 nt
  v_lshlrev_b32 v10, 16, v163
  v_dot2c_f32_bf16 v88, v148, v163
  v_dot2c_f32_bf16 v89, v148, v10
  v_dot2c_f32_bf16 v90, v149, v163
  v_dot2c_f32_bf16 v91, v149, v10
  v_dot2c_f32_bf16 v92, v150, v163
  v_dot2c_f32_bf16 v93, v150, v10
  v_dot2c_f32_bf16 v94, v151, v163
  v_dot2c_f32_bf16 v95, v151, v10
  v_dot2c_f32_bf16 v96, v152, v163
  v_dot2c_f32_bf16 v97, v152, v10
  v_dot2c_f32_bf16 v98, v153, v163
  v_dot2c_f32_bf16 v99, v153, v10
  v_dot2c_f32_bf16 v100, v154, v163
  v_dot2c_f32_bf16 v101, v154, v10
  v_dot2c_f32_bf16 v102, v155, v163
  v_dot2c_f32_bf16 v103, v155, v10
  v_dot2c_f32_bf16 v104, v156, v163
  v_dot2c_f32_bf16 v105, v156, v10
  v_dot2c_f32_bf16 v106, v157, v163
  v_dot2c_f32_bf16 v107, v157, v10
  v_dot2c_f32_bf16 v108, v158, v163
  v_dot2c_f32_bf16 v109, v158, v10
  v_dot2c_f32_bf16 v110, v159, v163
  v_dot2c_f32_bf16 v111, v159, v10
  s_waitcnt vmcnt(2)
  buffer_load_dwordx4 v[28:31], v1, s[12:15], s65 offen offset:0 nt
  s_waitcnt vmcnt(2)
  buffer_load_dwordx4 v[32:35], v1, s[12:15], s65 offen offset:128 nt
  s_waitcnt vmcnt(2)
  buffer_load_dwordx4 v[36:39], v1, s[12:15], s65 offen offset:256 nt
  v_lshlrev_b32 v10, 16, v164
  v_dot2c_f32_bf16 v88, v16, v164
  v_dot2c_f32_bf16 v89, v16, v10
  v_dot2c_f32_bf16 v90, v17, v164
  v_dot2c_f32_bf16 v91, v17, v10
  v_dot2c_f32_bf16 v92, v18, v164
  v_dot2c_f32_bf16 v93, v18, v10
  v_dot2c_f32_bf16 v94, v19, v164
  v_dot2c_f32_bf16 v95, v19, v10
  v_dot2c_f32_bf16 v96, v20, v164
  v_dot2c_f32_bf16 v97, v20, v10
  v_dot2c_f32_bf16 v98, v21, v164
  v_dot2c_f32_bf16 v99, v21, v10
  v_dot2c_f32_bf16 v100, v22, v164
  v_dot2c_f32_bf16 v101, v22, v10
  v_dot2c_f32_bf16 v102, v23, v164
  v_dot2c_f32_bf16 v103, v23, v10
  v_dot2c_f32_bf16 v104, v24, v164
  v_dot2c_f32_bf16 v105, v24, v10
  v_dot2c_f32_bf16 v106, v25, v164
  v_dot2c_f32_bf16 v107, v25, v10
  v_dot2c_f32_bf16 v108, v26, v164
  v_dot2c_f32_bf16 v109, v26, v10
  v_dot2c_f32_bf16 v110, v27, v164
  v_dot2c_f32_bf16 v111, v27, v10
  s_waitcnt vmcnt(2)
  buffer_load_dwordx4 v[40:43], v1, s[12:15], s66 offen offset:0 nt
  s_waitcnt vmcnt(2)
  buffer_load_dwordx4 v[44:47], v1, s[12:15], s66 offen offset:128 nt
  s_waitcnt vmcnt(2)
  buffer_load_dwordx4 v[48:51], v1, s[12:15], s66 offen offset:256 nt
  s_mov_b64 exec, 1
  ds_add_u32 v2, v11 offset:648
  s_mov_b64 exec, -1
  v_lshlrev_b32 v10, 16, v165
  v_dot2c_f32_bf16 v88, v28, v165
  v_dot2c_f32_bf16 v89, v28, v10
  v_dot2c_f32_bf16 v90, v29, v165
  v_dot2c_f32_bf16 v91, v29, v10
  v_dot2c_f32_bf16 v92, v30, v165
  v_dot2c_f32_bf16 v93, v30, v10
  v_dot2c_f32_bf16 v94, v31, v165
  v_dot2c_f32_bf16 v95, v31, v10
  v_dot2c_f32_bf16 v96, v32, v165
  v_dot2c_f32_bf16 v97, v32, v10
  v_dot2c_f32_bf16 v98, v33, v165
  v_dot2c_f32_bf16 v99, v33, v10
  v_dot2c_f32_bf16 v100, v34, v165
  v_dot2c_f32_bf16 v101, v34, v10
  v_dot2c_f32_bf16 v102, v35, v165
  v_dot2c_f32_bf16 v103, v35, v10
  v_dot2c_f32_bf16 v104, v36, v165
  v_dot2c_f32_bf16 v105, v36, v10
  v_dot2c_f32_bf16 v106, v37, v165
  v_dot2c_f32_bf16 v107, v37, v10
  v_dot2c_f32_bf16 v108, v38, v165
  v_dot2c_f32_bf16 v109, v38, v10
  v_dot2c_f32_bf16 v110, v39, v165
  v_dot2c_f32_bf16 v111, v39, v10
  s_waitcnt vmcnt(2)
  buffer_load_dwordx2 v[64:65], v3, s[12:15], s67 offen offset:0 nt
  buffer_load_dwordx2 v[66:67], v3, s[12:15], s67 offen offset:384 nt
  buffer_load_dwordx2 v[68:69], v3, s[12:15], s67 offen offset:768 nt
  s_waitcnt vmcnt(4)
  buffer_load_dwordx2 v[70:71], v3, s[12:15], s67 offen offset:1152 nt
  buffer_load_dwordx2 v[72:73], v3, s[12:15], s67 offen offset:1536 nt
  buffer_load_dwordx2 v[74:75], v3, s[12:15], s67 offen offset:1920 nt
  s_waitcnt vmcnt(6)
  buffer_load_dwordx2 v[76:77], v3, s[12:15], s67 offen offset:2304 nt
  buffer_load_dwordx2 v[78:79], v3, s[12:15], s67 offen offset:2688 nt
  s_mov_b64 exec, 1
  ds_add_u32 v2, v11 offset:644
  s_mov_b64 exec, -1
  v_lshlrev_b32 v10, 16, v166
  v_dot2c_f32_bf16 v88, v40, v166
  v_dot2c_f32_bf16 v89, v40, v10
  v_dot2c_f32_bf16 v90, v41, v166
  v_dot2c_f32_bf16 v91, v41, v10
  v_dot2c_f32_bf16 v92, v42, v166
  v_dot2c_f32_bf16 v93, v42, v10
  v_dot2c_f32_bf16 v94, v43, v166
  v_dot2c_f32_bf16 v95, v43, v10
  v_dot2c_f32_bf16 v96, v44, v166
  v_dot2c_f32_bf16 v97, v44, v10
  v_dot2c_f32_bf16 v98, v45, v166
  v_dot2c_f32_bf16 v99, v45, v10
  v_dot2c_f32_bf16 v100, v46, v166
  v_dot2c_f32_bf16 v101, v46, v10
  v_dot2c_f32_bf16 v102, v47, v166
  v_dot2c_f32_bf16 v103, v47, v10
  v_dot2c_f32_bf16 v104, v48, v166
  v_dot2c_f32_bf16 v105, v48, v10
  v_dot2c_f32_bf16 v106, v49, v166
  v_dot2c_f32_bf16 v107, v49, v10
  v_dot2c_f32_bf16 v108, v50, v166
  v_dot2c_f32_bf16 v109, v50, v10
  v_dot2c_f32_bf16 v110, v51, v166
  v_dot2c_f32_bf16 v111, v51, v10
  v_permlane32_swap_b32 v88, v92
  v_permlane32_swap_b32 v89, v93
  v_permlane32_swap_b32 v90, v94
  v_permlane32_swap_b32 v91, v95
  v_permlane32_swap_b32 v96, v100
  v_permlane32_swap_b32 v97, v101
  v_permlane32_swap_b32 v98, v102
  v_permlane32_swap_b32 v99, v103
  v_permlane32_swap_b32 v104, v108
  v_permlane32_swap_b32 v105, v109
  v_permlane32_swap_b32 v106, v110
  v_permlane32_swap_b32 v107, v111
  v_pk_add_f32 v[88:89], v[88:89], v[92:93]
  v_pk_add_f32 v[90:91], v[90:91], v[94:95]
  v_pk_add_f32 v[96:97], v[96:97], v[100:101]
  v_pk_add_f32 v[98:99], v[98:99], v[102:103]
  v_pk_add_f32 v[104:105], v[104:105], v[108:109]
  v_pk_add_f32 v[106:107], v[106:107], v[110:111]
  v_permlane16_swap_b32 v88, v90
  v_permlane16_swap_b32 v89, v91
  v_permlane16_swap_b32 v96, v98
  v_permlane16_swap_b32 v97, v99
  v_permlane16_swap_b32 v104, v106
  v_permlane16_swap_b32 v105, v107
  v_pk_add_f32 v[88:89], v[88:89], v[90:91]
  v_pk_add_f32 v[96:97], v[96:97], v[98:99]
  v_pk_add_f32 v[104:105], v[104:105], v[106:107]
  v_add_f32_dpp v88, v88, v88 row_ror:8 row_mask:0xf bank_mask:0xf
  v_add_f32_dpp v89, v89, v89 row_ror:8 row_mask:0xf bank_mask:0xf
  v_add_f32_dpp v96, v96, v96 row_ror:8 row_mask:0xf bank_mask:0xf
  v_add_f32_dpp v97, v97, v97 row_ror:8 row_mask:0xf bank_mask:0xf
  v_add_f32_dpp v104, v104, v104 row_ror:8 row_mask:0xf bank_mask:0xf
  v_add_f32_dpp v105, v105, v105 row_ror:8 row_mask:0xf bank_mask:0xf
  ds_write_b64 v8, v[88:89] offset:1024
  ds_write_b64 v8, v[96:97] offset:1280
  ds_write_b64 v8, v[104:105] offset:1536
  s_mul_i32 s69, s3, 768
  v_lshlrev_b32 v8, 1, v3
  v_add_u32 v8, s69, v8
  ds_read_b128 v[92:95], v8 offset:1024
  v_readlane_b32 s8, v167, 0
  v_readlane_b32 s10, v167, 8
  v_readlane_b32 s60, v167, 16
  v_readlane_b32 s62, v167, 24
  v_readlane_b32 s64, v167, 32
  v_readlane_b32 s66, v167, 40
  v_readlane_b32 s77, v167, 48
  v_readlane_b32 s20, v167, 56
  s_lshl_b32 s9, s8, 16
  s_lshl_b32 s11, s10, 16
  s_lshl_b32 s61, s60, 16
  s_lshl_b32 s63, s62, 16
  s_lshl_b32 s65, s64, 16
  s_lshl_b32 s76, s66, 16
  s_lshl_b32 s78, s77, 16
  s_lshl_b32 s21, s20, 16
  s_mov_b32 s70, 200007
L_spin_3:
  ds_read_b128 v[12:15], v2 offset:672
  ds_read_b32 v7, v2 offset:656
  s_waitcnt lgkmcnt(0)
  v_cmp_eq_u32 vcc, 0, v15
  s_nop 0
  s_cbranch_vccz L_sdone_4
  s_sleep 1
  s_sub_u32 s70, s70, 1
  s_cbranch_scc0 L_spin_3
L_sdone_4:
  v_sub_f32 v9, v4, v12
  v_mul_f32 v9, s68, v9
  v_exp_f32 v9, v9
  v_readfirstlane_b32 s46, v7
  v_mul_f32 v9, v9, v13
  v_min_u32 v12, 47, v0
  v_lshrrev_b32 v13, 1, v12
  v_and_b32 v14, 1, v12
  v_lshl_add_u32 v13, v13, 4, v14
  v_lshlrev_b32 v13, 4, v13
  v_lshlrev_b32 v12, 4, v12
  s_mul_i32 s74, s6, 6144
  s_lshl_b32 s75, s7, 5
  s_add_u32 s74, s74, s75
  s_add_u32 s74, s74, 1114112
  s_lshl_b32 s75, s4, 9
  s_lshl4_add_u32 s75, s79, s75
  s_add_u32 s75, s75, 1064960
  s_mov_b32 s22, 0xaaaaaaaa
  s_mov_b32 s23, 0xaaaaaaaa
  v_mov_b32 v14, s30
  v_mov_b32 v15, s31
  s_waitcnt vmcnt(7)
  v_dot2c_f32_bf16 v92, s8, v64
  v_dot2c_f32_bf16 v93, s9, v64
  v_dot2c_f32_bf16 v94, s8, v65
  v_dot2c_f32_bf16 v95, s9, v65
  s_waitcnt vmcnt(6)
  v_dot2c_f32_bf16 v92, s10, v66
  v_dot2c_f32_bf16 v93, s11, v66
  v_dot2c_f32_bf16 v94, s10, v67
  v_dot2c_f32_bf16 v95, s11, v67
  s_waitcnt vmcnt(5)
  v_dot2c_f32_bf16 v92, s60, v68
  v_dot2c_f32_bf16 v93, s61, v68
  v_dot2c_f32_bf16 v94, s60, v69
  v_dot2c_f32_bf16 v95, s61, v69
  s_waitcnt vmcnt(4)
  v_dot2c_f32_bf16 v92, s62, v70
  v_dot2c_f32_bf16 v93, s63, v70
  v_dot2c_f32_bf16 v94, s62, v71
  v_dot2c_f32_bf16 v95, s63, v71
  s_waitcnt vmcnt(3)
  v_dot2c_f32_bf16 v92, s64, v72
  v_dot2c_f32_bf16 v93, s65, v72
  v_dot2c_f32_bf16 v94, s64, v73
  v_dot2c_f32_bf16 v95, s65, v73
  s_waitcnt vmcnt(2)
  v_dot2c_f32_bf16 v92, s66, v74
  v_dot2c_f32_bf16 v93, s76, v74
  v_dot2c_f32_bf16 v94, s66, v75
  v_dot2c_f32_bf16 v95, s76, v75
  s_waitcnt vmcnt(1)
  v_dot2c_f32_bf16 v92, s77, v76
  v_dot2c_f32_bf16 v93, s78, v76
  v_dot2c_f32_bf16 v94, s77, v77
  v_dot2c_f32_bf16 v95, s78, v77
  s_waitcnt vmcnt(0)
  v_dot2c_f32_bf16 v92, s20, v78
  v_dot2c_f32_bf16 v93, s21, v78
  v_dot2c_f32_bf16 v94, s20, v79
  v_dot2c_f32_bf16 v95, s21, v79
  v_mul_f32 v92, v9, v92
  v_mul_f32 v93, v9, v93
  v_mul_f32 v94, v9, v94
  v_mul_f32 v95, v9, v95
  ds_write_b128 v8, v[92:95] offset:1024
  s_mov_b64 exec, 1
  ds_add_rtn_u32 v10, v2, v11 offset:640
  s_mov_b64 exec, -1
  ds_read_b128 v[16:19], v12 offset:1024
  ds_read_b128 v[20:23], v12 offset:1792
  ds_read_b128 v[24:27], v12 offset:2560
  ds_read_b128 v[28:31], v12 offset:3328
  ds_read_b128 v[32:35], v12 offset:4096
  ds_read_b128 v[36:39], v12 offset:4864
  ds_read_b128 v[40:43], v12 offset:5632
  ds_read_b128 v[44:47], v12 offset:6400
  s_waitcnt lgkmcnt(8)
  v_readfirstlane_b32 s68, v10
  s_nop 0
  s_cmp_lg_u32 s68, 7
  s_cbranch_scc1 L_nopub
  s_waitcnt lgkmcnt(6)
  v_pk_add_f32 v[16:17], v[16:17], v[20:21]
  v_pk_add_f32 v[18:19], v[18:19], v[22:23]
  s_waitcnt lgkmcnt(4)
  v_pk_add_f32 v[24:25], v[24:25], v[28:29]
  v_pk_add_f32 v[26:27], v[26:27], v[30:31]
  v_pk_add_f32 v[16:17], v[16:17], v[24:25]
  v_pk_add_f32 v[18:19], v[18:19], v[26:27]
  s_waitcnt lgkmcnt(2)
  v_pk_add_f32 v[32:33], v[32:33], v[36:37]
  v_pk_add_f32 v[34:35], v[34:35], v[38:39]
  s_waitcnt lgkmcnt(0)
  v_pk_add_f32 v[40:41], v[40:41], v[44:45]
  v_pk_add_f32 v[42:43], v[42:43], v[46:47]
  v_pk_add_f32 v[32:33], v[32:33], v[40:41]
  v_pk_add_f32 v[34:35], v[34:35], v[42:43]
  v_pk_add_f32 v[4:5], v[16:17], v[32:33]
  v_pk_add_f32 v[6:7], v[18:19], v[34:35]
  v_cvt_pk_bf16_f32 v8, v4, v5
  v_cvt_pk_bf16_f32 v9, v6, v7
  v_cndmask_b32 v4, v8, v14, s[22:23]
  v_cndmask_b32 v5, v9, v15, s[22:23]
  v_cndmask_b32 v6, v14, v8, s[22:23]
  v_cndmask_b32 v7, v15, v9, s[22:23]
  s_mov_b32 exec_lo, 0xffffffff
  s_mov_b32 exec_hi, 0xffff
  buffer_store_dwordx4 v[4:7], v13, s[32:35], s74 offen
  s_mov_b64 exec, -1
  s_cmp_lg_u32 s46, 1
  s_cbranch_scc1 L_slow_5
L_back_6:
  s_mov_b64 exec, 1
  ds_write_b32 v2, v11 offset:660
  s_mov_b64 exec, -1
L_nopub:
  s_cmp_eq_u32 s3, 7
  s_cbranch_scc1 L_end
  v_mov_b32 v1, 0
  s_mov_b32 s70, 200007
L_spin_7:
  ds_read_b64 v[4:5], v1 offset:664
  s_waitcnt lgkmcnt(0)
  v_cmp_eq_u32 vcc, 0, v5
  s_nop 0
  s_cbranch_vccz L_sdone_8
  s_sleep 1
  s_sub_u32 s70, s70, 1
  s_cbranch_scc0 L_spin_7
L_sdone_8:
  v_readfirstlane_b32 s5, v5
  v_readfirstlane_b32 s47, v4
  s_lshr_b32 s28, s5, 8
  s_and_b32 s5, s5, 0xff
  s_sub_u32 s5, s5, 1
  s_cmp_lt_u32 s5, 12
  s_cbranch_scc1 L_ffn
  s_cmp_lt_u32 s5, 20
  s_cbranch_scc1 L_end
  s_cmp_lt_u32 s3, 5
  s_cbranch_scc1 L_f1
  s_endpgm
L_q2:
  s_mov_b32 s69, 0xffff0000
  s_mov_b32 s24, s58
  s_mov_b32 s25, s59
  s_mov_b32 s26, 4194304
  s_mov_b32 s27, 0x20000
  s_add_u32 s32, s58, 4194304
  s_addc_u32 s33, s59, 0
  s_mov_b32 s34, 4194304
  s_mov_b32 s35, 0x20000
  s_lshl3_add_u32 s71, s6, s7
  s_lshr_b32 s79, s2, 3
  s_waitcnt lgkmcnt(0)
  s_mul_i32 s30, s28, 0x2c9277b5
  s_add_u32 s30, s30, 0xac564b05
  s_or_b32 s30, s30, 1
  s_mul_i32 s31, s29, 0x0019660d
  s_add_u32 s31, s31, 0x3c6ef35f
  s_mul_i32 s64, s4, 768
  s_add_u32 s64, s64, 1081344
  s_add_u32 s65, s79, s73
  s_cmp_eq_u32 s65, 0
  s_cselect_b32 s64, s64, 4194304
  v_mov_b32 v92, 0
  v_mov_b32 v93, 0
  v_mov_b32 v94, s30
  v_mov_b32 v95, s31
  s_mov_b64 exec, 1
  buffer_store_dwordx4 v[92:95], off, s[24:27], s64 sc1
  s_mov_b64 exec, -1
  s_waitcnt vmcnt(21)
  v_lshlrev_b32 v70, 16, v64
  v_and_b32 v71, s69, v64
  v_lshlrev_b32 v72, 16, v65
  v_and_b32 v73, s69, v65
  v_lshlrev_b32 v74, 16, v66
  v_and_b32 v75, s69, v66
  v_lshlrev_b32 v76, 16, v67
  v_and_b32 v77, s69, v67
  v_lshlrev_b32 v78, 16, v68
  v_and_b32 v79, s69, v68
  v_add_f32 v4, v70, v71
  v_add_f32 v5, v72, v73
  v_add_f32 v6, v74, v75
  v_add_f32 v7, v76, v77
  v_add_f32 v4, v4, v5
  v_add_f32 v6, v6, v7
  v_add_f32 v5, v78, v79
  v_add_f32 v4, v4, v6
  v_add_f32 v4, v4, v5
  s_nop 1
  v_add_f32_dpp v4, v4, v4 quad_perm:[1,0,3,2] row_mask:0xf bank_mask:0xf
  s_nop 1
  v_add_f32_dpp v4, v4, v4 quad_perm:[2,3,0,1] row_mask:0xf bank_mask:0xf
  s_nop 1
  v_add_f32_dpp v4, v4, v4 row_half_mirror row_mask:0xf bank_mask:0xf
  s_nop 1
  v_add_f32_dpp v4, v4, v4 row_mirror row_mask:0xf bank_mask:0xf
  v_mov_b32 v5, v4
  s_nop 1
  v_permlane16_swap_b32 v4, v5
  v_add_f32 v4, v4, v5
  v_mov_b32 v5, v4
  s_nop 1
  v_permlane32_swap_b32 v4, v5
  v_add_f32 v4, v4, v5
  v_mul_f32 v4, 0x3acccccd, v4
  v_sub_f32 v70, v70, v4
  v_sub_f32 v71, v71, v4
  v_sub_f32 v72, v72, v4
  v_sub_f32 v73, v73, v4
  v_sub_f32 v74, v74, v4
  v_sub_f32 v75, v75, v4
  v_sub_f32 v76, v76, v4
  v_sub_f32 v77, v77, v4
  v_sub_f32 v78, v78, v4
  v_sub_f32 v79, v79, v4
  v_mul_f32 v5, v70, v70
  v_fmac_f32 v5, v71, v71
  v_fmac_f32 v5, v72, v72
  v_fmac_f32 v5, v73, v73
  v_fmac_f32 v5, v74, v74
  v_fmac_f32 v5, v75, v75
  v_fmac_f32 v5, v76, v76
  v_fmac_f32 v5, v77, v77
  v_fmac_f32 v5, v78, v78
  v_fmac_f32 v5, v79, v79
  s_nop 1
  v_add_f32_dpp v5, v5, v5 quad_perm:[1,0,3,2] row_mask:0xf bank_mask:0xf
  s_nop 1
  v_add_f32_dpp v5, v5, v5 quad_perm:[2,3,0,1] row_mask:0xf bank_mask:0xf
  s_nop 1
  v_add_f32_dpp v5, v5, v5 row_half_mirror row_mask:0xf bank_mask:0xf
  s_nop 1
  v_add_f32_dpp v5, v5, v5 row_mirror row_mask:0xf bank_mask:0xf
  v_mov_b32 v6, v5
  s_nop 1
  v_permlane16_swap_b32 v5, v6
  v_add_f32 v5, v5, v6
  v_mov_b32 v6, v5
  s_nop 1
  v_permlane32_swap_b32 v5, v6
  v_add_f32 v5, v5, v6
  v_mul_f32 v5, 0x3acccccd, v5
  v_cvt_pk_bf16_f32 v4, v4, v4
  v_lshlrev_b32 v4, 16, v4
  v_cvt_pk_bf16_f32 v5, v5, v5
  v_lshlrev_b32 v5, 16, v5
  v_add_f32 v5, 0x3727c5ac, v5
  v_cvt_pk_bf16_f32 v5, v5, v5
  v_lshlrev_b32 v5, 16, v5
  v_sqrt_f32 v5, v5
  s_nop 0
  v_cvt_pk_bf16_f32 v5, v5, v5
  v_lshlrev_b32 v5, 16, v5
  v_rcp_f32 v5, v5
  v_mov_b32 v6, 0
  s_waitcnt vmcnt(11)
  v_lshlrev_b32 v8, 16, v8
  v_lshlrev_b32 v9, 16, v9
  v_lshlrev_b32 v10, 16, v10
  v_lshlrev_b32 v11, 16, v11
  v_lshlrev_b32 v12, 16, v12
  v_lshlrev_b32 v13, 16, v13
  v_lshlrev_b32 v14, 16, v14
  v_lshlrev_b32 v15, 16, v15
  v_lshlrev_b32 v16, 16, v16
  v_lshlrev_b32 v17, 16, v17
  v_sub_f32 v8, v8, v4
  v_sub_f32 v9, v9, v4
  v_sub_f32 v10, v10, v4
  v_sub_f32 v11, v11, v4
  v_sub_f32 v12, v12, v4
  v_sub_f32 v13, v13, v4
  v_sub_f32 v14, v14, v4
  v_sub_f32 v15, v15, v4
  v_sub_f32 v16, v16, v4
  v_sub_f32 v17, v17, v4
  v_cvt_pk_bf16_f32 v8, v6, v8
  v_cvt_pk_bf16_f32 v9, v6, v9
  v_cvt_pk_bf16_f32 v10, v6, v10
  v_cvt_pk_bf16_f32 v11, v6, v11
  v_cvt_pk_bf16_f32 v12, v6, v12
  v_cvt_pk_bf16_f32 v13, v6, v13
  v_cvt_pk_bf16_f32 v14, v6, v14
  v_cvt_pk_bf16_f32 v15, v6, v15
  v_cvt_pk_bf16_f32 v16, v6, v16
  v_cvt_pk_bf16_f32 v17, v6, v17
  v_mul_f32 v8, v8, v5
  v_mul_f32 v9, v9, v5
  v_mul_f32 v10, v10, v5
  v_mul_f32 v11, v11, v5
  v_mul_f32 v12, v12, v5
  v_mul_f32 v13, v13, v5
  v_mul_f32 v14, v14, v5
  v_mul_f32 v15, v15, v5
  v_mul_f32 v16, v16, v5
  v_mul_f32 v17, v17, v5
  v_cvt_pk_bf16_f32 v70, v6, v8
  v_cvt_pk_bf16_f32 v8, v8, v6
  v_cvt_pk_bf16_f32 v71, v6, v9
  v_cvt_pk_bf16_f32 v9, v9, v6
  v_cvt_pk_bf16_f32 v72, v6, v10
  v_cvt_pk_bf16_f32 v10, v10, v6
  v_cvt_pk_bf16_f32 v73, v6, v11
  v_cvt_pk_bf16_f32 v11, v11, v6
  v_cvt_pk_bf16_f32 v74, v6, v12
  v_cvt_pk_bf16_f32 v12, v12, v6
  v_cvt_pk_bf16_f32 v75, v6, v13
  v_cvt_pk_bf16_f32 v13, v13, v6
  v_cvt_pk_bf16_f32 v76, v6, v14
  v_cvt_pk_bf16_f32 v14, v14, v6
  v_cvt_pk_bf16_f32 v77, v6, v15
  v_cvt_pk_bf16_f32 v15, v15, v6
  v_cvt_pk_bf16_f32 v78, v6, v16
  v_cvt_pk_bf16_f32 v16, v16, v6
  v_cvt_pk_bf16_f32 v79, v6, v17
  v_cvt_pk_bf16_f32 v17, v17, v6
  v_mov_b32 v80, 0
  v_mov_b32 v81, 0
  v_mov_b32 v82, 0
  v_mov_b32 v83, 0
  v_mov_b32 v84, 0
  v_mov_b32 v85, 0
  v_mov_b32 v86, 0
  v_mov_b32 v87, 0
  v_and_b32 v90, 7, v0
  v_lshrrev_b32 v6, 5, v0
  v_lshl_add_u32 v90, v90, 1, v6
  v_lshlrev_b32 v90, 4, v90
  s_mul_i32 s60, s6, 3
  s_add_u32 s60, s60, s73
  s_lshl_b32 s60, s60, 11
  s_add_u32 s60, s60, 1114112
  s_lshl_b32 s64, s7, 8
  s_add_u32 s64, s64, s60
  s_waitcnt vmcnt(10)
  v_dot2c_f32_bf16 v80, v24, v8
  v_dot2c_f32_bf16 v81, v24, v70
  v_dot2c_f32_bf16 v82, v25, v8
  v_dot2c_f32_bf16 v83, v25, v70
  v_dot2c_f32_bf16 v84, v26, v8
  v_dot2c_f32_bf16 v85, v26, v70
  v_dot2c_f32_bf16 v86, v27, v8
  v_dot2c_f32_bf16 v87, v27, v70
  s_waitcnt vmcnt(9)
  v_dot2c_f32_bf16 v80, v28, v9
  v_dot2c_f32_bf16 v81, v28, v71
  v_dot2c_f32_bf16 v82, v29, v9
  v_dot2c_f32_bf16 v83, v29, v71
  v_dot2c_f32_bf16 v84, v30, v9
  v_dot2c_f32_bf16 v85, v30, v71
  v_dot2c_f32_bf16 v86, v31, v9
  v_dot2c_f32_bf16 v87, v31, v71
  s_waitcnt vmcnt(8)
  v_dot2c_f32_bf16 v80, v32, v10
  v_dot2c_f32_bf16 v81, v32, v72
  v_dot2c_f32_bf16 v82, v33, v10
  v_dot2c_f32_bf16 v83, v33, v72
  v_dot2c_f32_bf16 v84, v34, v10
  v_dot2c_f32_bf16 v85, v34, v72
  v_dot2c_f32_bf16 v86, v35, v10
  v_dot2c_f32_bf16 v87, v35, v72
  s_waitcnt vmcnt(7)
  v_dot2c_f32_bf16 v80, v36, v11
  v_dot2c_f32_bf16 v81, v36, v73
  v_dot2c_f32_bf16 v82, v37, v11
  v_dot2c_f32_bf16 v83, v37, v73
  v_dot2c_f32_bf16 v84, v38, v11
  v_dot2c_f32_bf16 v85, v38, v73
  v_dot2c_f32_bf16 v86, v39, v11
  v_dot2c_f32_bf16 v87, v39, v73
  s_waitcnt vmcnt(6)
  v_dot2c_f32_bf16 v80, v40, v12
  v_dot2c_f32_bf16 v81, v40, v74
  v_dot2c_f32_bf16 v82, v41, v12
  v_dot2c_f32_bf16 v83, v41, v74
  v_dot2c_f32_bf16 v84, v42, v12
  v_dot2c_f32_bf16 v85, v42, v74
  v_dot2c_f32_bf16 v86, v43, v12
  v_dot2c_f32_bf16 v87, v43, v74
  s_waitcnt vmcnt(5)
  v_dot2c_f32_bf16 v80, v44, v13
  v_dot2c_f32_bf16 v81, v44, v75
  v_dot2c_f32_bf16 v82, v45, v13
  v_dot2c_f32_bf16 v83, v45, v75
  v_dot2c_f32_bf16 v84, v46, v13
  v_dot2c_f32_bf16 v85, v46, v75
  v_dot2c_f32_bf16 v86, v47, v13
  v_dot2c_f32_bf16 v87, v47, v75
  s_waitcnt vmcnt(4)
  v_dot2c_f32_bf16 v80, v48, v14
  v_dot2c_f32_bf16 v81, v48, v76
  v_dot2c_f32_bf16 v82, v49, v14
  v_dot2c_f32_bf16 v83, v49, v76
  v_dot2c_f32_bf16 v84, v50, v14
  v_dot2c_f32_bf16 v85, v50, v76
  v_dot2c_f32_bf16 v86, v51, v14
  v_dot2c_f32_bf16 v87, v51, v76
  s_waitcnt vmcnt(3)
  v_dot2c_f32_bf16 v80, v52, v15
  v_dot2c_f32_bf16 v81, v52, v77
  v_dot2c_f32_bf16 v82, v53, v15
  v_dot2c_f32_bf16 v83, v53, v77
  v_dot2c_f32_bf16 v84, v54, v15
  v_dot2c_f32_bf16 v85, v54, v77
  v_dot2c_f32_bf16 v86, v55, v15
  v_dot2c_f32_bf16 v87, v55, v77
  s_waitcnt vmcnt(2)
  v_dot2c_f32_bf16 v80, v56, v16
  v_dot2c_f32_bf16 v81, v56, v78
  v_dot2c_f32_bf16 v82, v57, v16
  v_dot2c_f32_bf16 v83, v57, v78
  v_dot2c_f32_bf16 v84, v58, v16
  v_dot2c_f32_bf16 v85, v58, v78
  v_dot2c_f32_bf16 v86, v59, v16
  v_dot2c_f32_bf16 v87, v59, v78
  s_waitcnt vmcnt(0)
  v_dot2c_f32_bf16 v80, v60, v17
  v_dot2c_f32_bf16 v81, v60, v79
  v_dot2c_f32_bf16 v82, v61, v17
  v_dot2c_f32_bf16 v83, v61, v79
  v_dot2c_f32_bf16 v84, v62, v17
  v_dot2c_f32_bf16 v85, v62, v79
  v_dot2c_f32_bf16 v86, v63, v17
  v_dot2c_f32_bf16 v87, v63, v79
  v_permlane32_swap_b32 v80, v84
  v_permlane32_swap_b32 v81, v85
  v_permlane32_swap_b32 v82, v86
  v_permlane32_swap_b32 v83, v87
  v_add_f32 v80, v80, v84
  v_add_f32 v81, v81, v85
  v_add_f32 v82, v82, v86
  v_add_f32 v83, v83, v87
  v_mov_b32 v84, v80
  v_mov_b32 v85, v81
  v_mov_b32 v86, v82
  v_mov_b32 v87, v83
  v_permlane16_swap_b32 v80, v84
  v_permlane16_swap_b32 v81, v85
  v_permlane16_swap_b32 v82, v86
  v_permlane16_swap_b32 v83, v87
  v_add_f32 v80, v80, v84
  v_add_f32 v81, v81, v85
  v_add_f32 v82, v82, v86
  v_add_f32 v83, v83, v87
  v_add_f32_dpp v80, v80, v80 row_ror:8 row_mask:0xf bank_mask:0xf
  v_add_f32_dpp v81, v81, v81 row_ror:8 row_mask:0xf bank_mask:0xf
  v_add_f32_dpp v82, v82, v82 row_ror:8 row_mask:0xf bank_mask:0xf
  v_add_f32_dpp v83, v83, v83 row_ror:8 row_mask:0xf bank_mask:0xf
  s_mov_b32 s68, 0x07060501
  v_perm_b32 v80, v80, v83, s68
  s_mov_b32 s68, 0x07060502
  v_perm_b32 v81, v81, v83, s68
  s_mov_b32 s68, 0x07060503
  v_perm_b32 v82, v82, v83, s68
  v_mov_b32 v83, s30
  s_mov_b32 exec_lo, 0xff
  s_mov_b32 exec_hi, 0xff
  buffer_store_dwordx4 v[80:83], v90, s[32:35], s64 offen
  s_mov_b64 exec, -1
  v_lshlrev_b32 v2, 4, v0
  v_and_b32 v3, 15, v0
  v_lshl_add_u32 v3, v3, 1, v6
  v_lshlrev_b32 v3, 2, v3
  s_lshl_b32 s69, s73, 7
  v_add_u32 v3, s69, v3
  v_mov_b32 v1, 0
  s_mov_b32 s65, 0
  s_mov_b32 s61, 0x0c04000c
  s_mov_b32 s62, 0x0402010c
  s_sleep 40
  s_mov_b32 s16, s32
  s_mov_b32 s17, s33
  s_mov_b32 s18, 4194304
  s_mov_b32 s19, 0x20000
  s_mov_b32 s70, 200007
L_spin_9:
  buffer_load_dwordx4 v[8:11], v2, s[16:19], s60 offen offset:0 sc1 nt
  buffer_load_dwordx4 v[12:15], v2, s[16:19], s60 offen offset:1024 sc1 nt
  s_waitcnt vmcnt(0)
  v_cmp_ne_u32 vcc, s30, v11
  v_cmp_ne_u32 s[20:21], s30, v15
  s_nop 0
  s_or_b64 vcc, vcc, s[20:21]
  s_nop 0
  s_cbranch_vccz L_sdone_10
  s_sleep 20
  ds_read_b32 v4, v1 offset:656
  s_waitcnt lgkmcnt(0)
  v_readfirstlane_b32 s46, v4
  s_nop 0
  s_sub_u32 s68, s46, s65
  s_cmp_lg_u32 s68, 2
  s_cbranch_scc1 L_qlazy_11
  s_mov_b32 exec_lo, 0xff
  s_mov_b32 exec_hi, 0xff
  buffer_store_dwordx4 v[80:83], v90, s[24:27], s64 offen sc1
  s_mov_b64 exec, -1
  s_mov_b32 s65, 1
L_qlazy_11:
  s_and_b32 s99, s70, 7
  s_cselect_b32 s16, s32, s24
  s_cselect_b32 s17, s33, s25
  s_sub_u32 s70, s70, 1
  s_cbranch_scc0 L_spin_9
L_sdone_10:
  v_perm_b32 v11, v9, v8, s61
  v_perm_b32 v11, v10, v11, s62
  v_perm_b32 v15, v13, v12, s61
  v_perm_b32 v15, v14, v15, s62
  v_add_f32 v8, v8, v12
  v_add_f32 v9, v9, v13
  v_add_f32 v10, v10, v14
  v_add_f32 v11, v11, v15
  s_nop 0
  v_permlane32_swap_b32 v8, v10
  v_permlane32_swap_b32 v9, v11
  v_add_f32 v8, v8, v10
  v_add_f32 v9, v9, v11
  v_mov_b32 v10, v8
  v_mov_b32 v11, v9
  s_nop 0
  v_permlane16_swap_b32 v8, v10
  v_permlane16_swap_b32 v9, v11
  v_add_f32 v8, v8, v10
  v_add_f32 v9, v9, v11
  v_cvt_pk_bf16_f32 v8, v8, v9
  ds_write_b32 v3, v8 offset:0
  v_mov_b32 v1, 0
  s_mov_b32 s70, 200007
L_spin_12:
  ds_read_b32 v4, v1 offset:656
  s_waitcnt lgkmcnt(0)
  v_cmp_gt_u32 vcc, 1, v4
  s_nop 0
  s_cbranch_vccz L_sdone_13
  s_sleep 2
  s_sub_u32 s70, s70, 1
  s_cbranch_scc0 L_spin_12
L_sdone_13:
  v_readfirstlane_b32 s46, v4
  ds_read_b32 v4, v1 offset:656
  s_waitcnt lgkmcnt(0)
  v_readfirstlane_b32 s46, v4
  s_nop 0
  s_sub_u32 s68, s46, s65
  s_cmp_lg_u32 s68, 2
  s_cbranch_scc1 L_qlazy_14
  s_mov_b32 exec_lo, 0xff
  s_mov_b32 exec_hi, 0xff
  buffer_store_dwordx4 v[80:83], v90, s[24:27], s64 offen sc1
  s_mov_b64 exec, -1
  s_mov_b32 s65, 1
L_qlazy_14:
  s_lshl_b32 s69, s73, 3
  v_mov_b32 v4, s69
  v_mov_b32 v6, 1
  s_waitcnt vmcnt(0) lgkmcnt(0)
  ds_write_b32 v4, v6 offset:384
  s_cmp_lg_u32 s3, 8
  s_cbranch_scc1 L_role
  s_mul_i32 s66, s4, 768
  s_add_u32 s66, s66, 1081344
  s_mov_b32 s70, 200007
  s_load_dwordx4 s[20:23], s[58:59], s66
  s_branch L_tkw0
L_tkchk:
  s_load_dwordx4 s[20:23], s[58:59], s66 glc
L_tkw0:
  s_waitcnt lgkmcnt(0)
  s_cmp_eq_u64 s[22:23], s[30:31]
  s_cbranch_scc1 L_tkok
  s_sleep 20
  s_sub_u32 s70, s70, 1
  s_cbranch_scc0 L_tkchk
L_tkok:
  v_mov_b32 v1, 0
  s_mov_b32 s70, 200007
L_spin_15:
  ds_read_b32 v4, v1 offset:648
  s_waitcnt lgkmcnt(0)
  v_cmp_gt_u32 vcc, 8, v4
  s_nop 0
  s_cbranch_vccz L_sdone_16
  s_sleep 1
  s_sub_u32 s70, s70, 1
  s_cbranch_scc0 L_spin_15
L_sdone_16:
  s_mov_b32 s20, 1
  s_atomic_add s20, s[58:59], s66 glc
  s_mov_b32 s21, 0
  s_mov_b64 exec, 1
  s_waitcnt lgkmcnt(0)
  s_and_b32 s20, s20, 31
  s_add_u32 s20, s20, 1
  s_add_u32 s20, s20, s21
  v_mov_b32 v5, s20
  ds_write_b32 v1, v5 offset:668
  s_mov_b64 exec, -1
  s_branch L_role
L_misc2:
  s_getreg_b32 s64, hwreg(HW_REG_XCC_ID)
  s_mov_b32 s24, s58
  s_mov_b32 s25, s59
  s_mov_b32 s26, 4194304
  s_mov_b32 s27, 0x20000
  s_add_u32 s32, s58, 4194304
  s_addc_u32 s33, s59, 0
  s_mov_b32 s34, 4194304
  s_mov_b32 s35, 0x20000
  s_lshl3_add_u32 s71, s6, s7
  s_lshr_b32 s79, s2, 3
  v_and_b32 v1, 31, v0
  v_lshlrev_b32 v1, 4, v1
  v_lshrrev_b32 v2, 5, v0
  v_lshl_add_u32 v1, v2, 13, v1
  s_lshl_b32 s66, s79, 11
  s_and_b32 s68, s66, 0xffffe000
  s_add_u32 s66, s66, s68
  s_add_u32 s66, s66, 131072
  v_mov_b32 v6, 0
  v_mov_b32 v7, 0
  s_cmp_ge_u32 s79, 4
  s_cbranch_scc1 L_nopr0
  s_cmp_lg_u32 s4, 0
  s_cbranch_scc1 L_nopr0
  s_mov_b64 exec, -1
  buffer_store_dwordx4 v[4:7], v1, s[24:27], s66 offen sc1
  s_mov_b64 exec, -1
L_nopr0:
  s_waitcnt lgkmcnt(0)
  s_mul_i32 s30, s28, 0x2c9277b5
  s_add_u32 s30, s30, 0xac564b05
  s_or_b32 s30, s30, 1
  s_mul_i32 s31, s29, 0x0019660d
  s_add_u32 s31, s31, 0x3c6ef35f
  s_and_b32 s64, s64, 15
  v_mov_b32 v4, s30
  v_mov_b32 v5, s31
  v_mov_b32 v6, s64
  v_mov_b32 v7, s64
  s_lshl_b32 s68, s4, 9
  s_add_u32 s68, s68, 1056768
  s_lshl_b32 s69, s79, 4
  v_mov_b32 v1, s69
  s_mov_b64 exec, 1
  buffer_store_dwordx4 v[4:7], v1, s[32:35], s68 offen
  s_mov_b64 exec, -1
  v_and_b32 v1, 31, v0
  v_lshlrev_b32 v1, 4, v1
  s_mov_b32 s70, 12
  s_mov_b32 s46, 2
L_idpoll:
  s_sleep 16
  buffer_load_dwordx4 v[8:11], v1, s[32:35], s68 offen sc1 nt
  s_waitcnt vmcnt(0)
  v_cmp_ne_u64 vcc, s[30:31], v[8:9]
  s_nop 0
  s_cbranch_vccz L_iddone
  s_sub_u32 s70, s70, 1
  s_cbranch_scc0 L_idpoll
  s_branch L_idset
L_iddone:
  v_cmp_ne_u32 vcc, s64, v10
  s_nop 0
  s_cbranch_vccnz L_idset
  s_mov_b32 s46, 1
L_idset:
  v_mov_b32 v1, 0
  v_mov_b32 v4, s46
  ds_write_b32 v1, v4 offset:656
  s_mov_b32 s60, -1
  s_mov_b32 s61, -1
  s_lshl_b32 s67, s4, 9
  s_add_u32 s67, s67, 1069056
  s_cmp_ge_u32 s79, 4
  s_cbranch_scc1 L_nopr1
  s_waitcnt lgkmcnt(0)
  s_add_u32 s69, s66, 0
  s_memtime s[62:63]
  s_waitcnt lgkmcnt(0)
  s_load_dword s65, s[58:59], s69
  s_waitcnt lgkmcnt(0)
  s_memtime s[20:21]
  s_waitcnt lgkmcnt(0)
  s_sub_u32 s62, s20, s62
  s_min_u32 s60, s60, s62
  s_add_u32 s69, s66, 8192
  s_memtime s[62:63]
  s_waitcnt lgkmcnt(0)
  s_load_dword s65, s[58:59], s69
  s_waitcnt lgkmcnt(0)
  s_memtime s[20:21]
  s_waitcnt lgkmcnt(0)
  s_sub_u32 s62, s20, s62
  s_min_u32 s61, s61, s62
  s_add_u32 s69, s66, 128
  s_memtime s[62:63]
  s_waitcnt lgkmcnt(0)
  s_load_dword s65, s[58:59], s69
  s_waitcnt lgkmcnt(0)
  s_memtime s[20:21]
  s_waitcnt lgkmcnt(0)
  s_sub_u32 s62, s20, s62
  s_min_u32 s60, s60, s62
  s_add_u32 s69, s66, 8320
  s_memtime s[62:63]
  s_waitcnt lgkmcnt(0)
  s_load_dword s65, s[58:59], s69
  s_waitcnt lgkmcnt(0)
  s_memtime s[20:21]
  s_waitcnt lgkmcnt(0)
  s_sub_u32 s62, s20, s62
  s_min_u32 s61, s61, s62
  s_add_u32 s69, s66, 256
  s_memtime s[62:63]
  s_waitcnt lgkmcnt(0)
  s_load_dword s65, s[58:59], s69
  s_waitcnt lgkmcnt(0)
  s_memtime s[20:21]
  s_waitcnt lgkmcnt(0)
  s_sub_u32 s62, s20, s62
  s_min_u32 s60, s60, s62
  s_add_u32 s69, s66, 8448
  s_memtime s[62:63]
  s_waitcnt lgkmcnt(0)
  s_load_dword s65, s[58:59], s69
  s_waitcnt lgkmcnt(0)
  s_memtime s[20:21]
  s_waitcnt lgkmcnt(0)
  s_sub_u32 s62, s20, s62
  s_min_u32 s61, s61, s62
  s_add_u32 s69, s66, 384
  s_memtime s[62:63]
  s_waitcnt lgkmcnt(0)
  s_load_dword s65, s[58:59], s69
  s_waitcnt lgkmcnt(0)
  s_memtime s[20:21]
  s_waitcnt lgkmcnt(0)
  s_sub_u32 s62, s20, s62
  s_min_u32 s60, s60, s62
  s_add_u32 s69, s66, 8576
  s_memtime s[62:63]
  s_waitcnt lgkmcnt(0)
  s_load_dword s65, s[58:59], s69
  s_waitcnt lgkmcnt(0)
  s_memtime s[20:21]
  s_waitcnt lgkmcnt(0)
  s_sub_u32 s62, s20, s62
  s_min_u32 s61, s61, s62
  s_lshl_b32 s69, s79, 4
  v_mov_b32 v1, s69
  v_mov_b32 v4, s60
  v_mov_b32 v5, s61
  v_mov_b32 v6, s30
  v_mov_b32 v7, s31
  s_mov_b64 exec, 1
  buffer_store_dwordx4 v[4:7], v1, s[32:35], s67 offen
  s_mov_b64 exec, -1
L_nopr1:
  v_and_b32 v1, 7, v0
  v_lshlrev_b32 v1, 4, v1
  s_mov_b32 s70, 200007
L_spin_17:
  ds_read_b128 v[4:7], v1 offset:512
  s_waitcnt lgkmcnt(0)
  v_cmp_eq_u32 vcc, 0, v7
  s_nop 0
  s_cbranch_vccz L_sdone_18
  s_sleep 4
  s_sub_u32 s70, s70, 1
  s_cbranch_scc0 L_spin_17
L_sdone_18:
  s_mov_b32 s68, 0x3fb8aa3b
  v_mov_b32 v2, v4
  s_nop 1
  v_max_f32_dpp v2, v2, v2 quad_perm:[1,0,3,2] row_mask:0xf bank_mask:0xf
  s_nop 1
  v_max_f32_dpp v2, v2, v2 quad_perm:[2,3,0,1] row_mask:0xf bank_mask:0xf
  s_nop 1
  v_max_f32_dpp v2, v2, v2 row_half_mirror row_mask:0xf bank_mask:0xf
  v_sub_f32 v4, v4, v2
  v_mul_f32 v4, s68, v4
  v_exp_f32 v4, v4
  s_nop 0
  v_mul_f32 v3, v4, v5
  s_nop 1
  v_add_f32_dpp v3, v3, v3 quad_perm:[1,0,3,2] row_mask:0xf bank_mask:0xf
  s_nop 1
  v_add_f32_dpp v3, v3, v3 quad_perm:[2,3,0,1] row_mask:0xf bank_mask:0xf
  s_nop 1
  v_add_f32_dpp v3, v3, v3 row_half_mirror row_mask:0xf bank_mask:0xf
  s_lshl_b32 s68, s71, 4
  s_add_u32 s68, s68, 1052672
  v_mov_b32 v4, s30
  v_mov_b32 v5, s31
  s_mov_b32 exec_lo, 0x1
  s_mov_b32 exec_hi, 0x0
  buffer_store_dwordx4 v[2:5], v1, s[32:35], s68 offen
  s_mov_b64 exec, -1
  s_cmp_lg_u32 s46, 1
  s_cbranch_scc1 L_slow_19
L_back_20:
  s_cmp_lg_u32 s46, 1
  s_cbranch_scc1 L_noshare
  v_and_b32 v8, 7, v0
  v_lshlrev_b32 v8, 4, v8
  buffer_load_dwordx4 v[4:7], v8, s[32:35], s67 offen sc1 nt
  s_waitcnt vmcnt(0)
  v_cmp_eq_u64 vcc, s[30:31], v[6:7]
  s_nop 1
  v_cndmask_b32 v4, -1, v4, vcc
  v_cndmask_b32 v5, -1, v5, vcc
  s_nop 0
  v_min_u32_dpp v4, v4, v4 quad_perm:[1,0,3,2] row_mask:0xf bank_mask:0xf
  v_min_u32_dpp v5, v5, v5 quad_perm:[1,0,3,2] row_mask:0xf bank_mask:0xf
  s_nop 0
  v_min_u32_dpp v4, v4, v4 quad_perm:[2,3,0,1] row_mask:0xf bank_mask:0xf
  v_min_u32_dpp v5, v5, v5 quad_perm:[2,3,0,1] row_mask:0xf bank_mask:0xf
  s_nop 0
  v_min_u32_dpp v4, v4, v4 row_half_mirror row_mask:0xf bank_mask:0xf
  v_min_u32_dpp v5, v5, v5 row_half_mirror row_mask:0xf bank_mask:0xf
  s_nop 0
  v_min_u32_dpp v4, v4, v4 row_mirror row_mask:0xf bank_mask:0xf
  v_min_u32_dpp v5, v5, v5 row_mirror row_mask:0xf bank_mask:0xf
  v_mov_b32 v6, v4
  v_mov_b32 v7, v5
  s_nop 0
  v_permlane16_swap_b32 v4, v6
  v_permlane16_swap_b32 v5, v7
  v_min_u32 v4, v4, v6
  v_min_u32 v5, v5, v7
  v_readfirstlane_b32 s62, v4
  v_readfirstlane_b32 s63, v5
  s_min_u32 s60, s60, s62
  s_min_u32 s61, s61, s63
L_noshare:
  s_cmp_lt_u32 s61, s60
  s_cselect_b32 s47, 8192, 0
  v_mov_b32 v8, 0
  v_mov_b32 v4, s47
  ds_write_b32 v8, v4 offset:664
  s_lshl_b32 s74, s6, 7
  s_add_u32 s74, s74, 1052672
  s_mov_b32 s16, s32
  s_mov_b32 s17, s33
  s_mov_b32 s18, 4194304
  s_mov_b32 s19, 0x20000
  s_mov_b32 s70, 200007
L_spin_21:
  s_sleep 16
  buffer_load_dwordx4 v[4:7], v1, s[16:19], s74 offen sc1 nt
  s_waitcnt vmcnt(0)
  v_cmp_ne_u64 vcc, s[30:31], v[6:7]
  s_nop 0
  s_cbranch_vccz L_sdone_22
  s_and_b32 s99, s70, 7
  s_cmp_eq_u32 s46, 1
  s_cselect_b32 s99, 1, s99
  s_cmp_lg_u32 s99, 0
  s_cselect_b32 s16, s32, s24
  s_cselect_b32 s17, s33, s25
  s_sub_u32 s70, s70, 1
  s_cbranch_scc0 L_spin_21
L_sdone_22:
  s_mov_b32 s68, 0x3fb8aa3b
  v_mov_b32 v2, v4
  s_nop 1
  v_max_f32_dpp v2, v2, v2 quad_perm:[1,0,3,2] row_mask:0xf bank_mask:0xf
  s_nop 1
  v_max_f32_dpp v2, v2, v2 quad_perm:[2,3,0,1] row_mask:0xf bank_mask:0xf
  s_nop 1
  v_max_f32_dpp v2, v2, v2 row_half_mirror row_mask:0xf bank_mask:0xf
  v_sub_f32 v4, v4, v2
  v_mul_f32 v4, s68, v4
  v_exp_f32 v4, v4
  s_nop 0
  v_mul_f32 v3, v4, v5
  s_nop 1
  v_add_f32_dpp v3, v3, v3 quad_perm:[1,0,3,2] row_mask:0xf bank_mask:0xf
  s_nop 1
  v_add_f32_dpp v3, v3, v3 quad_perm:[2,3,0,1] row_mask:0xf bank_mask:0xf
  s_nop 1
  v_add_f32_dpp v3, v3, v3 row_half_mirror row_mask:0xf bank_mask:0xf
  v_rcp_f32 v3, v3
  v_mov_b32 v4, 1
  v_mov_b32 v5, 1
  v_mov_b32 v1, 0
  ds_write_b128 v1, v[2:5] offset:672
L_role:
  v_mov_b32 v1, 0
  s_mov_b32 s70, 200007
L_spin_23:
  ds_read_b64 v[4:5], v1 offset:664
  s_waitcnt lgkmcnt(0)
  v_cmp_eq_u32 vcc, 0, v5
  s_nop 0
  s_cbranch_vccz L_sdone_24
  s_sleep 4
  s_sub_u32 s70, s70, 1
  s_cbranch_scc0 L_spin_23
L_sdone_24:
  v_readfirstlane_b32 s5, v5
  v_readfirstlane_b32 s47, v4
  s_lshr_b32 s28, s5, 8
  s_and_b32 s5, s5, 0xff
  s_sub_u32 s5, s5, 1
  s_cmp_lt_u32 s5, 20
  s_cbranch_scc0 L_tiles
  s_mov_b32 s12, s44
  s_mov_b32 s13, s45
  s_mov_b32 s14, 7864320
  s_mov_b32 s15, 0x20000
  v_lshrrev_b32 v24, 4, v0
  v_lshlrev_b32 v24, 10, v24
  v_bfe_u32 v25, v0, 2, 2
  v_lshl_add_u32 v24, v25, 7, v24
  v_and_b32 v25, 3, v0
  v_lshl_add_u32 v24, v25, 3, v24
  s_cmp_ge_u32 s5, 10
  s_cselect_b32 s76, 1, 0
  s_mul_i32 s77, s76, 10
  s_sub_u32 s77, s5, s77
  s_lshl1_add_u32 s78, s4, s76
  s_lshl2_add_u32 s78, s78, s73
  v_lshrrev_b32 v2, 3, v0
  v_mul_u32_u24 v26, 1280, v2
  v_and_b32 v3, 7, v0
  v_lshl_add_u32 v26, v3, 4, v26
  s_mul_i32 s60, s78, 122880
  s_lshl_b32 s69, s77, 7
  s_add_u32 s60, s60, s69
  s_mul_i32 s61, s73, 12288
  v_add_u32 v24, s61, v24
  s_add_u32 s61, s61, 8704
  v_lshlrev_b32 v60, 4, v0
  s_mul_i32 s74, s78, 3072
  s_add_u32 s74, s74, 1114112
  v_lshlrev_b32 v62, 2, v0
  s_lshl_b32 s68, s73, 8
  v_add_u32 v61, s68, v62
  s_mul_i32 s75, s4, 5120
  s_lshl_b32 s69, s5, 8
  s_add_u32 s75, s75, s69
  s_and_b32 s69, s75, 0xffffe000
  s_add_u32 s75, s75, s69
  s_add_u32 s75, s75, 0
  s_xor_b32 s62, s47, 8192
  s_add_u32 s62, s62, s75
  s_add_u32 s63, s47, s75
  s_mov_b32 s66, 0xaaaaaaaa
  s_mov_b32 s67, 0xaaaaaaaa
  v_mov_b32 v50, s30
  v_mov_b32 v51, s31
  v_mov_b32 v28, 0
  v_mov_b32 v29, 1
  v_cndmask_b32 v52, 0, v50, s[66:67]
  v_cndmask_b32 v53, 0, v51, s[66:67]
  v_cndmask_b32 v54, v50, 0, s[66:67]
  v_cndmask_b32 v55, v51, 0, s[66:67]
  v_mov_b32 v1, 0
  s_mov_b32 s70, 200007
L_spin_25:
  ds_read_b32 v4, v1 offset:644
  s_waitcnt lgkmcnt(0)
  v_cmp_gt_u32 vcc, 8, v4
  s_nop 0
  s_cbranch_vccz L_sdone_26
  s_sleep 1
  s_sub_u32 s70, s70, 1
  s_cbranch_scc0 L_spin_25
L_sdone_26:
  s_mov_b32 m0, s61
  s_nop 0
  buffer_load_dwordx4 v26, s[12:15], s60 offen nt lds
  s_add_u32 s60, s60, 10240
  s_add_u32 s61, s61, 1024
  s_mov_b32 m0, s61
  s_nop 0
  buffer_load_dwordx4 v26, s[12:15], s60 offen nt lds
  s_add_u32 s60, s60, 10240
  s_add_u32 s61, s61, 1024
  s_mov_b32 m0, s61
  s_nop 0
  buffer_load_dwordx4 v26, s[12:15], s60 offen nt lds
  s_add_u32 s60, s60, 10240
  s_add_u32 s61, s61, 1024
  s_mov_b32 m0, s61
  s_nop 0
  buffer_load_dwordx4 v26, s[12:15], s60 offen nt lds
  s_add_u32 s60, s60, 10240
  s_add_u32 s61, s61, 1024
  s_mov_b32 m0, s61
  s_nop 0
  buffer_load_dwordx4 v26, s[12:15], s60 offen nt lds
  s_add_u32 s60, s60, 10240
  s_add_u32 s61, s61, 1024
  s_mov_b32 m0, s61
  s_nop 0
  buffer_load_dwordx4 v26, s[12:15], s60 offen nt lds
  s_add_u32 s60, s60, 10240
  s_add_u32 s61, s61, 1024
  s_mov_b32 m0, s61
  s_nop 0
  buffer_load_dwordx4 v26, s[12:15], s60 offen nt lds
  s_add_u32 s60, s60, 10240
  s_add_u32 s61, s61, 1024
  s_mov_b32 m0, s61
  s_nop 0
  buffer_load_dwordx4 v26, s[12:15], s60 offen nt lds
  s_add_u32 s60, s60, 10240
  s_add_u32 s61, s61, 1024
  v_mov_b32 v1, 0
  s_mov_b32 s70, 200007
L_spin_27:
  ds_read_b32 v4, v1 offset:660
  s_waitcnt lgkmcnt(0)
  v_cmp_gt_u32 vcc, 1, v4
  s_nop 0
  s_cbranch_vccz L_sdone_28
  s_sleep 1
  s_sub_u32 s70, s70, 1
  s_cbranch_scc0 L_spin_27
L_sdone_28:
  s_mov_b32 m0, s61
  s_nop 0
  buffer_load_dwordx4 v26, s[12:15], s60 offen nt lds
  s_add_u32 s60, s60, 10240
  s_add_u32 s61, s61, 1024
  s_mov_b32 m0, s61
  s_nop 0
  buffer_load_dwordx4 v26, s[12:15], s60 offen nt lds
  s_add_u32 s60, s60, 10240
  s_add_u32 s61, s61, 1024
  s_mov_b32 m0, s61
  s_nop 0
  buffer_load_dwordx4 v26, s[12:15], s60 offen nt lds
  s_add_u32 s60, s60, 10240
  s_add_u32 s61, s61, 1024
  s_mov_b32 m0, s61
  s_nop 0
  buffer_load_dwordx4 v26, s[12:15], s60 offen nt lds
L_wodone:
  s_cmp_eq_u32 s46, 1
  s_cselect_b32 s16, s32, s24
  s_cselect_b32 s17, s33, s25
  s_mov_b32 s18, 4194304
  s_mov_b32 s19, 0x20000
  s_mov_b32 s70, 200007
  s_waitcnt vmcnt(8)
  ds_read_b64_tr_b16 v[64:65], v24 offset:8704
  ds_read_b64_tr_b16 v[66:67], v24 offset:9216
  ds_read_b64_tr_b16 v[68:69], v24 offset:8736
  ds_read_b64_tr_b16 v[70:71], v24 offset:9248
  ds_read_b64_tr_b16 v[72:73], v24 offset:8768
  ds_read_b64_tr_b16 v[74:75], v24 offset:9280
  ds_read_b64_tr_b16 v[76:77], v24 offset:8800
  ds_read_b64_tr_b16 v[78:79], v24 offset:9312
  s_waitcnt vmcnt(4)
  ds_read_b64_tr_b16 v[80:81], v24 offset:12800
  ds_read_b64_tr_b16 v[82:83], v24 offset:13312
  ds_read_b64_tr_b16 v[84:85], v24 offset:12832
  ds_read_b64_tr_b16 v[86:87], v24 offset:13344
  ds_read_b64_tr_b16 v[88:89], v24 offset:12864
  ds_read_b64_tr_b16 v[90:91], v24 offset:13376
  ds_read_b64_tr_b16 v[92:93], v24 offset:12896
  ds_read_b64_tr_b16 v[94:95], v24 offset:13408
  s_waitcnt vmcnt(2)
  buffer_load_dwordx4 v[8:11], v60, s[32:35], s74 offen offset:0 sc1
  buffer_load_dwordx4 v[12:15], v60, s[32:35], s74 offen offset:1024 sc1
  buffer_load_dwordx4 v[16:19], v60, s[32:35], s74 offen offset:2048 sc1
  s_waitcnt vmcnt(3)
  ds_read_b64_tr_b16 v[96:97], v24 offset:16896
  ds_read_b64_tr_b16 v[98:99], v24 offset:17408
  ds_read_b64_tr_b16 v[100:101], v24 offset:16928
  ds_read_b64_tr_b16 v[102:103], v24 offset:17440
  ds_read_b64_tr_b16 v[104:105], v24 offset:16960
  ds_read_b64_tr_b16 v[106:107], v24 offset:17472
  ds_read_b64_tr_b16 v[108:109], v24 offset:16992
  ds_read_b64_tr_b16 v[110:111], v24 offset:17504
  s_waitcnt lgkmcnt(8)
L_opp:
  buffer_load_dwordx4 v[124:127], v60, s[16:19], s74 offen offset:0 sc1
  buffer_load_dwordx4 v[128:131], v60, s[16:19], s74 offen offset:1024 sc1
  buffer_load_dwordx4 v[132:135], v60, s[16:19], s74 offen offset:2048 sc1
  s_waitcnt vmcnt(5)
  v_xor_b32 v8, v8, v52
  v_xor_b32 v9, v9, v53
  v_xor_b32 v10, v10, v54
  v_xor_b32 v11, v11, v55
  s_nop 1
  v_mfma_f32_16x16x32_bf16 v[32:35], v[8:11], v[64:67], 0
  v_mfma_f32_16x16x32_bf16 v[36:39], v[8:11], v[68:71], 0
  v_mfma_f32_16x16x32_bf16 v[40:43], v[8:11], v[72:75], 0
  v_mfma_f32_16x16x32_bf16 v[44:47], v[8:11], v[76:79], 0
  v_or_b32 v2, v8, v9
  v_or_b32 v3, v10, v11
  s_waitcnt vmcnt(4)
  v_xor_b32 v12, v12, v52
  v_xor_b32 v13, v13, v53
  v_xor_b32 v14, v14, v54
  v_xor_b32 v15, v15, v55
  s_nop 1
  v_mfma_f32_16x16x32_bf16 v[32:35], v[12:15], v[80:83], v[32:35]
  v_mfma_f32_16x16x32_bf16 v[36:39], v[12:15], v[84:87], v[36:39]
  v_mfma_f32_16x16x32_bf16 v[40:43], v[12:15], v[88:91], v[40:43]
  v_mfma_f32_16x16x32_bf16 v[44:47], v[12:15], v[92:95], v[44:47]
  v_or3_b32 v2, v2, v12, v13
  v_or3_b32 v3, v3, v14, v15
  s_waitcnt vmcnt(3) lgkmcnt(0)
  v_xor_b32 v16, v16, v52
  v_xor_b32 v17, v17, v53
  v_xor_b32 v18, v18, v54
  v_xor_b32 v19, v19, v55
  s_nop 1
  v_mfma_f32_16x16x32_bf16 v[32:35], v[16:19], v[96:99], v[32:35]
  v_mfma_f32_16x16x32_bf16 v[36:39], v[16:19], v[100:103], v[36:39]
  v_mfma_f32_16x16x32_bf16 v[40:43], v[16:19], v[104:107], v[40:43]
  v_mfma_f32_16x16x32_bf16 v[44:47], v[16:19], v[108:111], v[44:47]
  v_or3_b32 v2, v2, v16, v17
  v_or3_b32 v3, v3, v18, v19
  v_cndmask_b32 v2, v3, v2, s[66:67]
  v_cmp_ne_u32 vcc, 0, v2
  s_nop 0
  s_cbranch_vccz L_opd
  buffer_load_dwordx4 v[8:11], v60, s[32:35], s74 offen offset:0 sc1
  buffer_load_dwordx4 v[12:15], v60, s[32:35], s74 offen offset:1024 sc1
  buffer_load_dwordx4 v[16:19], v60, s[32:35], s74 offen offset:2048 sc1
  s_waitcnt vmcnt(5)
  v_xor_b32 v124, v124, v52
  v_xor_b32 v125, v125, v53
  v_xor_b32 v126, v126, v54
  v_xor_b32 v127, v127, v55
  s_nop 1
  v_mfma_f32_16x16x32_bf16 v[32:35], v[124:127], v[64:67], 0
  v_mfma_f32_16x16x32_bf16 v[36:39], v[124:127], v[68:71], 0
  v_mfma_f32_16x16x32_bf16 v[40:43], v[124:127], v[72:75], 0
  v_mfma_f32_16x16x32_bf16 v[44:47], v[124:127], v[76:79], 0
  v_or_b32 v2, v124, v125
  v_or_b32 v3, v126, v127
  s_waitcnt vmcnt(4)
  v_xor_b32 v128, v128, v52
  v_xor_b32 v129, v129, v53
  v_xor_b32 v130, v130, v54
  v_xor_b32 v131, v131, v55
  s_nop 1
  v_mfma_f32_16x16x32_bf16 v[32:35], v[128:131], v[80:83], v[32:35]
  v_mfma_f32_16x16x32_bf16 v[36:39], v[128:131], v[84:87], v[36:39]
  v_mfma_f32_16x16x32_bf16 v[40:43], v[128:131], v[88:91], v[40:43]
  v_mfma_f32_16x16x32_bf16 v[44:47], v[128:131], v[92:95], v[44:47]
  v_or3_b32 v2, v2, v128, v129
  v_or3_b32 v3, v3, v130, v131
  s_waitcnt vmcnt(3) lgkmcnt(0)
  v_xor_b32 v132, v132, v52
  v_xor_b32 v133, v133, v53
  v_xor_b32 v134, v134, v54
  v_xor_b32 v135, v135, v55
  s_nop 1
  v_mfma_f32_16x16x32_bf16 v[32:35], v[132:135], v[96:99], v[32:35]
  v_mfma_f32_16x16x32_bf16 v[36:39], v[132:135], v[100:103], v[36:39]
  v_mfma_f32_16x16x32_bf16 v[40:43], v[132:135], v[104:107], v[40:43]
  v_mfma_f32_16x16x32_bf16 v[44:47], v[132:135], v[108:111], v[44:47]
  v_or3_b32 v2, v2, v132, v133
  v_or3_b32 v3, v3, v134, v135
  v_cndmask_b32 v2, v3, v2, s[66:67]
  v_cmp_ne_u32 vcc, 0, v2
  s_nop 0
  s_cbranch_vccz L_opd
  s_sub_u32 s70, s70, 1
  s_cbranch_scc0 L_opp
L_opd:
  v_add_f32 v4, v32, v33
  v_add_f32 v20, v34, v35
  v_add_f32 v5, v36, v37
  v_add_f32 v21, v38, v39
  v_add_f32 v6, v40, v41
  v_add_f32 v22, v42, v43
  v_add_f32 v7, v44, v45
  v_add_f32 v23, v46, v47
  v_add_f32 v4, v4, v20
  v_add_f32 v5, v5, v21
  v_add_f32 v6, v6, v22
  v_add_f32 v7, v7, v23
  s_nop 0
  v_permlane32_swap_b32 v4, v6
  v_permlane32_swap_b32 v5, v7
  v_add_f32 v4, v4, v6
  v_add_f32 v5, v5, v7
  s_nop 1
  v_permlane16_swap_b32 v4, v5
  v_add_f32 v4, v4, v5
  ds_write_b32 v61, v4 offset:7168
  s_mov_b64 exec, 1
  ds_add_rtn_u32 v27, v28, v29 offset:652
  s_mov_b64 exec, -1
  ds_read2st64_b32 v[4:5], v62 offset0:28 offset1:29
  ds_read2st64_b32 v[6:7], v62 offset0:30 offset1:31
  s_waitcnt lgkmcnt(2)
  v_readfirstlane_b32 s68, v27
  s_nop 0
  s_cmp_lg_u32 s68, 3
  s_cbranch_scc1 L_end
  s_waitcnt lgkmcnt(0)
  v_add_f32 v4, v4, v5
  v_add_f32 v6, v6, v7
  v_add_f32 v48, v4, v6
  s_nop 1
  v_mov_b32_dpp v49, v48 quad_perm:[1,0,3,2] row_mask:0xf bank_mask:0xf
  v_cvt_pk_bf16_f32 v48, v48, v49
  s_nop 1
  v_mov_b32_dpp v49, v48 quad_perm:[2,3,0,1] row_mask:0xf bank_mask:0xf
  s_mov_b32 exec_lo, 0x11111111
  s_mov_b32 exec_hi, 0x11111111
  buffer_store_dwordx4 v[48:51], v62, s[24:27], s62 offen sc1
  buffer_store_dwordx4 v[48:51], v62, s[24:27], s63 offen sc1
  s_barrier
  s_endpgm
L_tiles:
  s_mov_b32 s12, s48
  s_mov_b32 s13, s49
  s_mov_b32 s14, 1966080
  s_mov_b32 s15, 0x20000
  s_mov_b32 s16, s50
  s_mov_b32 s17, s51
  s_mov_b32 s18, 1966080
  s_mov_b32 s19, 0x20000
  s_sub_u32 s75, s5, 20
  s_lshr_b32 s78, s75, 2
  s_and_b32 s75, s75, 3
  s_mul_i32 s72, s75, 491520
  s_mul_i32 s68, s73, 24576
  s_add_u32 s72, s72, s68
  s_mul_i32 s68, s4, 3
  s_add_u32 s78, s78, s68
  s_lshl_b32 s68, s78, 7
  s_add_u32 s72, s72, s68
  s_lshl_b32 s61, s73, 10
  s_add_u32 s61, s61, 8704
  v_lshrrev_b32 v2, 3, v0
  v_and_b32 v3, 7, v0
  v_mul_u32_u24 v62, 3072, v2
  v_lshl_add_u32 v62, v3, 4, v62
  v_mov_b32 v1, 0
  s_mov_b32 s70, 200007
L_spin_29:
  ds_read_b32 v4, v1 offset:644
  s_waitcnt lgkmcnt(0)
  v_cmp_gt_u32 vcc, 8, v4
  s_nop 0
  s_cbranch_vccz L_sdone_30
  s_sleep 1
  s_sub_u32 s70, s70, 1
  s_cbranch_scc0 L_spin_29
L_sdone_30:
  s_add_u32 m0, s61, 0
  s_nop 0
  buffer_load_dwordx4 v62, s[12:15], s72 offen nt lds
  s_add_u32 m0, s61, 4096
  s_nop 0
  buffer_load_dwordx4 v62, s[16:19], s72 offen nt lds
  s_add_u32 s72, s72, 98304
  s_add_u32 m0, s61, 8192
  s_nop 0
  buffer_load_dwordx4 v62, s[12:15], s72 offen nt lds
  s_add_u32 m0, s61, 12288
  s_nop 0
  buffer_load_dwordx4 v62, s[16:19], s72 offen nt lds
  s_add_u32 s72, s72, 98304
  v_mov_b32 v1, 0
  s_mov_b32 s70, 200007
L_spin_31:
  ds_read_b32 v4, v1 offset:660
  s_waitcnt lgkmcnt(0)
  v_cmp_gt_u32 vcc, 1, v4
  s_nop 0
  s_cbranch_vccz L_sdone_32
  s_sleep 1
  s_sub_u32 s70, s70, 1
  s_cbranch_scc0 L_spin_31
L_sdone_32:
  s_add_u32 m0, s61, 16384
  s_nop 0
  buffer_load_dwordx4 v62, s[12:15], s72 offen nt lds
  s_add_u32 m0, s61, 20480
  s_nop 0
  buffer_load_dwordx4 v62, s[16:19], s72 offen nt lds
  s_add_u32 s72, s72, 98304
  s_add_u32 m0, s61, 24576
  s_nop 0
  buffer_load_dwordx4 v62, s[12:15], s72 offen nt lds
  s_add_u32 m0, s61, 28672
  s_nop 0
  buffer_load_dwordx4 v62, s[16:19], s72 offen nt lds
  s_add_u32 s72, s72, 98304
  s_add_u32 m0, s61, 32768
  s_nop 0
  buffer_load_dwordx4 v62, s[12:15], s72 offen nt lds
  s_add_u32 m0, s61, 36864
  s_nop 0
  buffer_load_dwordx4 v62, s[16:19], s72 offen nt lds
L_tdone:
  s_waitcnt vmcnt(0)
  s_barrier
  s_endpgm
L_f1:
  v_lshrrev_b32 v58, 4, v0
  v_lshlrev_b32 v58, 10, v58
  v_bfe_u32 v5, v0, 2, 2
  v_lshl_add_u32 v58, v5, 7, v58
  v_and_b32 v5, 3, v0
  v_lshl_add_u32 v58, v5, 3, v58
  s_sub_u32 s75, s5, 20
  s_lshr_b32 s78, s75, 2
  s_and_b32 s75, s75, 3
  s_mul_i32 s74, s75, 5
  s_add_u32 s74, s74, s3
  s_mul_i32 s68, s4, 3
  s_add_u32 s78, s78, s68
  s_lshl_b32 s68, s3, 5
  v_add_u32 v58, s68, v58
  v_lshrrev_b32 v3, 4, v0
  v_and_b32 v2, 7, v0
  v_lshl_add_u32 v50, v2, 2, v3
  v_lshlrev_b32 v50, 1, v50
  s_lshl_b32 s68, s74, 6
  v_add_u32 v61, s68, v50
  s_lshl_b32 s68, s3, 6
  v_add_u32 v51, s68, v50
  v_lshlrev_b32 v52, 4, v3
  v_lshlrev_b32 v54, 3, v0
  v_lshrrev_b32 v53, 3, v0
  v_mul_u32_u24 v53, 2560, v53
  v_lshl_add_u32 v53, v2, 4, v53
  s_lshl_b32 s68, s74, 7
  v_add_u32 v53, s68, v53
  v_add_u32 v59, 20480, v53
  s_add_u32 s60, s47, 0
  v_lshlrev_b32 v55, 4, v0
  v_mov_b32 v57, 0
  s_lshl2_add_u32 s76, s78, s3
  s_lshl2_add_u32 s76, s76, s75
  s_lshl_b32 s76, s76, 8
  s_add_u32 s76, s76, 2228224
  s_lshl3_add_u32 s68, s78, s75
  s_lshl_b32 s68, s68, 4
  s_add_u32 s68, s68, 2752512
  s_lshl2_add_u32 s69, s4, s75
  s_mul_i32 s69, s69, 640
  s_add_u32 s69, s69, 2785280
  v_add_u32 v63, s69, v55
  v_mov_b32 v4, s68
  s_mov_b32 s8, 0
  s_mov_b32 s9, 0x100
  v_cndmask_b32 v63, v63, v4, s[8:9]
  s_cmp_lt_u32 s5, 24
  s_cselect_b32 s62, -1, 0
  s_cselect_b32 s63, 0xff, 0
  s_or_b32 s63, s63, 0x100
  v_mov_b32 v14, s30
  v_mov_b32 v15, s31
  v_mov_b32 v44, 0x3f803f80
  v_mov_b32 v45, 0x3f803f80
  v_mov_b32 v46, 0x3f803f80
  v_mov_b32 v47, 0x3f803f80
  v_mov_b32 v8, 0
  v_mov_b32 v9, 0
  v_mov_b32 v10, 0
  v_mov_b32 v11, 0
  v_mov_b32 v112, 0x3f80
  v_mov_b32 v113, 0x3f800000
  v_mov_b32 v16, 0
  v_mov_b32 v20, 0
  v_and_b32 v4, 0xffffe000, v53
  v_add_u32 v53, v53, v4
  v_and_b32 v4, 0xffffe000, v59
  v_add_u32 v59, v59, v4
  global_load_ushort v56, v61, s[36:37]
  s_setprio 3
  s_barrier
  buffer_load_dwordx4 v[104:107], v53, s[24:27], s60 offen sc1
  buffer_load_dwordx4 v[108:111], v59, s[24:27], s60 offen sc1
  s_cmp_eq_u32 s3, 4
  s_cbranch_scc1 L_f1nob
  ds_read_b64_tr_b16 v[64:65], v58 offset:8704
  ds_read_b64_tr_b16 v[66:67], v58 offset:9216
  ds_read_b64_tr_b16 v[68:69], v58 offset:12800
  ds_read_b64_tr_b16 v[70:71], v58 offset:13312
  ds_read_b64_tr_b16 v[72:73], v58 offset:16896
  ds_read_b64_tr_b16 v[74:75], v58 offset:17408
  ds_read_b64_tr_b16 v[76:77], v58 offset:20992
  ds_read_b64_tr_b16 v[78:79], v58 offset:21504
  ds_read_b64_tr_b16 v[80:81], v58 offset:25088
  ds_read_b64_tr_b16 v[82:83], v58 offset:25600
  ds_read_b64_tr_b16 v[84:85], v58 offset:29184
  ds_read_b64_tr_b16 v[86:87], v58 offset:29696
  ds_read_b64_tr_b16 v[88:89], v58 offset:33280
  ds_read_b64_tr_b16 v[90:91], v58 offset:33792
  ds_read_b64_tr_b16 v[92:93], v58 offset:37376
  ds_read_b64_tr_b16 v[94:95], v58 offset:37888
  ds_read_b64_tr_b16 v[96:97], v58 offset:41472
  ds_read_b64_tr_b16 v[98:99], v58 offset:41984
  ds_read_b64_tr_b16 v[100:101], v58 offset:45568
  ds_read_b64_tr_b16 v[102:103], v58 offset:46080
  s_waitcnt lgkmcnt(0)
  v_mfma_f32_16x16x32_bf16 v[116:119], v[44:47], v[64:67], 0
  v_mfma_f32_16x16x32_bf16 v[124:127], v[44:47], v[68:71], 0
  v_mfma_f32_16x16x32_bf16 v[116:119], v[44:47], v[72:75], v[116:119]
  v_mfma_f32_16x16x32_bf16 v[124:127], v[44:47], v[76:79], v[124:127]
  v_mfma_f32_16x16x32_bf16 v[116:119], v[44:47], v[80:83], v[116:119]
  v_mfma_f32_16x16x32_bf16 v[124:127], v[44:47], v[84:87], v[124:127]
  v_mfma_f32_16x16x32_bf16 v[116:119], v[44:47], v[88:91], v[116:119]
  v_mfma_f32_16x16x32_bf16 v[124:127], v[44:47], v[92:95], v[124:127]
  v_mfma_f32_16x16x32_bf16 v[116:119], v[44:47], v[96:99], v[116:119]
  v_mfma_f32_16x16x32_bf16 v[124:127], v[44:47], v[100:103], v[124:127]
L_f1nob:
  s_waitcnt vmcnt(2)
  v_lshlrev_b32 v56, 16, v56
  s_mov_b32 s70, 200007
  s_branch L_ypw0
L_yppoll:
  buffer_load_dwordx4 v[104:107], v53, s[24:27], s60 offen sc1
  buffer_load_dwordx4 v[108:111], v59, s[24:27], s60 offen sc1
L_ypw0:
  s_waitcnt vmcnt(0)
  v_cmp_ne_u64 vcc, s[30:31], v[106:107]
  v_cmp_ne_u64 s[20:21], s[30:31], v[110:111]
  s_nop 0
  s_or_b64 vcc, vcc, s[20:21]
  s_nop 0
  s_cbranch_vccz L_ypok
  s_sub_u32 s70, s70, 1
  s_cbranch_scc0 L_yppoll
L_ypok:
  v_dot2c_f32_bf16 v8, v104, v112
  v_dot2c_f32_bf16 v10, v105, v112
  v_dot2c_f32_bf16 v9, v104, v113
  v_dot2c_f32_bf16 v11, v105, v113
  v_dot2c_f32_bf16 v8, v108, v112
  v_dot2c_f32_bf16 v10, v109, v112
  v_dot2c_f32_bf16 v9, v108, v113
  v_dot2c_f32_bf16 v11, v109, v113
  s_nop 0
  v_permlane32_swap_b32 v8, v10
  s_nop 0
  v_permlane32_swap_b32 v9, v11
  v_add_f32 v8, v8, v10
  v_add_f32 v9, v9, v11
  s_nop 1
  v_permlane16_swap_b32 v8, v9
  v_add_f32 v8, v8, v9
  s_nop 1
  v_add_f32_dpp v8, v8, v8 row_ror:8 row_mask:0xf bank_mask:0xf
  v_cvt_pk_bf16_f32 v8, v57, v8
  v_add_f32 v8, v8, v56
  v_cvt_pk_bf16_f32 v8, v8, v8
  ds_write_b16 v51, v8 offset:8192
  s_cmp_eq_u32 s3, 4
  s_waitcnt lgkmcnt(0)
  s_barrier
  s_cbranch_scc1 L_f1st
  ds_read_b128 v[24:27], v52 offset:8192
  ds_read_b128 v[28:31], v52 offset:8256
  ds_read_b128 v[32:35], v52 offset:8320
  ds_read_b128 v[36:39], v52 offset:8384
  ds_read_b128 v[40:43], v52 offset:8448
  s_waitcnt lgkmcnt(4)
  v_mfma_f32_16x16x32_bf16 v[16:19], v[24:27], v[64:67], 0
  v_mfma_f32_16x16x32_bf16 v[20:23], v[24:27], v[68:71], 0
  s_waitcnt lgkmcnt(3)
  v_mfma_f32_16x16x32_bf16 v[16:19], v[28:31], v[72:75], v[16:19]
  v_mfma_f32_16x16x32_bf16 v[20:23], v[28:31], v[76:79], v[20:23]
  s_waitcnt lgkmcnt(2)
  v_mfma_f32_16x16x32_bf16 v[16:19], v[32:35], v[80:83], v[16:19]
  v_mfma_f32_16x16x32_bf16 v[20:23], v[32:35], v[84:87], v[20:23]
  s_waitcnt lgkmcnt(1)
  v_mfma_f32_16x16x32_bf16 v[16:19], v[36:39], v[88:91], v[16:19]
  v_mfma_f32_16x16x32_bf16 v[20:23], v[36:39], v[92:95], v[20:23]
  s_waitcnt lgkmcnt(0)
  v_mfma_f32_16x16x32_bf16 v[16:19], v[40:43], v[96:99], v[16:19]
  v_mfma_f32_16x16x32_bf16 v[20:23], v[40:43], v[100:103], v[20:23]
  s_nop 6
  v_cvt_pk_bf16_f32 v12, v16, v116
  v_cvt_pk_bf16_f32 v13, v20, v124
  s_mov_b32 exec_lo, 0xffff
  s_mov_b32 exec_hi, 0x0
  buffer_store_dwordx4 v[12:15], v55, s[32:35], s76 offen
  s_mov_b64 exec, -1
  s_cmp_lg_u32 s46, 1
  s_cbranch_scc1 L_slow_33
L_back_34:
  s_endpgm
L_f1st:
  s_mov_b32 exec_hi, 0xff
  ds_read_b64 v[12:13], v54 offset:8192
  s_waitcnt lgkmcnt(0)
  v_dot2c_f32_bf16 v16, v12, v44
  v_dot2c_f32_bf16 v20, v12, v12
  v_dot2c_f32_bf16 v16, v13, v44
  v_dot2c_f32_bf16 v20, v13, v13
  s_mov_b32 exec_hi, -1
  s_nop 1
  v_permlane32_swap_b32 v16, v20
  v_add_f32 v16, v16, v20
  s_nop 1
  v_add_f32_dpp v16, v16, v16 quad_perm:[1,0,3,2] row_mask:0xf bank_mask:0xf
  s_nop 1
  v_add_f32_dpp v16, v16, v16 quad_perm:[2,3,0,1] row_mask:0xf bank_mask:0xf
  s_nop 1
  v_add_f32_dpp v16, v16, v16 row_half_mirror row_mask:0xf bank_mask:0xf
  s_nop 1
  v_add_f32_dpp v16, v16, v16 row_mirror row_mask:0xf bank_mask:0xf
  v_mov_b32 v20, v16
  s_nop 1
  v_permlane16_swap_b32 v16, v20
  v_add_f32 v16, v16, v20
  v_mov_b32 v20, v16
  s_nop 1
  v_permlane32_swap_b32 v16, v20
  s_waitcnt lgkmcnt(0)
  v_cndmask_b32 v12, v12, v16, s[8:9]
  v_cndmask_b32 v13, v13, v20, s[8:9]
  s_mov_b64 exec, s[62:63]
  buffer_store_dwordx4 v[12:15], v63, s[32:35], 0 offen
  s_mov_b64 exec, -1
  s_cmp_lg_u32 s46, 1
  s_cbranch_scc1 L_slow_35
L_back_36:
  s_endpgm
L_ffn:
  v_mov_b32 v57, 0
  s_mul_i32 s72, s4, 12
  s_add_u32 s72, s72, s5
  s_cmp_lt_u32 s3, 5
  s_cbranch_scc1 L_f2
  s_cmp_eq_u32 s3, 5
  s_cbranch_scc1 L_hid
  s_cmp_ge_u32 s5, 10
  s_cbranch_scc1 L_end
  s_mul_i32 s72, s4, 10
  s_add_u32 s72, s72, s5
  v_lshrrev_b32 v2, 1, v0
  v_mul_u32_u24 v2, 2560, v2
  v_and_b32 v3, 1, v0
  v_lshl_add_u32 v96, v3, 4, v2
  s_lshl_b32 s68, s72, 5
  v_add_u32 v96, s68, v96
  v_add_u32 v100, 81920, v96
  v_add_u32 v101, 163840, v96
  s_add_u32 s10, s47, 524288
  v_lshrrev_b32 v4, 4, v0
  v_lshl_add_u32 v97, v3, 2, v4
  v_lshlrev_b32 v97, 1, v97
  v_lshlrev_b32 v99, 4, v3
  v_and_b32 v98, 16, v0
  s_mul_i32 s13, s4, 2560
  s_lshl_b32 s68, s72, 5
  s_add_u32 s13, s13, s68
  s_add_u32 s13, s13, 2785280
  s_lshl_b32 s14, s72, 4
  s_mov_b32 s69, 0xffff0000
  v_and_b32 v4, 0xffffe000, v96
  v_add_u32 v96, v96, v4
  v_and_b32 v4, 0xffffe000, v100
  v_add_u32 v100, v100, v4
  v_and_b32 v4, 0xffffe000, v101
  v_add_u32 v101, v101, v4
  s_mov_b32 s64, s54
  s_mov_b32 s65, s55
  s_mov_b32 s66, 1280
  s_mov_b32 s67, 0x20000
  v_cmp_lt_u32 s[62:63], 31, v0
  s_setprio 3
  s_barrier
  buffer_load_dwordx4 v[12:15], v99, s[32:35], s13 offen nt
  v_mov_b32 v8, 0
  v_mov_b32 v9, 0
  v_mov_b32 v10, 0
  v_mov_b32 v11, 0
  v_mov_b32 v112, 0x3f80
  v_mov_b32 v113, 0x3f800000
  s_barrier
  s_mov_b32 s16, s32
  s_mov_b32 s17, s33
  s_mov_b32 s18, 4194304
  s_mov_b32 s19, 0x20000
  s_mov_b32 s70, 200007
L_spin_37:
  buffer_load_dwordx4 v[4:7], v99, s[16:19], s13 offen sc1
  buffer_load_dwordx4 v[16:19], v96, s[24:27], s10 offen sc1
  buffer_load_dwordx4 v[20:23], v100, s[24:27], s10 offen sc1
  buffer_load_dwordx4 v[24:27], v101, s[24:27], s10 offen sc1
  s_waitcnt vmcnt(0)
  v_cmp_ne_u64 vcc, s[30:31], v[6:7]
  v_cmp_ne_u64 s[20:21], s[30:31], v[18:19]
  v_cmp_ne_u64 s[22:23], s[30:31], v[22:23]
  s_or_b64 vcc, vcc, s[20:21]
  v_cmp_ne_u64 s[20:21], s[30:31], v[26:27]
  s_or_b64 vcc, vcc, s[22:23]
  s_or_b64 vcc, vcc, s[20:21]
  s_nop 0
  s_cbranch_vccz L_sdone_38
  s_and_b32 s99, s70, 7
  s_cmp_eq_u32 s46, 1
  s_cselect_b32 s99, 1, s99
  s_cmp_lg_u32 s99, 0
  s_cselect_b32 s16, s32, s24
  s_cselect_b32 s17, s33, s25
  s_sub_u32 s70, s70, 1
  s_cbranch_scc0 L_spin_37
L_sdone_38:
  v_dot2c_f32_bf16 v8, v16, v112
  v_dot2c_f32_bf16 v10, v17, v112
  v_dot2c_f32_bf16 v9, v16, v113
  v_dot2c_f32_bf16 v11, v17, v113
  v_dot2c_f32_bf16 v8, v20, v112
  v_dot2c_f32_bf16 v10, v21, v112
  v_dot2c_f32_bf16 v9, v20, v113
  v_dot2c_f32_bf16 v11, v21, v113
  v_dot2c_f32_bf16 v8, v24, v112
  v_dot2c_f32_bf16 v10, v25, v112
  v_dot2c_f32_bf16 v9, v24, v113
  v_dot2c_f32_bf16 v11, v25, v113
  v_cndmask_b32 v58, v4, v5, s[62:63]
  v_lshrrev_b32 v58, v98, v58
  v_permlane32_swap_b32 v8, v10
  v_permlane32_swap_b32 v9, v11
  v_add_f32 v8, v8, v10
  v_add_f32 v9, v9, v11
  v_lshlrev_b32 v58, 16, v58
  s_nop 0
  v_permlane16_swap_b32 v8, v9
  v_add_f32 v8, v8, v9
  s_nop 1
  v_add_f32_dpp v8, v8, v8 row_ror:8 row_mask:0xf bank_mask:0xf
  s_nop 1
  v_add_f32_dpp v8, v8, v8 row_ror:4 row_mask:0xf bank_mask:0xf
  s_nop 1
  v_add_f32_dpp v8, v8, v8 quad_perm:[2,3,0,1] row_mask:0xf bank_mask:0xf
  v_cvt_pk_bf16_f32 v8, v57, v8
  v_add_f32 v8, v8, v58
  v_cvt_pk_bf16_f32 v8, v8, v8
  s_mov_b32 exec_lo, 0x30003
  s_mov_b32 exec_hi, 0x30003
  buffer_store_short v8, v97, s[64:67], s14 offen
  s_cmp_lg_u32 s72, 0
  s_cbranch_scc1 L_fin_exit
  s_mov_b64 exec, 1
  v_mov_b32 v4, s30
  v_mov_b32 v5, s31
  s_mov_b32 s68, 1044480
  buffer_store_dwordx2 v[4:5], v57, s[24:27], s68 offen
L_fin_exit:
  s_endpgm
L_hid:
  s_endpgm
L_f2:
  s_mov_b32 s8, s52
  s_mov_b32 s9, s53
  s_mov_b32 s10, 1966080
  s_mov_b32 s11, 0x20000
  s_lshl_b32 s68, s3, 8
  v_lshlrev_b32 v58, 2, v0
  v_add_u32 v58, s68, v58
  v_lshlrev_b32 v116, 1, v58
  s_mul_i32 s68, s72, 2560
  v_add_u32 v116, s68, v116
  s_xor_b32 s78, s47, 8192
  s_add_u32 s78, s78, 524288
  s_add_u32 s77, s47, 524288
  s_mov_b32 s60, 0x05040100
  s_mov_b32 s61, 0x07060302
  s_mul_i32 s62, s72, 20480
  v_mov_b32 v40, 0
  v_mov_b32 v41, 0
  v_mov_b32 v46, s30
  v_mov_b32 v47, s31
  v_and_b32 v4, 0xffffe000, v116
  v_add_u32 v116, v116, v4
  v_lshlrev_b32 v60, 4, v0
  v_and_b32 v61, 48, v60
  s_lshr_b32 s68, s72, 2
  s_lshl_b32 s65, s68, 7
  s_add_u32 s65, s65, 2752512
  s_lshl_b32 s64, s72, 10
  s_add_u32 s64, s64, 2228224
  v_mov_b32 v8, 0
  v_mov_b32 v9, 0
  s_cmp_eq_u32 s46, 1
  s_cselect_b32 s16, s32, s24
  s_cselect_b32 s17, s33, s25
  s_mov_b32 s18, 4194304
  s_mov_b32 s19, 0x20000
  s_mov_b32 s70, 200007
  s_setprio 3
  s_barrier
  buffer_load_dword v64, v58, s[8:11], s62 offen offset:0 nt
  buffer_load_dword v65, v58, s[8:11], s62 offen offset:1280 nt
  buffer_load_dword v66, v58, s[8:11], s62 offen offset:2560 nt
  s_add_u32 s62, s62, 3840
  buffer_load_dword v67, v58, s[8:11], s62 offen offset:0 nt
  buffer_load_dword v68, v58, s[8:11], s62 offen offset:1280 nt
  buffer_load_dword v69, v58, s[8:11], s62 offen offset:2560 nt
  s_add_u32 s62, s62, 3840
  buffer_load_dword v70, v58, s[8:11], s62 offen offset:0 nt
  buffer_load_dword v71, v58, s[8:11], s62 offen offset:1280 nt
  buffer_load_dword v72, v58, s[8:11], s62 offen offset:2560 nt
  s_add_u32 s62, s62, 3840
  buffer_load_dword v73, v58, s[8:11], s62 offen offset:0 nt
  buffer_load_dword v74, v58, s[8:11], s62 offen offset:1280 nt
  buffer_load_dword v75, v58, s[8:11], s62 offen offset:2560 nt
  s_add_u32 s62, s62, 3840
  buffer_load_dword v76, v58, s[8:11], s62 offen offset:0 nt
  buffer_load_dword v77, v58, s[8:11], s62 offen offset:1280 nt
  buffer_load_dword v78, v58, s[8:11], s62 offen offset:2560 nt
  s_add_u32 s62, s62, 3840
  buffer_load_dword v79, v58, s[8:11], s62 offen offset:0 nt
  buffer_load_dwordx4 v[20:23], v61, s[32:35], s65 offen sc1 nt
  buffer_load_dwordx4 v[16:19], v60, s[32:35], s64 offen sc1 nt
  s_waitcnt vmcnt(2)
  v_perm_b32 v80, v65, v64, s60
  v_perm_b32 v88, v65, v64, s61
  v_perm_b32 v81, v67, v66, s60
  v_perm_b32 v89, v67, v66, s61
  v_perm_b32 v82, v69, v68, s60
  v_perm_b32 v90, v69, v68, s61
  v_perm_b32 v83, v71, v70, s60
  v_perm_b32 v91, v71, v70, s61
  v_perm_b32 v84, v73, v72, s60
  v_perm_b32 v92, v73, v72, s61
  v_perm_b32 v85, v75, v74, s60
  v_perm_b32 v93, v75, v74, s61
  v_perm_b32 v86, v77, v76, s60
  v_perm_b32 v94, v77, v76, s61
  v_perm_b32 v87, v79, v78, s60
  v_perm_b32 v95, v79, v78, s61
L_pap:
  buffer_load_dwordx4 v[28:31], v61, s[16:19], s65 offen sc1
  buffer_load_dwordx4 v[24:27], v60, s[16:19], s64 offen sc1
  s_waitcnt vmcnt(2)
  v_cmp_ne_u64 vcc, s[30:31], v[18:19]
  v_cmp_ne_u64 s[20:21], s[30:31], v[22:23]
  s_nop 0
  s_or_b64 vcc, vcc, s[20:21]
  s_nop 0
  s_cbranch_vccz L_pad0
  buffer_load_dwordx4 v[20:23], v61, s[32:35], s65 offen sc1
  buffer_load_dwordx4 v[16:19], v60, s[32:35], s64 offen sc1
  s_waitcnt vmcnt(2)
  v_cmp_ne_u64 vcc, s[30:31], v[26:27]
  v_cmp_ne_u64 s[20:21], s[30:31], v[30:31]
  s_nop 0
  s_or_b64 vcc, vcc, s[20:21]
  s_nop 0
  s_cbranch_vccz L_pad1
  s_sub_u32 s70, s70, 1
  s_cbranch_scc0 L_pap
L_pad1:
  v_add_f32_dpp v4, v28, v28 quad_perm:[1,0,3,2] row_mask:0xf bank_mask:0xf
  v_add_f32_dpp v5, v29, v29 quad_perm:[1,0,3,2] row_mask:0xf bank_mask:0xf
  s_nop 0
  v_add_f32_dpp v4, v4, v4 quad_perm:[2,3,0,1] row_mask:0xf bank_mask:0xf
  v_add_f32_dpp v5, v5, v5 quad_perm:[2,3,0,1] row_mask:0xf bank_mask:0xf
  v_mul_f32 v6, 0xbacccccd, v4
  v_mul_f32 v5, 0x3acccccd, v5
  v_cvt_pk_bf16_f32 v4, 1.0, v6
  v_fma_f32 v5, -v6, v6, v5
  v_dot2c_f32_bf16 v8, v24, v4
  v_dot2c_f32_bf16 v9, v25, v4
  s_branch L_paj
L_pad0:
  v_add_f32_dpp v4, v20, v20 quad_perm:[1,0,3,2] row_mask:0xf bank_mask:0xf
  v_add_f32_dpp v5, v21, v21 quad_perm:[1,0,3,2] row_mask:0xf bank_mask:0xf
  s_nop 0
  v_add_f32_dpp v4, v4, v4 quad_perm:[2,3,0,1] row_mask:0xf bank_mask:0xf
  v_add_f32_dpp v5, v5, v5 quad_perm:[2,3,0,1] row_mask:0xf bank_mask:0xf
  v_mul_f32 v6, 0xbacccccd, v4
  v_mul_f32 v5, 0x3acccccd, v5
  v_cvt_pk_bf16_f32 v4, 1.0, v6
  v_fma_f32 v5, -v6, v6, v5
  v_dot2c_f32_bf16 v8, v16, v4
  v_dot2c_f32_bf16 v9, v17, v4
L_paj:
  v_max_f32 v5, 0, v5
  v_cvt_pk_bf16_f32 v5, v57, v5
  v_add_f32 v5, 0x3727c5ac, v5
  v_permlane32_swap_b32 v8, v9
  v_cvt_pk_bf16_f32 v5, v57, v5
  v_add_f32 v8, v8, v9
  v_sqrt_f32 v5, v5
  v_mov_b32 v10, v8
  v_cvt_pk_bf16_f32 v5, v57, v5
  v_rcp_f32 v5, v5
  v_permlane16_swap_b32 v8, v10
  v_add_f32 v8, v8, v10
  v_mul_f32 v8, v8, v5
  v_cvt_pk_bf16_f32 v8, v57, v8
  v_mul_f32 v12, 0xbfb8aa3b, v8
  v_mov_b32 v9, v8
  v_exp_f32 v12, v12
  s_nop 0
  v_permlane32_swap_b32 v8, v9
  v_add_f32 v12, 1.0, v12
  v_rcp_f32 v12, v12
  s_nop 0
  v_mul_f32 v8, v8, v12
  v_cvt_pk_bf16_f32 v8, v57, v8
  v_mul_f32 v8, v8, v9
  s_nop 1
  v_mov_b32_dpp v9, v8 quad_perm:[1,0,3,2] row_mask:0xf bank_mask:0xf
  v_cvt_pk_bf16_f32 v8, v8, v9
  s_nop 0
  v_readlane_b32 s8, v8, 0
  v_readlane_b32 s9, v8, 2
  v_readlane_b32 s10, v8, 4
  v_readlane_b32 s11, v8, 6
  v_readlane_b32 s12, v8, 8
  v_readlane_b32 s13, v8, 10
  v_readlane_b32 s14, v8, 12
  v_readlane_b32 s15, v8, 14
  v_dot2c_f32_bf16 v40, s8, v80
  v_dot2c_f32_bf16 v41, s8, v88
  v_dot2c_f32_bf16 v40, s9, v81
  v_dot2c_f32_bf16 v41, s9, v89
  v_dot2c_f32_bf16 v40, s10, v82
  v_dot2c_f32_bf16 v41, s10, v90
  v_dot2c_f32_bf16 v40, s11, v83
  v_dot2c_f32_bf16 v41, s11, v91
  v_dot2c_f32_bf16 v40, s12, v84
  v_dot2c_f32_bf16 v41, s12, v92
  v_dot2c_f32_bf16 v40, s13, v85
  v_dot2c_f32_bf16 v41, s13, v93
  v_dot2c_f32_bf16 v40, s14, v86
  v_dot2c_f32_bf16 v41, s14, v94
  v_dot2c_f32_bf16 v40, s15, v87
  v_dot2c_f32_bf16 v41, s15, v95
  s_nop 2
  v_cvt_pk_bf16_f32 v44, v40, v41
  s_nop 1
  v_mov_b32_dpp v45, v44 quad_perm:[1,0,3,2] row_mask:0xf bank_mask:0xf
  s_mov_b32 exec_lo, 0x55555555
  s_mov_b32 exec_hi, 0x55555555
  buffer_store_dwordx4 v[44:47], v116, s[24:27], s78 offen sc1
  buffer_store_dwordx4 v[44:47], v116, s[24:27], s77 offen sc1
L_end:
  s_endpgm
L_slow_5:
  s_mov_b32 exec_lo, 0xffffffff
  s_mov_b32 exec_hi, 0xffff
  buffer_store_dwordx4 v[4:7], v13, s[24:27], s74 offen sc1
  s_mov_b64 exec, -1
  s_nop 1
  s_branch L_back_6
L_slow_19:
  s_mov_b32 exec_lo, 0x1
  s_mov_b32 exec_hi, 0x0
  buffer_store_dwordx4 v[2:5], v1, s[24:27], s68 offen sc1
  s_mov_b64 exec, -1
  s_nop 1
  s_branch L_back_20
L_slow_33:
  s_mov_b32 exec_lo, 0xffff
  s_mov_b32 exec_hi, 0x0
  buffer_store_dwordx4 v[12:15], v55, s[24:27], s76 offen sc1
  s_mov_b64 exec, -1
  s_nop 1
  s_branch L_back_34
L_slow_35:
  s_mov_b64 exec, s[62:63]
  buffer_store_dwordx4 v[12:15], v63, s[24:27], 0 offen sc1
  s_mov_b64 exec, -1
  s_nop 1
  s_branch L_back_36
L_codeend:
.section .rodata,"a"
.p2align 6
.amdhsa_kernel sequential_preLN__sliding_block_cached__glu_gated_swiglu__decode_kernel
  .amdhsa_next_free_vgpr 168
  .amdhsa_next_free_sgpr 100
  .amdhsa_accum_offset 168
  .amdhsa_group_segment_fixed_size 0
  .amdhsa_kernarg_size 96
  .amdhsa_user_sgpr_count 2
  .amdhsa_user_sgpr_kernarg_segment_ptr 1
  .amdhsa_system_sgpr_workgroup_id_x 1
.end_amdhsa_kernel
```

```asm
; @launch grid=(256,1,1) block=(768,1,1) lds=59392
.amdgcn_target "amdgcn-amd-amdhsa--gfx950"
.text
.globl sequential_preLN__sliding_block_cached__glu_gated_swiglu__decode_kernel
.p2align 8
.type sequential_preLN__sliding_block_cached__glu_gated_swiglu__decode_kernel,@function
sequential_preLN__sliding_block_cached__glu_gated_swiglu__decode_kernel:
  s_cmp_ge_u32 s2, 256
  s_cbranch_scc1 L_end
  s_load_dwordx2 s[8:9], s[0:1], 8
  s_load_dwordx16 s[36:51], s[0:1], 0
  s_load_dwordx8 s[52:59], s[0:1], 64
  v_lshrrev_b32 v1, 6, v0
  v_and_b32 v0, 63, v0
  v_readfirstlane_b32 s3, v1
  s_and_b32 s4, s2, 7
  s_lshr_b32 s79, s2, 6
  s_lshl2_add_u32 s6, s4, s79
  s_bfe_u32 s7, s2, 0x30003
  s_cmp_lg_u32 s3, 0
  s_cbranch_scc1 L_nocpf
  s_getpc_b64 s[20:21]
L_pc0:
  s_mul_i32 s68, s7, 2048
  v_min_u32 v8, 15, v0
  v_lshl_add_u32 v8, v8, 7, s68
  v_min_u32 v8, L_codeend-L_pc0-4, v8
  global_load_dword v10, v8, s[20:21]
L_nocpf:
  v_lshrrev_b32 v2, 3, v0
  v_and_b32 v3, 7, v0
  v_lshlrev_b32 v3, 4, v3
  s_mov_b32 s11, 0x20000
  s_cmp_gt_u32 s3, 7
  s_cbranch_scc1 L_helper
  s_lshl3_add_u32 s68, s7, s3
  s_mul_i32 s60, s6, 4096
  s_add_u32 s60, s60, s68
  s_addk_i32 s60, 3584
  s_mul_i32 s60, s60, 3072
  v_mul_u32_u24 v2, 384, v2
  v_add_u32 v1, v2, v3
  s_mov_b32 s10, 402653184
  s_waitcnt lgkmcnt(0)
  buffer_load_dwordx4 v[16:19], v1, s[8:11], s60 offen offset:0 nt
  buffer_load_dwordx4 v[20:23], v1, s[8:11], s60 offen offset:128 nt
  buffer_load_dwordx4 v[24:27], v1, s[8:11], s60 offen offset:256 nt
  s_barrier
  s_branch L_stream
L_helper:
  v_lshlrev_b32 v1, 3, v0
  v_mov_b32 v4, 0
  v_mov_b32 v5, 0
  ds_write_b64 v1, v[4:5] offset:384
  s_sub_u32 s73, s3, 8
  s_cmp_eq_u32 s3, 11
  s_cbranch_scc1 L_misc
  s_mul_i32 s68, s7, 80
  v_add_u32 v7, s68, v2
  v_lshlrev_b32 v7, 1, v7
  v_mul_u32_u24 v2, 12288, v2
  v_add_u32 v2, v2, v3
  s_mul_i32 s68, s68, 12288
  s_mul_i32 s69, s6, 384
  s_add_u32 s68, s68, s69
  s_lshl_b32 s69, s73, 7
  s_add_u32 s68, s68, s69
  v_lshlrev_b32 v1, 2, v0
  s_setprio 3
  s_waitcnt lgkmcnt(0)
  s_barrier
  s_mov_b32 s8, s42
  s_mov_b32 s9, s43
  s_mov_b32 s10, 7864320
  global_load_dword v64, v1, s[36:37] offset:0
  global_load_dword v65, v1, s[36:37] offset:256
  global_load_dword v66, v1, s[36:37] offset:512
  global_load_dword v67, v1, s[36:37] offset:768
  global_load_dword v68, v1, s[36:37] offset:1024
  global_load_ushort v8, v7, s[36:37] offset:0
  global_load_ushort v9, v7, s[36:37] offset:16
  global_load_ushort v10, v7, s[36:37] offset:32
  global_load_ushort v11, v7, s[36:37] offset:48
  global_load_ushort v12, v7, s[36:37] offset:64
  global_load_ushort v13, v7, s[36:37] offset:80
  global_load_ushort v14, v7, s[36:37] offset:96
  global_load_ushort v15, v7, s[36:37] offset:112
  global_load_ushort v16, v7, s[36:37] offset:128
  global_load_ushort v17, v7, s[36:37] offset:144
  buffer_load_dwordx4 v[24:27], v2, s[8:11], s68 offen nt
  s_add_u32 s68, s68, 98304
  buffer_load_dwordx4 v[28:31], v2, s[8:11], s68 offen nt
  s_add_u32 s68, s68, 98304
  buffer_load_dwordx4 v[32:35], v2, s[8:11], s68 offen nt
  s_add_u32 s68, s68, 98304
  buffer_load_dwordx4 v[36:39], v2, s[8:11], s68 offen nt
  s_add_u32 s68, s68, 98304
  buffer_load_dwordx4 v[40:43], v2, s[8:11], s68 offen nt
  s_add_u32 s68, s68, 98304
  buffer_load_dwordx4 v[44:47], v2, s[8:11], s68 offen nt
  s_add_u32 s68, s68, 98304
  buffer_load_dwordx4 v[48:51], v2, s[8:11], s68 offen nt
  s_add_u32 s68, s68, 98304
  buffer_load_dwordx4 v[52:55], v2, s[8:11], s68 offen nt
  s_add_u32 s68, s68, 98304
  buffer_load_dwordx4 v[56:59], v2, s[8:11], s68 offen nt
  s_add_u32 s68, s68, 98304
  buffer_load_dwordx4 v[60:63], v2, s[8:11], s68 offen nt
  s_load_dwordx2 s[28:29], s[58:59], 1044480
  s_branch L_q2
L_misc:
  s_setprio 3
  s_waitcnt lgkmcnt(0)
  s_barrier
  s_load_dwordx2 s[28:29], s[58:59], 1044480
  s_branch L_misc2
L_stream:
  s_add_u32 s61, s60, 196608
  s_waitcnt vmcnt(2)
  buffer_load_dwordx4 v[28:31], v1, s[8:11], s61 offen offset:0 nt
  s_load_dwordx2 s[28:29], s[58:59], 1044480
  s_mov_b32 s24, s58
  s_mov_b32 s25, s59
  s_mov_b32 s26, 4194304
  s_mov_b32 s27, 0x20000
  s_add_u32 s32, s58, 4194304
  s_addc_u32 s33, s59, 0
  s_mov_b32 s34, 4194304
  s_mov_b32 s35, 0x20000
  s_lshl3_add_u32 s71, s6, s7
  s_lshr_b32 s79, s2, 3
  s_mov_b32 s12, s40
  s_mov_b32 s13, s41
  s_mov_b32 s14, 402653184
  s_mov_b32 s15, 0x20000
  s_waitcnt vmcnt(2)
  buffer_load_dwordx4 v[32:35], v1, s[8:11], s61 offen offset:128 nt
  s_waitcnt vmcnt(2)
  buffer_load_dwordx4 v[36:39], v1, s[8:11], s61 offen offset:256 nt
  s_add_u32 s62, s61, 196608
  s_waitcnt vmcnt(2)
  buffer_load_dwordx4 v[40:43], v1, s[8:11], s62 offen offset:0 nt
  s_waitcnt vmcnt(2)
  buffer_load_dwordx4 v[44:47], v1, s[8:11], s62 offen offset:128 nt
  s_waitcnt vmcnt(2)
  buffer_load_dwordx4 v[48:51], v1, s[8:11], s62 offen offset:256 nt
  s_add_u32 s63, s62, 196608
  s_waitcnt vmcnt(2)
  buffer_load_dwordx4 v[52:55], v1, s[8:11], s63 offen offset:0 nt
  s_waitcnt vmcnt(2)
  buffer_load_dwordx4 v[56:59], v1, s[8:11], s63 offen offset:128 nt
  s_waitcnt vmcnt(2)
  buffer_load_dwordx4 v[60:63], v1, s[8:11], s63 offen offset:256 nt
  s_add_u32 s64, s63, 196608
  s_waitcnt vmcnt(2)
  buffer_load_dwordx4 v[64:67], v1, s[8:11], s64 offen offset:0 nt
  s_waitcnt vmcnt(2)
  buffer_load_dwordx4 v[68:71], v1, s[8:11], s64 offen offset:128 nt
  s_waitcnt vmcnt(2)
  buffer_load_dwordx4 v[72:75], v1, s[8:11], s64 offen offset:256 nt
  s_add_u32 s65, s64, 196608
  s_waitcnt vmcnt(2)
  buffer_load_dwordx4 v[76:79], v1, s[8:11], s65 offen offset:0 nt
  s_waitcnt vmcnt(2)
  buffer_load_dwordx4 v[80:83], v1, s[8:11], s65 offen offset:128 nt
  s_waitcnt vmcnt(2)
  buffer_load_dwordx4 v[84:87], v1, s[8:11], s65 offen offset:256 nt
  s_add_u32 s66, s65, 196608
  s_waitcnt vmcnt(2)
  buffer_load_dwordx4 v[88:91], v1, s[8:11], s66 offen offset:0 nt
  s_waitcnt vmcnt(2)
  buffer_load_dwordx4 v[92:95], v1, s[8:11], s66 offen offset:128 nt
  s_waitcnt vmcnt(2)
  buffer_load_dwordx4 v[96:99], v1, s[8:11], s66 offen offset:256 nt
  s_add_u32 s67, s66, 196608
  s_waitcnt vmcnt(2)
  buffer_load_dwordx4 v[100:103], v1, s[8:11], s67 offen offset:0 nt
  s_waitcnt vmcnt(2)
  buffer_load_dwordx4 v[104:107], v1, s[8:11], s67 offen offset:128 nt
  s_waitcnt vmcnt(2)
  buffer_load_dwordx4 v[108:111], v1, s[8:11], s67 offen offset:256 nt
  s_waitcnt vmcnt(2)
  buffer_load_dwordx4 v[112:115], v1, s[12:15], s60 offen offset:0 nt
  s_waitcnt vmcnt(2)
  buffer_load_dwordx4 v[116:119], v1, s[12:15], s60 offen offset:128 nt
  s_waitcnt vmcnt(2)
  buffer_load_dwordx4 v[120:123], v1, s[12:15], s60 offen offset:256 nt
  s_waitcnt lgkmcnt(0)
  s_mul_i32 s30, s28, 0x2c9277b5
  s_add_u32 s30, s30, 0xac564b05
  s_or_b32 s30, s30, 1
  s_mul_i32 s31, s29, 0x0019660d
  s_add_u32 s31, s31, 0x3c6ef35f
  v_and_b32 v2, 3, v0
  v_min_u32 v2, 2, v2
  v_lshlrev_b32 v2, 3, v2
  s_mov_b32 s70, 200007
L_spin_1:
  ds_read_b32 v4, v2 offset:384
  s_waitcnt lgkmcnt(0)
  v_cmp_eq_u32 vcc, 0, v4
  s_nop 0
  s_cbranch_vccz L_sdone_2
  s_sleep 1
  s_sub_u32 s70, s70, 1
  s_cbranch_scc0 L_spin_1
L_sdone_2:
  ds_read_b128 v[4:7], v3 offset:0
  ds_read_b128 v[8:11], v3 offset:128
  ds_read_b128 v[12:15], v3 offset:256
  v_mov_b32 v160, 0
  v_mov_b32 v161, 0
  v_mov_b32 v162, 0
  v_mov_b32 v163, 0
  v_mov_b32 v164, 0
  v_mov_b32 v165, 0
  v_mov_b32 v166, 0
  v_mov_b32 v167, 0
  s_waitcnt vmcnt(3) lgkmcnt(0)
  v_dot2c_f32_bf16 v160, v16, v4
  v_dot2c_f32_bf16 v161, v28, v4
  v_dot2c_f32_bf16 v162, v40, v4
  v_dot2c_f32_bf16 v163, v52, v4
  v_dot2c_f32_bf16 v160, v17, v5
  v_dot2c_f32_bf16 v161, v29, v5
  v_dot2c_f32_bf16 v162, v41, v5
  v_dot2c_f32_bf16 v163, v53, v5
  v_dot2c_f32_bf16 v160, v18, v6
  v_dot2c_f32_bf16 v161, v30, v6
  v_dot2c_f32_bf16 v162, v42, v6
  v_dot2c_f32_bf16 v163, v54, v6
  v_dot2c_f32_bf16 v160, v19, v7
  v_dot2c_f32_bf16 v161, v31, v7
  v_dot2c_f32_bf16 v162, v43, v7
  v_dot2c_f32_bf16 v163, v55, v7
  v_dot2c_f32_bf16 v160, v20, v8
  v_dot2c_f32_bf16 v161, v32, v8
  v_dot2c_f32_bf16 v162, v44, v8
  v_dot2c_f32_bf16 v163, v56, v8
  v_dot2c_f32_bf16 v160, v21, v9
  v_dot2c_f32_bf16 v161, v33, v9
  v_dot2c_f32_bf16 v162, v45, v9
  v_dot2c_f32_bf16 v163, v57, v9
  v_dot2c_f32_bf16 v160, v22, v10
  v_dot2c_f32_bf16 v161, v34, v10
  v_dot2c_f32_bf16 v162, v46, v10
  v_dot2c_f32_bf16 v163, v58, v10
  v_dot2c_f32_bf16 v160, v23, v11
  v_dot2c_f32_bf16 v161, v35, v11
  v_dot2c_f32_bf16 v162, v47, v11
  v_dot2c_f32_bf16 v163, v59, v11
  v_dot2c_f32_bf16 v160, v24, v12
  v_dot2c_f32_bf16 v161, v36, v12
  v_dot2c_f32_bf16 v162, v48, v12
  v_dot2c_f32_bf16 v163, v60, v12
  v_dot2c_f32_bf16 v160, v25, v13
  v_dot2c_f32_bf16 v161, v37, v13
  v_dot2c_f32_bf16 v162, v49, v13
  v_dot2c_f32_bf16 v163, v61, v13
  v_dot2c_f32_bf16 v160, v26, v14
  v_dot2c_f32_bf16 v161, v38, v14
  v_dot2c_f32_bf16 v162, v50, v14
  v_dot2c_f32_bf16 v163, v62, v14
  v_dot2c_f32_bf16 v160, v27, v15
  v_dot2c_f32_bf16 v161, v39, v15
  v_dot2c_f32_bf16 v162, v51, v15
  v_dot2c_f32_bf16 v163, v63, v15
  v_dot2c_f32_bf16 v164, v64, v4
  v_dot2c_f32_bf16 v165, v76, v4
  v_dot2c_f32_bf16 v166, v88, v4
  v_dot2c_f32_bf16 v167, v100, v4
  v_dot2c_f32_bf16 v164, v65, v5
  v_dot2c_f32_bf16 v165, v77, v5
  v_dot2c_f32_bf16 v166, v89, v5
  v_dot2c_f32_bf16 v167, v101, v5
  v_dot2c_f32_bf16 v164, v66, v6
  v_dot2c_f32_bf16 v165, v78, v6
  v_dot2c_f32_bf16 v166, v90, v6
  v_dot2c_f32_bf16 v167, v102, v6
  v_dot2c_f32_bf16 v164, v67, v7
  v_dot2c_f32_bf16 v165, v79, v7
  v_dot2c_f32_bf16 v166, v91, v7
  v_dot2c_f32_bf16 v167, v103, v7
  v_dot2c_f32_bf16 v164, v68, v8
  v_dot2c_f32_bf16 v165, v80, v8
  v_dot2c_f32_bf16 v166, v92, v8
  v_dot2c_f32_bf16 v167, v104, v8
  v_dot2c_f32_bf16 v164, v69, v9
  v_dot2c_f32_bf16 v165, v81, v9
  v_dot2c_f32_bf16 v166, v93, v9
  v_dot2c_f32_bf16 v167, v105, v9
  v_dot2c_f32_bf16 v164, v70, v10
  v_dot2c_f32_bf16 v165, v82, v10
  v_dot2c_f32_bf16 v166, v94, v10
  v_dot2c_f32_bf16 v167, v106, v10
  v_dot2c_f32_bf16 v164, v71, v11
  v_dot2c_f32_bf16 v165, v83, v11
  v_dot2c_f32_bf16 v166, v95, v11
  v_dot2c_f32_bf16 v167, v107, v11
  v_dot2c_f32_bf16 v164, v72, v12
  v_dot2c_f32_bf16 v165, v84, v12
  v_dot2c_f32_bf16 v166, v96, v12
  v_dot2c_f32_bf16 v167, v108, v12
  v_dot2c_f32_bf16 v164, v73, v13
  v_dot2c_f32_bf16 v165, v85, v13
  v_dot2c_f32_bf16 v166, v97, v13
  v_dot2c_f32_bf16 v167, v109, v13
  v_dot2c_f32_bf16 v164, v74, v14
  v_dot2c_f32_bf16 v165, v86, v14
  v_dot2c_f32_bf16 v166, v98, v14
  v_dot2c_f32_bf16 v167, v110, v14
  v_dot2c_f32_bf16 v164, v75, v15
  v_dot2c_f32_bf16 v165, v87, v15
  v_dot2c_f32_bf16 v166, v99, v15
  v_dot2c_f32_bf16 v167, v111, v15
  v_add_f32_dpp v160, v160, v160 quad_perm:[1,0,3,2] row_mask:0xf bank_mask:0xf
  v_add_f32_dpp v161, v161, v161 quad_perm:[1,0,3,2] row_mask:0xf bank_mask:0xf
  v_add_f32_dpp v162, v162, v162 quad_perm:[1,0,3,2] row_mask:0xf bank_mask:0xf
  v_add_f32_dpp v163, v163, v163 quad_perm:[1,0,3,2] row_mask:0xf bank_mask:0xf
  v_add_f32_dpp v164, v164, v164 quad_perm:[1,0,3,2] row_mask:0xf bank_mask:0xf
  v_add_f32_dpp v165, v165, v165 quad_perm:[1,0,3,2] row_mask:0xf bank_mask:0xf
  v_add_f32_dpp v166, v166, v166 quad_perm:[1,0,3,2] row_mask:0xf bank_mask:0xf
  v_add_f32_dpp v167, v167, v167 quad_perm:[1,0,3,2] row_mask:0xf bank_mask:0xf
  v_add_f32_dpp v160, v160, v160 quad_perm:[2,3,0,1] row_mask:0xf bank_mask:0xf
  v_add_f32_dpp v161, v161, v161 quad_perm:[2,3,0,1] row_mask:0xf bank_mask:0xf
  v_add_f32_dpp v162, v162, v162 quad_perm:[2,3,0,1] row_mask:0xf bank_mask:0xf
  v_add_f32_dpp v163, v163, v163 quad_perm:[2,3,0,1] row_mask:0xf bank_mask:0xf
  v_add_f32_dpp v164, v164, v164 quad_perm:[2,3,0,1] row_mask:0xf bank_mask:0xf
  v_add_f32_dpp v165, v165, v165 quad_perm:[2,3,0,1] row_mask:0xf bank_mask:0xf
  v_add_f32_dpp v166, v166, v166 quad_perm:[2,3,0,1] row_mask:0xf bank_mask:0xf
  v_add_f32_dpp v167, v167, v167 quad_perm:[2,3,0,1] row_mask:0xf bank_mask:0xf
  v_add_f32_dpp v160, v160, v160 row_half_mirror row_mask:0xf bank_mask:0xf
  v_add_f32_dpp v161, v161, v161 row_half_mirror row_mask:0xf bank_mask:0xf
  v_add_f32_dpp v162, v162, v162 row_half_mirror row_mask:0xf bank_mask:0xf
  v_add_f32_dpp v163, v163, v163 row_half_mirror row_mask:0xf bank_mask:0xf
  v_add_f32_dpp v164, v164, v164 row_half_mirror row_mask:0xf bank_mask:0xf
  v_add_f32_dpp v165, v165, v165 row_half_mirror row_mask:0xf bank_mask:0xf
  v_add_f32_dpp v166, v166, v166 row_half_mirror row_mask:0xf bank_mask:0xf
  v_add_f32_dpp v167, v167, v167 row_half_mirror row_mask:0xf bank_mask:0xf
  s_mov_b32 s68, 0x3d93cd3a
  v_mov_b32 v2, 0
  v_cvt_pk_bf16_f32 v160, v2, v160
  v_cvt_pk_bf16_f32 v161, v2, v161
  v_cvt_pk_bf16_f32 v162, v2, v162
  v_cvt_pk_bf16_f32 v163, v2, v163
  v_cvt_pk_bf16_f32 v164, v2, v164
  v_cvt_pk_bf16_f32 v165, v2, v165
  v_cvt_pk_bf16_f32 v166, v2, v166
  v_cvt_pk_bf16_f32 v167, v2, v167
  v_mul_f32 v160, s68, v160
  v_mul_f32 v161, s68, v161
  v_mul_f32 v162, s68, v162
  v_mul_f32 v163, s68, v163
  v_mul_f32 v164, s68, v164
  v_mul_f32 v165, s68, v165
  v_mul_f32 v166, s68, v166
  v_mul_f32 v167, s68, v167
  v_cvt_pk_bf16_f32 v160, v2, v160
  v_cvt_pk_bf16_f32 v161, v2, v161
  v_cvt_pk_bf16_f32 v162, v2, v162
  v_cvt_pk_bf16_f32 v163, v2, v163
  v_cvt_pk_bf16_f32 v164, v2, v164
  v_cvt_pk_bf16_f32 v165, v2, v165
  v_cvt_pk_bf16_f32 v166, v2, v166
  v_cvt_pk_bf16_f32 v167, v2, v167
  v_max_f32 v4, v160, v161
  v_max3_f32 v4, v4, v162, v163
  v_max3_f32 v4, v4, v164, v165
  v_max3_f32 v4, v4, v166, v167
  s_nop 1
  v_max_f32_dpp v4, v4, v4 row_ror:8 row_mask:0xf bank_mask:0xf
  v_mov_b32 v88, v4
  s_nop 1
  v_permlane16_swap_b32 v4, v88
  v_max_f32 v4, v4, v88
  v_mov_b32 v88, v4
  s_nop 1
  v_permlane32_swap_b32 v4, v88
  v_max_f32 v4, v4, v88
  s_mov_b32 s68, 0x3fb8aa3b
  v_sub_f32 v160, v160, v4
  v_sub_f32 v161, v161, v4
  v_sub_f32 v162, v162, v4
  v_sub_f32 v163, v163, v4
  v_sub_f32 v164, v164, v4
  v_sub_f32 v165, v165, v4
  v_sub_f32 v166, v166, v4
  v_sub_f32 v167, v167, v4
  v_mul_f32 v160, s68, v160
  v_mul_f32 v161, s68, v161
  v_mul_f32 v162, s68, v162
  v_mul_f32 v163, s68, v163
  v_mul_f32 v164, s68, v164
  v_mul_f32 v165, s68, v165
  v_mul_f32 v166, s68, v166
  v_mul_f32 v167, s68, v167
  v_exp_f32 v160, v160
  v_exp_f32 v161, v161
  v_exp_f32 v162, v162
  v_exp_f32 v163, v163
  v_exp_f32 v164, v164
  v_exp_f32 v165, v165
  v_exp_f32 v166, v166
  v_exp_f32 v167, v167
  v_add_f32 v5, v160, v161
  v_add_f32 v5, v5, v162
  v_add_f32 v5, v5, v163
  v_add_f32 v5, v5, v164
  v_add_f32 v5, v5, v165
  v_add_f32 v5, v5, v166
  v_add_f32 v5, v5, v167
  s_nop 1
  v_add_f32_dpp v5, v5, v5 row_ror:8 row_mask:0xf bank_mask:0xf
  v_mov_b32 v88, v5
  s_nop 1
  v_permlane16_swap_b32 v5, v88
  v_add_f32 v5, v5, v88
  v_mov_b32 v88, v5
  s_nop 1
  v_permlane32_swap_b32 v5, v88
  v_add_f32 v5, v5, v88
  s_lshl_b32 s69, s3, 4
  v_mov_b32 v88, s69
  v_mov_b32 v6, 1
  v_mov_b32 v7, 1
  ds_write_b128 v88, v[4:7] offset:512
  v_cvt_pk_bf16_f32 v160, v160, v2
  v_cvt_pk_bf16_f32 v161, v161, v2
  v_cvt_pk_bf16_f32 v162, v162, v2
  v_cvt_pk_bf16_f32 v163, v163, v2
  v_cvt_pk_bf16_f32 v164, v164, v2
  v_cvt_pk_bf16_f32 v165, v165, v2
  v_cvt_pk_bf16_f32 v166, v166, v2
  v_cvt_pk_bf16_f32 v167, v167, v2
  v_mov_b32 v88, 0
  v_mov_b32 v89, 0
  v_mov_b32 v90, 0
  v_mov_b32 v91, 0
  v_mov_b32 v92, 0
  v_mov_b32 v93, 0
  v_mov_b32 v94, 0
  v_mov_b32 v95, 0
  v_mov_b32 v96, 0
  v_mov_b32 v97, 0
  v_mov_b32 v98, 0
  v_mov_b32 v99, 0
  v_mov_b32 v100, 0
  v_mov_b32 v101, 0
  v_mov_b32 v102, 0
  v_mov_b32 v103, 0
  v_mov_b32 v104, 0
  v_mov_b32 v105, 0
  v_mov_b32 v106, 0
  v_mov_b32 v107, 0
  v_mov_b32 v108, 0
  v_mov_b32 v109, 0
  v_mov_b32 v110, 0
  v_mov_b32 v111, 0
  v_and_b32 v8, 7, v0
  v_lshlrev_b32 v8, 5, v8
  v_lshrrev_b32 v9, 4, v0
  v_lshl_add_u32 v8, v9, 3, v8
  s_mul_i32 s69, s3, 768
  v_add_u32 v8, s69, v8
  v_mov_b32 v11, 1
  v_min_u32 v3, 47, v0
  v_lshlrev_b32 v3, 3, v3
  s_waitcnt vmcnt(2)
  buffer_load_dwordx4 v[124:127], v1, s[12:15], s61 offen offset:0 nt
  s_waitcnt vmcnt(2)
  buffer_load_dwordx4 v[128:131], v1, s[12:15], s61 offen offset:128 nt
  s_waitcnt vmcnt(2)
  buffer_load_dwordx4 v[132:135], v1, s[12:15], s61 offen offset:256 nt
  v_lshlrev_b32 v10, 16, v160
  v_dot2c_f32_bf16 v88, v112, v160
  v_dot2c_f32_bf16 v89, v112, v10
  v_dot2c_f32_bf16 v90, v113, v160
  v_dot2c_f32_bf16 v91, v113, v10
  v_dot2c_f32_bf16 v92, v114, v160
  v_dot2c_f32_bf16 v93, v114, v10
  v_dot2c_f32_bf16 v94, v115, v160
  v_dot2c_f32_bf16 v95, v115, v10
  v_dot2c_f32_bf16 v96, v116, v160
  v_dot2c_f32_bf16 v97, v116, v10
  v_dot2c_f32_bf16 v98, v117, v160
  v_dot2c_f32_bf16 v99, v117, v10
  v_dot2c_f32_bf16 v100, v118, v160
  v_dot2c_f32_bf16 v101, v118, v10
  v_dot2c_f32_bf16 v102, v119, v160
  v_dot2c_f32_bf16 v103, v119, v10
  v_dot2c_f32_bf16 v104, v120, v160
  v_dot2c_f32_bf16 v105, v120, v10
  v_dot2c_f32_bf16 v106, v121, v160
  v_dot2c_f32_bf16 v107, v121, v10
  v_dot2c_f32_bf16 v108, v122, v160
  v_dot2c_f32_bf16 v109, v122, v10
  v_dot2c_f32_bf16 v110, v123, v160
  v_dot2c_f32_bf16 v111, v123, v10
  s_waitcnt vmcnt(2)
  buffer_load_dwordx4 v[136:139], v1, s[12:15], s62 offen offset:0 nt
  s_waitcnt vmcnt(2)
  buffer_load_dwordx4 v[140:143], v1, s[12:15], s62 offen offset:128 nt
  s_waitcnt vmcnt(2)
  buffer_load_dwordx4 v[144:147], v1, s[12:15], s62 offen offset:256 nt
  v_lshlrev_b32 v10, 16, v161
  v_dot2c_f32_bf16 v88, v124, v161
  v_dot2c_f32_bf16 v89, v124, v10
  v_dot2c_f32_bf16 v90, v125, v161
  v_dot2c_f32_bf16 v91, v125, v10
  v_dot2c_f32_bf16 v92, v126, v161
  v_dot2c_f32_bf16 v93, v126, v10
  v_dot2c_f32_bf16 v94, v127, v161
  v_dot2c_f32_bf16 v95, v127, v10
  v_dot2c_f32_bf16 v96, v128, v161
  v_dot2c_f32_bf16 v97, v128, v10
  v_dot2c_f32_bf16 v98, v129, v161
  v_dot2c_f32_bf16 v99, v129, v10
  v_dot2c_f32_bf16 v100, v130, v161
  v_dot2c_f32_bf16 v101, v130, v10
  v_dot2c_f32_bf16 v102, v131, v161
  v_dot2c_f32_bf16 v103, v131, v10
  v_dot2c_f32_bf16 v104, v132, v161
  v_dot2c_f32_bf16 v105, v132, v10
  v_dot2c_f32_bf16 v106, v133, v161
  v_dot2c_f32_bf16 v107, v133, v10
  v_dot2c_f32_bf16 v108, v134, v161
  v_dot2c_f32_bf16 v109, v134, v10
  v_dot2c_f32_bf16 v110, v135, v161
  v_dot2c_f32_bf16 v111, v135, v10
  s_waitcnt vmcnt(2)
  buffer_load_dwordx4 v[148:151], v1, s[12:15], s63 offen offset:0 nt
  s_waitcnt vmcnt(2)
  buffer_load_dwordx4 v[152:155], v1, s[12:15], s63 offen offset:128 nt
  s_waitcnt vmcnt(2)
  buffer_load_dwordx4 v[156:159], v1, s[12:15], s63 offen offset:256 nt
  v_lshlrev_b32 v10, 16, v162
  v_dot2c_f32_bf16 v88, v136, v162
  v_dot2c_f32_bf16 v89, v136, v10
  v_dot2c_f32_bf16 v90, v137, v162
  v_dot2c_f32_bf16 v91, v137, v10
  v_dot2c_f32_bf16 v92, v138, v162
  v_dot2c_f32_bf16 v93, v138, v10
  v_dot2c_f32_bf16 v94, v139, v162
  v_dot2c_f32_bf16 v95, v139, v10
  v_dot2c_f32_bf16 v96, v140, v162
  v_dot2c_f32_bf16 v97, v140, v10
  v_dot2c_f32_bf16 v98, v141, v162
  v_dot2c_f32_bf16 v99, v141, v10
  v_dot2c_f32_bf16 v100, v142, v162
  v_dot2c_f32_bf16 v101, v142, v10
  v_dot2c_f32_bf16 v102, v143, v162
  v_dot2c_f32_bf16 v103, v143, v10
  v_dot2c_f32_bf16 v104, v144, v162
  v_dot2c_f32_bf16 v105, v144, v10
  v_dot2c_f32_bf16 v106, v145, v162
  v_dot2c_f32_bf16 v107, v145, v10
  v_dot2c_f32_bf16 v108, v146, v162
  v_dot2c_f32_bf16 v109, v146, v10
  v_dot2c_f32_bf16 v110, v147, v162
  v_dot2c_f32_bf16 v111, v147, v10
  s_waitcnt vmcnt(2)
  buffer_load_dwordx4 v[16:19], v1, s[12:15], s64 offen offset:0 nt
  s_waitcnt vmcnt(2)
  buffer_load_dwordx4 v[20:23], v1, s[12:15], s64 offen offset:128 nt
  s_waitcnt vmcnt(2)
  buffer_load_dwordx4 v[24:27], v1, s[12:15], s64 offen offset:256 nt
  v_lshlrev_b32 v10, 16, v163
  v_dot2c_f32_bf16 v88, v148, v163
  v_dot2c_f32_bf16 v89, v148, v10
  v_dot2c_f32_bf16 v90, v149, v163
  v_dot2c_f32_bf16 v91, v149, v10
  v_dot2c_f32_bf16 v92, v150, v163
  v_dot2c_f32_bf16 v93, v150, v10
  v_dot2c_f32_bf16 v94, v151, v163
  v_dot2c_f32_bf16 v95, v151, v10
  v_dot2c_f32_bf16 v96, v152, v163
  v_dot2c_f32_bf16 v97, v152, v10
  v_dot2c_f32_bf16 v98, v153, v163
  v_dot2c_f32_bf16 v99, v153, v10
  v_dot2c_f32_bf16 v100, v154, v163
  v_dot2c_f32_bf16 v101, v154, v10
  v_dot2c_f32_bf16 v102, v155, v163
  v_dot2c_f32_bf16 v103, v155, v10
  v_dot2c_f32_bf16 v104, v156, v163
  v_dot2c_f32_bf16 v105, v156, v10
  v_dot2c_f32_bf16 v106, v157, v163
  v_dot2c_f32_bf16 v107, v157, v10
  v_dot2c_f32_bf16 v108, v158, v163
  v_dot2c_f32_bf16 v109, v158, v10
  v_dot2c_f32_bf16 v110, v159, v163
  v_dot2c_f32_bf16 v111, v159, v10
  s_waitcnt vmcnt(2)
  buffer_load_dwordx4 v[28:31], v1, s[12:15], s65 offen offset:0 nt
  s_waitcnt vmcnt(2)
  buffer_load_dwordx4 v[32:35], v1, s[12:15], s65 offen offset:128 nt
  s_waitcnt vmcnt(2)
  buffer_load_dwordx4 v[36:39], v1, s[12:15], s65 offen offset:256 nt
  v_lshlrev_b32 v10, 16, v164
  v_dot2c_f32_bf16 v88, v16, v164
  v_dot2c_f32_bf16 v89, v16, v10
  v_dot2c_f32_bf16 v90, v17, v164
  v_dot2c_f32_bf16 v91, v17, v10
  v_dot2c_f32_bf16 v92, v18, v164
  v_dot2c_f32_bf16 v93, v18, v10
  v_dot2c_f32_bf16 v94, v19, v164
  v_dot2c_f32_bf16 v95, v19, v10
  v_dot2c_f32_bf16 v96, v20, v164
  v_dot2c_f32_bf16 v97, v20, v10
  v_dot2c_f32_bf16 v98, v21, v164
  v_dot2c_f32_bf16 v99, v21, v10
  v_dot2c_f32_bf16 v100, v22, v164
  v_dot2c_f32_bf16 v101, v22, v10
  v_dot2c_f32_bf16 v102, v23, v164
  v_dot2c_f32_bf16 v103, v23, v10
  v_dot2c_f32_bf16 v104, v24, v164
  v_dot2c_f32_bf16 v105, v24, v10
  v_dot2c_f32_bf16 v106, v25, v164
  v_dot2c_f32_bf16 v107, v25, v10
  v_dot2c_f32_bf16 v108, v26, v164
  v_dot2c_f32_bf16 v109, v26, v10
  v_dot2c_f32_bf16 v110, v27, v164
  v_dot2c_f32_bf16 v111, v27, v10
  s_waitcnt vmcnt(2)
  buffer_load_dwordx4 v[40:43], v1, s[12:15], s66 offen offset:0 nt
  s_waitcnt vmcnt(2)
  buffer_load_dwordx4 v[44:47], v1, s[12:15], s66 offen offset:128 nt
  s_waitcnt vmcnt(2)
  buffer_load_dwordx4 v[48:51], v1, s[12:15], s66 offen offset:256 nt
  s_mov_b64 exec, 1
  ds_add_u32 v2, v11 offset:648
  s_mov_b64 exec, -1
  v_lshlrev_b32 v10, 16, v165
  v_dot2c_f32_bf16 v88, v28, v165
  v_dot2c_f32_bf16 v89, v28, v10
  v_dot2c_f32_bf16 v90, v29, v165
  v_dot2c_f32_bf16 v91, v29, v10
  v_dot2c_f32_bf16 v92, v30, v165
  v_dot2c_f32_bf16 v93, v30, v10
  v_dot2c_f32_bf16 v94, v31, v165
  v_dot2c_f32_bf16 v95, v31, v10
  v_dot2c_f32_bf16 v96, v32, v165
  v_dot2c_f32_bf16 v97, v32, v10
  v_dot2c_f32_bf16 v98, v33, v165
  v_dot2c_f32_bf16 v99, v33, v10
  v_dot2c_f32_bf16 v100, v34, v165
  v_dot2c_f32_bf16 v101, v34, v10
  v_dot2c_f32_bf16 v102, v35, v165
  v_dot2c_f32_bf16 v103, v35, v10
  v_dot2c_f32_bf16 v104, v36, v165
  v_dot2c_f32_bf16 v105, v36, v10
  v_dot2c_f32_bf16 v106, v37, v165
  v_dot2c_f32_bf16 v107, v37, v10
  v_dot2c_f32_bf16 v108, v38, v165
  v_dot2c_f32_bf16 v109, v38, v10
  v_dot2c_f32_bf16 v110, v39, v165
  v_dot2c_f32_bf16 v111, v39, v10
  s_waitcnt vmcnt(2)
  buffer_load_dwordx2 v[64:65], v3, s[12:15], s67 offen offset:0 nt
  buffer_load_dwordx2 v[66:67], v3, s[12:15], s67 offen offset:384 nt
  buffer_load_dwordx2 v[68:69], v3, s[12:15], s67 offen offset:768 nt
  s_waitcnt vmcnt(4)
  buffer_load_dwordx2 v[70:71], v3, s[12:15], s67 offen offset:1152 nt
  buffer_load_dwordx2 v[72:73], v3, s[12:15], s67 offen offset:1536 nt
  buffer_load_dwordx2 v[74:75], v3, s[12:15], s67 offen offset:1920 nt
  s_waitcnt vmcnt(6)
  buffer_load_dwordx2 v[76:77], v3, s[12:15], s67 offen offset:2304 nt
  buffer_load_dwordx2 v[78:79], v3, s[12:15], s67 offen offset:2688 nt
  s_mov_b64 exec, 1
  ds_add_u32 v2, v11 offset:644
  s_mov_b64 exec, -1
  v_lshlrev_b32 v10, 16, v166
  v_dot2c_f32_bf16 v88, v40, v166
  v_dot2c_f32_bf16 v89, v40, v10
  v_dot2c_f32_bf16 v90, v41, v166
  v_dot2c_f32_bf16 v91, v41, v10
  v_dot2c_f32_bf16 v92, v42, v166
  v_dot2c_f32_bf16 v93, v42, v10
  v_dot2c_f32_bf16 v94, v43, v166
  v_dot2c_f32_bf16 v95, v43, v10
  v_dot2c_f32_bf16 v96, v44, v166
  v_dot2c_f32_bf16 v97, v44, v10
  v_dot2c_f32_bf16 v98, v45, v166
  v_dot2c_f32_bf16 v99, v45, v10
  v_dot2c_f32_bf16 v100, v46, v166
  v_dot2c_f32_bf16 v101, v46, v10
  v_dot2c_f32_bf16 v102, v47, v166
  v_dot2c_f32_bf16 v103, v47, v10
  v_dot2c_f32_bf16 v104, v48, v166
  v_dot2c_f32_bf16 v105, v48, v10
  v_dot2c_f32_bf16 v106, v49, v166
  v_dot2c_f32_bf16 v107, v49, v10
  v_dot2c_f32_bf16 v108, v50, v166
  v_dot2c_f32_bf16 v109, v50, v10
  v_dot2c_f32_bf16 v110, v51, v166
  v_dot2c_f32_bf16 v111, v51, v10
  v_permlane32_swap_b32 v88, v92
  v_permlane32_swap_b32 v89, v93
  v_permlane32_swap_b32 v90, v94
  v_permlane32_swap_b32 v91, v95
  v_permlane32_swap_b32 v96, v100
  v_permlane32_swap_b32 v97, v101
  v_permlane32_swap_b32 v98, v102
  v_permlane32_swap_b32 v99, v103
  v_permlane32_swap_b32 v104, v108
  v_permlane32_swap_b32 v105, v109
  v_permlane32_swap_b32 v106, v110
  v_permlane32_swap_b32 v107, v111
  v_pk_add_f32 v[88:89], v[88:89], v[92:93]
  v_pk_add_f32 v[90:91], v[90:91], v[94:95]
  v_pk_add_f32 v[96:97], v[96:97], v[100:101]
  v_pk_add_f32 v[98:99], v[98:99], v[102:103]
  v_pk_add_f32 v[104:105], v[104:105], v[108:109]
  v_pk_add_f32 v[106:107], v[106:107], v[110:111]
  v_permlane16_swap_b32 v88, v90
  v_permlane16_swap_b32 v89, v91
  v_permlane16_swap_b32 v96, v98
  v_permlane16_swap_b32 v97, v99
  v_permlane16_swap_b32 v104, v106
  v_permlane16_swap_b32 v105, v107
  v_pk_add_f32 v[88:89], v[88:89], v[90:91]
  v_pk_add_f32 v[96:97], v[96:97], v[98:99]
  v_pk_add_f32 v[104:105], v[104:105], v[106:107]
  v_add_f32_dpp v88, v88, v88 row_ror:8 row_mask:0xf bank_mask:0xf
  v_add_f32_dpp v89, v89, v89 row_ror:8 row_mask:0xf bank_mask:0xf
  v_add_f32_dpp v96, v96, v96 row_ror:8 row_mask:0xf bank_mask:0xf
  v_add_f32_dpp v97, v97, v97 row_ror:8 row_mask:0xf bank_mask:0xf
  v_add_f32_dpp v104, v104, v104 row_ror:8 row_mask:0xf bank_mask:0xf
  v_add_f32_dpp v105, v105, v105 row_ror:8 row_mask:0xf bank_mask:0xf
  ds_write_b64 v8, v[88:89] offset:1024
  ds_write_b64 v8, v[96:97] offset:1280
  ds_write_b64 v8, v[104:105] offset:1536
  s_mul_i32 s69, s3, 768
  v_lshlrev_b32 v8, 1, v3
  v_add_u32 v8, s69, v8
  ds_read_b128 v[92:95], v8 offset:1024
  v_readlane_b32 s8, v167, 0
  v_readlane_b32 s10, v167, 8
  v_readlane_b32 s60, v167, 16
  v_readlane_b32 s62, v167, 24
  v_readlane_b32 s64, v167, 32
  v_readlane_b32 s66, v167, 40
  v_readlane_b32 s77, v167, 48
  v_readlane_b32 s20, v167, 56
  s_lshl_b32 s9, s8, 16
  s_lshl_b32 s11, s10, 16
  s_lshl_b32 s61, s60, 16
  s_lshl_b32 s63, s62, 16
  s_lshl_b32 s65, s64, 16
  s_lshl_b32 s76, s66, 16
  s_lshl_b32 s78, s77, 16
  s_lshl_b32 s21, s20, 16
  s_mov_b32 s70, 200007
L_spin_3:
  ds_read_b128 v[12:15], v2 offset:672
  ds_read_b32 v7, v2 offset:656
  s_waitcnt lgkmcnt(0)
  v_cmp_eq_u32 vcc, 0, v15
  s_nop 0
  s_cbranch_vccz L_sdone_4
  s_sleep 1
  s_sub_u32 s70, s70, 1
  s_cbranch_scc0 L_spin_3
L_sdone_4:
  v_sub_f32 v9, v4, v12
  v_mul_f32 v9, s68, v9
  v_exp_f32 v9, v9
  v_readfirstlane_b32 s46, v7
  v_mul_f32 v9, v9, v13
  v_min_u32 v12, 47, v0
  v_lshrrev_b32 v13, 1, v12
  v_and_b32 v14, 1, v12
  v_lshl_add_u32 v13, v13, 4, v14
  v_lshlrev_b32 v13, 4, v13
  v_lshlrev_b32 v12, 4, v12
  s_mul_i32 s74, s6, 6144
  s_lshl_b32 s75, s7, 5
  s_add_u32 s74, s74, s75
  s_add_u32 s74, s74, 1114112
  s_lshl_b32 s75, s4, 9
  s_lshl4_add_u32 s75, s79, s75
  s_add_u32 s75, s75, 1064960
  s_mov_b32 s22, 0xaaaaaaaa
  s_mov_b32 s23, 0xaaaaaaaa
  v_mov_b32 v14, s30
  v_mov_b32 v15, s31
  s_waitcnt vmcnt(7)
  v_dot2c_f32_bf16 v92, s8, v64
  v_dot2c_f32_bf16 v93, s9, v64
  v_dot2c_f32_bf16 v94, s8, v65
  v_dot2c_f32_bf16 v95, s9, v65
  s_waitcnt vmcnt(6)
  v_dot2c_f32_bf16 v92, s10, v66
  v_dot2c_f32_bf16 v93, s11, v66
  v_dot2c_f32_bf16 v94, s10, v67
  v_dot2c_f32_bf16 v95, s11, v67
  s_waitcnt vmcnt(5)
  v_dot2c_f32_bf16 v92, s60, v68
  v_dot2c_f32_bf16 v93, s61, v68
  v_dot2c_f32_bf16 v94, s60, v69
  v_dot2c_f32_bf16 v95, s61, v69
  s_waitcnt vmcnt(4)
  v_dot2c_f32_bf16 v92, s62, v70
  v_dot2c_f32_bf16 v93, s63, v70
  v_dot2c_f32_bf16 v94, s62, v71
  v_dot2c_f32_bf16 v95, s63, v71
  s_waitcnt vmcnt(3)
  v_dot2c_f32_bf16 v92, s64, v72
  v_dot2c_f32_bf16 v93, s65, v72
  v_dot2c_f32_bf16 v94, s64, v73
  v_dot2c_f32_bf16 v95, s65, v73
  s_waitcnt vmcnt(2)
  v_dot2c_f32_bf16 v92, s66, v74
  v_dot2c_f32_bf16 v93, s76, v74
  v_dot2c_f32_bf16 v94, s66, v75
  v_dot2c_f32_bf16 v95, s76, v75
  s_waitcnt vmcnt(1)
  v_dot2c_f32_bf16 v92, s77, v76
  v_dot2c_f32_bf16 v93, s78, v76
  v_dot2c_f32_bf16 v94, s77, v77
  v_dot2c_f32_bf16 v95, s78, v77
  s_waitcnt vmcnt(0)
  v_dot2c_f32_bf16 v92, s20, v78
  v_dot2c_f32_bf16 v93, s21, v78
  v_dot2c_f32_bf16 v94, s20, v79
  v_dot2c_f32_bf16 v95, s21, v79
  v_mul_f32 v92, v9, v92
  v_mul_f32 v93, v9, v93
  v_mul_f32 v94, v9, v94
  v_mul_f32 v95, v9, v95
  ds_write_b128 v8, v[92:95] offset:1024
  s_mov_b64 exec, 1
  ds_add_rtn_u32 v10, v2, v11 offset:640
  s_mov_b64 exec, -1
  ds_read_b128 v[16:19], v12 offset:1024
  ds_read_b128 v[20:23], v12 offset:1792
  ds_read_b128 v[24:27], v12 offset:2560
  ds_read_b128 v[28:31], v12 offset:3328
  ds_read_b128 v[32:35], v12 offset:4096
  ds_read_b128 v[36:39], v12 offset:4864
  ds_read_b128 v[40:43], v12 offset:5632
  ds_read_b128 v[44:47], v12 offset:6400
  s_waitcnt lgkmcnt(8)
  v_readfirstlane_b32 s68, v10
  s_nop 0
  s_cmp_lg_u32 s68, 7
  s_cbranch_scc1 L_nopub
  s_waitcnt lgkmcnt(6)
  v_pk_add_f32 v[16:17], v[16:17], v[20:21]
  v_pk_add_f32 v[18:19], v[18:19], v[22:23]
  s_waitcnt lgkmcnt(4)
  v_pk_add_f32 v[24:25], v[24:25], v[28:29]
  v_pk_add_f32 v[26:27], v[26:27], v[30:31]
  v_pk_add_f32 v[16:17], v[16:17], v[24:25]
  v_pk_add_f32 v[18:19], v[18:19], v[26:27]
  s_waitcnt lgkmcnt(2)
  v_pk_add_f32 v[32:33], v[32:33], v[36:37]
  v_pk_add_f32 v[34:35], v[34:35], v[38:39]
  s_waitcnt lgkmcnt(0)
  v_pk_add_f32 v[40:41], v[40:41], v[44:45]
  v_pk_add_f32 v[42:43], v[42:43], v[46:47]
  v_pk_add_f32 v[32:33], v[32:33], v[40:41]
  v_pk_add_f32 v[34:35], v[34:35], v[42:43]
  v_pk_add_f32 v[4:5], v[16:17], v[32:33]
  v_pk_add_f32 v[6:7], v[18:19], v[34:35]
  v_cvt_pk_bf16_f32 v8, v4, v5
  v_cvt_pk_bf16_f32 v9, v6, v7
  v_cndmask_b32 v4, v8, v14, s[22:23]
  v_cndmask_b32 v5, v9, v15, s[22:23]
  v_cndmask_b32 v6, v14, v8, s[22:23]
  v_cndmask_b32 v7, v15, v9, s[22:23]
  s_mov_b32 exec_lo, 0xffffffff
  s_mov_b32 exec_hi, 0xffff
  buffer_store_dwordx4 v[4:7], v13, s[32:35], s74 offen
  s_mov_b64 exec, -1
  s_cmp_lg_u32 s46, 1
  s_cbranch_scc1 L_slow_5
L_back_6:
  s_mov_b64 exec, 1
  ds_write_b32 v2, v11 offset:660
  s_mov_b64 exec, -1
L_nopub:
  s_cmp_eq_u32 s3, 7
  s_cbranch_scc1 L_end
  v_mov_b32 v1, 0
  s_mov_b32 s70, 200007
L_spin_7:
  ds_read_b64 v[4:5], v1 offset:664
  s_waitcnt lgkmcnt(0)
  v_cmp_eq_u32 vcc, 0, v5
  s_nop 0
  s_cbranch_vccz L_sdone_8
  s_sleep 1
  s_sub_u32 s70, s70, 1
  s_cbranch_scc0 L_spin_7
L_sdone_8:
  v_readfirstlane_b32 s5, v5
  v_readfirstlane_b32 s47, v4
  s_lshr_b32 s28, s5, 8
  s_and_b32 s5, s5, 0xff
  s_sub_u32 s5, s5, 1
  s_cmp_lt_u32 s5, 12
  s_cbranch_scc1 L_ffn
  s_cmp_lt_u32 s5, 20
  s_cbranch_scc1 L_end
  s_cmp_lt_u32 s3, 5
  s_cbranch_scc1 L_f1
  s_endpgm
L_q2:
  s_mov_b32 s69, 0xffff0000
  s_mov_b32 s24, s58
  s_mov_b32 s25, s59
  s_mov_b32 s26, 4194304
  s_mov_b32 s27, 0x20000
  s_add_u32 s32, s58, 4194304
  s_addc_u32 s33, s59, 0
  s_mov_b32 s34, 4194304
  s_mov_b32 s35, 0x20000
  s_lshl3_add_u32 s71, s6, s7
  s_lshr_b32 s79, s2, 3
  s_waitcnt lgkmcnt(0)
  s_mul_i32 s30, s28, 0x2c9277b5
  s_add_u32 s30, s30, 0xac564b05
  s_or_b32 s30, s30, 1
  s_mul_i32 s31, s29, 0x0019660d
  s_add_u32 s31, s31, 0x3c6ef35f
  s_mul_i32 s64, s4, 768
  s_add_u32 s64, s64, 1081344
  s_add_u32 s65, s79, s73
  s_cmp_eq_u32 s65, 0
  s_cselect_b32 s64, s64, 4194304
  v_mov_b32 v92, 0
  v_mov_b32 v93, 0
  v_mov_b32 v94, s30
  v_mov_b32 v95, s31
  s_mov_b64 exec, 1
  buffer_store_dwordx4 v[92:95], off, s[24:27], s64 sc1
  s_mov_b64 exec, -1
  s_waitcnt vmcnt(21)
  v_lshlrev_b32 v70, 16, v64
  v_and_b32 v71, s69, v64
  v_lshlrev_b32 v72, 16, v65
  v_and_b32 v73, s69, v65
  v_lshlrev_b32 v74, 16, v66
  v_and_b32 v75, s69, v66
  v_lshlrev_b32 v76, 16, v67
  v_and_b32 v77, s69, v67
  v_lshlrev_b32 v78, 16, v68
  v_and_b32 v79, s69, v68
  v_add_f32 v4, v70, v71
  v_add_f32 v5, v72, v73
  v_add_f32 v6, v74, v75
  v_add_f32 v7, v76, v77
  v_add_f32 v4, v4, v5
  v_add_f32 v6, v6, v7
  v_add_f32 v5, v78, v79
  v_add_f32 v4, v4, v6
  v_add_f32 v4, v4, v5
  s_nop 1
  v_add_f32_dpp v4, v4, v4 quad_perm:[1,0,3,2] row_mask:0xf bank_mask:0xf
  s_nop 1
  v_add_f32_dpp v4, v4, v4 quad_perm:[2,3,0,1] row_mask:0xf bank_mask:0xf
  s_nop 1
  v_add_f32_dpp v4, v4, v4 row_half_mirror row_mask:0xf bank_mask:0xf
  s_nop 1
  v_add_f32_dpp v4, v4, v4 row_mirror row_mask:0xf bank_mask:0xf
  v_mov_b32 v5, v4
  s_nop 1
  v_permlane16_swap_b32 v4, v5
  v_add_f32 v4, v4, v5
  v_mov_b32 v5, v4
  s_nop 1
  v_permlane32_swap_b32 v4, v5
  v_add_f32 v4, v4, v5
  v_mul_f32 v4, 0x3acccccd, v4
  v_sub_f32 v70, v70, v4
  v_sub_f32 v71, v71, v4
  v_sub_f32 v72, v72, v4
  v_sub_f32 v73, v73, v4
  v_sub_f32 v74, v74, v4
  v_sub_f32 v75, v75, v4
  v_sub_f32 v76, v76, v4
  v_sub_f32 v77, v77, v4
  v_sub_f32 v78, v78, v4
  v_sub_f32 v79, v79, v4
  v_mul_f32 v5, v70, v70
  v_fmac_f32 v5, v71, v71
  v_fmac_f32 v5, v72, v72
  v_fmac_f32 v5, v73, v73
  v_fmac_f32 v5, v74, v74
  v_fmac_f32 v5, v75, v75
  v_fmac_f32 v5, v76, v76
  v_fmac_f32 v5, v77, v77
  v_fmac_f32 v5, v78, v78
  v_fmac_f32 v5, v79, v79
  s_nop 1
  v_add_f32_dpp v5, v5, v5 quad_perm:[1,0,3,2] row_mask:0xf bank_mask:0xf
  s_nop 1
  v_add_f32_dpp v5, v5, v5 quad_perm:[2,3,0,1] row_mask:0xf bank_mask:0xf
  s_nop 1
  v_add_f32_dpp v5, v5, v5 row_half_mirror row_mask:0xf bank_mask:0xf
  s_nop 1
  v_add_f32_dpp v5, v5, v5 row_mirror row_mask:0xf bank_mask:0xf
  v_mov_b32 v6, v5
  s_nop 1
  v_permlane16_swap_b32 v5, v6
  v_add_f32 v5, v5, v6
  v_mov_b32 v6, v5
  s_nop 1
  v_permlane32_swap_b32 v5, v6
  v_add_f32 v5, v5, v6
  v_mul_f32 v5, 0x3acccccd, v5
  v_cvt_pk_bf16_f32 v4, v4, v4
  v_lshlrev_b32 v4, 16, v4
  v_cvt_pk_bf16_f32 v5, v5, v5
  v_lshlrev_b32 v5, 16, v5
  v_add_f32 v5, 0x3727c5ac, v5
  v_cvt_pk_bf16_f32 v5, v5, v5
  v_lshlrev_b32 v5, 16, v5
  v_sqrt_f32 v5, v5
  s_nop 0
  v_cvt_pk_bf16_f32 v5, v5, v5
  v_lshlrev_b32 v5, 16, v5
  v_rcp_f32 v5, v5
  v_mov_b32 v6, 0
  s_waitcnt vmcnt(11)
  v_lshlrev_b32 v8, 16, v8
  v_lshlrev_b32 v9, 16, v9
  v_lshlrev_b32 v10, 16, v10
  v_lshlrev_b32 v11, 16, v11
  v_lshlrev_b32 v12, 16, v12
  v_lshlrev_b32 v13, 16, v13
  v_lshlrev_b32 v14, 16, v14
  v_lshlrev_b32 v15, 16, v15
  v_lshlrev_b32 v16, 16, v16
  v_lshlrev_b32 v17, 16, v17
  v_sub_f32 v8, v8, v4
  v_sub_f32 v9, v9, v4
  v_sub_f32 v10, v10, v4
  v_sub_f32 v11, v11, v4
  v_sub_f32 v12, v12, v4
  v_sub_f32 v13, v13, v4
  v_sub_f32 v14, v14, v4
  v_sub_f32 v15, v15, v4
  v_sub_f32 v16, v16, v4
  v_sub_f32 v17, v17, v4
  v_cvt_pk_bf16_f32 v8, v6, v8
  v_cvt_pk_bf16_f32 v9, v6, v9
  v_cvt_pk_bf16_f32 v10, v6, v10
  v_cvt_pk_bf16_f32 v11, v6, v11
  v_cvt_pk_bf16_f32 v12, v6, v12
  v_cvt_pk_bf16_f32 v13, v6, v13
  v_cvt_pk_bf16_f32 v14, v6, v14
  v_cvt_pk_bf16_f32 v15, v6, v15
  v_cvt_pk_bf16_f32 v16, v6, v16
  v_cvt_pk_bf16_f32 v17, v6, v17
  v_mul_f32 v8, v8, v5
  v_mul_f32 v9, v9, v5
  v_mul_f32 v10, v10, v5
  v_mul_f32 v11, v11, v5
  v_mul_f32 v12, v12, v5
  v_mul_f32 v13, v13, v5
  v_mul_f32 v14, v14, v5
  v_mul_f32 v15, v15, v5
  v_mul_f32 v16, v16, v5
  v_mul_f32 v17, v17, v5
  v_cvt_pk_bf16_f32 v70, v6, v8
  v_cvt_pk_bf16_f32 v8, v8, v6
  v_cvt_pk_bf16_f32 v71, v6, v9
  v_cvt_pk_bf16_f32 v9, v9, v6
  v_cvt_pk_bf16_f32 v72, v6, v10
  v_cvt_pk_bf16_f32 v10, v10, v6
  v_cvt_pk_bf16_f32 v73, v6, v11
  v_cvt_pk_bf16_f32 v11, v11, v6
  v_cvt_pk_bf16_f32 v74, v6, v12
  v_cvt_pk_bf16_f32 v12, v12, v6
  v_cvt_pk_bf16_f32 v75, v6, v13
  v_cvt_pk_bf16_f32 v13, v13, v6
  v_cvt_pk_bf16_f32 v76, v6, v14
  v_cvt_pk_bf16_f32 v14, v14, v6
  v_cvt_pk_bf16_f32 v77, v6, v15
  v_cvt_pk_bf16_f32 v15, v15, v6
  v_cvt_pk_bf16_f32 v78, v6, v16
  v_cvt_pk_bf16_f32 v16, v16, v6
  v_cvt_pk_bf16_f32 v79, v6, v17
  v_cvt_pk_bf16_f32 v17, v17, v6
  v_mov_b32 v80, 0
  v_mov_b32 v81, 0
  v_mov_b32 v82, 0
  v_mov_b32 v83, 0
  v_mov_b32 v84, 0
  v_mov_b32 v85, 0
  v_mov_b32 v86, 0
  v_mov_b32 v87, 0
  v_and_b32 v90, 7, v0
  v_lshrrev_b32 v6, 5, v0
  v_lshl_add_u32 v90, v90, 1, v6
  v_lshlrev_b32 v90, 4, v90
  s_mul_i32 s60, s6, 3
  s_add_u32 s60, s60, s73
  s_lshl_b32 s60, s60, 11
  s_add_u32 s60, s60, 1114112
  s_lshl_b32 s64, s7, 8
  s_add_u32 s64, s64, s60
  s_waitcnt vmcnt(10)
  v_dot2c_f32_bf16 v80, v24, v8
  v_dot2c_f32_bf16 v81, v24, v70
  v_dot2c_f32_bf16 v82, v25, v8
  v_dot2c_f32_bf16 v83, v25, v70
  v_dot2c_f32_bf16 v84, v26, v8
  v_dot2c_f32_bf16 v85, v26, v70
  v_dot2c_f32_bf16 v86, v27, v8
  v_dot2c_f32_bf16 v87, v27, v70
  s_waitcnt vmcnt(9)
  v_dot2c_f32_bf16 v80, v28, v9
  v_dot2c_f32_bf16 v81, v28, v71
  v_dot2c_f32_bf16 v82, v29, v9
  v_dot2c_f32_bf16 v83, v29, v71
  v_dot2c_f32_bf16 v84, v30, v9
  v_dot2c_f32_bf16 v85, v30, v71
  v_dot2c_f32_bf16 v86, v31, v9
  v_dot2c_f32_bf16 v87, v31, v71
  s_waitcnt vmcnt(8)
  v_dot2c_f32_bf16 v80, v32, v10
  v_dot2c_f32_bf16 v81, v32, v72
  v_dot2c_f32_bf16 v82, v33, v10
  v_dot2c_f32_bf16 v83, v33, v72
  v_dot2c_f32_bf16 v84, v34, v10
  v_dot2c_f32_bf16 v85, v34, v72
  v_dot2c_f32_bf16 v86, v35, v10
  v_dot2c_f32_bf16 v87, v35, v72
  s_waitcnt vmcnt(7)
  v_dot2c_f32_bf16 v80, v36, v11
  v_dot2c_f32_bf16 v81, v36, v73
  v_dot2c_f32_bf16 v82, v37, v11
  v_dot2c_f32_bf16 v83, v37, v73
  v_dot2c_f32_bf16 v84, v38, v11
  v_dot2c_f32_bf16 v85, v38, v73
  v_dot2c_f32_bf16 v86, v39, v11
  v_dot2c_f32_bf16 v87, v39, v73
  s_waitcnt vmcnt(6)
  v_dot2c_f32_bf16 v80, v40, v12
  v_dot2c_f32_bf16 v81, v40, v74
  v_dot2c_f32_bf16 v82, v41, v12
  v_dot2c_f32_bf16 v83, v41, v74
  v_dot2c_f32_bf16 v84, v42, v12
  v_dot2c_f32_bf16 v85, v42, v74
  v_dot2c_f32_bf16 v86, v43, v12
  v_dot2c_f32_bf16 v87, v43, v74
  s_waitcnt vmcnt(5)
  v_dot2c_f32_bf16 v80, v44, v13
  v_dot2c_f32_bf16 v81, v44, v75
  v_dot2c_f32_bf16 v82, v45, v13
  v_dot2c_f32_bf16 v83, v45, v75
  v_dot2c_f32_bf16 v84, v46, v13
  v_dot2c_f32_bf16 v85, v46, v75
  v_dot2c_f32_bf16 v86, v47, v13
  v_dot2c_f32_bf16 v87, v47, v75
  s_waitcnt vmcnt(4)
  v_dot2c_f32_bf16 v80, v48, v14
  v_dot2c_f32_bf16 v81, v48, v76
  v_dot2c_f32_bf16 v82, v49, v14
  v_dot2c_f32_bf16 v83, v49, v76
  v_dot2c_f32_bf16 v84, v50, v14
  v_dot2c_f32_bf16 v85, v50, v76
  v_dot2c_f32_bf16 v86, v51, v14
  v_dot2c_f32_bf16 v87, v51, v76
  s_waitcnt vmcnt(3)
  v_dot2c_f32_bf16 v80, v52, v15
  v_dot2c_f32_bf16 v81, v52, v77
  v_dot2c_f32_bf16 v82, v53, v15
  v_dot2c_f32_bf16 v83, v53, v77
  v_dot2c_f32_bf16 v84, v54, v15
  v_dot2c_f32_bf16 v85, v54, v77
  v_dot2c_f32_bf16 v86, v55, v15
  v_dot2c_f32_bf16 v87, v55, v77
  s_waitcnt vmcnt(2)
  v_dot2c_f32_bf16 v80, v56, v16
  v_dot2c_f32_bf16 v81, v56, v78
  v_dot2c_f32_bf16 v82, v57, v16
  v_dot2c_f32_bf16 v83, v57, v78
  v_dot2c_f32_bf16 v84, v58, v16
  v_dot2c_f32_bf16 v85, v58, v78
  v_dot2c_f32_bf16 v86, v59, v16
  v_dot2c_f32_bf16 v87, v59, v78
  s_waitcnt vmcnt(0)
  v_dot2c_f32_bf16 v80, v60, v17
  v_dot2c_f32_bf16 v81, v60, v79
  v_dot2c_f32_bf16 v82, v61, v17
  v_dot2c_f32_bf16 v83, v61, v79
  v_dot2c_f32_bf16 v84, v62, v17
  v_dot2c_f32_bf16 v85, v62, v79
  v_dot2c_f32_bf16 v86, v63, v17
  v_dot2c_f32_bf16 v87, v63, v79
  v_permlane32_swap_b32 v80, v84
  v_permlane32_swap_b32 v81, v85
  v_permlane32_swap_b32 v82, v86
  v_permlane32_swap_b32 v83, v87
  v_add_f32 v80, v80, v84
  v_add_f32 v81, v81, v85
  v_add_f32 v82, v82, v86
  v_add_f32 v83, v83, v87
  v_mov_b32 v84, v80
  v_mov_b32 v85, v81
  v_mov_b32 v86, v82
  v_mov_b32 v87, v83
  v_permlane16_swap_b32 v80, v84
  v_permlane16_swap_b32 v81, v85
  v_permlane16_swap_b32 v82, v86
  v_permlane16_swap_b32 v83, v87
  v_add_f32 v80, v80, v84
  v_add_f32 v81, v81, v85
  v_add_f32 v82, v82, v86
  v_add_f32 v83, v83, v87
  v_add_f32_dpp v80, v80, v80 row_ror:8 row_mask:0xf bank_mask:0xf
  v_add_f32_dpp v81, v81, v81 row_ror:8 row_mask:0xf bank_mask:0xf
  v_add_f32_dpp v82, v82, v82 row_ror:8 row_mask:0xf bank_mask:0xf
  v_add_f32_dpp v83, v83, v83 row_ror:8 row_mask:0xf bank_mask:0xf
  s_mov_b32 s68, 0x07060501
  v_perm_b32 v80, v80, v83, s68
  s_mov_b32 s68, 0x07060502
  v_perm_b32 v81, v81, v83, s68
  s_mov_b32 s68, 0x07060503
  v_perm_b32 v82, v82, v83, s68
  v_mov_b32 v83, s30
  s_mov_b32 exec_lo, 0xff
  s_mov_b32 exec_hi, 0xff
  buffer_store_dwordx4 v[80:83], v90, s[32:35], s64 offen
  s_mov_b64 exec, -1
  v_lshlrev_b32 v2, 4, v0
  v_and_b32 v3, 15, v0
  v_lshl_add_u32 v3, v3, 1, v6
  v_lshlrev_b32 v3, 2, v3
  s_lshl_b32 s69, s73, 7
  v_add_u32 v3, s69, v3
  v_mov_b32 v1, 0
  s_mov_b32 s65, 0
  s_mov_b32 s61, 0x0c04000c
  s_mov_b32 s62, 0x0402010c
  s_sleep 40
  s_mov_b32 s16, s32
  s_mov_b32 s17, s33
  s_mov_b32 s18, 4194304
  s_mov_b32 s19, 0x20000
  s_mov_b32 s70, 200007
L_spin_9:
  buffer_load_dwordx4 v[8:11], v2, s[16:19], s60 offen offset:0 sc1 nt
  buffer_load_dwordx4 v[12:15], v2, s[16:19], s60 offen offset:1024 sc1 nt
  s_waitcnt vmcnt(0)
  v_cmp_ne_u32 vcc, s30, v11
  v_cmp_ne_u32 s[20:21], s30, v15
  s_nop 0
  s_or_b64 vcc, vcc, s[20:21]
  s_nop 0
  s_cbranch_vccz L_sdone_10
  s_sleep 20
  ds_read_b32 v4, v1 offset:656
  s_waitcnt lgkmcnt(0)
  v_readfirstlane_b32 s46, v4
  s_nop 0
  s_sub_u32 s68, s46, s65
  s_cmp_lg_u32 s68, 2
  s_cbranch_scc1 L_qlazy_11
  s_mov_b32 exec_lo, 0xff
  s_mov_b32 exec_hi, 0xff
  buffer_store_dwordx4 v[80:83], v90, s[24:27], s64 offen sc1
  s_mov_b64 exec, -1
  s_mov_b32 s65, 1
L_qlazy_11:
  s_and_b32 s99, s70, 7
  s_cselect_b32 s16, s32, s24
  s_cselect_b32 s17, s33, s25
  s_sub_u32 s70, s70, 1
  s_cbranch_scc0 L_spin_9
L_sdone_10:
  v_perm_b32 v11, v9, v8, s61
  v_perm_b32 v11, v10, v11, s62
  v_perm_b32 v15, v13, v12, s61
  v_perm_b32 v15, v14, v15, s62
  v_add_f32 v8, v8, v12
  v_add_f32 v9, v9, v13
  v_add_f32 v10, v10, v14
  v_add_f32 v11, v11, v15
  s_nop 0
  v_permlane32_swap_b32 v8, v10
  v_permlane32_swap_b32 v9, v11
  v_add_f32 v8, v8, v10
  v_add_f32 v9, v9, v11
  v_mov_b32 v10, v8
  v_mov_b32 v11, v9
  s_nop 0
  v_permlane16_swap_b32 v8, v10
  v_permlane16_swap_b32 v9, v11
  v_add_f32 v8, v8, v10
  v_add_f32 v9, v9, v11
  v_cvt_pk_bf16_f32 v8, v8, v9
  ds_write_b32 v3, v8 offset:0
  v_mov_b32 v1, 0
  s_mov_b32 s70, 200007
L_spin_12:
  ds_read_b32 v4, v1 offset:656
  s_waitcnt lgkmcnt(0)
  v_cmp_gt_u32 vcc, 1, v4
  s_nop 0
  s_cbranch_vccz L_sdone_13
  s_sleep 2
  s_sub_u32 s70, s70, 1
  s_cbranch_scc0 L_spin_12
L_sdone_13:
  v_readfirstlane_b32 s46, v4
  ds_read_b32 v4, v1 offset:656
  s_waitcnt lgkmcnt(0)
  v_readfirstlane_b32 s46, v4
  s_nop 0
  s_sub_u32 s68, s46, s65
  s_cmp_lg_u32 s68, 2
  s_cbranch_scc1 L_qlazy_14
  s_mov_b32 exec_lo, 0xff
  s_mov_b32 exec_hi, 0xff
  buffer_store_dwordx4 v[80:83], v90, s[24:27], s64 offen sc1
  s_mov_b64 exec, -1
  s_mov_b32 s65, 1
L_qlazy_14:
  s_lshl_b32 s69, s73, 3
  v_mov_b32 v4, s69
  v_mov_b32 v6, 1
  s_waitcnt vmcnt(0) lgkmcnt(0)
  ds_write_b32 v4, v6 offset:384
  s_cmp_lg_u32 s3, 8
  s_cbranch_scc1 L_role
  s_mul_i32 s66, s4, 768
  s_add_u32 s66, s66, 1081344
  s_mov_b32 s70, 200007
  s_load_dwordx4 s[20:23], s[58:59], s66
  s_branch L_tkw0
L_tkchk:
  s_load_dwordx4 s[20:23], s[58:59], s66 glc
L_tkw0:
  s_waitcnt lgkmcnt(0)
  s_cmp_eq_u64 s[22:23], s[30:31]
  s_cbranch_scc1 L_tkok
  s_sleep 20
  s_sub_u32 s70, s70, 1
  s_cbranch_scc0 L_tkchk
L_tkok:
  v_mov_b32 v1, 0
  s_mov_b32 s70, 200007
L_spin_15:
  ds_read_b32 v4, v1 offset:648
  s_waitcnt lgkmcnt(0)
  v_cmp_gt_u32 vcc, 8, v4
  s_nop 0
  s_cbranch_vccz L_sdone_16
  s_sleep 1
  s_sub_u32 s70, s70, 1
  s_cbranch_scc0 L_spin_15
L_sdone_16:
  s_mov_b32 s20, 1
  s_atomic_add s20, s[58:59], s66 glc
  s_mov_b32 s21, 0
  s_mov_b64 exec, 1
  s_waitcnt lgkmcnt(0)
  s_and_b32 s20, s20, 31
  s_add_u32 s20, s20, 1
  s_add_u32 s20, s20, s21
  v_mov_b32 v5, s20
  ds_write_b32 v1, v5 offset:668
  s_mov_b64 exec, -1
  s_branch L_role
L_misc2:
  s_getreg_b32 s64, hwreg(HW_REG_XCC_ID)
  s_mov_b32 s24, s58
  s_mov_b32 s25, s59
  s_mov_b32 s26, 4194304
  s_mov_b32 s27, 0x20000
  s_add_u32 s32, s58, 4194304
  s_addc_u32 s33, s59, 0
  s_mov_b32 s34, 4194304
  s_mov_b32 s35, 0x20000
  s_lshl3_add_u32 s71, s6, s7
  s_lshr_b32 s79, s2, 3
  v_and_b32 v1, 31, v0
  v_lshlrev_b32 v1, 4, v1
  v_lshrrev_b32 v2, 5, v0
  v_lshl_add_u32 v1, v2, 13, v1
  s_lshl_b32 s66, s79, 11
  s_and_b32 s68, s66, 0xffffe000
  s_add_u32 s66, s66, s68
  s_add_u32 s66, s66, 131072
  v_mov_b32 v6, 0
  v_mov_b32 v7, 0
  s_cmp_ge_u32 s79, 4
  s_cbranch_scc1 L_nopr0
  s_cmp_lg_u32 s4, 0
  s_cbranch_scc1 L_nopr0
  s_mov_b64 exec, -1
  buffer_store_dwordx4 v[4:7], v1, s[24:27], s66 offen sc1
  s_mov_b64 exec, -1
L_nopr0:
  s_waitcnt lgkmcnt(0)
  s_mul_i32 s30, s28, 0x2c9277b5
  s_add_u32 s30, s30, 0xac564b05
  s_or_b32 s30, s30, 1
  s_mul_i32 s31, s29, 0x0019660d
  s_add_u32 s31, s31, 0x3c6ef35f
  s_and_b32 s64, s64, 15
  v_mov_b32 v4, s30
  v_mov_b32 v5, s31
  v_mov_b32 v6, s64
  v_mov_b32 v7, s64
  s_lshl_b32 s68, s4, 9
  s_add_u32 s68, s68, 1056768
  s_lshl_b32 s69, s79, 4
  v_mov_b32 v1, s69
  s_mov_b64 exec, 1
  buffer_store_dwordx4 v[4:7], v1, s[32:35], s68 offen
  s_mov_b64 exec, -1
  v_and_b32 v1, 31, v0
  v_lshlrev_b32 v1, 4, v1
  s_mov_b32 s70, 12
  s_mov_b32 s46, 2
L_idpoll:
  s_sleep 16
  buffer_load_dwordx4 v[8:11], v1, s[32:35], s68 offen sc1 nt
  s_waitcnt vmcnt(0)
  v_cmp_ne_u64 vcc, s[30:31], v[8:9]
  s_nop 0
  s_cbranch_vccz L_iddone
  s_sub_u32 s70, s70, 1
  s_cbranch_scc0 L_idpoll
  s_branch L_idset
L_iddone:
  v_cmp_ne_u32 vcc, s64, v10
  s_nop 0
  s_cbranch_vccnz L_idset
  s_mov_b32 s46, 1
L_idset:
  v_mov_b32 v1, 0
  v_mov_b32 v4, s46
  ds_write_b32 v1, v4 offset:656
  s_mov_b32 s60, -1
  s_mov_b32 s61, -1
  s_lshl_b32 s67, s4, 9
  s_add_u32 s67, s67, 1069056
  s_cmp_ge_u32 s79, 4
  s_cbranch_scc1 L_nopr1
  s_waitcnt lgkmcnt(0)
  s_add_u32 s69, s66, 0
  s_memtime s[62:63]
  s_waitcnt lgkmcnt(0)
  s_load_dword s65, s[58:59], s69
  s_waitcnt lgkmcnt(0)
  s_memtime s[20:21]
  s_waitcnt lgkmcnt(0)
  s_sub_u32 s62, s20, s62
  s_min_u32 s60, s60, s62
  s_add_u32 s69, s66, 8192
  s_memtime s[62:63]
  s_waitcnt lgkmcnt(0)
  s_load_dword s65, s[58:59], s69
  s_waitcnt lgkmcnt(0)
  s_memtime s[20:21]
  s_waitcnt lgkmcnt(0)
  s_sub_u32 s62, s20, s62
  s_min_u32 s61, s61, s62
  s_add_u32 s69, s66, 128
  s_memtime s[62:63]
  s_waitcnt lgkmcnt(0)
  s_load_dword s65, s[58:59], s69
  s_waitcnt lgkmcnt(0)
  s_memtime s[20:21]
  s_waitcnt lgkmcnt(0)
  s_sub_u32 s62, s20, s62
  s_min_u32 s60, s60, s62
  s_add_u32 s69, s66, 8320
  s_memtime s[62:63]
  s_waitcnt lgkmcnt(0)
  s_load_dword s65, s[58:59], s69
  s_waitcnt lgkmcnt(0)
  s_memtime s[20:21]
  s_waitcnt lgkmcnt(0)
  s_sub_u32 s62, s20, s62
  s_min_u32 s61, s61, s62
  s_add_u32 s69, s66, 256
  s_memtime s[62:63]
  s_waitcnt lgkmcnt(0)
  s_load_dword s65, s[58:59], s69
  s_waitcnt lgkmcnt(0)
  s_memtime s[20:21]
  s_waitcnt lgkmcnt(0)
  s_sub_u32 s62, s20, s62
  s_min_u32 s60, s60, s62
  s_add_u32 s69, s66, 8448
  s_memtime s[62:63]
  s_waitcnt lgkmcnt(0)
  s_load_dword s65, s[58:59], s69
  s_waitcnt lgkmcnt(0)
  s_memtime s[20:21]
  s_waitcnt lgkmcnt(0)
  s_sub_u32 s62, s20, s62
  s_min_u32 s61, s61, s62
  s_add_u32 s69, s66, 384
  s_memtime s[62:63]
  s_waitcnt lgkmcnt(0)
  s_load_dword s65, s[58:59], s69
  s_waitcnt lgkmcnt(0)
  s_memtime s[20:21]
  s_waitcnt lgkmcnt(0)
  s_sub_u32 s62, s20, s62
  s_min_u32 s60, s60, s62
  s_add_u32 s69, s66, 8576
  s_memtime s[62:63]
  s_waitcnt lgkmcnt(0)
  s_load_dword s65, s[58:59], s69
  s_waitcnt lgkmcnt(0)
  s_memtime s[20:21]
  s_waitcnt lgkmcnt(0)
  s_sub_u32 s62, s20, s62
  s_min_u32 s61, s61, s62
  s_lshl_b32 s69, s79, 4
  v_mov_b32 v1, s69
  v_mov_b32 v4, s60
  v_mov_b32 v5, s61
  v_mov_b32 v6, s30
  v_mov_b32 v7, s31
  s_mov_b64 exec, 1
  buffer_store_dwordx4 v[4:7], v1, s[32:35], s67 offen
  s_mov_b64 exec, -1
L_nopr1:
  v_and_b32 v1, 7, v0
  v_lshlrev_b32 v1, 4, v1
  s_mov_b32 s70, 200007
L_spin_17:
  ds_read_b128 v[4:7], v1 offset:512
  s_waitcnt lgkmcnt(0)
  v_cmp_eq_u32 vcc, 0, v7
  s_nop 0
  s_cbranch_vccz L_sdone_18
  s_sleep 4
  s_sub_u32 s70, s70, 1
  s_cbranch_scc0 L_spin_17
L_sdone_18:
  s_mov_b32 s68, 0x3fb8aa3b
  v_mov_b32 v2, v4
  s_nop 1
  v_max_f32_dpp v2, v2, v2 quad_perm:[1,0,3,2] row_mask:0xf bank_mask:0xf
  s_nop 1
  v_max_f32_dpp v2, v2, v2 quad_perm:[2,3,0,1] row_mask:0xf bank_mask:0xf
  s_nop 1
  v_max_f32_dpp v2, v2, v2 row_half_mirror row_mask:0xf bank_mask:0xf
  v_sub_f32 v4, v4, v2
  v_mul_f32 v4, s68, v4
  v_exp_f32 v4, v4
  s_nop 0
  v_mul_f32 v3, v4, v5
  s_nop 1
  v_add_f32_dpp v3, v3, v3 quad_perm:[1,0,3,2] row_mask:0xf bank_mask:0xf
  s_nop 1
  v_add_f32_dpp v3, v3, v3 quad_perm:[2,3,0,1] row_mask:0xf bank_mask:0xf
  s_nop 1
  v_add_f32_dpp v3, v3, v3 row_half_mirror row_mask:0xf bank_mask:0xf
  s_lshl_b32 s68, s71, 4
  s_add_u32 s68, s68, 1052672
  v_mov_b32 v4, s30
  v_mov_b32 v5, s31
  s_mov_b32 exec_lo, 0x1
  s_mov_b32 exec_hi, 0x0
  buffer_store_dwordx4 v[2:5], v1, s[32:35], s68 offen
  s_mov_b64 exec, -1
  s_cmp_lg_u32 s46, 1
  s_cbranch_scc1 L_slow_19
L_back_20:
  s_cmp_lg_u32 s46, 1
  s_cbranch_scc1 L_noshare
  v_and_b32 v8, 7, v0
  v_lshlrev_b32 v8, 4, v8
  buffer_load_dwordx4 v[4:7], v8, s[32:35], s67 offen sc1 nt
  s_waitcnt vmcnt(0)
  v_cmp_eq_u64 vcc, s[30:31], v[6:7]
  s_nop 1
  v_cndmask_b32 v4, -1, v4, vcc
  v_cndmask_b32 v5, -1, v5, vcc
  s_nop 0
  v_min_u32_dpp v4, v4, v4 quad_perm:[1,0,3,2] row_mask:0xf bank_mask:0xf
  v_min_u32_dpp v5, v5, v5 quad_perm:[1,0,3,2] row_mask:0xf bank_mask:0xf
  s_nop 0
  v_min_u32_dpp v4, v4, v4 quad_perm:[2,3,0,1] row_mask:0xf bank_mask:0xf
  v_min_u32_dpp v5, v5, v5 quad_perm:[2,3,0,1] row_mask:0xf bank_mask:0xf
  s_nop 0
  v_min_u32_dpp v4, v4, v4 row_half_mirror row_mask:0xf bank_mask:0xf
  v_min_u32_dpp v5, v5, v5 row_half_mirror row_mask:0xf bank_mask:0xf
  s_nop 0
  v_min_u32_dpp v4, v4, v4 row_mirror row_mask:0xf bank_mask:0xf
  v_min_u32_dpp v5, v5, v5 row_mirror row_mask:0xf bank_mask:0xf
  v_mov_b32 v6, v4
  v_mov_b32 v7, v5
  s_nop 0
  v_permlane16_swap_b32 v4, v6
  v_permlane16_swap_b32 v5, v7
  v_min_u32 v4, v4, v6
  v_min_u32 v5, v5, v7
  v_readfirstlane_b32 s62, v4
  v_readfirstlane_b32 s63, v5
  s_min_u32 s60, s60, s62
  s_min_u32 s61, s61, s63
L_noshare:
  s_cmp_lt_u32 s61, s60
  s_cselect_b32 s47, 8192, 0
  v_mov_b32 v8, 0
  v_mov_b32 v4, s47
  ds_write_b32 v8, v4 offset:664
  s_lshl_b32 s74, s6, 7
  s_add_u32 s74, s74, 1052672
  s_mov_b32 s16, s32
  s_mov_b32 s17, s33
  s_mov_b32 s18, 4194304
  s_mov_b32 s19, 0x20000
  s_mov_b32 s70, 200007
L_spin_21:
  s_sleep 16
  buffer_load_dwordx4 v[4:7], v1, s[16:19], s74 offen sc1 nt
  s_waitcnt vmcnt(0)
  v_cmp_ne_u64 vcc, s[30:31], v[6:7]
  s_nop 0
  s_cbranch_vccz L_sdone_22
  s_and_b32 s99, s70, 7
  s_cmp_eq_u32 s46, 1
  s_cselect_b32 s99, 1, s99
  s_cmp_lg_u32 s99, 0
  s_cselect_b32 s16, s32, s24
  s_cselect_b32 s17, s33, s25
  s_sub_u32 s70, s70, 1
  s_cbranch_scc0 L_spin_21
L_sdone_22:
  s_mov_b32 s68, 0x3fb8aa3b
  v_mov_b32 v2, v4
  s_nop 1
  v_max_f32_dpp v2, v2, v2 quad_perm:[1,0,3,2] row_mask:0xf bank_mask:0xf
  s_nop 1
  v_max_f32_dpp v2, v2, v2 quad_perm:[2,3,0,1] row_mask:0xf bank_mask:0xf
  s_nop 1
  v_max_f32_dpp v2, v2, v2 row_half_mirror row_mask:0xf bank_mask:0xf
  v_sub_f32 v4, v4, v2
  v_mul_f32 v4, s68, v4
  v_exp_f32 v4, v4
  s_nop 0
  v_mul_f32 v3, v4, v5
  s_nop 1
  v_add_f32_dpp v3, v3, v3 quad_perm:[1,0,3,2] row_mask:0xf bank_mask:0xf
  s_nop 1
  v_add_f32_dpp v3, v3, v3 quad_perm:[2,3,0,1] row_mask:0xf bank_mask:0xf
  s_nop 1
  v_add_f32_dpp v3, v3, v3 row_half_mirror row_mask:0xf bank_mask:0xf
  v_rcp_f32 v3, v3
  v_mov_b32 v4, 1
  v_mov_b32 v5, 1
  v_mov_b32 v1, 0
  ds_write_b128 v1, v[2:5] offset:672
L_role:
  v_mov_b32 v1, 0
  s_mov_b32 s70, 200007
L_spin_23:
  ds_read_b64 v[4:5], v1 offset:664
  s_waitcnt lgkmcnt(0)
  v_cmp_eq_u32 vcc, 0, v5
  s_nop 0
  s_cbranch_vccz L_sdone_24
  s_sleep 4
  s_sub_u32 s70, s70, 1
  s_cbranch_scc0 L_spin_23
L_sdone_24:
  v_readfirstlane_b32 s5, v5
  v_readfirstlane_b32 s47, v4
  s_lshr_b32 s28, s5, 8
  s_and_b32 s5, s5, 0xff
  s_sub_u32 s5, s5, 1
  s_cmp_lt_u32 s5, 20
  s_cbranch_scc0 L_tiles
  s_mov_b32 s12, s44
  s_mov_b32 s13, s45
  s_mov_b32 s14, 7864320
  s_mov_b32 s15, 0x20000
  v_lshrrev_b32 v24, 4, v0
  v_mul_u32_u24 v24, 1056, v24
  v_bfe_u32 v25, v0, 2, 2
  v_lshl_add_u32 v24, v25, 7, v24
  v_and_b32 v25, 3, v0
  v_lshl_add_u32 v24, v25, 3, v24
  s_cmp_ge_u32 s5, 10
  s_cselect_b32 s76, 1, 0
  s_mul_i32 s77, s76, 10
  s_sub_u32 s77, s5, s77
  s_lshl1_add_u32 s78, s4, s76
  s_lshl2_add_u32 s78, s78, s73
  v_lshrrev_b32 v2, 3, v0
  v_mul_u32_u24 v26, 1280, v2
  v_and_b32 v3, 7, v0
  v_and_b32 v4, 2, v2
  v_lshlrev_b32 v4, 1, v4
  v_xor_b32 v3, v3, v4
  v_lshl_add_u32 v26, v3, 4, v26
  v_xor_b32 v56, 0, v26
  s_mul_i32 s60, s78, 122880
  s_lshl_b32 s69, s77, 7
  s_add_u32 s60, s60, s69
  s_mul_i32 s61, s73, 12672
  v_add_u32 v24, s61, v24
  v_bfe_u32 v4, v0, 3, 1
  v_lshlrev_b32 v4, 1, v4
  v_xor_b32 v5, 1, v4
  v_lshl_add_u32 v25, v5, 5, v24
  v_xor_b32 v5, 2, v4
  v_lshl_add_u32 v30, v5, 5, v24
  v_xor_b32 v5, 3, v4
  v_lshl_add_u32 v31, v5, 5, v24
  v_lshl_add_u32 v24, v4, 5, v24
  s_add_u32 s61, s61, 8704
  v_lshlrev_b32 v60, 4, v0
  s_mul_i32 s74, s78, 3072
  s_add_u32 s74, s74, 1114112
  v_lshlrev_b32 v62, 2, v0
  s_lshl_b32 s68, s73, 8
  v_add_u32 v61, s68, v62
  s_mul_i32 s75, s4, 5120
  s_lshl_b32 s69, s5, 8
  s_add_u32 s75, s75, s69
  s_and_b32 s69, s75, 0xffffe000
  s_add_u32 s75, s75, s69
  s_add_u32 s75, s75, 0
  s_xor_b32 s62, s47, 8192
  s_add_u32 s62, s62, s75
  s_add_u32 s63, s47, s75
  s_mov_b32 s66, 0xaaaaaaaa
  s_mov_b32 s67, 0xaaaaaaaa
  v_mov_b32 v50, s30
  v_mov_b32 v51, s31
  v_mov_b32 v28, 0
  v_mov_b32 v29, 1
  v_cndmask_b32 v52, 0, v50, s[66:67]
  v_cndmask_b32 v53, 0, v51, s[66:67]
  v_cndmask_b32 v54, v50, 0, s[66:67]
  v_cndmask_b32 v55, v51, 0, s[66:67]
  v_mov_b32 v1, 0
  s_mov_b32 s70, 200007
L_spin_25:
  ds_read_b32 v4, v1 offset:644
  s_waitcnt lgkmcnt(0)
  v_cmp_gt_u32 vcc, 8, v4
  s_nop 0
  s_cbranch_vccz L_sdone_26
  s_sleep 1
  s_sub_u32 s70, s70, 1
  s_cbranch_scc0 L_spin_25
L_sdone_26:
  s_mov_b32 m0, s61
  s_nop 0
  buffer_load_dwordx4 v26, s[12:15], s60 offen nt lds
  s_add_u32 s60, s60, 10240
  s_add_u32 s61, s61, 1056
  s_mov_b32 m0, s61
  s_nop 0
  buffer_load_dwordx4 v56, s[12:15], s60 offen nt lds
  s_add_u32 s60, s60, 10240
  s_add_u32 s61, s61, 1056
  s_mov_b32 m0, s61
  s_nop 0
  buffer_load_dwordx4 v26, s[12:15], s60 offen nt lds
  s_add_u32 s60, s60, 10240
  s_add_u32 s61, s61, 1056
  s_mov_b32 m0, s61
  s_nop 0
  buffer_load_dwordx4 v56, s[12:15], s60 offen nt lds
  s_add_u32 s60, s60, 10240
  s_add_u32 s61, s61, 1056
  s_mov_b32 m0, s61
  s_nop 0
  buffer_load_dwordx4 v26, s[12:15], s60 offen nt lds
  s_add_u32 s60, s60, 10240
  s_add_u32 s61, s61, 1056
  s_mov_b32 m0, s61
  s_nop 0
  buffer_load_dwordx4 v56, s[12:15], s60 offen nt lds
  s_add_u32 s60, s60, 10240
  s_add_u32 s61, s61, 1056
  s_mov_b32 m0, s61
  s_nop 0
  buffer_load_dwordx4 v26, s[12:15], s60 offen nt lds
  s_add_u32 s60, s60, 10240
  s_add_u32 s61, s61, 1056
  s_mov_b32 m0, s61
  s_nop 0
  buffer_load_dwordx4 v56, s[12:15], s60 offen nt lds
  s_add_u32 s60, s60, 10240
  s_add_u32 s61, s61, 1056
  v_mov_b32 v1, 0
  s_mov_b32 s70, 200007
L_spin_27:
  ds_read_b32 v4, v1 offset:660
  s_waitcnt lgkmcnt(0)
  v_cmp_gt_u32 vcc, 1, v4
  s_nop 0
  s_cbranch_vccz L_sdone_28
  s_sleep 1
  s_sub_u32 s70, s70, 1
  s_cbranch_scc0 L_spin_27
L_sdone_28:
  s_mov_b32 m0, s61
  s_nop 0
  buffer_load_dwordx4 v26, s[12:15], s60 offen nt lds
  s_add_u32 s60, s60, 10240
  s_add_u32 s61, s61, 1056
  s_mov_b32 m0, s61
  s_nop 0
  buffer_load_dwordx4 v56, s[12:15], s60 offen nt lds
  s_add_u32 s60, s60, 10240
  s_add_u32 s61, s61, 1056
  s_mov_b32 m0, s61
  s_nop 0
  buffer_load_dwordx4 v26, s[12:15], s60 offen nt lds
  s_add_u32 s60, s60, 10240
  s_add_u32 s61, s61, 1056
  s_mov_b32 m0, s61
  s_nop 0
  buffer_load_dwordx4 v56, s[12:15], s60 offen nt lds
L_wodone:
  s_cmp_eq_u32 s46, 1
  s_cselect_b32 s16, s32, s24
  s_cselect_b32 s17, s33, s25
  s_mov_b32 s18, 4194304
  s_mov_b32 s19, 0x20000
  s_mov_b32 s70, 200007
  s_waitcnt vmcnt(8)
  ds_read_b64_tr_b16 v[64:65], v24 offset:8704
  ds_read_b64_tr_b16 v[66:67], v24 offset:9216
  ds_read_b64_tr_b16 v[68:69], v25 offset:8704
  ds_read_b64_tr_b16 v[70:71], v25 offset:9216
  ds_read_b64_tr_b16 v[72:73], v30 offset:8704
  ds_read_b64_tr_b16 v[74:75], v30 offset:9216
  ds_read_b64_tr_b16 v[76:77], v31 offset:8704
  ds_read_b64_tr_b16 v[78:79], v31 offset:9216
  s_waitcnt vmcnt(4)
  ds_read_b64_tr_b16 v[80:81], v24 offset:12928
  ds_read_b64_tr_b16 v[82:83], v24 offset:13440
  ds_read_b64_tr_b16 v[84:85], v25 offset:12928
  ds_read_b64_tr_b16 v[86:87], v25 offset:13440
  ds_read_b64_tr_b16 v[88:89], v30 offset:12928
  ds_read_b64_tr_b16 v[90:91], v30 offset:13440
  ds_read_b64_tr_b16 v[92:93], v31 offset:12928
  ds_read_b64_tr_b16 v[94:95], v31 offset:13440
  s_waitcnt vmcnt(2)
  buffer_load_dwordx4 v[8:11], v60, s[32:35], s74 offen offset:0 sc1
  buffer_load_dwordx4 v[12:15], v60, s[32:35], s74 offen offset:1024 sc1
  buffer_load_dwordx4 v[16:19], v60, s[32:35], s74 offen offset:2048 sc1
  s_waitcnt vmcnt(3)
  ds_read_b64_tr_b16 v[96:97], v24 offset:17152
  ds_read_b64_tr_b16 v[98:99], v24 offset:17664
  ds_read_b64_tr_b16 v[100:101], v25 offset:17152
  ds_read_b64_tr_b16 v[102:103], v25 offset:17664
  ds_read_b64_tr_b16 v[104:105], v30 offset:17152
  ds_read_b64_tr_b16 v[106:107], v30 offset:17664
  ds_read_b64_tr_b16 v[108:109], v31 offset:17152
  ds_read_b64_tr_b16 v[110:111], v31 offset:17664
  s_waitcnt lgkmcnt(8)
L_opp:
  buffer_load_dwordx4 v[124:127], v60, s[16:19], s74 offen offset:0 sc1
  buffer_load_dwordx4 v[128:131], v60, s[16:19], s74 offen offset:1024 sc1
  buffer_load_dwordx4 v[132:135], v60, s[16:19], s74 offen offset:2048 sc1
  s_waitcnt vmcnt(5)
  v_xor_b32 v8, v8, v52
  v_xor_b32 v9, v9, v53
  v_xor_b32 v10, v10, v54
  v_xor_b32 v11, v11, v55
  s_nop 1
  v_mfma_f32_16x16x32_bf16 v[32:35], v[8:11], v[64:67], 0
  v_mfma_f32_16x16x32_bf16 v[36:39], v[8:11], v[68:71], 0
  v_mfma_f32_16x16x32_bf16 v[40:43], v[8:11], v[72:75], 0
  v_mfma_f32_16x16x32_bf16 v[44:47], v[8:11], v[76:79], 0
  v_or_b32 v2, v8, v9
  v_or_b32 v3, v10, v11
  s_waitcnt vmcnt(4)
  v_xor_b32 v12, v12, v52
  v_xor_b32 v13, v13, v53
  v_xor_b32 v14, v14, v54
  v_xor_b32 v15, v15, v55
  s_nop 1
  v_mfma_f32_16x16x32_bf16 v[32:35], v[12:15], v[80:83], v[32:35]
  v_mfma_f32_16x16x32_bf16 v[36:39], v[12:15], v[84:87], v[36:39]
  v_mfma_f32_16x16x32_bf16 v[40:43], v[12:15], v[88:91], v[40:43]
  v_mfma_f32_16x16x32_bf16 v[44:47], v[12:15], v[92:95], v[44:47]
  v_or3_b32 v2, v2, v12, v13
  v_or3_b32 v3, v3, v14, v15
  s_waitcnt vmcnt(3) lgkmcnt(0)
  v_xor_b32 v16, v16, v52
  v_xor_b32 v17, v17, v53
  v_xor_b32 v18, v18, v54
  v_xor_b32 v19, v19, v55
  s_nop 1
  v_mfma_f32_16x16x32_bf16 v[32:35], v[16:19], v[96:99], v[32:35]
  v_mfma_f32_16x16x32_bf16 v[36:39], v[16:19], v[100:103], v[36:39]
  v_mfma_f32_16x16x32_bf16 v[40:43], v[16:19], v[104:107], v[40:43]
  v_mfma_f32_16x16x32_bf16 v[44:47], v[16:19], v[108:111], v[44:47]
  v_or3_b32 v2, v2, v16, v17
  v_or3_b32 v3, v3, v18, v19
  v_cndmask_b32 v2, v3, v2, s[66:67]
  v_cmp_ne_u32 vcc, 0, v2
  s_nop 0
  s_cbranch_vccz L_opd
  buffer_load_dwordx4 v[8:11], v60, s[32:35], s74 offen offset:0 sc1
  buffer_load_dwordx4 v[12:15], v60, s[32:35], s74 offen offset:1024 sc1
  buffer_load_dwordx4 v[16:19], v60, s[32:35], s74 offen offset:2048 sc1
  s_waitcnt vmcnt(5)
  v_xor_b32 v124, v124, v52
  v_xor_b32 v125, v125, v53
  v_xor_b32 v126, v126, v54
  v_xor_b32 v127, v127, v55
  s_nop 1
  v_mfma_f32_16x16x32_bf16 v[32:35], v[124:127], v[64:67], 0
  v_mfma_f32_16x16x32_bf16 v[36:39], v[124:127], v[68:71], 0
  v_mfma_f32_16x16x32_bf16 v[40:43], v[124:127], v[72:75], 0
  v_mfma_f32_16x16x32_bf16 v[44:47], v[124:127], v[76:79], 0
  v_or_b32 v2, v124, v125
  v_or_b32 v3, v126, v127
  s_waitcnt vmcnt(4)
  v_xor_b32 v128, v128, v52
  v_xor_b32 v129, v129, v53
  v_xor_b32 v130, v130, v54
  v_xor_b32 v131, v131, v55
  s_nop 1
  v_mfma_f32_16x16x32_bf16 v[32:35], v[128:131], v[80:83], v[32:35]
  v_mfma_f32_16x16x32_bf16 v[36:39], v[128:131], v[84:87], v[36:39]
  v_mfma_f32_16x16x32_bf16 v[40:43], v[128:131], v[88:91], v[40:43]
  v_mfma_f32_16x16x32_bf16 v[44:47], v[128:131], v[92:95], v[44:47]
  v_or3_b32 v2, v2, v128, v129
  v_or3_b32 v3, v3, v130, v131
  s_waitcnt vmcnt(3) lgkmcnt(0)
  v_xor_b32 v132, v132, v52
  v_xor_b32 v133, v133, v53
  v_xor_b32 v134, v134, v54
  v_xor_b32 v135, v135, v55
  s_nop 1
  v_mfma_f32_16x16x32_bf16 v[32:35], v[132:135], v[96:99], v[32:35]
  v_mfma_f32_16x16x32_bf16 v[36:39], v[132:135], v[100:103], v[36:39]
  v_mfma_f32_16x16x32_bf16 v[40:43], v[132:135], v[104:107], v[40:43]
  v_mfma_f32_16x16x32_bf16 v[44:47], v[132:135], v[108:111], v[44:47]
  v_or3_b32 v2, v2, v132, v133
  v_or3_b32 v3, v3, v134, v135
  v_cndmask_b32 v2, v3, v2, s[66:67]
  v_cmp_ne_u32 vcc, 0, v2
  s_nop 0
  s_cbranch_vccz L_opd
  s_sub_u32 s70, s70, 1
  s_cbranch_scc0 L_opp
L_opd:
  v_add_f32 v4, v32, v33
  v_add_f32 v20, v34, v35
  v_add_f32 v5, v36, v37
  v_add_f32 v21, v38, v39
  v_add_f32 v6, v40, v41
  v_add_f32 v22, v42, v43
  v_add_f32 v7, v44, v45
  v_add_f32 v23, v46, v47
  v_add_f32 v4, v4, v20
  v_add_f32 v5, v5, v21
  v_add_f32 v6, v6, v22
  v_add_f32 v7, v7, v23
  s_nop 0
  v_permlane32_swap_b32 v4, v6
  v_permlane32_swap_b32 v5, v7
  v_add_f32 v4, v4, v6
  v_add_f32 v5, v5, v7
  s_nop 1
  v_permlane16_swap_b32 v4, v5
  v_add_f32 v4, v4, v5
  ds_write_b32 v61, v4 offset:7168
  s_mov_b64 exec, 1
  ds_add_rtn_u32 v27, v28, v29 offset:652
  s_mov_b64 exec, -1
  ds_read2st64_b32 v[4:5], v62 offset0:28 offset1:29
  ds_read2st64_b32 v[6:7], v62 offset0:30 offset1:31
  s_waitcnt lgkmcnt(2)
  v_readfirstlane_b32 s68, v27
  s_nop 0
  s_cmp_lg_u32 s68, 3
  s_cbranch_scc1 L_end
  s_waitcnt lgkmcnt(0)
  v_add_f32 v4, v4, v5
  v_add_f32 v6, v6, v7
  v_add_f32 v48, v4, v6
  s_nop 1
  v_mov_b32_dpp v49, v48 quad_perm:[1,0,3,2] row_mask:0xf bank_mask:0xf
  v_cvt_pk_bf16_f32 v48, v48, v49
  s_nop 1
  v_mov_b32_dpp v49, v48 quad_perm:[2,3,0,1] row_mask:0xf bank_mask:0xf
  s_mov_b32 exec_lo, 0x11111111
  s_mov_b32 exec_hi, 0x11111111
  buffer_store_dwordx4 v[48:51], v62, s[24:27], s62 offen sc1
  buffer_store_dwordx4 v[48:51], v62, s[24:27], s63 offen sc1
  s_barrier
  s_endpgm
L_tiles:
  s_mov_b32 s12, s48
  s_mov_b32 s13, s49
  s_mov_b32 s14, 1966080
  s_mov_b32 s15, 0x20000
  s_mov_b32 s16, s50
  s_mov_b32 s17, s51
  s_mov_b32 s18, 1966080
  s_mov_b32 s19, 0x20000
  s_sub_u32 s75, s5, 20
  s_lshr_b32 s78, s75, 2
  s_and_b32 s75, s75, 3
  s_mul_i32 s72, s75, 491520
  s_mul_i32 s68, s73, 24576
  s_add_u32 s72, s72, s68
  s_mul_i32 s68, s4, 3
  s_add_u32 s78, s78, s68
  s_lshl_b32 s68, s78, 7
  s_add_u32 s72, s72, s68
  s_mul_i32 s61, s73, 1056
  s_add_u32 s61, s61, 8704
  v_lshrrev_b32 v2, 3, v0
  v_and_b32 v3, 7, v0
  v_and_b32 v4, 2, v2
  v_lshlrev_b32 v4, 1, v4
  v_xor_b32 v3, v3, v4
  v_mul_u32_u24 v62, 3072, v2
  v_lshl_add_u32 v62, v3, 4, v62
  v_mov_b32 v1, 0
  s_mov_b32 s70, 200007
L_spin_29:
  ds_read_b32 v4, v1 offset:644
  s_waitcnt lgkmcnt(0)
  v_cmp_gt_u32 vcc, 8, v4
  s_nop 0
  s_cbranch_vccz L_sdone_30
  s_sleep 1
  s_sub_u32 s70, s70, 1
  s_cbranch_scc0 L_spin_29
L_sdone_30:
  s_add_u32 m0, s61, 0
  s_nop 0
  buffer_load_dwordx4 v62, s[12:15], s72 offen nt lds
  s_add_u32 m0, s61, 4224
  s_nop 0
  buffer_load_dwordx4 v62, s[16:19], s72 offen nt lds
  s_add_u32 s72, s72, 98304
  s_add_u32 m0, s61, 8448
  s_nop 0
  buffer_load_dwordx4 v62, s[12:15], s72 offen nt lds
  s_add_u32 m0, s61, 12672
  s_nop 0
  buffer_load_dwordx4 v62, s[16:19], s72 offen nt lds
  s_add_u32 s72, s72, 98304
  v_mov_b32 v1, 0
  s_mov_b32 s70, 200007
L_spin_31:
  ds_read_b32 v4, v1 offset:660
  s_waitcnt lgkmcnt(0)
  v_cmp_gt_u32 vcc, 1, v4
  s_nop 0
  s_cbranch_vccz L_sdone_32
  s_sleep 1
  s_sub_u32 s70, s70, 1
  s_cbranch_scc0 L_spin_31
L_sdone_32:
  s_add_u32 m0, s61, 16896
  s_nop 0
  buffer_load_dwordx4 v62, s[12:15], s72 offen nt lds
  s_add_u32 m0, s61, 21120
  s_nop 0
  buffer_load_dwordx4 v62, s[16:19], s72 offen nt lds
  s_add_u32 s72, s72, 98304
  s_add_u32 m0, s61, 25344
  s_nop 0
  buffer_load_dwordx4 v62, s[12:15], s72 offen nt lds
  s_add_u32 m0, s61, 29568
  s_nop 0
  buffer_load_dwordx4 v62, s[16:19], s72 offen nt lds
  s_add_u32 s72, s72, 98304
  s_add_u32 m0, s61, 33792
  s_nop 0
  buffer_load_dwordx4 v62, s[12:15], s72 offen nt lds
  s_add_u32 m0, s61, 38016
  s_nop 0
  buffer_load_dwordx4 v62, s[16:19], s72 offen nt lds
L_tdone:
  s_waitcnt vmcnt(0)
  s_barrier
  s_endpgm
L_f1:
  v_lshrrev_b32 v58, 4, v0
  v_mul_u32_u24 v58, 1056, v58
  v_bfe_u32 v5, v0, 2, 2
  v_lshl_add_u32 v58, v5, 7, v58
  v_and_b32 v5, 3, v0
  v_lshl_add_u32 v58, v5, 3, v58
  s_sub_u32 s75, s5, 20
  s_lshr_b32 s78, s75, 2
  s_and_b32 s75, s75, 3
  s_mul_i32 s74, s75, 5
  s_add_u32 s74, s74, s3
  s_mul_i32 s68, s4, 3
  s_add_u32 s78, s78, s68
  v_bfe_u32 v4, v0, 3, 1
  v_lshlrev_b32 v4, 1, v4
  v_xor_b32 v4, s3, v4
  v_lshl_add_u32 v58, v4, 5, v58
  v_lshrrev_b32 v3, 4, v0
  v_and_b32 v2, 7, v0
  v_lshl_add_u32 v50, v2, 2, v3
  v_lshlrev_b32 v50, 1, v50
  s_lshl_b32 s68, s74, 6
  v_add_u32 v61, s68, v50
  s_lshl_b32 s68, s3, 6
  v_add_u32 v51, s68, v50
  v_lshlrev_b32 v52, 4, v3
  v_lshlrev_b32 v54, 3, v0
  v_lshrrev_b32 v53, 3, v0
  v_mul_u32_u24 v53, 2560, v53
  v_lshl_add_u32 v53, v2, 4, v53
  s_lshl_b32 s68, s74, 7
  v_add_u32 v53, s68, v53
  v_add_u32 v59, 20480, v53
  s_add_u32 s60, s47, 0
  v_lshlrev_b32 v55, 4, v0
  v_mov_b32 v57, 0
  s_lshl2_add_u32 s76, s78, s3
  s_lshl2_add_u32 s76, s76, s75
  s_lshl_b32 s76, s76, 8
  s_add_u32 s76, s76, 2228224
  s_lshl3_add_u32 s68, s78, s75
  s_lshl_b32 s68, s68, 4
  s_add_u32 s68, s68, 2752512
  s_lshl2_add_u32 s69, s4, s75
  s_mul_i32 s69, s69, 640
  s_add_u32 s69, s69, 2785280
  v_add_u32 v63, s69, v55
  v_mov_b32 v4, s68
  s_mov_b32 s8, 0
  s_mov_b32 s9, 0x100
  v_cndmask_b32 v63, v63, v4, s[8:9]
  s_cmp_lt_u32 s5, 24
  s_cselect_b32 s62, -1, 0
  s_cselect_b32 s63, 0xff, 0
  s_or_b32 s63, s63, 0x100
  v_mov_b32 v14, s30
  v_mov_b32 v15, s31
  v_mov_b32 v44, 0x3f803f80
  v_mov_b32 v45, 0x3f803f80
  v_mov_b32 v46, 0x3f803f80
  v_mov_b32 v47, 0x3f803f80
  v_mov_b32 v8, 0
  v_mov_b32 v9, 0
  v_mov_b32 v10, 0
  v_mov_b32 v11, 0
  v_mov_b32 v112, 0x3f80
  v_mov_b32 v113, 0x3f800000
  v_mov_b32 v16, 0
  v_mov_b32 v20, 0
  v_and_b32 v4, 0xffffe000, v53
  v_add_u32 v53, v53, v4
  v_and_b32 v4, 0xffffe000, v59
  v_add_u32 v59, v59, v4
  global_load_ushort v56, v61, s[36:37]
  s_setprio 3
  s_barrier
  buffer_load_dwordx4 v[104:107], v53, s[24:27], s60 offen sc1
  buffer_load_dwordx4 v[108:111], v59, s[24:27], s60 offen sc1
  s_cmp_eq_u32 s3, 4
  s_cbranch_scc1 L_f1nob
  ds_read_b64_tr_b16 v[64:65], v58 offset:8704
  ds_read_b64_tr_b16 v[66:67], v58 offset:9216
  ds_read_b64_tr_b16 v[68:69], v58 offset:12928
  ds_read_b64_tr_b16 v[70:71], v58 offset:13440
  ds_read_b64_tr_b16 v[72:73], v58 offset:17152
  ds_read_b64_tr_b16 v[74:75], v58 offset:17664
  ds_read_b64_tr_b16 v[76:77], v58 offset:21376
  ds_read_b64_tr_b16 v[78:79], v58 offset:21888
  ds_read_b64_tr_b16 v[80:81], v58 offset:25600
  ds_read_b64_tr_b16 v[82:83], v58 offset:26112
  ds_read_b64_tr_b16 v[84:85], v58 offset:29824
  ds_read_b64_tr_b16 v[86:87], v58 offset:30336
  ds_read_b64_tr_b16 v[88:89], v58 offset:34048
  ds_read_b64_tr_b16 v[90:91], v58 offset:34560
  ds_read_b64_tr_b16 v[92:93], v58 offset:38272
  ds_read_b64_tr_b16 v[94:95], v58 offset:38784
  ds_read_b64_tr_b16 v[96:97], v58 offset:42496
  ds_read_b64_tr_b16 v[98:99], v58 offset:43008
  ds_read_b64_tr_b16 v[100:101], v58 offset:46720
  ds_read_b64_tr_b16 v[102:103], v58 offset:47232
  s_waitcnt lgkmcnt(0)
  v_mfma_f32_16x16x32_bf16 v[116:119], v[44:47], v[64:67], 0
  v_mfma_f32_16x16x32_bf16 v[124:127], v[44:47], v[68:71], 0
  v_mfma_f32_16x16x32_bf16 v[116:119], v[44:47], v[72:75], v[116:119]
  v_mfma_f32_16x16x32_bf16 v[124:127], v[44:47], v[76:79], v[124:127]
  v_mfma_f32_16x16x32_bf16 v[116:119], v[44:47], v[80:83], v[116:119]
  v_mfma_f32_16x16x32_bf16 v[124:127], v[44:47], v[84:87], v[124:127]
  v_mfma_f32_16x16x32_bf16 v[116:119], v[44:47], v[88:91], v[116:119]
  v_mfma_f32_16x16x32_bf16 v[124:127], v[44:47], v[92:95], v[124:127]
  v_mfma_f32_16x16x32_bf16 v[116:119], v[44:47], v[96:99], v[116:119]
  v_mfma_f32_16x16x32_bf16 v[124:127], v[44:47], v[100:103], v[124:127]
L_f1nob:
  s_waitcnt vmcnt(2)
  v_lshlrev_b32 v56, 16, v56
  s_mov_b32 s70, 200007
  s_branch L_ypw0
L_yppoll:
  buffer_load_dwordx4 v[104:107], v53, s[24:27], s60 offen sc1
  buffer_load_dwordx4 v[108:111], v59, s[24:27], s60 offen sc1
L_ypw0:
  s_waitcnt vmcnt(0)
  v_cmp_ne_u64 vcc, s[30:31], v[106:107]
  v_cmp_ne_u64 s[20:21], s[30:31], v[110:111]
  s_nop 0
  s_or_b64 vcc, vcc, s[20:21]
  s_nop 0
  s_cbranch_vccz L_ypok
  s_sub_u32 s70, s70, 1
  s_cbranch_scc0 L_yppoll
L_ypok:
  v_dot2c_f32_bf16 v8, v104, v112
  v_dot2c_f32_bf16 v10, v105, v112
  v_dot2c_f32_bf16 v9, v104, v113
  v_dot2c_f32_bf16 v11, v105, v113
  v_dot2c_f32_bf16 v8, v108, v112
  v_dot2c_f32_bf16 v10, v109, v112
  v_dot2c_f32_bf16 v9, v108, v113
  v_dot2c_f32_bf16 v11, v109, v113
  s_nop 0
  v_permlane32_swap_b32 v8, v10
  s_nop 0
  v_permlane32_swap_b32 v9, v11
  v_add_f32 v8, v8, v10
  v_add_f32 v9, v9, v11
  s_nop 1
  v_permlane16_swap_b32 v8, v9
  v_add_f32 v8, v8, v9
  s_nop 1
  v_add_f32_dpp v8, v8, v8 row_ror:8 row_mask:0xf bank_mask:0xf
  v_cvt_pk_bf16_f32 v8, v57, v8
  v_add_f32 v8, v8, v56
  v_cvt_pk_bf16_f32 v8, v8, v8
  ds_write_b16 v51, v8 offset:8192
  s_cmp_eq_u32 s3, 4
  s_waitcnt lgkmcnt(0)
  s_barrier
  s_cbranch_scc1 L_f1st
  ds_read_b128 v[24:27], v52 offset:8192
  ds_read_b128 v[28:31], v52 offset:8256
  ds_read_b128 v[32:35], v52 offset:8320
  ds_read_b128 v[36:39], v52 offset:8384
  ds_read_b128 v[40:43], v52 offset:8448
  s_waitcnt lgkmcnt(4)
  v_mfma_f32_16x16x32_bf16 v[16:19], v[24:27], v[64:67], 0
  v_mfma_f32_16x16x32_bf16 v[20:23], v[24:27], v[68:71], 0
  s_waitcnt lgkmcnt(3)
  v_mfma_f32_16x16x32_bf16 v[16:19], v[28:31], v[72:75], v[16:19]
  v_mfma_f32_16x16x32_bf16 v[20:23], v[28:31], v[76:79], v[20:23]
  s_waitcnt lgkmcnt(2)
  v_mfma_f32_16x16x32_bf16 v[16:19], v[32:35], v[80:83], v[16:19]
  v_mfma_f32_16x16x32_bf16 v[20:23], v[32:35], v[84:87], v[20:23]
  s_waitcnt lgkmcnt(1)
  v_mfma_f32_16x16x32_bf16 v[16:19], v[36:39], v[88:91], v[16:19]
  v_mfma_f32_16x16x32_bf16 v[20:23], v[36:39], v[92:95], v[20:23]
  s_waitcnt lgkmcnt(0)
  v_mfma_f32_16x16x32_bf16 v[16:19], v[40:43], v[96:99], v[16:19]
  v_mfma_f32_16x16x32_bf16 v[20:23], v[40:43], v[100:103], v[20:23]
  s_nop 6
  v_cvt_pk_bf16_f32 v12, v16, v116
  v_cvt_pk_bf16_f32 v13, v20, v124
  s_mov_b32 exec_lo, 0xffff
  s_mov_b32 exec_hi, 0x0
  buffer_store_dwordx4 v[12:15], v55, s[32:35], s76 offen
  s_mov_b64 exec, -1
  s_cmp_lg_u32 s46, 1
  s_cbranch_scc1 L_slow_33
L_back_34:
  s_endpgm
L_f1st:
  s_mov_b32 exec_hi, 0xff
  ds_read_b64 v[12:13], v54 offset:8192
  s_waitcnt lgkmcnt(0)
  v_dot2c_f32_bf16 v16, v12, v44
  v_dot2c_f32_bf16 v20, v12, v12
  v_dot2c_f32_bf16 v16, v13, v44
  v_dot2c_f32_bf16 v20, v13, v13
  s_mov_b32 exec_hi, -1
  s_nop 1
  v_permlane32_swap_b32 v16, v20
  v_add_f32 v16, v16, v20
  s_nop 1
  v_add_f32_dpp v16, v16, v16 quad_perm:[1,0,3,2] row_mask:0xf bank_mask:0xf
  s_nop 1
  v_add_f32_dpp v16, v16, v16 quad_perm:[2,3,0,1] row_mask:0xf bank_mask:0xf
  s_nop 1
  v_add_f32_dpp v16, v16, v16 row_half_mirror row_mask:0xf bank_mask:0xf
  s_nop 1
  v_add_f32_dpp v16, v16, v16 row_mirror row_mask:0xf bank_mask:0xf
  v_mov_b32 v20, v16
  s_nop 1
  v_permlane16_swap_b32 v16, v20
  v_add_f32 v16, v16, v20
  v_mov_b32 v20, v16
  s_nop 1
  v_permlane32_swap_b32 v16, v20
  s_waitcnt lgkmcnt(0)
  v_cndmask_b32 v12, v12, v16, s[8:9]
  v_cndmask_b32 v13, v13, v20, s[8:9]
  s_mov_b64 exec, s[62:63]
  buffer_store_dwordx4 v[12:15], v63, s[32:35], 0 offen
  s_mov_b64 exec, -1
  s_cmp_lg_u32 s46, 1
  s_cbranch_scc1 L_slow_35
L_back_36:
  s_endpgm
L_ffn:
  v_mov_b32 v57, 0
  s_mul_i32 s72, s4, 12
  s_add_u32 s72, s72, s5
  s_cmp_lt_u32 s3, 5
  s_cbranch_scc1 L_f2
  s_cmp_eq_u32 s3, 5
  s_cbranch_scc1 L_hid
  s_cmp_ge_u32 s5, 10
  s_cbranch_scc1 L_end
  s_mul_i32 s72, s4, 10
  s_add_u32 s72, s72, s5
  v_lshrrev_b32 v2, 1, v0
  v_mul_u32_u24 v2, 2560, v2
  v_and_b32 v3, 1, v0
  v_lshl_add_u32 v96, v3, 4, v2
  s_lshl_b32 s68, s72, 5
  v_add_u32 v96, s68, v96
  v_add_u32 v100, 81920, v96
  v_add_u32 v101, 163840, v96
  s_add_u32 s10, s47, 524288
  v_lshrrev_b32 v4, 4, v0
  v_lshl_add_u32 v97, v3, 2, v4
  v_lshlrev_b32 v97, 1, v97
  v_lshlrev_b32 v99, 4, v3
  v_and_b32 v98, 16, v0
  s_mul_i32 s13, s4, 2560
  s_lshl_b32 s68, s72, 5
  s_add_u32 s13, s13, s68
  s_add_u32 s13, s13, 2785280
  s_lshl_b32 s14, s72, 4
  s_mov_b32 s69, 0xffff0000
  v_and_b32 v4, 0xffffe000, v96
  v_add_u32 v96, v96, v4
  v_and_b32 v4, 0xffffe000, v100
  v_add_u32 v100, v100, v4
  v_and_b32 v4, 0xffffe000, v101
  v_add_u32 v101, v101, v4
  s_mov_b32 s64, s54
  s_mov_b32 s65, s55
  s_mov_b32 s66, 1280
  s_mov_b32 s67, 0x20000
  v_cmp_lt_u32 s[62:63], 31, v0
  s_setprio 3
  s_barrier
  buffer_load_dwordx4 v[12:15], v99, s[32:35], s13 offen nt
  v_mov_b32 v8, 0
  v_mov_b32 v9, 0
  v_mov_b32 v10, 0
  v_mov_b32 v11, 0
  v_mov_b32 v112, 0x3f80
  v_mov_b32 v113, 0x3f800000
  s_barrier
  s_mov_b32 s16, s32
  s_mov_b32 s17, s33
  s_mov_b32 s18, 4194304
  s_mov_b32 s19, 0x20000
  s_mov_b32 s70, 200007
L_spin_37:
  buffer_load_dwordx4 v[4:7], v99, s[16:19], s13 offen sc1
  buffer_load_dwordx4 v[16:19], v96, s[24:27], s10 offen sc1
  buffer_load_dwordx4 v[20:23], v100, s[24:27], s10 offen sc1
  buffer_load_dwordx4 v[24:27], v101, s[24:27], s10 offen sc1
  s_waitcnt vmcnt(0)
  v_cmp_ne_u64 vcc, s[30:31], v[6:7]
  v_cmp_ne_u64 s[20:21], s[30:31], v[18:19]
  v_cmp_ne_u64 s[22:23], s[30:31], v[22:23]
  s_or_b64 vcc, vcc, s[20:21]
  v_cmp_ne_u64 s[20:21], s[30:31], v[26:27]
  s_or_b64 vcc, vcc, s[22:23]
  s_or_b64 vcc, vcc, s[20:21]
  s_nop 0
  s_cbranch_vccz L_sdone_38
  s_and_b32 s99, s70, 7
  s_cmp_eq_u32 s46, 1
  s_cselect_b32 s99, 1, s99
  s_cmp_lg_u32 s99, 0
  s_cselect_b32 s16, s32, s24
  s_cselect_b32 s17, s33, s25
  s_sub_u32 s70, s70, 1
  s_cbranch_scc0 L_spin_37
L_sdone_38:
  v_dot2c_f32_bf16 v8, v16, v112
  v_dot2c_f32_bf16 v10, v17, v112
  v_dot2c_f32_bf16 v9, v16, v113
  v_dot2c_f32_bf16 v11, v17, v113
  v_dot2c_f32_bf16 v8, v20, v112
  v_dot2c_f32_bf16 v10, v21, v112
  v_dot2c_f32_bf16 v9, v20, v113
  v_dot2c_f32_bf16 v11, v21, v113
  v_dot2c_f32_bf16 v8, v24, v112
  v_dot2c_f32_bf16 v10, v25, v112
  v_dot2c_f32_bf16 v9, v24, v113
  v_dot2c_f32_bf16 v11, v25, v113
  v_cndmask_b32 v58, v4, v5, s[62:63]
  v_lshrrev_b32 v58, v98, v58
  v_permlane32_swap_b32 v8, v10
  v_permlane32_swap_b32 v9, v11
  v_add_f32 v8, v8, v10
  v_add_f32 v9, v9, v11
  v_lshlrev_b32 v58, 16, v58
  s_nop 0
  v_permlane16_swap_b32 v8, v9
  v_add_f32 v8, v8, v9
  s_nop 1
  v_add_f32_dpp v8, v8, v8 row_ror:8 row_mask:0xf bank_mask:0xf
  s_nop 1
  v_add_f32_dpp v8, v8, v8 row_ror:4 row_mask:0xf bank_mask:0xf
  s_nop 1
  v_add_f32_dpp v8, v8, v8 quad_perm:[2,3,0,1] row_mask:0xf bank_mask:0xf
  v_cvt_pk_bf16_f32 v8, v57, v8
  v_add_f32 v8, v8, v58
  v_cvt_pk_bf16_f32 v8, v8, v8
  s_mov_b32 exec_lo, 0x30003
  s_mov_b32 exec_hi, 0x30003
  buffer_store_short v8, v97, s[64:67], s14 offen
  s_cmp_lg_u32 s72, 0
  s_cbranch_scc1 L_fin_exit
  s_mov_b64 exec, 1
  v_mov_b32 v4, s30
  v_mov_b32 v5, s31
  s_mov_b32 s68, 1044480
  buffer_store_dwordx2 v[4:5], v57, s[24:27], s68 offen
L_fin_exit:
  s_endpgm
L_hid:
  s_endpgm
L_f2:
  s_mov_b32 s8, s52
  s_mov_b32 s9, s53
  s_mov_b32 s10, 1966080
  s_mov_b32 s11, 0x20000
  s_lshl_b32 s68, s3, 8
  v_lshlrev_b32 v58, 2, v0
  v_add_u32 v58, s68, v58
  v_lshlrev_b32 v116, 1, v58
  s_mul_i32 s68, s72, 2560
  v_add_u32 v116, s68, v116
  s_xor_b32 s78, s47, 8192
  s_add_u32 s78, s78, 524288
  s_add_u32 s77, s47, 524288
  s_mov_b32 s60, 0x05040100
  s_mov_b32 s61, 0x07060302
  s_mul_i32 s62, s72, 20480
  v_mov_b32 v40, 0
  v_mov_b32 v41, 0
  v_mov_b32 v46, s30
  v_mov_b32 v47, s31
  v_and_b32 v4, 0xffffe000, v116
  v_add_u32 v116, v116, v4
  v_lshlrev_b32 v60, 4, v0
  v_and_b32 v61, 48, v60
  s_lshr_b32 s68, s72, 2
  s_lshl_b32 s65, s68, 7
  s_add_u32 s65, s65, 2752512
  s_lshl_b32 s64, s72, 10
  s_add_u32 s64, s64, 2228224
  v_mov_b32 v8, 0
  v_mov_b32 v9, 0
  s_cmp_eq_u32 s46, 1
  s_cselect_b32 s16, s32, s24
  s_cselect_b32 s17, s33, s25
  s_mov_b32 s18, 4194304
  s_mov_b32 s19, 0x20000
  s_mov_b32 s70, 200007
  s_setprio 3
  s_barrier
  buffer_load_dword v64, v58, s[8:11], s62 offen offset:0 nt
  buffer_load_dword v65, v58, s[8:11], s62 offen offset:1280 nt
  buffer_load_dword v66, v58, s[8:11], s62 offen offset:2560 nt
  s_add_u32 s62, s62, 3840
  buffer_load_dword v67, v58, s[8:11], s62 offen offset:0 nt
  buffer_load_dword v68, v58, s[8:11], s62 offen offset:1280 nt
  buffer_load_dword v69, v58, s[8:11], s62 offen offset:2560 nt
  s_add_u32 s62, s62, 3840
  buffer_load_dword v70, v58, s[8:11], s62 offen offset:0 nt
  buffer_load_dword v71, v58, s[8:11], s62 offen offset:1280 nt
  buffer_load_dword v72, v58, s[8:11], s62 offen offset:2560 nt
  s_add_u32 s62, s62, 3840
  buffer_load_dword v73, v58, s[8:11], s62 offen offset:0 nt
  buffer_load_dword v74, v58, s[8:11], s62 offen offset:1280 nt
  buffer_load_dword v75, v58, s[8:11], s62 offen offset:2560 nt
  s_add_u32 s62, s62, 3840
  buffer_load_dword v76, v58, s[8:11], s62 offen offset:0 nt
  buffer_load_dword v77, v58, s[8:11], s62 offen offset:1280 nt
  buffer_load_dword v78, v58, s[8:11], s62 offen offset:2560 nt
  s_add_u32 s62, s62, 3840
  buffer_load_dword v79, v58, s[8:11], s62 offen offset:0 nt
  buffer_load_dwordx4 v[20:23], v61, s[32:35], s65 offen sc1 nt
  buffer_load_dwordx4 v[16:19], v60, s[32:35], s64 offen sc1 nt
  s_waitcnt vmcnt(2)
  v_perm_b32 v80, v65, v64, s60
  v_perm_b32 v88, v65, v64, s61
  v_perm_b32 v81, v67, v66, s60
  v_perm_b32 v89, v67, v66, s61
  v_perm_b32 v82, v69, v68, s60
  v_perm_b32 v90, v69, v68, s61
  v_perm_b32 v83, v71, v70, s60
  v_perm_b32 v91, v71, v70, s61
  v_perm_b32 v84, v73, v72, s60
  v_perm_b32 v92, v73, v72, s61
  v_perm_b32 v85, v75, v74, s60
  v_perm_b32 v93, v75, v74, s61
  v_perm_b32 v86, v77, v76, s60
  v_perm_b32 v94, v77, v76, s61
  v_perm_b32 v87, v79, v78, s60
  v_perm_b32 v95, v79, v78, s61
L_pap:
  buffer_load_dwordx4 v[28:31], v61, s[16:19], s65 offen sc1
  buffer_load_dwordx4 v[24:27], v60, s[16:19], s64 offen sc1
  s_waitcnt vmcnt(2)
  v_cmp_ne_u64 vcc, s[30:31], v[18:19]
  v_cmp_ne_u64 s[20:21], s[30:31], v[22:23]
  s_nop 0
  s_or_b64 vcc, vcc, s[20:21]
  s_nop 0
  s_cbranch_vccz L_pad0
  buffer_load_dwordx4 v[20:23], v61, s[32:35], s65 offen sc1
  buffer_load_dwordx4 v[16:19], v60, s[32:35], s64 offen sc1
  s_waitcnt vmcnt(2)
  v_cmp_ne_u64 vcc, s[30:31], v[26:27]
  v_cmp_ne_u64 s[20:21], s[30:31], v[30:31]
  s_nop 0
  s_or_b64 vcc, vcc, s[20:21]
  s_nop 0
  s_cbranch_vccz L_pad1
  s_sub_u32 s70, s70, 1
  s_cbranch_scc0 L_pap
L_pad1:
  v_add_f32_dpp v4, v28, v28 quad_perm:[1,0,3,2] row_mask:0xf bank_mask:0xf
  v_add_f32_dpp v5, v29, v29 quad_perm:[1,0,3,2] row_mask:0xf bank_mask:0xf
  s_nop 0
  v_add_f32_dpp v4, v4, v4 quad_perm:[2,3,0,1] row_mask:0xf bank_mask:0xf
  v_add_f32_dpp v5, v5, v5 quad_perm:[2,3,0,1] row_mask:0xf bank_mask:0xf
  v_mul_f32 v6, 0xbacccccd, v4
  v_mul_f32 v5, 0x3acccccd, v5
  v_cvt_pk_bf16_f32 v4, 1.0, v6
  v_fma_f32 v5, -v6, v6, v5
  v_dot2c_f32_bf16 v8, v24, v4
  v_dot2c_f32_bf16 v9, v25, v4
  s_branch L_paj
L_pad0:
  v_add_f32_dpp v4, v20, v20 quad_perm:[1,0,3,2] row_mask:0xf bank_mask:0xf
  v_add_f32_dpp v5, v21, v21 quad_perm:[1,0,3,2] row_mask:0xf bank_mask:0xf
  s_nop 0
  v_add_f32_dpp v4, v4, v4 quad_perm:[2,3,0,1] row_mask:0xf bank_mask:0xf
  v_add_f32_dpp v5, v5, v5 quad_perm:[2,3,0,1] row_mask:0xf bank_mask:0xf
  v_mul_f32 v6, 0xbacccccd, v4
  v_mul_f32 v5, 0x3acccccd, v5
  v_cvt_pk_bf16_f32 v4, 1.0, v6
  v_fma_f32 v5, -v6, v6, v5
  v_dot2c_f32_bf16 v8, v16, v4
  v_dot2c_f32_bf16 v9, v17, v4
L_paj:
  v_max_f32 v5, 0, v5
  v_cvt_pk_bf16_f32 v5, v57, v5
  v_add_f32 v5, 0x3727c5ac, v5
  v_permlane32_swap_b32 v8, v9
  v_cvt_pk_bf16_f32 v5, v57, v5
  v_add_f32 v8, v8, v9
  v_sqrt_f32 v5, v5
  v_mov_b32 v10, v8
  v_cvt_pk_bf16_f32 v5, v57, v5
  v_rcp_f32 v5, v5
  v_permlane16_swap_b32 v8, v10
  v_add_f32 v8, v8, v10
  v_mul_f32 v8, v8, v5
  v_cvt_pk_bf16_f32 v8, v57, v8
  v_mul_f32 v12, 0xbfb8aa3b, v8
  v_mov_b32 v9, v8
  v_exp_f32 v12, v12
  s_nop 0
  v_permlane32_swap_b32 v8, v9
  v_add_f32 v12, 1.0, v12
  v_rcp_f32 v12, v12
  s_nop 0
  v_mul_f32 v8, v8, v12
  v_cvt_pk_bf16_f32 v8, v57, v8
  v_mul_f32 v8, v8, v9
  s_nop 1
  v_mov_b32_dpp v9, v8 quad_perm:[1,0,3,2] row_mask:0xf bank_mask:0xf
  v_cvt_pk_bf16_f32 v8, v8, v9
  s_nop 0
  v_readlane_b32 s8, v8, 0
  v_readlane_b32 s9, v8, 2
  v_readlane_b32 s10, v8, 4
  v_readlane_b32 s11, v8, 6
  v_readlane_b32 s12, v8, 8
  v_readlane_b32 s13, v8, 10
  v_readlane_b32 s14, v8, 12
  v_readlane_b32 s15, v8, 14
  v_dot2c_f32_bf16 v40, s8, v80
  v_dot2c_f32_bf16 v41, s8, v88
  v_dot2c_f32_bf16 v40, s9, v81
  v_dot2c_f32_bf16 v41, s9, v89
  v_dot2c_f32_bf16 v40, s10, v82
  v_dot2c_f32_bf16 v41, s10, v90
  v_dot2c_f32_bf16 v40, s11, v83
  v_dot2c_f32_bf16 v41, s11, v91
  v_dot2c_f32_bf16 v40, s12, v84
  v_dot2c_f32_bf16 v41, s12, v92
  v_dot2c_f32_bf16 v40, s13, v85
  v_dot2c_f32_bf16 v41, s13, v93
  v_dot2c_f32_bf16 v40, s14, v86
  v_dot2c_f32_bf16 v41, s14, v94
  v_dot2c_f32_bf16 v40, s15, v87
  v_dot2c_f32_bf16 v41, s15, v95
  s_nop 2
  v_cvt_pk_bf16_f32 v44, v40, v41
  s_nop 1
  v_mov_b32_dpp v45, v44 quad_perm:[1,0,3,2] row_mask:0xf bank_mask:0xf
  s_mov_b32 exec_lo, 0x55555555
  s_mov_b32 exec_hi, 0x55555555
  buffer_store_dwordx4 v[44:47], v116, s[24:27], s78 offen sc1
  buffer_store_dwordx4 v[44:47], v116, s[24:27], s77 offen sc1
L_end:
  s_endpgm
L_slow_5:
  s_mov_b32 exec_lo, 0xffffffff
  s_mov_b32 exec_hi, 0xffff
  buffer_store_dwordx4 v[4:7], v13, s[24:27], s74 offen sc1
  s_mov_b64 exec, -1
  s_nop 1
  s_branch L_back_6
L_slow_19:
  s_mov_b32 exec_lo, 0x1
  s_mov_b32 exec_hi, 0x0
  buffer_store_dwordx4 v[2:5], v1, s[24:27], s68 offen sc1
  s_mov_b64 exec, -1
  s_nop 1
  s_branch L_back_20
L_slow_33:
  s_mov_b32 exec_lo, 0xffff
  s_mov_b32 exec_hi, 0x0
  buffer_store_dwordx4 v[12:15], v55, s[24:27], s76 offen sc1
  s_mov_b64 exec, -1
  s_nop 1
  s_branch L_back_34
L_slow_35:
  s_mov_b64 exec, s[62:63]
  buffer_store_dwordx4 v[12:15], v63, s[24:27], 0 offen sc1
  s_mov_b64 exec, -1
  s_nop 1
  s_branch L_back_36
L_codeend:
.section .rodata,"a"
.p2align 6
.amdhsa_kernel sequential_preLN__sliding_block_cached__glu_gated_swiglu__decode_kernel
  .amdhsa_next_free_vgpr 168
  .amdhsa_next_free_sgpr 100
  .amdhsa_accum_offset 168
  .amdhsa_group_segment_fixed_size 0
  .amdhsa_kernarg_size 96
  .amdhsa_user_sgpr_count 2
  .amdhsa_user_sgpr_kernarg_segment_ptr 1
  .amdhsa_system_sgpr_workgroup_id_x 1
.end_amdhsa_kernel
```
